```python
import torch

def _softmax(x, axis=-1):
    return torch.softmax(x, dim=axis)
def _gelu(x):
    return torch.nn.functional.gelu(x, approximate="tanh")
def _silu(x):
    return torch.nn.functional.silu(x)
def _sigmoid(x):
    return torch.sigmoid(x)
def _layernorm(x, axis=-1, eps=1e-5):
    m = x.mean(dim=axis, keepdim=True)
    v = x.var(dim=axis, keepdim=True, unbiased=False)
    return (x - m) / torch.sqrt(v + eps)
def _scatter_add(tgt, idx, src, axis=0):
    return tgt.clone().index_add_(axis, idx, src)
def _segment_sum(src, seg, n):
    out = torch.zeros((n,) + src.shape[1:], dtype=src.dtype)
    return out.index_add_(0, seg, src)
def _pad(x, pw):
    flat = tuple(v for pair in reversed(pw) for v in pair)
    return torch.nn.functional.pad(x, flat)

kernel_name = 'parallel_sum__spectral_gfnet__dense_activation_gelu__prompt'

def setup_inputs():

    _w = (lambda a: (lambda t: t.to(torch.bfloat16) if t.is_floating_point() else t)(torch.as_tensor(a)))
    def _A_setup():
        B, S, D = 1, 2048, 576
        Df = D // 2 + 1
        return {
            "x": _w((lambda *s: torch.randn(*s, dtype=torch.bfloat16) * 0.05)(B, S, D)),
            "w_r": _w((lambda *s: torch.randn(*s, dtype=torch.bfloat16) * 0.8)(S, Df) * 0.02),
            "w_i": _w((lambda *s: torch.randn(*s, dtype=torch.bfloat16) * 0.8)(S, Df) * 0.02),
        }
    _A_in = _A_setup()

    def _B_setup():
        B, S, D, F = 1, 2048, 576, 4608
        return {
            "x": _w((lambda *s: torch.randn(*s, dtype=torch.bfloat16) * 0.05)(B, S, D)),
            "w1": _w((lambda *s: torch.randn(*s, dtype=torch.bfloat16) * 0.4)(D, F) * (D ** -0.5)),
            "b1": _w((lambda *s: torch.randn(*s, dtype=torch.bfloat16) * 12.8)(F) * 0.01),
            "w2": _w((lambda *s: torch.randn(*s, dtype=torch.bfloat16) * 0.2)(F, D) * (F ** -0.5)),
            "b2": _w((lambda *s: torch.randn(*s, dtype=torch.bfloat16) * 1.6)(D) * 0.01),
        }
    _B_in = _B_setup()

    return {
        "A_x": _A_in["x"],
        "A_w_r": _A_in["w_r"],
        "A_w_i": _A_in["w_i"],
        "B_x": _B_in["x"],
        "B_w1": _B_in["w1"],
        "B_b1": _B_in["b1"],
        "B_w2": _B_in["w2"],
        "B_b2": _B_in["b2"],
    }

def reference(A_x, A_w_r, A_w_i, B_x, B_w1, B_b1, B_w2, B_b2):
    def _A_ref(x, w_r, w_i):
        B, S, D = x.shape
        X = (lambda x, axes=(-2,-1): torch.fft.rfft2(x.float(), dim=axes))(x, axes=(-2, -1))
        W = w_r + 1j * w_i
        X = X * W
        y = (lambda x, s, axes=(-2,-1): torch.fft.irfft2(x, s=s, dim=axes).to(torch.bfloat16))(X, (S, D), axes=(-2, -1))
        return y

    def _B_ref(x, w1, b1, w2, b2):
        h = torch.einsum("bsd,df->bsf", x, w1) + b1
        h = _gelu(h)
        return torch.einsum("bsf,fd->bsd", h, w2) + b2

    x = A_x
    xn = _layernorm(x, axis=-1)
    return x + _A_ref(xn, A_w_r, A_w_i) + _B_ref(xn, B_w1, B_b1, B_w2, B_b2)
```

```asm
; @launch kernel=mega_kernel grid=(256,1,1) block=(512,1,1) lds=163840
.amdgcn_target "amdgcn-amd-amdhsa--gfx950"
.text
.globl mega_kernel
.p2align 8
.type mega_kernel,@function
mega_kernel:
  s_cmp_ge_u32 s2, 256
  s_cbranch_scc1 L_k1_end
  s_load_dwordx4 s[20:23], s[0:1], 0
  s_load_dwordx2 s[24:25], s[0:1], 16
  s_load_dwordx4 s[36:39], s[0:1], 32
  s_load_dwordx2 s[56:57], s[0:1], 48
  s_load_dwordx4 s[52:55], s[0:1], 72
  s_bfe_u32 s16, s2, 0x30003
  s_and_b32 s28, s2, 4
  s_lshl_b32 s28, s28, 1
  s_add_u32 s16, s16, s28
  s_and_b32 s17, s2, 3
  s_lshl_b32 s17, s17, 2
  s_lshr_b32 s28, s2, 6
  s_add_u32 s17, s17, s28
  v_lshrrev_b32 v1, 6, v0
  s_nop 0
  v_readfirstlane_b32 s18, v1
  v_and_b32 v1, 63, v0
  s_and_b32 s19, s18, 3
  s_lshr_b32 s26, s18, 2
  s_and_b32 s27, s17, 1
  s_lshl_b32 s28, s16, 7
  s_lshl_b32 s29, s19, 5
  s_add_u32 s33, s28, s29
  v_and_b32 v11, 31, v1
  v_lshrrev_b32 v14, 5, v1
  v_lshlrev_b32 v3, 4, v1
  v_mov_b32 v15, 0x7ff00000
  s_lshl_b32 s34, s16, 3
  s_add_u32 s34, s34, s18
  s_mul_i32 s34, s34, 18432
  s_mul_i32 s3, s18, 18432
  v_lshrrev_b32 v4, 3, v1
  v_lshrrev_b32 v5, 1, v4
  v_and_b32 v6, 7, v1
  v_xor_b32 v5, v5, v6
  v_mul_u32_u24 v4, 1152, v4
  v_lshl_add_u32 v8, v5, 4, v4
  v_xor_b32 v9, 64, v8
  s_waitcnt lgkmcnt(0)
  s_mov_b32 s40, s20
  s_and_b32 s41, s21, 0xffff
  s_mov_b32 s42, 0x240000
  s_mov_b32 s43, 0x00020000
  s_and_b32 s31, s17, 3
  s_lshl_b32 s31, s31, 1
  s_mov_b32 s8, s36
  s_and_b32 s9, s37, 0xffff
  s_mov_b32 s10, 0x510000
  s_mov_b32 s11, 0x00020000
  s_mul_i32 s35, s17, 576
  s_add_u32 s31, s31, 1
  s_cmp_eq_u32 s31, 9
  s_cselect_b32 s31, 0, s31
  s_lshl_b32 s32, s31, 10
  s_add_u32 s32, s32, s3
  s_lshl_b32 s94, s31, 7
  s_add_u32 s94, s94, s34
  s_add_u32 m0, s32, 0
  s_add_u32 s30, s94, 0
  buffer_load_dwordx4 v8, s[40:43], s30 offen lds
  s_add_u32 m0, s32, 9216
  s_add_u32 s30, s94, 9216
  buffer_load_dwordx4 v9, s[40:43], s30 offen lds
  s_add_u32 s31, s31, 1
  s_cmp_eq_u32 s31, 9
  s_cselect_b32 s31, 0, s31
  s_lshl_b32 s32, s31, 10
  s_add_u32 s32, s32, s3
  s_lshl_b32 s94, s31, 7
  s_add_u32 s94, s94, s34
  s_add_u32 m0, s32, 0
  s_add_u32 s30, s94, 0
  buffer_load_dwordx4 v8, s[40:43], s30 offen lds
  s_add_u32 m0, s32, 9216
  s_add_u32 s30, s94, 9216
  buffer_load_dwordx4 v9, s[40:43], s30 offen lds
  s_add_u32 s31, s31, 1
  s_cmp_eq_u32 s31, 9
  s_cselect_b32 s31, 0, s31
  s_lshl_b32 s32, s31, 10
  s_add_u32 s32, s32, s3
  s_lshl_b32 s94, s31, 7
  s_add_u32 s94, s94, s34
  s_add_u32 m0, s32, 0
  s_add_u32 s30, s94, 0
  buffer_load_dwordx4 v8, s[40:43], s30 offen lds
  s_add_u32 m0, s32, 9216
  s_add_u32 s30, s94, 9216
  buffer_load_dwordx4 v9, s[40:43], s30 offen lds
  s_lshr_b32 s28, s18, 1
  s_cmp_eq_u32 s28, 1
  s_cbranch_scc0 L_nocs_1
  v_subrev_u32 v4, 128, v0
  v_mul_u32_u24 v12, 1821, v4
  v_lshrrev_b32 v12, 16, v12
  v_mul_u32_u24 v13, 36, v12
  v_sub_u32 v13, v4, v13
  v_mul_u32_u24 v176, 1152, v12
  v_lshl_add_u32 v176, v13, 5, v176
  v_add_u32 v176, 147968, v176
  s_mov_b32 s29, 110592
  v_mul_lo_u32 v12, v12, s29
  v_lshl_add_u32 v12, v13, 4, v12
  v_cmp_gt_u32 vcc, 108, v4
  s_mul_i32 s28, s16, 331776
  s_add_u32 s28, s28, s35
  v_cndmask_b32 v12, v15, v12, vcc
  buffer_load_dwordx4 v[128:131], v12, s[8:11], s28 offen
  s_add_u32 s28, s28, 9216
  buffer_load_dwordx4 v[132:135], v12, s[8:11], s28 offen
  s_add_u32 s28, s28, 9216
  buffer_load_dwordx4 v[136:139], v12, s[8:11], s28 offen
  s_add_u32 s28, s28, 9216
  buffer_load_dwordx4 v[140:143], v12, s[8:11], s28 offen
  s_add_u32 s28, s28, 9216
  buffer_load_dwordx4 v[144:147], v12, s[8:11], s28 offen
  s_add_u32 s28, s28, 9216
  buffer_load_dwordx4 v[148:151], v12, s[8:11], s28 offen
  s_add_u32 s28, s28, 9216
  buffer_load_dwordx4 v[152:155], v12, s[8:11], s28 offen
  s_add_u32 s28, s28, 9216
  buffer_load_dwordx4 v[156:159], v12, s[8:11], s28 offen
  s_add_u32 s28, s28, 9216
  buffer_load_dwordx4 v[160:163], v12, s[8:11], s28 offen
  s_add_u32 s28, s28, 9216
  buffer_load_dwordx4 v[164:167], v12, s[8:11], s28 offen
  s_add_u32 s28, s28, 9216
  buffer_load_dwordx4 v[168:171], v12, s[8:11], s28 offen
  s_add_u32 s28, s28, 9216
  buffer_load_dwordx4 v[172:175], v12, s[8:11], s28 offen
L_nocs_1:
  s_mov_b32 s4, s54
  s_and_b32 s5, s55, 0xffff
  s_mov_b32 s6, 0x443c000
  s_mov_b32 s7, 0x00020000
  s_mov_b32 s12, s38
  s_and_b32 s13, s39, 0xffff
  s_mov_b32 s14, 0x2400
  s_mov_b32 s15, 0x00020000
  s_mov_b32 s44, s22
  s_and_b32 s45, s23, 0xffff
  s_mov_b32 s46, 0x121000
  s_mov_b32 s47, 0x00020000
  s_mov_b32 s48, s24
  s_and_b32 s49, s25, 0xffff
  s_mov_b32 s50, 0x121000
  s_mov_b32 s51, 0x00020000
  s_mov_b32 s58, s52
  s_mov_b32 s59, s53
  s_mov_b32 s52, s56
  s_and_b32 s53, s57, 0xffff
  s_mov_b32 s54, 0x510000
  s_mov_b32 s55, 0x00020000
  s_mov_b32 s20, s58
  s_and_b32 s21, s59, 0xffff
  s_mov_b32 s22, 0x100
  s_mov_b32 s23, 0x00020000
  s_or_b32 s28, s2, s18
  s_cmp_eq_u32 s28, 0
  s_cbranch_scc0 L_nonce_2
  s_memrealtime s[28:29]
  s_waitcnt lgkmcnt(0)
  s_lshl_b32 s28, s28, 3
  s_or_b32 s28, s28, 8
  v_mov_b32 v16, s28
  v_mov_b32 v17, 0
  s_mov_b64 exec, 1
  buffer_store_dword v16, v17, s[20:23], 0 offen sc1
  s_mov_b64 exec, -1
L_nonce_2:
  s_lshl_b32 s101, s2, 4
  s_add_u32 s101, s101, 0x33e4000
  v_bfe_u32 v13, v1, 2, 3
  v_and_b32 v12, 3, v1
  v_lshlrev_b32 v12, 4, v12
  v_lshl_add_u32 v12, v14, 6, v12
  v_mul_u32_u24 v2, 9216, v13
  v_add_u32 v2, v2, v12
  v_cmp_eq_u32 s[24:25], 1, v14
  s_cmp_eq_u32 s26, 1
  s_cbranch_scc1 L_k1_g1
  s_mul_i32 s36, s17, 36
  s_add_u32 s36, s36, 0
  v_add_u32 v72, s36, v11
  v_lshrrev_b32 v73, 1, v72
  v_and_b32 v74, 1, v72
  v_mul_u32_u24 v74, 144, v74
  v_cmp_eq_u32 vcc, 1, v72
  v_mov_b32 v75, 288
  s_nop 0
  v_cndmask_b32 v73, v73, v75, vcc
  v_cndmask_b32 v74, v74, 0, vcc
  s_mul_i32 s37, s19, 144
  v_lshlrev_b32 v75, 3, v14
  v_add_u32 v75, s37, v75
  v_mad_u32_u24 v75, v75, v73, v74
  v_cvt_f32_u32 v76, v75
  v_mul_f32 v76, 0x3ae38e39, v76
  v_cvt_u32_f32 v76, v76
  v_mul_u32_u24 v76, 576, v76
  v_sub_u32 v75, v75, v76
  v_mul_u32_u24 v77, 15, v73
  v_cvt_f32_u32 v76, v77
  v_mul_f32 v76, 0x3ae38e39, v76
  v_cvt_u32_f32 v76, v76
  v_mul_u32_u24 v76, 576, v76
  v_sub_u32 v77, v77, v76
  v_cvt_f32_u32 v78, v73
  v_mul_f32 v78, 0x3ae38e39, v78
  v_cos_f32 v78, v78
  v_mov_b32 v79, 0
  v_add_f32 v78, v78, v78
  v_mov_b32 v74, 0x3f803f80
  v_cvt_f32_u32 v80, v75
  v_add_u32 v75, v75, v73
  v_mul_f32 v80, 0x3ae38e39, v80
  v_subrev_u32 v76, 576, v75
  v_cos_f32 v80, v80
  v_min_u32 v75, v75, v76
  v_cvt_f32_u32 v81, v75
  v_add_u32 v75, v75, v77
  v_mul_f32 v81, 0x3ae38e39, v81
  v_subrev_u32 v76, 576, v75
  v_cos_f32 v81, v81
  v_min_u32 v75, v75, v76
  v_fma_f32 v82, v78, v81, -v80
  v_fma_f32 v83, v78, v82, -v81
  v_cvt_pk_bf16_f32 v16, v80, v81
  v_fma_f32 v84, v78, v83, -v82
  v_fma_f32 v85, v78, v84, -v83
  v_cvt_pk_bf16_f32 v17, v82, v83
  v_fma_f32 v86, v78, v85, -v84
  v_fma_f32 v87, v78, v86, -v85
  v_cvt_pk_bf16_f32 v18, v84, v85
  v_cvt_pk_bf16_f32 v19, v86, v87
  v_dot2c_f32_bf16 v79, v16, v74
  v_dot2c_f32_bf16 v79, v17, v74
  v_dot2c_f32_bf16 v79, v18, v74
  v_dot2c_f32_bf16 v79, v19, v74
  s_add_u32 s31, s31, 1
  s_cmp_eq_u32 s31, 9
  s_cselect_b32 s31, 0, s31
  s_lshl_b32 s32, s31, 10
  s_add_u32 s32, s32, s3
  s_lshl_b32 s94, s31, 7
  s_add_u32 s94, s94, s34
  s_add_u32 m0, s32, 0
  s_add_u32 s30, s94, 0
  buffer_load_dwordx4 v8, s[40:43], s30 offen lds
  v_cvt_f32_u32 v80, v75
  v_add_u32 v75, v75, v73
  v_mul_f32 v80, 0x3ae38e39, v80
  v_subrev_u32 v76, 576, v75
  v_cos_f32 v80, v80
  v_min_u32 v75, v75, v76
  v_cvt_f32_u32 v81, v75
  v_add_u32 v75, v75, v77
  v_mul_f32 v81, 0x3ae38e39, v81
  v_subrev_u32 v76, 576, v75
  v_cos_f32 v81, v81
  v_min_u32 v75, v75, v76
  v_fma_f32 v82, v78, v81, -v80
  v_fma_f32 v83, v78, v82, -v81
  v_cvt_pk_bf16_f32 v20, v80, v81
  v_fma_f32 v84, v78, v83, -v82
  v_fma_f32 v85, v78, v84, -v83
  v_cvt_pk_bf16_f32 v21, v82, v83
  v_fma_f32 v86, v78, v85, -v84
  v_fma_f32 v87, v78, v86, -v85
  v_cvt_pk_bf16_f32 v22, v84, v85
  v_cvt_pk_bf16_f32 v23, v86, v87
  v_dot2c_f32_bf16 v79, v20, v74
  v_dot2c_f32_bf16 v79, v21, v74
  v_dot2c_f32_bf16 v79, v22, v74
  v_dot2c_f32_bf16 v79, v23, v74
  s_add_u32 m0, s32, 9216
  s_add_u32 s30, s94, 9216
  buffer_load_dwordx4 v9, s[40:43], s30 offen lds
  v_cvt_f32_u32 v80, v75
  v_add_u32 v75, v75, v73
  v_mul_f32 v80, 0x3ae38e39, v80
  v_subrev_u32 v76, 576, v75
  v_cos_f32 v80, v80
  v_min_u32 v75, v75, v76
  v_cvt_f32_u32 v81, v75
  v_add_u32 v75, v75, v77
  v_mul_f32 v81, 0x3ae38e39, v81
  v_subrev_u32 v76, 576, v75
  v_cos_f32 v81, v81
  v_min_u32 v75, v75, v76
  v_fma_f32 v82, v78, v81, -v80
  v_fma_f32 v83, v78, v82, -v81
  v_cvt_pk_bf16_f32 v24, v80, v81
  v_fma_f32 v84, v78, v83, -v82
  v_fma_f32 v85, v78, v84, -v83
  v_cvt_pk_bf16_f32 v25, v82, v83
  v_fma_f32 v86, v78, v85, -v84
  v_fma_f32 v87, v78, v86, -v85
  v_cvt_pk_bf16_f32 v26, v84, v85
  v_cvt_pk_bf16_f32 v27, v86, v87
  v_dot2c_f32_bf16 v79, v24, v74
  v_dot2c_f32_bf16 v79, v25, v74
  v_dot2c_f32_bf16 v79, v26, v74
  v_dot2c_f32_bf16 v79, v27, v74
  s_add_u32 s31, s31, 1
  s_cmp_eq_u32 s31, 9
  s_cselect_b32 s31, 0, s31
  s_lshl_b32 s32, s31, 10
  s_add_u32 s32, s32, s3
  s_lshl_b32 s94, s31, 7
  s_add_u32 s94, s94, s34
  s_add_u32 m0, s32, 0
  s_add_u32 s30, s94, 0
  buffer_load_dwordx4 v8, s[40:43], s30 offen lds
  s_add_u32 m0, s32, 9216
  s_add_u32 s30, s94, 9216
  buffer_load_dwordx4 v9, s[40:43], s30 offen lds
  v_cvt_f32_u32 v80, v75
  v_add_u32 v75, v75, v73
  v_mul_f32 v80, 0x3ae38e39, v80
  v_subrev_u32 v76, 576, v75
  v_cos_f32 v80, v80
  v_min_u32 v75, v75, v76
  v_cvt_f32_u32 v81, v75
  v_add_u32 v75, v75, v77
  v_mul_f32 v81, 0x3ae38e39, v81
  v_subrev_u32 v76, 576, v75
  v_cos_f32 v81, v81
  v_min_u32 v75, v75, v76
  v_fma_f32 v82, v78, v81, -v80
  v_fma_f32 v83, v78, v82, -v81
  v_cvt_pk_bf16_f32 v28, v80, v81
  v_fma_f32 v84, v78, v83, -v82
  v_fma_f32 v85, v78, v84, -v83
  v_cvt_pk_bf16_f32 v29, v82, v83
  v_fma_f32 v86, v78, v85, -v84
  v_fma_f32 v87, v78, v86, -v85
  v_cvt_pk_bf16_f32 v30, v84, v85
  v_cvt_pk_bf16_f32 v31, v86, v87
  v_dot2c_f32_bf16 v79, v28, v74
  v_dot2c_f32_bf16 v79, v29, v74
  v_dot2c_f32_bf16 v79, v30, v74
  v_dot2c_f32_bf16 v79, v31, v74
  s_add_u32 s31, s31, 1
  s_cmp_eq_u32 s31, 9
  s_cselect_b32 s31, 0, s31
  s_lshl_b32 s32, s31, 10
  s_add_u32 s32, s32, s3
  s_lshl_b32 s94, s31, 7
  s_add_u32 s94, s94, s34
  s_add_u32 m0, s32, 0
  s_add_u32 s30, s94, 0
  buffer_load_dwordx4 v8, s[40:43], s30 offen lds
  v_cvt_f32_u32 v80, v75
  v_add_u32 v75, v75, v73
  v_mul_f32 v80, 0x3ae38e39, v80
  v_subrev_u32 v76, 576, v75
  v_cos_f32 v80, v80
  v_min_u32 v75, v75, v76
  v_cvt_f32_u32 v81, v75
  v_add_u32 v75, v75, v77
  v_mul_f32 v81, 0x3ae38e39, v81
  v_subrev_u32 v76, 576, v75
  v_cos_f32 v81, v81
  v_min_u32 v75, v75, v76
  v_fma_f32 v82, v78, v81, -v80
  v_fma_f32 v83, v78, v82, -v81
  v_cvt_pk_bf16_f32 v32, v80, v81
  v_fma_f32 v84, v78, v83, -v82
  v_fma_f32 v85, v78, v84, -v83
  v_cvt_pk_bf16_f32 v33, v82, v83
  v_fma_f32 v86, v78, v85, -v84
  v_fma_f32 v87, v78, v86, -v85
  v_cvt_pk_bf16_f32 v34, v84, v85
  v_cvt_pk_bf16_f32 v35, v86, v87
  v_dot2c_f32_bf16 v79, v32, v74
  v_dot2c_f32_bf16 v79, v33, v74
  v_dot2c_f32_bf16 v79, v34, v74
  v_dot2c_f32_bf16 v79, v35, v74
  s_add_u32 m0, s32, 9216
  s_add_u32 s30, s94, 9216
  buffer_load_dwordx4 v9, s[40:43], s30 offen lds
  v_cvt_f32_u32 v80, v75
  v_add_u32 v75, v75, v73
  v_mul_f32 v80, 0x3ae38e39, v80
  v_subrev_u32 v76, 576, v75
  v_cos_f32 v80, v80
  v_min_u32 v75, v75, v76
  v_cvt_f32_u32 v81, v75
  v_add_u32 v75, v75, v77
  v_mul_f32 v81, 0x3ae38e39, v81
  v_subrev_u32 v76, 576, v75
  v_cos_f32 v81, v81
  v_min_u32 v75, v75, v76
  v_fma_f32 v82, v78, v81, -v80
  v_fma_f32 v83, v78, v82, -v81
  v_cvt_pk_bf16_f32 v36, v80, v81
  v_fma_f32 v84, v78, v83, -v82
  v_fma_f32 v85, v78, v84, -v83
  v_cvt_pk_bf16_f32 v37, v82, v83
  v_fma_f32 v86, v78, v85, -v84
  v_fma_f32 v87, v78, v86, -v85
  v_cvt_pk_bf16_f32 v38, v84, v85
  v_cvt_pk_bf16_f32 v39, v86, v87
  v_dot2c_f32_bf16 v79, v36, v74
  v_dot2c_f32_bf16 v79, v37, v74
  v_dot2c_f32_bf16 v79, v38, v74
  v_dot2c_f32_bf16 v79, v39, v74
  s_add_u32 s31, s31, 1
  s_cmp_eq_u32 s31, 9
  s_cselect_b32 s31, 0, s31
  s_lshl_b32 s32, s31, 10
  s_add_u32 s32, s32, s3
  s_lshl_b32 s94, s31, 7
  s_add_u32 s94, s94, s34
  s_add_u32 m0, s32, 0
  s_add_u32 s30, s94, 0
  buffer_load_dwordx4 v8, s[40:43], s30 offen lds
  s_add_u32 m0, s32, 9216
  s_add_u32 s30, s94, 9216
  buffer_load_dwordx4 v9, s[40:43], s30 offen lds
  v_cvt_f32_u32 v80, v75
  v_add_u32 v75, v75, v73
  v_mul_f32 v80, 0x3ae38e39, v80
  v_subrev_u32 v76, 576, v75
  v_cos_f32 v80, v80
  v_min_u32 v75, v75, v76
  v_cvt_f32_u32 v81, v75
  v_add_u32 v75, v75, v77
  v_mul_f32 v81, 0x3ae38e39, v81
  v_subrev_u32 v76, 576, v75
  v_cos_f32 v81, v81
  v_min_u32 v75, v75, v76
  v_fma_f32 v82, v78, v81, -v80
  v_fma_f32 v83, v78, v82, -v81
  v_cvt_pk_bf16_f32 v40, v80, v81
  v_fma_f32 v84, v78, v83, -v82
  v_fma_f32 v85, v78, v84, -v83
  v_cvt_pk_bf16_f32 v41, v82, v83
  v_fma_f32 v86, v78, v85, -v84
  v_fma_f32 v87, v78, v86, -v85
  v_cvt_pk_bf16_f32 v42, v84, v85
  v_cvt_pk_bf16_f32 v43, v86, v87
  v_dot2c_f32_bf16 v79, v40, v74
  v_dot2c_f32_bf16 v79, v41, v74
  v_dot2c_f32_bf16 v79, v42, v74
  v_dot2c_f32_bf16 v79, v43, v74
  s_add_u32 s31, s31, 1
  s_cmp_eq_u32 s31, 9
  s_cselect_b32 s31, 0, s31
  s_lshl_b32 s32, s31, 10
  s_add_u32 s32, s32, s3
  s_lshl_b32 s94, s31, 7
  s_add_u32 s94, s94, s34
  s_add_u32 m0, s32, 0
  s_add_u32 s30, s94, 0
  buffer_load_dwordx4 v8, s[40:43], s30 offen lds
  v_cvt_f32_u32 v80, v75
  v_add_u32 v75, v75, v73
  v_mul_f32 v80, 0x3ae38e39, v80
  v_subrev_u32 v76, 576, v75
  v_cos_f32 v80, v80
  v_min_u32 v75, v75, v76
  v_cvt_f32_u32 v81, v75
  v_add_u32 v75, v75, v77
  v_mul_f32 v81, 0x3ae38e39, v81
  v_subrev_u32 v76, 576, v75
  v_cos_f32 v81, v81
  v_min_u32 v75, v75, v76
  v_fma_f32 v82, v78, v81, -v80
  v_fma_f32 v83, v78, v82, -v81
  v_cvt_pk_bf16_f32 v44, v80, v81
  v_fma_f32 v84, v78, v83, -v82
  v_fma_f32 v85, v78, v84, -v83
  v_cvt_pk_bf16_f32 v45, v82, v83
  v_fma_f32 v86, v78, v85, -v84
  v_fma_f32 v87, v78, v86, -v85
  v_cvt_pk_bf16_f32 v46, v84, v85
  v_cvt_pk_bf16_f32 v47, v86, v87
  v_dot2c_f32_bf16 v79, v44, v74
  v_dot2c_f32_bf16 v79, v45, v74
  v_dot2c_f32_bf16 v79, v46, v74
  v_dot2c_f32_bf16 v79, v47, v74
  s_add_u32 m0, s32, 9216
  s_add_u32 s30, s94, 9216
  buffer_load_dwordx4 v9, s[40:43], s30 offen lds
  v_cvt_f32_u32 v80, v75
  v_add_u32 v75, v75, v73
  v_mul_f32 v80, 0x3ae38e39, v80
  v_subrev_u32 v76, 576, v75
  v_cos_f32 v80, v80
  v_min_u32 v75, v75, v76
  v_cvt_f32_u32 v81, v75
  v_add_u32 v75, v75, v77
  v_mul_f32 v81, 0x3ae38e39, v81
  v_subrev_u32 v76, 576, v75
  v_cos_f32 v81, v81
  v_min_u32 v75, v75, v76
  v_fma_f32 v82, v78, v81, -v80
  v_fma_f32 v83, v78, v82, -v81
  v_cvt_pk_bf16_f32 v48, v80, v81
  v_fma_f32 v84, v78, v83, -v82
  v_fma_f32 v85, v78, v84, -v83
  v_cvt_pk_bf16_f32 v49, v82, v83
  v_fma_f32 v86, v78, v85, -v84
  v_fma_f32 v87, v78, v86, -v85
  v_cvt_pk_bf16_f32 v50, v84, v85
  v_cvt_pk_bf16_f32 v51, v86, v87
  v_dot2c_f32_bf16 v79, v48, v74
  v_dot2c_f32_bf16 v79, v49, v74
  v_dot2c_f32_bf16 v79, v50, v74
  v_dot2c_f32_bf16 v79, v51, v74
  s_add_u32 s31, s31, 1
  s_cmp_eq_u32 s31, 9
  s_cselect_b32 s31, 0, s31
  s_lshl_b32 s32, s31, 10
  s_add_u32 s32, s32, s3
  s_lshl_b32 s94, s31, 7
  s_add_u32 s94, s94, s34
  s_add_u32 m0, s32, 0
  s_add_u32 s30, s94, 0
  buffer_load_dwordx4 v8, s[40:43], s30 offen lds
  s_add_u32 m0, s32, 9216
  s_add_u32 s30, s94, 9216
  buffer_load_dwordx4 v9, s[40:43], s30 offen lds
  s_lshl_b32 s36, s19, 8
  s_add_u32 s36, s36, 161792
  v_lshlrev_b32 v12, 2, v1
  v_add_u32 v12, s36, v12
  ds_write_b32 v12, v79
  s_lshl_b32 s36, s18, 8
  s_add_u32 s36, s36, s2
  v_lshlrev_b32 v12, 2, v0
  v_add_u32 v12, 151424, v12
  v_mov_b32 v13, 0
  v_cmp_gt_u32 vcc, 32, v0
  s_and_saveexec_b64 s[36:37], vcc
  ds_write_b32 v12, v13
  s_mov_b64 exec, s[36:37]
  s_cmp_lt_u32 s18, 2
  s_cbranch_scc1 L_nocs2_3
  s_waitcnt vmcnt(12)
  v_lshlrev_b32 v72, 16, v128
  v_and_b32 v73, 0xffff0000, v128
  v_lshlrev_b32 v74, 16, v129
  v_and_b32 v75, 0xffff0000, v129
  v_lshlrev_b32 v76, 16, v130
  v_and_b32 v77, 0xffff0000, v130
  v_lshlrev_b32 v78, 16, v131
  v_and_b32 v79, 0xffff0000, v131
  v_lshlrev_b32 v80, 16, v132
  v_and_b32 v81, 0xffff0000, v132
  v_lshlrev_b32 v82, 16, v133
  v_and_b32 v83, 0xffff0000, v133
  v_lshlrev_b32 v84, 16, v134
  v_and_b32 v85, 0xffff0000, v134
  v_lshlrev_b32 v86, 16, v135
  v_and_b32 v87, 0xffff0000, v135
  v_add_f32 v72, v72, v80
  v_add_f32 v73, v73, v81
  v_add_f32 v74, v74, v82
  v_add_f32 v75, v75, v83
  v_add_f32 v76, v76, v84
  v_add_f32 v77, v77, v85
  v_add_f32 v78, v78, v86
  v_add_f32 v79, v79, v87
  v_lshlrev_b32 v80, 16, v136
  v_and_b32 v81, 0xffff0000, v136
  v_lshlrev_b32 v82, 16, v137
  v_and_b32 v83, 0xffff0000, v137
  v_lshlrev_b32 v84, 16, v138
  v_and_b32 v85, 0xffff0000, v138
  v_lshlrev_b32 v86, 16, v139
  v_and_b32 v87, 0xffff0000, v139
  v_add_f32 v72, v72, v80
  v_add_f32 v73, v73, v81
  v_add_f32 v74, v74, v82
  v_add_f32 v75, v75, v83
  v_add_f32 v76, v76, v84
  v_add_f32 v77, v77, v85
  v_add_f32 v78, v78, v86
  v_add_f32 v79, v79, v87
  v_lshlrev_b32 v80, 16, v140
  v_and_b32 v81, 0xffff0000, v140
  v_lshlrev_b32 v82, 16, v141
  v_and_b32 v83, 0xffff0000, v141
  v_lshlrev_b32 v84, 16, v142
  v_and_b32 v85, 0xffff0000, v142
  v_lshlrev_b32 v86, 16, v143
  v_and_b32 v87, 0xffff0000, v143
  v_add_f32 v72, v72, v80
  v_add_f32 v73, v73, v81
  v_add_f32 v74, v74, v82
  v_add_f32 v75, v75, v83
  v_add_f32 v76, v76, v84
  v_add_f32 v77, v77, v85
  v_add_f32 v78, v78, v86
  v_add_f32 v79, v79, v87
  v_lshlrev_b32 v80, 16, v144
  v_and_b32 v81, 0xffff0000, v144
  v_lshlrev_b32 v82, 16, v145
  v_and_b32 v83, 0xffff0000, v145
  v_lshlrev_b32 v84, 16, v146
  v_and_b32 v85, 0xffff0000, v146
  v_lshlrev_b32 v86, 16, v147
  v_and_b32 v87, 0xffff0000, v147
  v_add_f32 v72, v72, v80
  v_add_f32 v73, v73, v81
  v_add_f32 v74, v74, v82
  v_add_f32 v75, v75, v83
  v_add_f32 v76, v76, v84
  v_add_f32 v77, v77, v85
  v_add_f32 v78, v78, v86
  v_add_f32 v79, v79, v87
  v_lshlrev_b32 v80, 16, v148
  v_and_b32 v81, 0xffff0000, v148
  v_lshlrev_b32 v82, 16, v149
  v_and_b32 v83, 0xffff0000, v149
  v_lshlrev_b32 v84, 16, v150
  v_and_b32 v85, 0xffff0000, v150
  v_lshlrev_b32 v86, 16, v151
  v_and_b32 v87, 0xffff0000, v151
  v_add_f32 v72, v72, v80
  v_add_f32 v73, v73, v81
  v_add_f32 v74, v74, v82
  v_add_f32 v75, v75, v83
  v_add_f32 v76, v76, v84
  v_add_f32 v77, v77, v85
  v_add_f32 v78, v78, v86
  v_add_f32 v79, v79, v87
  v_lshlrev_b32 v80, 16, v152
  v_and_b32 v81, 0xffff0000, v152
  v_lshlrev_b32 v82, 16, v153
  v_and_b32 v83, 0xffff0000, v153
  v_lshlrev_b32 v84, 16, v154
  v_and_b32 v85, 0xffff0000, v154
  v_lshlrev_b32 v86, 16, v155
  v_and_b32 v87, 0xffff0000, v155
  v_add_f32 v72, v72, v80
  v_add_f32 v73, v73, v81
  v_add_f32 v74, v74, v82
  v_add_f32 v75, v75, v83
  v_add_f32 v76, v76, v84
  v_add_f32 v77, v77, v85
  v_add_f32 v78, v78, v86
  v_add_f32 v79, v79, v87
  v_lshlrev_b32 v80, 16, v156
  v_and_b32 v81, 0xffff0000, v156
  v_lshlrev_b32 v82, 16, v157
  v_and_b32 v83, 0xffff0000, v157
  v_lshlrev_b32 v84, 16, v158
  v_and_b32 v85, 0xffff0000, v158
  v_lshlrev_b32 v86, 16, v159
  v_and_b32 v87, 0xffff0000, v159
  v_add_f32 v72, v72, v80
  v_add_f32 v73, v73, v81
  v_add_f32 v74, v74, v82
  v_add_f32 v75, v75, v83
  v_add_f32 v76, v76, v84
  v_add_f32 v77, v77, v85
  v_add_f32 v78, v78, v86
  v_add_f32 v79, v79, v87
  v_lshlrev_b32 v80, 16, v160
  v_and_b32 v81, 0xffff0000, v160
  v_lshlrev_b32 v82, 16, v161
  v_and_b32 v83, 0xffff0000, v161
  v_lshlrev_b32 v84, 16, v162
  v_and_b32 v85, 0xffff0000, v162
  v_lshlrev_b32 v86, 16, v163
  v_and_b32 v87, 0xffff0000, v163
  v_add_f32 v72, v72, v80
  v_add_f32 v73, v73, v81
  v_add_f32 v74, v74, v82
  v_add_f32 v75, v75, v83
  v_add_f32 v76, v76, v84
  v_add_f32 v77, v77, v85
  v_add_f32 v78, v78, v86
  v_add_f32 v79, v79, v87
  v_lshlrev_b32 v80, 16, v164
  v_and_b32 v81, 0xffff0000, v164
  v_lshlrev_b32 v82, 16, v165
  v_and_b32 v83, 0xffff0000, v165
  v_lshlrev_b32 v84, 16, v166
  v_and_b32 v85, 0xffff0000, v166
  v_lshlrev_b32 v86, 16, v167
  v_and_b32 v87, 0xffff0000, v167
  v_add_f32 v72, v72, v80
  v_add_f32 v73, v73, v81
  v_add_f32 v74, v74, v82
  v_add_f32 v75, v75, v83
  v_add_f32 v76, v76, v84
  v_add_f32 v77, v77, v85
  v_add_f32 v78, v78, v86
  v_add_f32 v79, v79, v87
  v_lshlrev_b32 v80, 16, v168
  v_and_b32 v81, 0xffff0000, v168
  v_lshlrev_b32 v82, 16, v169
  v_and_b32 v83, 0xffff0000, v169
  v_lshlrev_b32 v84, 16, v170
  v_and_b32 v85, 0xffff0000, v170
  v_lshlrev_b32 v86, 16, v171
  v_and_b32 v87, 0xffff0000, v171
  v_add_f32 v72, v72, v80
  v_add_f32 v73, v73, v81
  v_add_f32 v74, v74, v82
  v_add_f32 v75, v75, v83
  v_add_f32 v76, v76, v84
  v_add_f32 v77, v77, v85
  v_add_f32 v78, v78, v86
  v_add_f32 v79, v79, v87
  v_lshlrev_b32 v80, 16, v172
  v_and_b32 v81, 0xffff0000, v172
  v_lshlrev_b32 v82, 16, v173
  v_and_b32 v83, 0xffff0000, v173
  v_lshlrev_b32 v84, 16, v174
  v_and_b32 v85, 0xffff0000, v174
  v_lshlrev_b32 v86, 16, v175
  v_and_b32 v87, 0xffff0000, v175
  v_add_f32 v72, v72, v80
  v_add_f32 v73, v73, v81
  v_add_f32 v74, v74, v82
  v_add_f32 v75, v75, v83
  v_add_f32 v76, v76, v84
  v_add_f32 v77, v77, v85
  v_add_f32 v78, v78, v86
  v_add_f32 v79, v79, v87
  v_cmp_gt_u32 vcc, 236, v0
  s_and_saveexec_b64 s[36:37], vcc
  ds_write_b128 v176, v[72:75]
  ds_write_b128 v176, v[76:79] offset:16
  s_mov_b64 exec, s[36:37]
L_nocs2_3:
  s_cmp_ge_u32 s18, 3
  s_cselect_b32 s38, 3, 0
  s_sub_u32 s38, s18, s38
  s_lshl_b32 s38, s38, 12
  s_add_u32 s38, s38, 151552
  s_lshl_b32 s56, s18, 8
  s_add_u32 s56, s56, s2
  s_mul_hi_u32 s32, s56, 0x1c71c71d
  s_mul_i32 s28, s32, 9
  s_sub_u32 s28, s56, s28
  s_mul_i32 s3, s32, 36864
  s_lshl_b32 s57, s28, 7
  s_add_u32 s3, s3, s57
  v_lshrrev_b32 v4, 3, v1
  v_mul_u32_u24 v4, 1152, v4
  v_and_b32 v5, 7, v1
  v_lshl_add_u32 v248, v5, 4, v4
  s_mul_i32 s32, s32, 36
  s_lshl_b32 s28, s28, 2
  s_add_u32 s32, s32, s28
  s_lshl_b32 s32, s32, 10
  s_add_u32 s32, s32, 0x1c22000
  s_mov_b32 s100, s56
  s_and_b32 s56, s2, 31
  s_lshr_b32 s57, s2, 5
  s_lshr_b32 s28, s56, 4
  s_lshl_b32 s28, s28, 4
  s_and_b32 s36, s56, 15
  s_lshl_b32 s36, s36, 7
  s_add_u32 s28, s28, s36
  s_mul_i32 s28, s28, 578
  s_mul_i32 s36, s57, 72
  s_add_u32 s28, s28, s36
  v_mul_u32_u24 v4, 13108, v0
  v_lshrrev_b32 v4, 16, v4
  v_mul_u32_u24 v5, 5, v4
  v_sub_u32 v5, v0, v5
  v_lshrrev_b32 v6, 4, v4
  v_lshlrev_b32 v6, 5, v6
  v_and_b32 v7, 15, v4
  v_add_u32 v6, v6, v7
  v_mul_u32_u24 v6, 578, v6
  v_lshl_add_u32 v6, v5, 4, v6
  v_and_b32 v4, 1, v4
  v_lshlrev_b32 v4, 1, v4
  v_sub_u32 v6, v6, v4
  v_add_u32 v249, s28, v6
  s_mul_i32 s57, s57, 294912
  s_lshl_b32 s56, s56, 8
  s_add_u32 s56, s56, s57
  s_add_u32 s56, s56, 0x19e0000
  s_lshl_b32 s36, s19, 5
  v_add_u32 v13, s36, v11
  v_bfe_u32 v12, v13, 1, 3
  v_lshrrev_b32 v10, 3, v13
  v_mul_u32_u24 v10, 9216, v10
  v_and_b32 v9, 7, v13
  v_lshl_add_u32 v10, v9, 7, v10
  v_add_u32 v4, 0, v14
  v_xor_b32 v4, v4, v12
  v_lshl_add_u32 v4, v4, 4, v10
  v_add_u32 v5, 2, v14
  v_xor_b32 v5, v5, v12
  v_lshl_add_u32 v5, v5, 4, v10
  v_add_u32 v6, 4, v14
  v_xor_b32 v6, v6, v12
  v_lshl_add_u32 v6, v6, 4, v10
  v_add_u32 v7, 6, v14
  v_xor_b32 v7, v7, v12
  v_lshl_add_u32 v7, v7, 4, v10
  v_lshlrev_b32 v9, 5, v13
  v_add_u32 v9, 151552, v9
  v_lshl_add_u32 v8, v14, 3, v9
  s_waitcnt vmcnt(0) lgkmcnt(0)
  s_barrier
  s_cmp_eq_u32 s18, 3
  s_cbranch_scc0 L_nopub_4
  v_lshlrev_b32 v12, 5, v1
  v_add_u32 v13, 147968, v12
  ds_read_b128 v[232:235], v13 offset:0
  ds_read_b128 v[236:239], v13 offset:16
  ds_read_b128 v[240:243], v13 offset:1152
  ds_read_b128 v[244:247], v13 offset:1168
  ds_read_b128 v[72:75], v13 offset:2304
  ds_read_b128 v[76:79], v13 offset:2320
  s_lshl_b32 s36, s17, 4
  s_add_u32 s36, s36, s16
  s_mul_i32 s36, s36, 1152
  s_add_u32 s36, s36, 0x33f4000
  v_cmp_gt_u32 vcc, 36, v1
  s_nop 1
  v_cndmask_b32 v12, v15, v12, vcc
  s_waitcnt lgkmcnt(0)
  v_add_f32 v232, v232, v240
  v_add_f32 v232, v232, v72
  v_add_f32 v233, v233, v241
  v_add_f32 v233, v233, v73
  v_add_f32 v234, v234, v242
  v_add_f32 v234, v234, v74
  v_add_f32 v235, v235, v243
  v_add_f32 v235, v235, v75
  v_add_f32 v236, v236, v244
  v_add_f32 v236, v236, v76
  v_add_f32 v237, v237, v245
  v_add_f32 v237, v237, v77
  v_add_f32 v238, v238, v246
  v_add_f32 v238, v238, v78
  v_add_f32 v239, v239, v247
  v_add_f32 v239, v239, v79
  buffer_store_dwordx4 v[232:235], v12, s[4:7], s36 offen sc1
  buffer_store_dwordx4 v[236:239], v12, s[4:7], s36 offen offset:16 sc1
L_nopub_4:
  v_mov_b32 v253, 0
  buffer_load_dword v255, v253, s[20:23], 0 offen sc1
  v_mul_u32_u24 v12, 1152, v11
  s_cmp_lt_u32 s100, 1296
  s_cbranch_scc0 L_skip_5
  buffer_load_dword v254, v12, s[52:55], s3 offen
L_skip_5:
  ds_read_b128 v[88:91], v4 offset:0
  ds_read_b128 v[92:95], v5 offset:0
  ds_read_b128 v[96:99], v6 offset:0
  ds_read_b128 v[100:103], v7 offset:0
  ds_read_b128 v[104:107], v4 offset:1024
  ds_read_b128 v[108:111], v5 offset:1024
  ds_read_b128 v[112:115], v6 offset:1024
  ds_read_b128 v[116:119], v7 offset:1024
  ds_read_b128 v[120:123], v4 offset:2048
  ds_read_b128 v[124:127], v5 offset:2048
  ds_read_b128 v[128:131], v6 offset:2048
  ds_read_b128 v[132:135], v7 offset:2048
  ds_read_b128 v[136:139], v4 offset:3072
  ds_read_b128 v[140:143], v5 offset:3072
  ds_read_b128 v[144:147], v6 offset:3072
  ds_read_b128 v[148:151], v7 offset:3072
  ds_read_b128 v[152:155], v4 offset:4096
  ds_read_b128 v[156:159], v5 offset:4096
  v_mov_b32 v80, 0
  v_mov_b32 v81, 0
  v_mov_b32 v82, 0
  v_mov_b32 v83, 0
  v_mov_b32 v84, 0
  v_mov_b32 v85, 0
  v_mov_b32 v86, 0
  v_mov_b32 v87, 0
  v_mov_b32 v79, 0x3f803f80
  ds_read_b128 v[160:163], v6 offset:4096
  s_waitcnt lgkmcnt(15)
  v_dot2c_f32_bf16 v80, v88, v79
  v_dot2c_f32_bf16 v84, v88, v88
  v_dot2c_f32_bf16 v81, v89, v79
  v_dot2c_f32_bf16 v85, v89, v89
  v_dot2c_f32_bf16 v82, v90, v79
  v_dot2c_f32_bf16 v86, v90, v90
  v_dot2c_f32_bf16 v83, v91, v79
  v_dot2c_f32_bf16 v87, v91, v91
  ds_read_b128 v[164:167], v7 offset:4096
  s_waitcnt lgkmcnt(15)
  v_dot2c_f32_bf16 v80, v92, v79
  v_dot2c_f32_bf16 v84, v92, v92
  v_dot2c_f32_bf16 v81, v93, v79
  v_dot2c_f32_bf16 v85, v93, v93
  v_dot2c_f32_bf16 v82, v94, v79
  v_dot2c_f32_bf16 v86, v94, v94
  v_dot2c_f32_bf16 v83, v95, v79
  v_dot2c_f32_bf16 v87, v95, v95
  ds_read_b128 v[168:171], v4 offset:5120
  s_waitcnt lgkmcnt(15)
  v_dot2c_f32_bf16 v80, v96, v79
  v_dot2c_f32_bf16 v84, v96, v96
  v_dot2c_f32_bf16 v81, v97, v79
  v_dot2c_f32_bf16 v85, v97, v97
  v_dot2c_f32_bf16 v82, v98, v79
  v_dot2c_f32_bf16 v86, v98, v98
  v_dot2c_f32_bf16 v83, v99, v79
  v_dot2c_f32_bf16 v87, v99, v99
  ds_read_b128 v[172:175], v5 offset:5120
  s_waitcnt lgkmcnt(15)
  v_dot2c_f32_bf16 v80, v100, v79
  v_dot2c_f32_bf16 v84, v100, v100
  v_dot2c_f32_bf16 v81, v101, v79
  v_dot2c_f32_bf16 v85, v101, v101
  v_dot2c_f32_bf16 v82, v102, v79
  v_dot2c_f32_bf16 v86, v102, v102
  v_dot2c_f32_bf16 v83, v103, v79
  v_dot2c_f32_bf16 v87, v103, v103
  ds_read_b128 v[176:179], v6 offset:5120
  s_waitcnt lgkmcnt(15)
  v_dot2c_f32_bf16 v80, v104, v79
  v_dot2c_f32_bf16 v84, v104, v104
  v_dot2c_f32_bf16 v81, v105, v79
  v_dot2c_f32_bf16 v85, v105, v105
  v_dot2c_f32_bf16 v82, v106, v79
  v_dot2c_f32_bf16 v86, v106, v106
  v_dot2c_f32_bf16 v83, v107, v79
  v_dot2c_f32_bf16 v87, v107, v107
  ds_read_b128 v[180:183], v7 offset:5120
  s_waitcnt lgkmcnt(15)
  v_dot2c_f32_bf16 v80, v108, v79
  v_dot2c_f32_bf16 v84, v108, v108
  v_dot2c_f32_bf16 v81, v109, v79
  v_dot2c_f32_bf16 v85, v109, v109
  v_dot2c_f32_bf16 v82, v110, v79
  v_dot2c_f32_bf16 v86, v110, v110
  v_dot2c_f32_bf16 v83, v111, v79
  v_dot2c_f32_bf16 v87, v111, v111
  ds_read_b128 v[184:187], v4 offset:6144
  s_waitcnt lgkmcnt(15)
  v_dot2c_f32_bf16 v80, v112, v79
  v_dot2c_f32_bf16 v84, v112, v112
  v_dot2c_f32_bf16 v81, v113, v79
  v_dot2c_f32_bf16 v85, v113, v113
  v_dot2c_f32_bf16 v82, v114, v79
  v_dot2c_f32_bf16 v86, v114, v114
  v_dot2c_f32_bf16 v83, v115, v79
  v_dot2c_f32_bf16 v87, v115, v115
  ds_read_b128 v[188:191], v5 offset:6144
  s_waitcnt lgkmcnt(15)
  v_dot2c_f32_bf16 v80, v116, v79
  v_dot2c_f32_bf16 v84, v116, v116
  v_dot2c_f32_bf16 v81, v117, v79
  v_dot2c_f32_bf16 v85, v117, v117
  v_dot2c_f32_bf16 v82, v118, v79
  v_dot2c_f32_bf16 v86, v118, v118
  v_dot2c_f32_bf16 v83, v119, v79
  v_dot2c_f32_bf16 v87, v119, v119
  ds_read_b128 v[192:195], v6 offset:6144
  s_waitcnt lgkmcnt(15)
  v_dot2c_f32_bf16 v80, v120, v79
  v_dot2c_f32_bf16 v84, v120, v120
  v_dot2c_f32_bf16 v81, v121, v79
  v_dot2c_f32_bf16 v85, v121, v121
  v_dot2c_f32_bf16 v82, v122, v79
  v_dot2c_f32_bf16 v86, v122, v122
  v_dot2c_f32_bf16 v83, v123, v79
  v_dot2c_f32_bf16 v87, v123, v123
  ds_read_b128 v[196:199], v7 offset:6144
  s_waitcnt lgkmcnt(15)
  v_dot2c_f32_bf16 v80, v124, v79
  v_dot2c_f32_bf16 v84, v124, v124
  v_dot2c_f32_bf16 v81, v125, v79
  v_dot2c_f32_bf16 v85, v125, v125
  v_dot2c_f32_bf16 v82, v126, v79
  v_dot2c_f32_bf16 v86, v126, v126
  v_dot2c_f32_bf16 v83, v127, v79
  v_dot2c_f32_bf16 v87, v127, v127
  ds_read_b128 v[200:203], v4 offset:7168
  s_waitcnt lgkmcnt(15)
  v_dot2c_f32_bf16 v80, v128, v79
  v_dot2c_f32_bf16 v84, v128, v128
  v_dot2c_f32_bf16 v81, v129, v79
  v_dot2c_f32_bf16 v85, v129, v129
  v_dot2c_f32_bf16 v82, v130, v79
  v_dot2c_f32_bf16 v86, v130, v130
  v_dot2c_f32_bf16 v83, v131, v79
  v_dot2c_f32_bf16 v87, v131, v131
  ds_read_b128 v[204:207], v5 offset:7168
  s_waitcnt lgkmcnt(15)
  v_dot2c_f32_bf16 v80, v132, v79
  v_dot2c_f32_bf16 v84, v132, v132
  v_dot2c_f32_bf16 v81, v133, v79
  v_dot2c_f32_bf16 v85, v133, v133
  v_dot2c_f32_bf16 v82, v134, v79
  v_dot2c_f32_bf16 v86, v134, v134
  v_dot2c_f32_bf16 v83, v135, v79
  v_dot2c_f32_bf16 v87, v135, v135
  ds_read_b128 v[208:211], v6 offset:7168
  s_waitcnt lgkmcnt(15)
  v_dot2c_f32_bf16 v80, v136, v79
  v_dot2c_f32_bf16 v84, v136, v136
  v_dot2c_f32_bf16 v81, v137, v79
  v_dot2c_f32_bf16 v85, v137, v137
  v_dot2c_f32_bf16 v82, v138, v79
  v_dot2c_f32_bf16 v86, v138, v138
  v_dot2c_f32_bf16 v83, v139, v79
  v_dot2c_f32_bf16 v87, v139, v139
  ds_read_b128 v[212:215], v7 offset:7168
  s_waitcnt lgkmcnt(15)
  v_dot2c_f32_bf16 v80, v140, v79
  v_dot2c_f32_bf16 v84, v140, v140
  v_dot2c_f32_bf16 v81, v141, v79
  v_dot2c_f32_bf16 v85, v141, v141
  v_dot2c_f32_bf16 v82, v142, v79
  v_dot2c_f32_bf16 v86, v142, v142
  v_dot2c_f32_bf16 v83, v143, v79
  v_dot2c_f32_bf16 v87, v143, v143
  ds_read_b128 v[216:219], v4 offset:8192
  s_waitcnt lgkmcnt(15)
  v_dot2c_f32_bf16 v80, v144, v79
  v_dot2c_f32_bf16 v84, v144, v144
  v_dot2c_f32_bf16 v81, v145, v79
  v_dot2c_f32_bf16 v85, v145, v145
  v_dot2c_f32_bf16 v82, v146, v79
  v_dot2c_f32_bf16 v86, v146, v146
  v_dot2c_f32_bf16 v83, v147, v79
  v_dot2c_f32_bf16 v87, v147, v147
  ds_read_b128 v[220:223], v5 offset:8192
  s_waitcnt lgkmcnt(15)
  v_dot2c_f32_bf16 v80, v148, v79
  v_dot2c_f32_bf16 v84, v148, v148
  v_dot2c_f32_bf16 v81, v149, v79
  v_dot2c_f32_bf16 v85, v149, v149
  v_dot2c_f32_bf16 v82, v150, v79
  v_dot2c_f32_bf16 v86, v150, v150
  v_dot2c_f32_bf16 v83, v151, v79
  v_dot2c_f32_bf16 v87, v151, v151
  ds_read_b128 v[224:227], v6 offset:8192
  s_waitcnt lgkmcnt(15)
  v_dot2c_f32_bf16 v80, v152, v79
  v_dot2c_f32_bf16 v84, v152, v152
  v_dot2c_f32_bf16 v81, v153, v79
  v_dot2c_f32_bf16 v85, v153, v153
  v_dot2c_f32_bf16 v82, v154, v79
  v_dot2c_f32_bf16 v86, v154, v154
  v_dot2c_f32_bf16 v83, v155, v79
  v_dot2c_f32_bf16 v87, v155, v155
  ds_read_b128 v[228:231], v7 offset:8192
  s_waitcnt lgkmcnt(15)
  v_dot2c_f32_bf16 v80, v156, v79
  v_dot2c_f32_bf16 v84, v156, v156
  v_dot2c_f32_bf16 v81, v157, v79
  v_dot2c_f32_bf16 v85, v157, v157
  v_dot2c_f32_bf16 v82, v158, v79
  v_dot2c_f32_bf16 v86, v158, v158
  v_dot2c_f32_bf16 v83, v159, v79
  v_dot2c_f32_bf16 v87, v159, v159
  s_nop 2
  v_add_f32 v80, v80, v81
  v_add_f32 v82, v82, v83
  v_add_f32 v84, v84, v85
  v_add_f32 v86, v86, v87
  v_add_f32 v80, v80, v82
  v_add_f32 v81, v84, v86
  ds_write_b64 v8, v[80:81] offset:0
  v_bfe_u32 v13, v1, 2, 2
  v_lshlrev_b32 v12, 6, v13
  v_bfe_u32 v13, v1, 4, 1
  v_lshl_add_u32 v12, v13, 5, v12
  v_and_b32 v13, 3, v1
  v_lshl_add_u32 v12, v13, 3, v12
  v_lshl_add_u32 v12, v14, 10, v12
  v_add_u32 v12, 0, v12
  s_lshr_b32 s36, s19, 1
  s_mul_i32 s36, s36, 36864
  s_and_b32 s37, s19, 1
  s_mul_i32 s37, s37, 18432
  s_add_u32 s36, s36, s37
  v_add_u32 v13, s36, v3
  s_lshl_b32 s29, s27, 6
  s_add_u32 s35, s35, s29
  s_mul_i32 s34, s18, 73728
  s_add_u32 s35, s35, s34
  s_lshl_b32 s34, s18, 10
  s_mul_i32 s29, s27, 640
  s_sub_u32 s31, s35, s29
  s_and_b32 s96, s16, 3
  s_add_u32 s29, s96, 0
  s_and_b32 s29, s29, 3
  s_lshl_b32 s29, s29, 7
  s_add_u32 s92, s35, s29
  s_add_u32 s29, s96, 1
  s_and_b32 s29, s29, 3
  s_lshl_b32 s29, s29, 7
  s_add_u32 s93, s35, s29
  s_add_u32 s29, s96, 2
  s_and_b32 s29, s29, 3
  s_lshl_b32 s29, s29, 7
  s_add_u32 s94, s35, s29
  s_add_u32 s29, s96, 3
  s_and_b32 s29, s29, 3
  s_lshl_b32 s29, s29, 7
  s_add_u32 s95, s35, s29
  s_waitcnt lgkmcnt(0)
  s_barrier
  ds_read_b128 v[72:75], v9
  ds_read_b128 v[76:79], v9 offset:16
  ds_write_b128 v13, v[16:19] offset:0
  ds_write_b128 v13, v[20:23] offset:2048
  ds_write_b128 v13, v[24:27] offset:4096
  ds_write_b128 v13, v[28:31] offset:6144
  ds_write_b128 v13, v[32:35] offset:8192
  ds_write_b128 v13, v[36:39] offset:10240
  ds_write_b128 v13, v[40:43] offset:12288
  ds_write_b128 v13, v[44:47] offset:14336
  ds_write_b128 v13, v[48:51] offset:16384
  v_mov_b32 v4, v12
  v_add_u32 v5, 49152, v12
  v_add_u32 v6, 98304, v12
  v_add_u32 v13, 0, v3
  s_waitcnt lgkmcnt(0)
  s_barrier
  s_waitcnt vmcnt(0)
  v_readfirstlane_b32 s59, v255
  s_cmp_lg_u32 s59, 0
  s_cbranch_scc1 L_nok_6
  s_mov_b32 s28, 0
L_nlp_7:
  s_sleep 8
  buffer_load_dword v255, v253, s[20:23], 0 offen sc1
  s_waitcnt vmcnt(0)
  v_readfirstlane_b32 s59, v255
  s_cmp_lg_u32 s59, 0
  s_cbranch_scc1 L_nok_6
  s_add_u32 s28, s28, 1
  s_cmp_lt_u32 s28, 0x40000
  s_cbranch_scc1 L_nlp_7
L_nok_6:
  ds_read_b128 v[48:51], v13 offset:0
  ds_read_b128 v[52:55], v13 offset:2048
  ds_read_b128 v[56:59], v13 offset:4096
  ds_read_b128 v[60:63], v13 offset:6144
  ds_read_b128 v[64:67], v13 offset:8192
  s_cmp_eq_u32 s18, 3
  s_cbranch_scc0 L_noflag_8
  v_mov_b32 v81, s59
  v_mov_b32 v80, 0
  s_waitcnt vmcnt(1)
  s_mov_b64 exec, 1
  buffer_store_dword v81, v80, s[4:7], s101 offen sc1
  s_mov_b64 exec, -1
L_noflag_8:
  ds_read_b128 v[68:71], v13 offset:10240
  s_waitcnt lgkmcnt(5)
  v_mfma_f32_32x32x16_bf16 v[16:31], v[88:91], v[48:51], 0
  s_cmp_lt_u32 s18, 5
  s_cbranch_scc0 L_skip_9
  s_add_u32 m0, s34, 151552
  s_nop 0
  buffer_load_dwordx4 v249, s[44:47], 0 offen lds
  s_add_u32 m0, s34, 156672
  s_nop 0
  buffer_load_dwordx4 v249, s[48:51], 0 offen lds
L_skip_9:
  s_add_u32 m0, s34, 73728
  s_add_u32 s30, s92, 0
  buffer_load_dwordx4 v2, s[8:11], s30 offen lds
  s_add_u32 m0, s34, 81920
  s_add_u32 s30, s92, 589824
  buffer_load_dwordx4 v2, s[8:11], s30 offen lds
  s_add_u32 m0, s34, 90112
  s_add_u32 s30, s92, 1179648
  buffer_load_dwordx4 v2, s[8:11], s30 offen lds
  ds_read_b128 v[48:51], v13 offset:12288
  s_waitcnt lgkmcnt(5)
  v_mfma_f32_32x32x16_bf16 v[16:31], v[92:95], v[52:55], v[16:31]
  s_add_u32 m0, s34, 98304
  s_add_u32 s30, s92, 1769472
  buffer_load_dwordx4 v2, s[8:11], s30 offen lds
  s_add_u32 m0, s34, 106496
  s_add_u32 s30, s92, 2359296
  buffer_load_dwordx4 v2, s[8:11], s30 offen lds
  v_add_f32 v72, v72, v74
  v_add_f32 v76, v76, v78
  ds_read_b128 v[52:55], v13 offset:14336
  s_waitcnt lgkmcnt(5)
  v_mfma_f32_32x32x16_bf16 v[16:31], v[96:99], v[56:59], v[16:31]
  v_add_f32 v73, v73, v75
  v_add_f32 v77, v77, v79
  v_add_f32 v72, v72, v76
  v_add_f32 v73, v73, v77
  ds_read_b128 v[56:59], v13 offset:16384
  s_waitcnt lgkmcnt(5)
  v_mfma_f32_32x32x16_bf16 v[16:31], v[100:103], v[60:63], v[16:31]
  v_mul_f32 v72, 0x3ae38e39, v72
  v_mul_f32 v73, 0x3ae38e39, v73
  v_fma_f32 v73, -v72, v72, v73
  ds_read_b128 v[60:63], v13 offset:18432
  s_waitcnt lgkmcnt(5)
  v_mfma_f32_32x32x16_bf16 v[16:31], v[104:107], v[64:67], v[16:31]
  v_max_f32 v73, 0, v73
  v_cvt_pk_bf16_f32 v74, -v72, v73
  v_and_b32 v73, 0xffff0000, v74
  v_add_f32 v73, 0x3727c5ac, v73
  ds_read_b128 v[64:67], v13 offset:20480
  s_waitcnt lgkmcnt(5)
  v_mfma_f32_32x32x16_bf16 v[16:31], v[108:111], v[68:71], v[16:31]
  v_cvt_pk_bf16_f32 v73, v73, v73
  v_lshlrev_b32 v73, 16, v73
  v_sqrt_f32 v73, v73
  v_and_b32 v74, 0xffff, v74
  ds_read_b128 v[68:71], v13 offset:22528
  s_waitcnt lgkmcnt(5)
  v_mfma_f32_32x32x16_bf16 v[16:31], v[112:115], v[48:51], v[16:31]
  v_cvt_pk_bf16_f32 v73, v73, v73
  v_lshl_or_b32 v232, v74, 16, v74
  v_and_b32 v75, 0xffff0000, v73
  v_or_b32 v233, v75, v74
  ds_read_b128 v[48:51], v13 offset:24576
  s_waitcnt lgkmcnt(5)
  v_mfma_f32_32x32x16_bf16 v[16:31], v[116:119], v[52:55], v[16:31]
  v_rcp_f32 v72, v75
  v_lshrrev_b32 v76, 3, v9
  v_add_u32 v76, 128512, v76
  ds_read_b128 v[52:55], v13 offset:26624
  s_waitcnt lgkmcnt(5)
  v_mfma_f32_32x32x16_bf16 v[16:31], v[120:123], v[56:59], v[16:31]
  v_mul_f32 v73, 0x3d2aaaab, v72
  ds_write_b32 v76, v73
  v_mov_b32 v234, 0
  v_mov_b32 v235, 0
  ds_read_b128 v[56:59], v13 offset:28672
  s_waitcnt lgkmcnt(6)
  v_mfma_f32_32x32x16_bf16 v[16:31], v[124:127], v[60:63], v[16:31]
  v_mov_b32 v238, 0
  v_mov_b32 v239, 0
  v_cndmask_b32 v232, v232, 0, s[24:25]
  v_cndmask_b32 v233, v233, 0, s[24:25]
  ds_read_b128 v[60:63], v13 offset:30720
  s_waitcnt lgkmcnt(6)
  v_mfma_f32_32x32x16_bf16 v[16:31], v[128:131], v[64:67], v[16:31]
  v_mul_f32 v9, 0xc0135761, v72
  v_mul_f32 v10, v72, v72
  v_mul_f32 v10, v10, v72
  ds_read_b128 v[64:67], v13 offset:32768
  s_waitcnt lgkmcnt(6)
  v_mfma_f32_32x32x16_bf16 v[16:31], v[132:135], v[68:71], v[16:31]
  v_mul_f32 v10, 0xbdd2d3e8, v10
  s_lshr_b32 s29, s33, 4
  v_bfe_u32 v73, v1, 4, 1
  v_add_u32 v73, s29, v73
  ds_read_b128 v[68:71], v13 offset:34816
  s_waitcnt lgkmcnt(6)
  v_mfma_f32_32x32x16_bf16 v[16:31], v[136:139], v[48:51], v[16:31]
  s_mov_b32 s29, 147456
  v_mul_lo_u32 v7, v73, s29
  v_lshl_add_u32 v7, v14, 8, v7
  v_and_b32 v73, 15, v1
  s_waitcnt lgkmcnt(4)
  s_barrier
  v_add_u32 v13, 36864, v13
  ds_read_b128 v[48:51], v13 offset:0
  v_mfma_f32_32x32x16_bf16 v[16:31], v[140:143], v[52:55], v[16:31]
  v_lshl_add_u32 v7, v73, 4, v7
  v_add_u32 v7, 0x360000, v7
  v_add_u32 v73, 0, v11
  s_mul_i32 s29, s17, 36
  ds_read_b128 v[52:55], v13 offset:2048
  s_add_u32 m0, s34, 110592
  s_add_u32 s30, s92, 2654208
  buffer_load_dwordx4 v2, s[8:11], s30 offen lds
  s_waitcnt lgkmcnt(5)
  v_mfma_f32_32x32x16_bf16 v[16:31], v[144:147], v[56:59], v[16:31]
  v_add_u32 v12, s29, v73
  v_lshlrev_b32 v12, 12, v12
  v_lshl_add_u32 v12, v14, 4, v12
  ds_read_b128 v[56:59], v13 offset:4096
  s_waitcnt lgkmcnt(5)
  v_mfma_f32_32x32x16_bf16 v[16:31], v[148:151], v[60:63], v[16:31]
  s_lshl_b32 s29, s33, 1
  s_add_u32 s29, s29, 0x1560000
  v_add_u32 v12, s29, v12
  v_cmp_gt_u32 vcc, 36, v73
  s_mul_i32 s39, s17, 9
  s_nop 0
  v_cndmask_b32 v12, v15, v12, vcc
  ds_read_b128 v[60:63], v13 offset:6144
  s_add_u32 m0, s34, 118784
  s_add_u32 s30, s92, 3244032
  buffer_load_dwordx4 v2, s[8:11], s30 offen lds
  s_waitcnt lgkmcnt(5)
  v_mfma_f32_32x32x16_bf16 v[16:31], v[152:155], v[64:67], v[16:31]
  v_lshlrev_b32 v73, 2, v11
  v_add_u32 v73, 161792, v73
  ds_read_b32 v80, v73 offset:0
  ds_read_b32 v81, v73 offset:128
  ds_read_b128 v[64:67], v13 offset:8192
  s_waitcnt lgkmcnt(7)
  v_mfma_f32_32x32x16_bf16 v[16:31], v[156:159], v[68:71], v[16:31]
  ds_read_b32 v82, v73 offset:256
  ds_read_b32 v83, v73 offset:384
  ds_read_b32 v84, v73 offset:512
  ds_read_b128 v[68:71], v13 offset:10240
  s_add_u32 m0, s34, 126976
  s_add_u32 s30, s92, 3833856
  buffer_load_dwordx4 v2, s[8:11], s30 offen lds
  s_waitcnt lgkmcnt(10)
  v_mfma_f32_32x32x16_bf16 v[16:31], v[160:163], v[48:51], v[16:31]
  ds_read_b32 v85, v73 offset:640
  ds_read_b32 v86, v73 offset:768
  ds_read_b32 v87, v73 offset:896
  v_mov_b32 v11, v75
  ds_read_b128 v[48:51], v13 offset:12288
  s_waitcnt lgkmcnt(13)
  v_mfma_f32_32x32x16_bf16 v[16:31], v[164:167], v[52:55], v[16:31]
  v_and_b32 v8, 31, v1
  v_lshlrev_b32 v8, 3, v8
  v_add_u32 v8, 147968, v8
  v_mov_b32 v73, 151424
  ds_read_b128 v[52:55], v13 offset:14336
  s_add_u32 m0, s34, 135168
  s_add_u32 s30, s92, 4423680
  buffer_load_dwordx4 v2, s[8:11], s30 offen lds
  s_waitcnt lgkmcnt(13)
  v_mfma_f32_32x32x16_bf16 v[16:31], v[168:171], v[56:59], v[16:31]
  v_cndmask_b32 v8, v8, v73, s[24:25]
  s_waitcnt lgkmcnt(2)
  v_add_f32 v80, v80, v81
  v_add_f32 v80, v80, v82
  ds_read_b128 v[56:59], v13 offset:16384
  v_mfma_f32_32x32x16_bf16 v[16:31], v[172:175], v[60:63], v[16:31]
  v_add_f32 v80, v80, v83
  v_add_f32 v80, v80, v84
  v_add_f32 v80, v80, v85
  ds_read_b128 v[60:63], v13 offset:18432
  s_add_u32 m0, s34, 143360
  s_add_u32 s30, s92, 5013504
  buffer_load_dwordx4 v2, s[8:11], s30 offen lds
  v_mfma_f32_32x32x16_bf16 v[16:31], v[176:179], v[64:67], v[16:31]
  v_add_f32 v80, v80, v86
  v_add_f32 v80, v80, v87
  v_cvt_pk_bf16_f32 v81, v80, v80
  v_lshlrev_b32 v81, 16, v81
  ds_read_b128 v[64:67], v13 offset:20480
  v_mfma_f32_32x32x16_bf16 v[16:31], v[180:183], v[68:71], v[16:31]
  v_sub_f32 v81, v80, v81
  v_cvt_pk_bf16_f32 v236, v80, v81
  v_and_b32 v80, 0xffff0000, v236
  v_sub_f32 v81, v81, v80
  ds_read_b128 v[68:71], v13 offset:22528
  s_waitcnt lgkmcnt(5)
  v_mfma_f32_32x32x16_bf16 v[16:31], v[184:187], v[48:51], v[16:31]
  v_cvt_pk_bf16_f32 v237, v81, 0
  v_cndmask_b32 v236, v236, 0, s[24:25]
  v_cndmask_b32 v237, v237, 0, s[24:25]
  ds_read_b128 v[48:51], v13 offset:24576
  s_waitcnt lgkmcnt(5)
  v_mfma_f32_32x32x16_bf16 v[16:31], v[188:191], v[52:55], v[16:31]
  ds_read_b128 v[52:55], v13 offset:26624
  s_waitcnt lgkmcnt(5)
  v_mfma_f32_32x32x16_bf16 v[16:31], v[192:195], v[56:59], v[16:31]
  v_and_b32 v76, 15, v0
  v_mul_u32_u24 v77, 80, v76
  v_and_b32 v78, 1, v0
  ds_read_b128 v[56:59], v13 offset:28672
  s_waitcnt lgkmcnt(5)
  v_mfma_f32_32x32x16_bf16 v[16:31], v[196:199], v[60:63], v[16:31]
  v_lshl_add_u32 v77, v78, 1, v77
  v_lshrrev_b32 v78, 4, v0
  ds_read_b128 v[60:63], v13 offset:30720
  s_waitcnt lgkmcnt(5)
  v_mfma_f32_32x32x16_bf16 v[16:31], v[200:203], v[64:67], v[16:31]
  v_lshl_add_u32 v77, v78, 1, v77
  v_add_u32 v77, 151552, v77
  v_lshlrev_b32 v76, 4, v76
  ds_read_b128 v[64:67], v13 offset:32768
  s_waitcnt lgkmcnt(5)
  v_mfma_f32_32x32x16_bf16 v[16:31], v[204:207], v[68:71], v[16:31]
  v_lshl_add_u32 v76, v78, 13, v76
  v_cmp_gt_u32 vcc, 80, v0
  v_add_u32 v78, 262144, v76
  s_nop 0
  v_cndmask_b32 v78, v15, v78, vcc
  ds_read_b128 v[68:71], v13 offset:34816
  s_waitcnt lgkmcnt(5)
  v_mfma_f32_32x32x16_bf16 v[16:31], v[208:211], v[48:51], v[16:31]
  s_waitcnt vmcnt(5)
  s_waitcnt vmcnt(10)
  s_barrier
  ds_read_b64_tr_b16 v[48:49], v5 offset:24576
  ds_read_b64_tr_b16 v[50:51], v5 offset:24832
  s_waitcnt lgkmcnt(6)
  v_mfma_f32_32x32x16_bf16 v[16:31], v[212:215], v[52:55], v[16:31]
  ds_read_u16 v240, v77 offset:0
  ds_read_u16 v80, v77 offset:5120
  ds_read_u16 v241, v77 offset:1280
  ds_read_u16 v81, v77 offset:6400
  ds_read_u16 v242, v77 offset:2560
  ds_read_u16 v82, v77 offset:7680
  ds_read_b64_tr_b16 v[52:53], v5 offset:26624
  ds_read_b64_tr_b16 v[54:55], v5 offset:26880
  s_add_u32 m0, s34, 0
  s_add_u32 s30, s93, 0
  buffer_load_dwordx4 v2, s[8:11], s30 offen lds
  s_waitcnt lgkmcnt(13)
  v_mfma_f32_32x32x16_bf16 v[16:31], v[216:219], v[56:59], v[16:31]
  ds_read_u16 v243, v77 offset:3840
  ds_read_u16 v83, v77 offset:8960
  ds_read_u16 v244, v77 offset:64
  ds_read_u16 v84, v77 offset:5184
  ds_read_u16 v245, v77 offset:1344
  ds_read_b64_tr_b16 v[56:57], v5 offset:28672
  ds_read_b64_tr_b16 v[58:59], v5 offset:28928
  s_waitcnt lgkmcnt(15)
  v_mfma_f32_32x32x16_bf16 v[16:31], v[220:223], v[60:63], v[16:31]
  ds_read_u16 v85, v77 offset:6464
  ds_read_u16 v246, v77 offset:2624
  ds_read_u16 v86, v77 offset:7744
  ds_read_u16 v247, v77 offset:3904
  ds_read_u16 v87, v77 offset:9024
  s_waitcnt lgkmcnt(0)
  ds_read_b64_tr_b16 v[60:61], v5 offset:30720
  ds_read_b64_tr_b16 v[62:63], v5 offset:30976
  s_add_u32 m0, s34, 8192
  s_add_u32 s30, s93, 589824
  buffer_load_dwordx4 v2, s[8:11], s30 offen lds
  v_mfma_f32_32x32x16_bf16 v[16:31], v[224:227], v[64:67], v[16:31]
  v_lshl_or_b32 v240, v80, 16, v240
  v_lshl_or_b32 v241, v81, 16, v241
  v_lshl_or_b32 v242, v82, 16, v242
  v_lshl_or_b32 v243, v83, 16, v243
  v_lshl_or_b32 v244, v84, 16, v244
  ds_read_b64_tr_b16 v[64:65], v5 offset:32768
  ds_read_b64_tr_b16 v[66:67], v5 offset:33024
  v_mfma_f32_32x32x16_bf16 v[16:31], v[228:231], v[68:71], v[16:31]
  v_lshl_or_b32 v245, v85, 16, v245
  v_lshl_or_b32 v246, v86, 16, v246
  v_lshl_or_b32 v247, v87, 16, v247
  buffer_store_dwordx4 v[240:243], v76, s[4:7], s56 offen sc1
  s_cmp_lt_u32 s18, 2
  s_cbranch_scc0 L_skip_10
  buffer_store_dwordx4 v[244:247], v78, s[4:7], s56 offen sc1
L_skip_10:
  v_mfma_f32_32x32x16_bf16 v[16:31], v[232:235], v[236:239], v[16:31]
  ds_read_b64_tr_b16 v[68:69], v5 offset:34816
  ds_read_b64_tr_b16 v[70:71], v5 offset:35072
  s_add_u32 m0, s34, 16384
  s_add_u32 s30, s93, 1179648
  buffer_load_dwordx4 v2, s[8:11], s30 offen lds
  v_mfma_f32_32x32x16_bf16 v[32:47], v[48:51], v[88:91], 0
  v_lshrrev_b32 v249, 5, v1
  v_lshlrev_b32 v249, 4, v249
  v_bfe_u32 v250, v1, 4, 1
  ds_read_b64_tr_b16 v[48:49], v5 offset:36864
  ds_read_b64_tr_b16 v[50:51], v5 offset:37120
  v_mfma_f32_32x32x16_bf16 v[32:47], v[52:55], v[92:95], v[32:47]
  v_lshl_add_u32 v249, v250, 2, v249
  v_bfe_u32 v250, v1, 2, 2
  v_add_u32 v249, v249, v250
  ds_read_b64_tr_b16 v[52:53], v5 offset:38912
  ds_read_b64_tr_b16 v[54:55], v5 offset:39168
  s_add_u32 m0, s34, 24576
  s_add_u32 s30, s93, 1769472
  buffer_load_dwordx4 v2, s[8:11], s30 offen lds
  v_mfma_f32_32x32x16_bf16 v[32:47], v[56:59], v[96:99], v[32:47]
  v_lshlrev_b32 v249, 7, v249
  v_and_b32 v250, 3, v1
  v_lshl_add_u32 v249, v250, 3, v249
  ds_read_b64_tr_b16 v[56:57], v5 offset:40960
  ds_read_b64_tr_b16 v[58:59], v5 offset:41216
  s_waitcnt lgkmcnt(10)
  v_mfma_f32_32x32x16_bf16 v[32:47], v[60:63], v[100:103], v[32:47]
  v_add_u32 v249, s38, v249
  s_cmp_ge_u32 s18, 3
  s_cselect_b32 s57, 2, 1
  s_cmp_lt_u32 s100, 1296
  s_cselect_b32 s57, s57, 0
  ds_read_b64_tr_b16 v[60:61], v5 offset:43008
  ds_read_b64_tr_b16 v[62:63], v5 offset:43264
  s_add_u32 m0, s34, 32768
  s_add_u32 s30, s93, 2359296
  buffer_load_dwordx4 v2, s[8:11], s30 offen lds
  s_waitcnt lgkmcnt(10)
  v_mfma_f32_32x32x16_bf16 v[32:47], v[64:67], v[104:107], v[32:47]
  s_lshl_b32 s28, s19, 7
  v_lshlrev_b32 v72, 4, v14
  v_add_u32 v72, s28, v72
  v_add_u32 v72, 147456, v72
  ds_read_b128 v[240:243], v72 offset:0
  ds_read_b128 v[244:247], v72 offset:32
  ds_read_b64_tr_b16 v[64:65], v5 offset:45056
  ds_read_b64_tr_b16 v[66:67], v5 offset:45312
  s_waitcnt lgkmcnt(12)
  v_mfma_f32_32x32x16_bf16 v[32:47], v[68:71], v[108:111], v[32:47]
  ds_read_b128 v[76:79], v72 offset:64
  ds_read_b128 v[84:87], v72 offset:96
  s_waitcnt lgkmcnt(0)
  v_mul_f32 v16, v16, v240
  v_mul_f32 v17, v17, v241
  ds_read_b64_tr_b16 v[68:69], v5 offset:47104
  ds_read_b64_tr_b16 v[70:71], v5 offset:47360
  v_mfma_f32_32x32x16_bf16 v[32:47], v[48:51], v[112:115], v[32:47]
  v_mul_f32 v18, v18, v242
  v_mul_f32 v19, v19, v243
  v_mul_f32 v20, v20, v244
  v_mul_f32 v21, v21, v245
  v_mul_f32 v22, v22, v246
  ds_read_b64_tr_b16 v[48:49], v6 offset:0
  ds_read_b64_tr_b16 v[50:51], v6 offset:256
  v_mfma_f32_32x32x16_bf16 v[32:47], v[52:55], v[116:119], v[32:47]
  v_mul_f32 v23, v23, v247
  v_mul_f32 v24, v24, v76
  v_mul_f32 v25, v25, v77
  v_mul_f32 v26, v26, v78
  v_mul_f32 v27, v27, v79
  ds_read_b64_tr_b16 v[52:53], v6 offset:2048
  ds_read_b64_tr_b16 v[54:55], v6 offset:2304
  v_mfma_f32_32x32x16_bf16 v[32:47], v[56:59], v[120:123], v[32:47]
  v_mul_f32 v28, v28, v84
  v_mul_f32 v29, v29, v85
  v_mul_f32 v30, v30, v86
  v_mul_f32 v31, v31, v87
  v_cvt_pk_f16_f32 v80, v16, v17
  s_and_b32 s28, s2, 0xc3
  v_and_b32 v253, 15, v1
  v_lshlrev_b32 v253, 2, v253
  v_or_b32 v253, s28, v253
  v_lshlrev_b32 v253, 4, v253
  v_add_u32 v253, 0x33e4000, v253
  s_cmp_lt_u32 s18, 5
  s_cbranch_scc0 L_skip_11
  buffer_load_dword v254, v253, s[4:7], 0 offen sc1
L_skip_11:
  ds_read_b64_tr_b16 v[56:57], v6 offset:4096
  ds_read_b64_tr_b16 v[58:59], v6 offset:4352
  v_mfma_f32_32x32x16_bf16 v[32:47], v[60:63], v[124:127], v[32:47]
  v_cvt_pk_f16_f32 v81, v18, v19
  v_cvt_pk_f16_f32 v82, v20, v21
  v_cvt_pk_f16_f32 v83, v22, v23
  v_cvt_pk_f16_f32 v84, v24, v25
  v_cvt_pk_f16_f32 v85, v26, v27
  s_lshl_b32 s28, s18, 4
  v_and_b32 v251, 15, v1
  v_add_u32 v251, s28, v251
  v_lshrrev_b32 v252, 4, v1
  ds_read_b64_tr_b16 v[60:61], v6 offset:6144
  ds_read_b64_tr_b16 v[62:63], v6 offset:6400
  v_mfma_f32_32x32x16_bf16 v[32:47], v[64:67], v[128:131], v[32:47]
  v_cvt_pk_f16_f32 v86, v28, v29
  v_cvt_pk_f16_f32 v87, v30, v31
  s_nop 0
  s_nop 0
  v_permlane32_swap_b32 v80, v82
  v_mul_u32_u24 v252, 4608, v252
  v_lshl_add_u32 v252, v251, 4, v252
  ds_read_b64_tr_b16 v[64:65], v6 offset:8192
  ds_read_b64_tr_b16 v[66:67], v6 offset:8448
  s_waitcnt lgkmcnt(10)
  v_mfma_f32_32x32x16_bf16 v[32:47], v[68:71], v[132:135], v[32:47]
  v_permlane32_swap_b32 v81, v83
  v_permlane32_swap_b32 v84, v86
  v_permlane32_swap_b32 v85, v87
  buffer_store_dwordx4 v[80:83], v12, s[4:7], 0 offen offset:0 sc1
  buffer_store_dwordx4 v[84:87], v12, s[4:7], 0 offen offset:32 sc1
  v_cmp_gt_u32 vcc, 72, v251
  s_nop 1
  v_cndmask_b32 v252, v15, v252, vcc
  ds_read_b64_tr_b16 v[68:69], v6 offset:10240
  ds_read_b64_tr_b16 v[70:71], v6 offset:10496
  s_waitcnt lgkmcnt(10)
  v_mfma_f32_32x32x16_bf16 v[32:47], v[48:51], v[136:139], v[32:47]
  s_waitcnt vmcnt(8)
  s_barrier
  ds_read_b64_tr_b16 v[48:49], v6 offset:12288
  ds_read_b64_tr_b16 v[50:51], v6 offset:12544
  s_waitcnt lgkmcnt(10)
  v_mfma_f32_32x32x16_bf16 v[32:47], v[52:55], v[140:143], v[32:47]
  s_cmp_eq_u32 s57, 1
  s_cbranch_scc0 L_skip_12
  s_add_u32 m0, s38, 0
  s_add_u32 s28, s3, 0
  buffer_load_dwordx4 v248, s[52:55], s28 offen lds
  s_add_u32 m0, s38, 1024
  s_add_u32 s28, s3, 9216
  buffer_load_dwordx4 v248, s[52:55], s28 offen lds
L_skip_12:
  ds_read_b64_tr_b16 v[52:53], v6 offset:14336
  ds_read_b64_tr_b16 v[54:55], v6 offset:14592
  s_add_u32 m0, s34, 36864
  s_add_u32 s30, s93, 2654208
  buffer_load_dwordx4 v2, s[8:11], s30 offen lds
  s_waitcnt lgkmcnt(10)
  v_mfma_f32_32x32x16_bf16 v[32:47], v[56:59], v[144:147], v[32:47]
  s_cmp_eq_u32 s57, 1
  s_cbranch_scc0 L_skip_13
  s_add_u32 m0, s38, 2048
  s_add_u32 s28, s3, 18432
  buffer_load_dwordx4 v248, s[52:55], s28 offen lds
  s_add_u32 m0, s38, 3072
  s_add_u32 s28, s3, 27648
  buffer_load_dwordx4 v248, s[52:55], s28 offen lds
L_skip_13:
  ds_read_b64_tr_b16 v[56:57], v6 offset:16384
  ds_read_b64_tr_b16 v[58:59], v6 offset:16640
  s_waitcnt lgkmcnt(10)
  v_mfma_f32_32x32x16_bf16 v[32:47], v[60:63], v[148:151], v[32:47]
  ds_read_b64_tr_b16 v[60:61], v6 offset:18432
  ds_read_b64_tr_b16 v[62:63], v6 offset:18688
  s_add_u32 m0, s34, 45056
  s_add_u32 s30, s93, 3244032
  buffer_load_dwordx4 v2, s[8:11], s30 offen lds
  s_waitcnt lgkmcnt(10)
  v_mfma_f32_32x32x16_bf16 v[32:47], v[64:67], v[152:155], v[32:47]
  ds_read_b64_tr_b16 v[64:65], v6 offset:20480
  ds_read_b64_tr_b16 v[66:67], v6 offset:20736
  s_waitcnt lgkmcnt(10)
  v_mfma_f32_32x32x16_bf16 v[32:47], v[68:71], v[156:159], v[32:47]
  ds_read_b64_tr_b16 v[68:69], v6 offset:22528
  ds_read_b64_tr_b16 v[70:71], v6 offset:22784
  s_add_u32 m0, s34, 53248
  s_add_u32 s30, s93, 3833856
  buffer_load_dwordx4 v2, s[8:11], s30 offen lds
  s_waitcnt lgkmcnt(10)
  v_mfma_f32_32x32x16_bf16 v[32:47], v[48:51], v[160:163], v[32:47]
  ds_read_b64_tr_b16 v[48:49], v6 offset:24576
  ds_read_b64_tr_b16 v[50:51], v6 offset:24832
  s_waitcnt lgkmcnt(10)
  v_mfma_f32_32x32x16_bf16 v[32:47], v[52:55], v[164:167], v[32:47]
  ds_read_b64_tr_b16 v[52:53], v6 offset:26624
  ds_read_b64_tr_b16 v[54:55], v6 offset:26880
  s_add_u32 m0, s34, 61440
  s_add_u32 s30, s93, 4423680
  buffer_load_dwordx4 v2, s[8:11], s30 offen lds
  s_waitcnt lgkmcnt(10)
  v_mfma_f32_32x32x16_bf16 v[32:47], v[56:59], v[168:171], v[32:47]
  ds_read_b64_tr_b16 v[56:57], v6 offset:28672
  ds_read_b64_tr_b16 v[58:59], v6 offset:28928
  s_waitcnt lgkmcnt(10)
  v_mfma_f32_32x32x16_bf16 v[32:47], v[60:63], v[172:175], v[32:47]
  ds_read_b64_tr_b16 v[60:61], v6 offset:30720
  ds_read_b64_tr_b16 v[62:63], v6 offset:30976
  s_add_u32 m0, s34, 69632
  s_add_u32 s30, s93, 5013504
  buffer_load_dwordx4 v2, s[8:11], s30 offen lds
  s_waitcnt lgkmcnt(10)
  v_mfma_f32_32x32x16_bf16 v[32:47], v[64:67], v[176:179], v[32:47]
  ds_read_b64_tr_b16 v[64:65], v6 offset:32768
  ds_read_b64_tr_b16 v[66:67], v6 offset:33024
  s_waitcnt lgkmcnt(10)
  v_mfma_f32_32x32x16_bf16 v[32:47], v[68:71], v[180:183], v[32:47]
  ds_read_b64_tr_b16 v[68:69], v6 offset:34816
  ds_read_b64_tr_b16 v[70:71], v6 offset:35072
  s_waitcnt lgkmcnt(10)
  v_mfma_f32_32x32x16_bf16 v[32:47], v[48:51], v[184:187], v[32:47]
  ds_read_b64_tr_b16 v[48:49], v6 offset:36864
  ds_read_b64_tr_b16 v[50:51], v6 offset:37120
  s_waitcnt lgkmcnt(10)
  v_mfma_f32_32x32x16_bf16 v[32:47], v[52:55], v[188:191], v[32:47]
  s_cmp_lt_u32 s18, 5
  s_cbranch_scc0 L_csskip_14
  s_waitcnt vmcnt(7)
  v_cmp_eq_u32 vcc, s59, v254
  s_nop 1
  s_cmp_eq_u64 vcc, -1
  s_cbranch_scc1 L_csok_16
  s_mov_b32 s33, 0
L_cspoll_15:
  s_sleep 4
  buffer_load_dword v254, v253, s[4:7], 0 offen sc1
  s_waitcnt vmcnt(0)
  v_cmp_eq_u32 vcc, s59, v254
  s_nop 1
  s_cmp_eq_u64 vcc, -1
  s_cbranch_scc1 L_csok_16
  s_add_u32 s33, s33, 1
  s_cmp_lt_u32 s33, 0x40000
  s_cbranch_scc1 L_cspoll_15
L_csok_16:
  s_mul_i32 s28, s17, 18432
  s_add_u32 s28, s28, 0x33f4000
  s_mul_i32 s29, s17, 576
  v_lshlrev_b32 v253, 3, v251
  buffer_load_dwordx2 v[254:255], v253, s[12:15], s29 offen
  buffer_load_dwordx4 v[72:75], v252, s[4:7], s28 offen offset:0 sc1
  buffer_load_dwordx4 v[76:79], v252, s[4:7], s28 offen offset:1152 sc1
  buffer_load_dwordx4 v[80:83], v252, s[4:7], s28 offen offset:2304 sc1
  buffer_load_dwordx4 v[84:87], v252, s[4:7], s28 offen offset:3456 sc1
L_csskip_14:
  ds_read_b64_tr_b16 v[52:53], v6 offset:38912
  ds_read_b64_tr_b16 v[54:55], v6 offset:39168
  s_waitcnt lgkmcnt(10)
  v_mfma_f32_32x32x16_bf16 v[32:47], v[56:59], v[192:195], v[32:47]
  ds_read_b64_tr_b16 v[56:57], v6 offset:40960
  ds_read_b64_tr_b16 v[58:59], v6 offset:41216
  s_waitcnt lgkmcnt(10)
  v_mfma_f32_32x32x16_bf16 v[32:47], v[60:63], v[196:199], v[32:47]
  ds_read_b64_tr_b16 v[60:61], v6 offset:43008
  ds_read_b64_tr_b16 v[62:63], v6 offset:43264
  s_waitcnt lgkmcnt(10)
  v_mfma_f32_32x32x16_bf16 v[32:47], v[64:67], v[200:203], v[32:47]
  ds_read_b64_tr_b16 v[64:65], v6 offset:45056
  ds_read_b64_tr_b16 v[66:67], v6 offset:45312
  s_waitcnt lgkmcnt(10)
  v_mfma_f32_32x32x16_bf16 v[32:47], v[68:71], v[204:207], v[32:47]
  s_waitcnt vmcnt(4)
  ds_read_b64_tr_b16 v[240:241], v249 offset:0
  ds_read_b64_tr_b16 v[242:243], v249 offset:1024
  ds_read_b64_tr_b16 v[68:69], v6 offset:47104
  ds_read_b64_tr_b16 v[70:71], v6 offset:47360
  s_waitcnt lgkmcnt(12)
  v_mfma_f32_32x32x16_bf16 v[32:47], v[48:51], v[208:211], v[32:47]
  ds_read_b64_tr_b16 v[244:245], v249 offset:32
  ds_read_b64_tr_b16 v[246:247], v249 offset:1056
  s_waitcnt vmcnt(7)
  s_barrier
  ds_read_b64_tr_b16 v[48:49], v4 offset:0
  ds_read_b64_tr_b16 v[50:51], v4 offset:256
  s_waitcnt lgkmcnt(14)
  v_mfma_f32_32x32x16_bf16 v[32:47], v[52:55], v[212:215], v[32:47]
  s_waitcnt lgkmcnt(2)
  s_cmp_eq_u32 s57, 1
  s_cbranch_scc0 L_skip_17
  buffer_store_dwordx4 v[240:243], v3, s[4:7], s32 offen offset:0 sc1
  buffer_store_dwordx4 v[244:247], v3, s[4:7], s32 offen offset:1024 sc1
L_skip_17:
  s_nop 0
  ds_read_b64_tr_b16 v[52:53], v4 offset:2048
  ds_read_b64_tr_b16 v[54:55], v4 offset:2304
  s_add_u32 m0, s34, 73728
  s_add_u32 s30, s94, 0
  buffer_load_dwordx4 v2, s[8:11], s30 offen lds
  v_mfma_f32_32x32x16_bf16 v[32:47], v[56:59], v[216:219], v[32:47]
  ds_read_b64_tr_b16 v[240:241], v249 offset:64
  ds_read_b64_tr_b16 v[242:243], v249 offset:1088
  ds_read_b64_tr_b16 v[56:57], v4 offset:4096
  ds_read_b64_tr_b16 v[58:59], v4 offset:4352
  v_mfma_f32_32x32x16_bf16 v[32:47], v[60:63], v[220:223], v[32:47]
  ds_read_b64_tr_b16 v[244:245], v249 offset:96
  ds_read_b64_tr_b16 v[246:247], v249 offset:1120
  s_waitcnt lgkmcnt(0)
  ds_read_b64_tr_b16 v[60:61], v4 offset:6144
  ds_read_b64_tr_b16 v[62:63], v4 offset:6400
  s_add_u32 m0, s34, 81920
  s_add_u32 s30, s94, 589824
  buffer_load_dwordx4 v2, s[8:11], s30 offen lds
  v_mfma_f32_32x32x16_bf16 v[32:47], v[64:67], v[224:227], v[32:47]
  s_cmp_eq_u32 s57, 1
  s_cbranch_scc0 L_skip_18
  buffer_store_dwordx4 v[240:243], v3, s[4:7], s32 offen offset:2048 sc1
  buffer_store_dwordx4 v[244:247], v3, s[4:7], s32 offen offset:3072 sc1
L_skip_18:
  s_nop 0
  ds_read_b64_tr_b16 v[64:65], v4 offset:8192
  ds_read_b64_tr_b16 v[66:67], v4 offset:8448
  v_mfma_f32_32x32x16_bf16 v[32:47], v[68:71], v[228:231], v[32:47]
  ds_read_b64_tr_b16 v[68:69], v4 offset:10240
  ds_read_b64_tr_b16 v[70:71], v4 offset:10496
  s_add_u32 m0, s34, 90112
  s_add_u32 s30, s94, 1179648
  buffer_load_dwordx4 v2, s[8:11], s30 offen lds
  v_mfma_f32_32x32x16_bf16 v[16:31], v[48:51], v[88:91], 0
  ds_read_b64_tr_b16 v[48:49], v4 offset:12288
  ds_read_b64_tr_b16 v[50:51], v4 offset:12544
  v_mfma_f32_32x32x16_bf16 v[16:31], v[52:55], v[92:95], v[16:31]
  ds_read_b64_tr_b16 v[52:53], v4 offset:14336
  ds_read_b64_tr_b16 v[54:55], v4 offset:14592
  s_add_u32 m0, s34, 98304
  s_add_u32 s30, s94, 1769472
  buffer_load_dwordx4 v2, s[8:11], s30 offen lds
  v_mfma_f32_32x32x16_bf16 v[16:31], v[56:59], v[96:99], v[16:31]
  ds_read_b64_tr_b16 v[56:57], v4 offset:16384
  ds_read_b64_tr_b16 v[58:59], v4 offset:16640
  s_waitcnt lgkmcnt(10)
  v_mfma_f32_32x32x16_bf16 v[16:31], v[60:63], v[100:103], v[16:31]
  s_waitcnt vmcnt(4)
  v_add_f32 v72, v72, v76
  v_add_f32 v73, v73, v77
  v_add_f32 v74, v74, v78
  v_add_f32 v75, v75, v79
  v_add_f32 v72, v72, v80
  v_add_f32 v73, v73, v81
  v_add_f32 v74, v74, v82
  v_add_f32 v75, v75, v83
  ds_read_b64_tr_b16 v[60:61], v4 offset:18432
  ds_read_b64_tr_b16 v[62:63], v4 offset:18688
  s_add_u32 m0, s34, 106496
  s_add_u32 s30, s94, 2359296
  buffer_load_dwordx4 v2, s[8:11], s30 offen lds
  s_waitcnt lgkmcnt(10)
  v_mfma_f32_32x32x16_bf16 v[16:31], v[64:67], v[104:107], v[16:31]
  v_add_f32 v72, v72, v84
  v_add_f32 v73, v73, v85
  v_add_f32 v74, v74, v86
  v_add_f32 v75, v75, v87
  v_mov_b32 v76, v72
  v_mov_b32 v77, v73
  v_mov_b32 v78, v74
  v_mov_b32 v79, v75
  ds_read_b64_tr_b16 v[64:65], v4 offset:20480
  ds_read_b64_tr_b16 v[66:67], v4 offset:20736
  s_waitcnt lgkmcnt(10)
  v_mfma_f32_32x32x16_bf16 v[16:31], v[68:71], v[108:111], v[16:31]
  s_nop 0
  v_permlane32_swap_b32 v72, v76
  v_permlane32_swap_b32 v73, v77
  v_permlane32_swap_b32 v74, v78
  v_permlane32_swap_b32 v75, v79
  v_add_f32 v72, v72, v76
  v_add_f32 v73, v73, v77
  v_add_f32 v74, v74, v78
  v_add_f32 v75, v75, v79
  ds_read_b64_tr_b16 v[68:69], v4 offset:22528
  ds_read_b64_tr_b16 v[70:71], v4 offset:22784
  s_waitcnt lgkmcnt(10)
  v_mfma_f32_32x32x16_bf16 v[16:31], v[48:51], v[112:115], v[16:31]
  v_mov_b32 v76, v72
  v_mov_b32 v77, v73
  v_mov_b32 v78, v74
  v_mov_b32 v79, v75
  s_nop 0
  v_permlane16_swap_b32 v72, v76
  v_permlane16_swap_b32 v73, v77
  v_permlane16_swap_b32 v74, v78
  ds_read_b64_tr_b16 v[48:49], v4 offset:24576
  ds_read_b64_tr_b16 v[50:51], v4 offset:24832
  s_waitcnt lgkmcnt(10)
  v_mfma_f32_32x32x16_bf16 v[16:31], v[52:55], v[116:119], v[16:31]
  v_permlane16_swap_b32 v75, v79
  v_add_f32 v72, v72, v76
  v_add_f32 v73, v73, v77
  v_add_f32 v74, v74, v78
  v_add_f32 v75, v75, v79
  v_lshlrev_b32 v76, 16, v254
  v_and_b32 v77, 0xffff0000, v254
  v_lshlrev_b32 v78, 16, v255
  v_and_b32 v79, 0xffff0000, v255
  ds_read_b64_tr_b16 v[52:53], v4 offset:26624
  ds_read_b64_tr_b16 v[54:55], v4 offset:26880
  s_waitcnt lgkmcnt(10)
  v_mfma_f32_32x32x16_bf16 v[16:31], v[56:59], v[120:123], v[16:31]
  v_cvt_pk_bf16_f32 v253, v72, v72
  v_lshlrev_b32 v253, 16, v253
  v_sub_f32 v253, v72, v253
  v_cvt_pk_bf16_f32 v80, v72, v253
  v_and_b32 v72, 0xffff0000, v80
  v_sub_f32 v253, v253, v72
  v_cvt_pk_bf16_f32 v81, v253, v76
  v_cvt_pk_bf16_f32 v253, v73, v73
  ds_read_b64_tr_b16 v[56:57], v4 offset:28672
  ds_read_b64_tr_b16 v[58:59], v4 offset:28928
  s_waitcnt lgkmcnt(10)
  v_mfma_f32_32x32x16_bf16 v[16:31], v[60:63], v[124:127], v[16:31]
  v_lshlrev_b32 v253, 16, v253
  v_sub_f32 v253, v73, v253
  v_cvt_pk_bf16_f32 v82, v73, v253
  v_and_b32 v73, 0xffff0000, v82
  v_sub_f32 v253, v253, v73
  v_cvt_pk_bf16_f32 v83, v253, v77
  v_cvt_pk_bf16_f32 v253, v74, v74
  v_lshlrev_b32 v253, 16, v253
  v_sub_f32 v253, v74, v253
  ds_read_b64_tr_b16 v[60:61], v4 offset:30720
  ds_read_b64_tr_b16 v[62:63], v4 offset:30976
  s_waitcnt lgkmcnt(10)
  v_mfma_f32_32x32x16_bf16 v[16:31], v[64:67], v[128:131], v[16:31]
  v_cvt_pk_bf16_f32 v84, v74, v253
  v_and_b32 v74, 0xffff0000, v84
  v_sub_f32 v253, v253, v74
  v_cvt_pk_bf16_f32 v85, v253, v78
  v_cvt_pk_bf16_f32 v253, v75, v75
  v_lshlrev_b32 v253, 16, v253
  v_sub_f32 v253, v75, v253
  v_cvt_pk_bf16_f32 v86, v75, v253
  ds_read_b64_tr_b16 v[64:65], v4 offset:32768
  ds_read_b64_tr_b16 v[66:67], v4 offset:33024
  s_waitcnt lgkmcnt(10)
  v_mfma_f32_32x32x16_bf16 v[16:31], v[68:71], v[132:135], v[16:31]
  v_and_b32 v75, 0xffff0000, v86
  v_sub_f32 v253, v253, v75
  v_cvt_pk_bf16_f32 v87, v253, v79
  v_lshlrev_b32 v253, 5, v251
  v_add_u32 v253, 147968, v253
  v_and_b32 v252, 48, v1
  v_lshl_add_u32 v252, v252, 3, v251
  v_cmp_gt_u32 vcc, 72, v252
  s_and_saveexec_b64 s[28:29], vcc
  ds_write_b128 v253, v[80:83]
  ds_write_b128 v253, v[84:87] offset:16
  s_mov_b64 exec, -1
  ds_read_b64_tr_b16 v[68:69], v4 offset:34816
  ds_read_b64_tr_b16 v[70:71], v4 offset:35072
  s_waitcnt lgkmcnt(12)
  v_mfma_f32_32x32x16_bf16 v[16:31], v[48:51], v[136:139], v[16:31]
  s_waitcnt vmcnt(5)
  s_waitcnt lgkmcnt(2)
  s_barrier
  ds_read_b64_tr_b16 v[48:49], v4 offset:36864
  ds_read_b64_tr_b16 v[50:51], v4 offset:37120
  v_mfma_f32_32x32x16_bf16 v[16:31], v[52:55], v[140:143], v[16:31]
  s_add_u32 s37, s96, 0
  s_and_b32 s37, s37, 3
  s_lshl_b32 s37, s37, 1
  s_add_u32 s37, s37, s27
  s_add_u32 s37, s37, 0
  s_lshl_b32 s28, s37, 8
  v_mov_b32 v15, s28
  v_cndmask_b32 v15, v15, 0, s[24:25]
  v_add_u32 v15, v15, v8
  ds_read_b64 v[236:237], v15
  s_waitcnt lgkmcnt(0)
  s_cmp_eq_u32 s57, 2
  s_cbranch_scc0 L_skip_19
  s_add_u32 m0, s38, 0
  s_add_u32 s28, s3, 0
  buffer_load_dwordx4 v248, s[52:55], s28 offen lds
  s_add_u32 m0, s38, 1024
  s_add_u32 s28, s3, 9216
  buffer_load_dwordx4 v248, s[52:55], s28 offen lds
L_skip_19:
  ds_read_b64_tr_b16 v[52:53], v4 offset:38912
  ds_read_b64_tr_b16 v[54:55], v4 offset:39168
  s_add_u32 m0, s34, 110592
  s_add_u32 s30, s94, 2654208
  buffer_load_dwordx4 v2, s[8:11], s30 offen lds
  v_mfma_f32_32x32x16_bf16 v[16:31], v[56:59], v[144:147], v[16:31]
  v_mfma_f32_32x32x16_bf16 v[32:47], v[236:239], v[232:235], v[32:47]
  s_cmp_eq_u32 s57, 2
  s_cbranch_scc0 L_skip_20
  s_add_u32 m0, s38, 2048
  s_add_u32 s28, s3, 18432
  buffer_load_dwordx4 v248, s[52:55], s28 offen lds
  s_add_u32 m0, s38, 3072
  s_add_u32 s28, s3, 27648
  buffer_load_dwordx4 v248, s[52:55], s28 offen lds
L_skip_20:
  ds_read_b64_tr_b16 v[56:57], v4 offset:40960
  ds_read_b64_tr_b16 v[58:59], v4 offset:41216
  v_mfma_f32_32x32x16_bf16 v[16:31], v[60:63], v[148:151], v[16:31]
  ds_read_b64_tr_b16 v[60:61], v4 offset:43008
  ds_read_b64_tr_b16 v[62:63], v4 offset:43264
  s_add_u32 m0, s34, 118784
  s_add_u32 s30, s94, 3244032
  buffer_load_dwordx4 v2, s[8:11], s30 offen lds
  v_mfma_f32_32x32x16_bf16 v[16:31], v[64:67], v[152:155], v[16:31]
  ds_read_b64_tr_b16 v[64:65], v4 offset:45056
  ds_read_b64_tr_b16 v[66:67], v4 offset:45312
  v_mfma_f32_32x32x16_bf16 v[16:31], v[68:71], v[156:159], v[16:31]
  v_mul_f32 v72, v32, v32
  v_mul_f32 v73, v33, v33
  v_mul_f32 v74, v34, v34
  v_mul_f32 v75, v35, v35
  v_mul_f32 v76, v36, v36
  v_mul_f32 v77, v37, v37
  v_mul_f32 v78, v38, v38
  ds_read_b64_tr_b16 v[68:69], v4 offset:47104
  ds_read_b64_tr_b16 v[70:71], v4 offset:47360
  s_add_u32 m0, s34, 126976
  s_add_u32 s30, s94, 3833856
  buffer_load_dwordx4 v2, s[8:11], s30 offen lds
  v_mfma_f32_32x32x16_bf16 v[16:31], v[48:51], v[160:163], v[16:31]
  v_mul_f32 v79, v39, v39
  v_fma_f32 v72, v72, v10, v9
  v_fma_f32 v73, v73, v10, v9
  v_fma_f32 v74, v74, v10, v9
  v_fma_f32 v75, v75, v10, v9
  v_fma_f32 v76, v76, v10, v9
  ds_read_b64_tr_b16 v[48:49], v5 offset:0
  ds_read_b64_tr_b16 v[50:51], v5 offset:256
  s_waitcnt lgkmcnt(10)
  v_mfma_f32_32x32x16_bf16 v[16:31], v[52:55], v[164:167], v[16:31]
  v_fma_f32 v77, v77, v10, v9
  v_fma_f32 v78, v78, v10, v9
  v_fma_f32 v79, v79, v10, v9
  v_mul_f32 v72, v32, v72
  v_mul_f32 v73, v33, v73
  v_mul_f32 v74, v34, v74
  v_mul_f32 v75, v35, v75
  ds_read_b64_tr_b16 v[52:53], v5 offset:2048
  ds_read_b64_tr_b16 v[54:55], v5 offset:2304
  s_add_u32 m0, s34, 135168
  s_add_u32 s30, s94, 4423680
  buffer_load_dwordx4 v2, s[8:11], s30 offen lds
  s_waitcnt lgkmcnt(10)
  v_mfma_f32_32x32x16_bf16 v[16:31], v[56:59], v[168:171], v[16:31]
  v_mul_f32 v76, v36, v76
  v_mul_f32 v77, v37, v77
  v_mul_f32 v78, v38, v78
  v_mul_f32 v79, v39, v79
  v_exp_f32 v72, v72
  v_exp_f32 v73, v73
  ds_read_b64_tr_b16 v[56:57], v5 offset:4096
  ds_read_b64_tr_b16 v[58:59], v5 offset:4352
  s_waitcnt lgkmcnt(10)
  v_mfma_f32_32x32x16_bf16 v[16:31], v[60:63], v[172:175], v[16:31]
  v_exp_f32 v74, v74
  v_exp_f32 v75, v75
  v_exp_f32 v76, v76
  v_exp_f32 v77, v77
  v_exp_f32 v78, v78
  v_exp_f32 v79, v79
  v_fma_f32 v72, v72, v11, v11
  ds_read_b64_tr_b16 v[60:61], v5 offset:6144
  ds_read_b64_tr_b16 v[62:63], v5 offset:6400
  s_add_u32 m0, s34, 143360
  s_add_u32 s30, s94, 5013504
  buffer_load_dwordx4 v2, s[8:11], s30 offen lds
  s_waitcnt lgkmcnt(10)
  v_mfma_f32_32x32x16_bf16 v[16:31], v[64:67], v[176:179], v[16:31]
  v_fma_f32 v73, v73, v11, v11
  v_fma_f32 v74, v74, v11, v11
  v_fma_f32 v75, v75, v11, v11
  v_fma_f32 v76, v76, v11, v11
  v_fma_f32 v77, v77, v11, v11
  v_fma_f32 v78, v78, v11, v11
  ds_read_b64_tr_b16 v[64:65], v5 offset:8192
  ds_read_b64_tr_b16 v[66:67], v5 offset:8448
  s_waitcnt lgkmcnt(10)
  v_mfma_f32_32x32x16_bf16 v[16:31], v[68:71], v[180:183], v[16:31]
  v_fma_f32 v79, v79, v11, v11
  v_rcp_f32 v72, v72
  v_rcp_f32 v73, v73
  v_rcp_f32 v74, v74
  v_rcp_f32 v75, v75
  v_rcp_f32 v76, v76
  ds_read_b64_tr_b16 v[68:69], v5 offset:10240
  ds_read_b64_tr_b16 v[70:71], v5 offset:10496
  s_waitcnt lgkmcnt(10)
  v_mfma_f32_32x32x16_bf16 v[16:31], v[48:51], v[184:187], v[16:31]
  v_rcp_f32 v77, v77
  v_rcp_f32 v78, v78
  v_rcp_f32 v79, v79
  v_mul_f32 v72, v32, v72
  v_mul_f32 v73, v33, v73
  v_mul_f32 v74, v34, v74
  v_mul_f32 v75, v35, v75
  ds_read_b64_tr_b16 v[48:49], v5 offset:12288
  ds_read_b64_tr_b16 v[50:51], v5 offset:12544
  s_waitcnt lgkmcnt(10)
  v_mfma_f32_32x32x16_bf16 v[16:31], v[52:55], v[188:191], v[16:31]
  v_mul_f32 v76, v36, v76
  v_mul_f32 v77, v37, v77
  v_mul_f32 v78, v38, v78
  v_mul_f32 v79, v39, v79
  v_cvt_pk_bf16_f32 v80, v72, v73
  v_cvt_pk_bf16_f32 v81, v74, v75
  v_mov_b32 v12, 151488
  v_mov_b32 v13, 1
  s_waitcnt vmcnt(5)
  s_mov_b64 exec, 1
  ds_add_u32 v12, v13 offset:40
  s_mov_b64 exec, -1
  ds_read_b64_tr_b16 v[52:53], v5 offset:14336
  ds_read_b64_tr_b16 v[54:55], v5 offset:14592
  s_waitcnt lgkmcnt(11)
  v_mfma_f32_32x32x16_bf16 v[16:31], v[56:59], v[192:195], v[16:31]
  v_cvt_pk_bf16_f32 v82, v76, v77
  v_cvt_pk_bf16_f32 v83, v78, v79
  s_add_u32 s28, s39, s37
  s_lshl_b32 s28, s28, 10
  buffer_store_dwordx4 v[80:83], v7, s[4:7], s28 offen offset:0 sc1
  v_mul_f32 v72, v40, v40
  v_mul_f32 v73, v41, v41
  v_mul_f32 v74, v42, v42
  v_mul_f32 v75, v43, v43
  s_waitcnt vmcnt(5)
  ds_read_b64_tr_b16 v[240:241], v249 offset:0
  ds_read_b64_tr_b16 v[242:243], v249 offset:1024
  ds_read_b64_tr_b16 v[56:57], v5 offset:16384
  ds_read_b64_tr_b16 v[58:59], v5 offset:16640
  s_waitcnt lgkmcnt(13)
  v_mfma_f32_32x32x16_bf16 v[16:31], v[60:63], v[196:199], v[16:31]
  v_mul_f32 v76, v44, v44
  v_mul_f32 v77, v45, v45
  v_mul_f32 v78, v46, v46
  v_mul_f32 v79, v47, v47
  v_fma_f32 v72, v72, v10, v9
  v_fma_f32 v73, v73, v10, v9
  ds_read_b64_tr_b16 v[244:245], v249 offset:32
  ds_read_b64_tr_b16 v[246:247], v249 offset:1056
  s_waitcnt lgkmcnt(0)
  ds_read_b64_tr_b16 v[60:61], v5 offset:18432
  ds_read_b64_tr_b16 v[62:63], v5 offset:18688
  v_mfma_f32_32x32x16_bf16 v[16:31], v[64:67], v[200:203], v[16:31]
  v_fma_f32 v74, v74, v10, v9
  v_fma_f32 v75, v75, v10, v9
  v_fma_f32 v76, v76, v10, v9
  v_fma_f32 v77, v77, v10, v9
  v_fma_f32 v78, v78, v10, v9
  v_fma_f32 v79, v79, v10, v9
  v_mul_f32 v72, v40, v72
  s_cmp_eq_u32 s57, 2
  s_cbranch_scc0 L_skip_21
  buffer_store_dwordx4 v[240:243], v3, s[4:7], s32 offen offset:0 sc1
  buffer_store_dwordx4 v[244:247], v3, s[4:7], s32 offen offset:1024 sc1
L_skip_21:
  s_nop 0
  ds_read_b64_tr_b16 v[240:241], v249 offset:64
  ds_read_b32 v255, v12 offset:40
  ds_read_b64_tr_b16 v[64:65], v5 offset:20480
  ds_read_b64_tr_b16 v[66:67], v5 offset:20736
  v_mfma_f32_32x32x16_bf16 v[16:31], v[68:71], v[204:207], v[16:31]
  v_mul_f32 v73, v41, v73
  v_mul_f32 v74, v42, v74
  v_mul_f32 v75, v43, v75
  v_mul_f32 v76, v44, v76
  v_mul_f32 v77, v45, v77
  v_mul_f32 v78, v46, v78
  ds_read_b64_tr_b16 v[242:243], v249 offset:1088
  ds_read_b64_tr_b16 v[244:245], v249 offset:96
  ds_read_b64_tr_b16 v[246:247], v249 offset:1120
  ds_read_b64_tr_b16 v[68:69], v5 offset:22528
  ds_read_b64_tr_b16 v[70:71], v5 offset:22784
  v_mfma_f32_32x32x16_bf16 v[16:31], v[48:51], v[208:211], v[16:31]
  v_mul_f32 v79, v47, v79
  v_exp_f32 v72, v72
  v_exp_f32 v73, v73
  v_exp_f32 v74, v74
  v_exp_f32 v75, v75
  v_exp_f32 v76, v76
  s_waitcnt lgkmcnt(2)
  s_cmp_eq_u32 s57, 2
  s_cbranch_scc0 L_skip_22
  buffer_store_dwordx4 v[240:243], v3, s[4:7], s32 offen offset:2048 sc1
  buffer_store_dwordx4 v[244:247], v3, s[4:7], s32 offen offset:3072 sc1
L_skip_22:
  s_nop 0
  v_readfirstlane_b32 s28, v255
  s_cmp_eq_u32 s28, 8
  s_cbranch_scc1 L_wok_23
  s_mov_b32 s33, 0
L_wlp_24:
  ds_read_b32 v255, v12 offset:40
  s_waitcnt lgkmcnt(0)
  v_readfirstlane_b32 s28, v255
  s_cmp_eq_u32 s28, 8
  s_cbranch_scc1 L_wok_23
  s_add_u32 s33, s33, 1
  s_cmp_lt_u32 s33, 0x100000
  s_cbranch_scc1 L_wlp_24
L_wok_23:
  s_cmp_eq_u32 s18, 0
  s_cbranch_scc0 L_noall_25
  s_add_u32 s28, s59, 0
  v_mov_b32 v253, 4096
  v_mov_b32 v254, s28
  s_mov_b64 exec, 1
  buffer_store_dword v254, v253, s[4:7], s101 offen sc1
  s_mov_b64 exec, -1
L_noall_25:
  ds_read_b64_tr_b16 v[48:49], v5 offset:24576
  ds_read_b64_tr_b16 v[50:51], v5 offset:24832
  v_mfma_f32_32x32x16_bf16 v[16:31], v[52:55], v[212:215], v[16:31]
  v_exp_f32 v77, v77
  v_exp_f32 v78, v78
  v_exp_f32 v79, v79
  v_fma_f32 v72, v72, v11, v11
  v_fma_f32 v73, v73, v11, v11
  v_fma_f32 v74, v74, v11, v11
  v_fma_f32 v75, v75, v11, v11
  ds_read_b64_tr_b16 v[52:53], v5 offset:26624
  ds_read_b64_tr_b16 v[54:55], v5 offset:26880
  s_add_u32 m0, s34, 0
  s_add_u32 s30, s95, 0
  buffer_load_dwordx4 v2, s[8:11], s30 offen lds
  v_mfma_f32_32x32x16_bf16 v[16:31], v[56:59], v[216:219], v[16:31]
  v_fma_f32 v76, v76, v11, v11
  v_fma_f32 v77, v77, v11, v11
  v_fma_f32 v78, v78, v11, v11
  v_fma_f32 v79, v79, v11, v11
  v_rcp_f32 v72, v72
  v_rcp_f32 v73, v73
  s_add_u32 s36, s96, 1
  s_and_b32 s36, s36, 3
  s_lshl_b32 s36, s36, 1
  s_add_u32 s36, s36, s27
  s_add_u32 s36, s36, 0
  s_lshl_b32 s28, s36, 8
  v_mov_b32 v15, s28
  v_cndmask_b32 v15, v15, 0, s[24:25]
  v_add_u32 v15, v15, v8
  ds_read_b64 v[236:237], v15
  ds_read_b64_tr_b16 v[56:57], v5 offset:28672
  ds_read_b64_tr_b16 v[58:59], v5 offset:28928
  v_mfma_f32_32x32x16_bf16 v[16:31], v[60:63], v[220:223], v[16:31]
  v_rcp_f32 v74, v74
  v_rcp_f32 v75, v75
  v_rcp_f32 v76, v76
  v_rcp_f32 v77, v77
  v_rcp_f32 v78, v78
  v_rcp_f32 v79, v79
  v_mul_f32 v72, v40, v72
  ds_read_b64_tr_b16 v[60:61], v5 offset:30720
  ds_read_b64_tr_b16 v[62:63], v5 offset:30976
  s_add_u32 m0, s34, 8192
  s_add_u32 s30, s95, 589824
  buffer_load_dwordx4 v2, s[8:11], s30 offen lds
  v_mfma_f32_32x32x16_bf16 v[16:31], v[64:67], v[224:227], v[16:31]
  v_mul_f32 v73, v41, v73
  v_mul_f32 v74, v42, v74
  v_mul_f32 v75, v43, v75
  v_mul_f32 v76, v44, v76
  v_mul_f32 v77, v45, v77
  v_mul_f32 v78, v46, v78
  ds_read_b64_tr_b16 v[64:65], v5 offset:32768
  ds_read_b64_tr_b16 v[66:67], v5 offset:33024
  s_waitcnt lgkmcnt(11)
  v_mfma_f32_32x32x16_bf16 v[16:31], v[68:71], v[228:231], v[16:31]
  v_mul_f32 v79, v47, v79
  v_cvt_pk_bf16_f32 v84, v72, v73
  v_cvt_pk_bf16_f32 v85, v74, v75
  v_cvt_pk_bf16_f32 v86, v76, v77
  v_cvt_pk_bf16_f32 v87, v78, v79
  s_add_u32 s28, s39, s37
  s_lshl_b32 s28, s28, 10
  buffer_store_dwordx4 v[84:87], v7, s[4:7], s28 offen offset:512 sc1
  s_waitcnt lgkmcnt(6)
  v_mfma_f32_32x32x16_bf16 v[16:31], v[236:239], v[232:235], v[16:31]
  ds_read_b64_tr_b16 v[68:69], v5 offset:34816
  ds_read_b64_tr_b16 v[70:71], v5 offset:35072
  s_add_u32 m0, s34, 16384
  s_add_u32 s30, s95, 1179648
  buffer_load_dwordx4 v2, s[8:11], s30 offen lds
  v_mfma_f32_32x32x16_bf16 v[32:47], v[48:51], v[88:91], 0
  ds_read_b64_tr_b16 v[48:49], v5 offset:36864
  ds_read_b64_tr_b16 v[50:51], v5 offset:37120
  v_mfma_f32_32x32x16_bf16 v[32:47], v[52:55], v[92:95], v[32:47]
  ds_read_b64_tr_b16 v[52:53], v5 offset:38912
  ds_read_b64_tr_b16 v[54:55], v5 offset:39168
  s_add_u32 m0, s34, 24576
  s_add_u32 s30, s95, 1769472
  buffer_load_dwordx4 v2, s[8:11], s30 offen lds
  s_waitcnt lgkmcnt(10)
  v_mfma_f32_32x32x16_bf16 v[32:47], v[56:59], v[96:99], v[32:47]
  ds_read_b64_tr_b16 v[56:57], v5 offset:40960
  ds_read_b64_tr_b16 v[58:59], v5 offset:41216
  s_waitcnt lgkmcnt(10)
  v_mfma_f32_32x32x16_bf16 v[32:47], v[60:63], v[100:103], v[32:47]
  v_mul_f32 v72, v16, v16
  v_mul_f32 v73, v17, v17
  v_mul_f32 v74, v18, v18
  v_mul_f32 v75, v19, v19
  v_mul_f32 v76, v20, v20
  ds_read_b64_tr_b16 v[60:61], v5 offset:43008
  ds_read_b64_tr_b16 v[62:63], v5 offset:43264
  s_add_u32 m0, s34, 32768
  s_add_u32 s30, s95, 2359296
  buffer_load_dwordx4 v2, s[8:11], s30 offen lds
  s_waitcnt lgkmcnt(10)
  v_mfma_f32_32x32x16_bf16 v[32:47], v[64:67], v[104:107], v[32:47]
  v_mul_f32 v77, v21, v21
  v_mul_f32 v78, v22, v22
  v_mul_f32 v79, v23, v23
  v_fma_f32 v72, v72, v10, v9
  ds_read_b64_tr_b16 v[64:65], v5 offset:45056
  ds_read_b64_tr_b16 v[66:67], v5 offset:45312
  s_waitcnt lgkmcnt(10)
  v_mfma_f32_32x32x16_bf16 v[32:47], v[68:71], v[108:111], v[32:47]
  v_fma_f32 v73, v73, v10, v9
  v_fma_f32 v74, v74, v10, v9
  v_fma_f32 v75, v75, v10, v9
  v_fma_f32 v76, v76, v10, v9
  ds_read_b64_tr_b16 v[68:69], v5 offset:47104
  ds_read_b64_tr_b16 v[70:71], v5 offset:47360
  s_waitcnt lgkmcnt(10)
  v_mfma_f32_32x32x16_bf16 v[32:47], v[48:51], v[112:115], v[32:47]
  v_fma_f32 v77, v77, v10, v9
  v_fma_f32 v78, v78, v10, v9
  v_fma_f32 v79, v79, v10, v9
  v_mul_f32 v72, v16, v72
  ds_read_b64_tr_b16 v[48:49], v6 offset:0
  ds_read_b64_tr_b16 v[50:51], v6 offset:256
  s_waitcnt lgkmcnt(10)
  v_mfma_f32_32x32x16_bf16 v[32:47], v[52:55], v[116:119], v[32:47]
  v_mul_f32 v73, v17, v73
  v_mul_f32 v74, v18, v74
  v_mul_f32 v75, v19, v75
  v_mul_f32 v76, v20, v76
  v_mul_f32 v77, v21, v77
  s_waitcnt vmcnt(7)
  s_mov_b64 exec, 1
  ds_add_u32 v12, v13 offset:44
  s_mov_b64 exec, -1
  ds_read_b64_tr_b16 v[52:53], v6 offset:2048
  ds_read_b64_tr_b16 v[54:55], v6 offset:2304
  s_waitcnt lgkmcnt(11)
  v_mfma_f32_32x32x16_bf16 v[32:47], v[56:59], v[120:123], v[32:47]
  v_mul_f32 v78, v22, v78
  v_mul_f32 v79, v23, v79
  v_exp_f32 v72, v72
  v_exp_f32 v73, v73
  ds_read_b64_tr_b16 v[56:57], v6 offset:4096
  ds_read_b64_tr_b16 v[58:59], v6 offset:4352
  s_waitcnt lgkmcnt(11)
  v_mfma_f32_32x32x16_bf16 v[32:47], v[60:63], v[124:127], v[32:47]
  v_exp_f32 v74, v74
  v_exp_f32 v75, v75
  v_exp_f32 v76, v76
  v_exp_f32 v77, v77
  ds_read_b64_tr_b16 v[60:61], v6 offset:6144
  ds_read_b64_tr_b16 v[62:63], v6 offset:6400
  s_waitcnt lgkmcnt(11)
  v_mfma_f32_32x32x16_bf16 v[32:47], v[64:67], v[128:131], v[32:47]
  v_exp_f32 v78, v78
  v_exp_f32 v79, v79
  v_fma_f32 v72, v72, v11, v11
  v_fma_f32 v73, v73, v11, v11
  ds_read_b32 v255, v12 offset:44
  ds_read_b64_tr_b16 v[64:65], v6 offset:8192
  ds_read_b64_tr_b16 v[66:67], v6 offset:8448
  s_waitcnt lgkmcnt(12)
  v_mfma_f32_32x32x16_bf16 v[32:47], v[68:71], v[132:135], v[32:47]
  v_fma_f32 v74, v74, v11, v11
  v_fma_f32 v75, v75, v11, v11
  v_fma_f32 v76, v76, v11, v11
  v_fma_f32 v77, v77, v11, v11
  ds_read_b64_tr_b16 v[68:69], v6 offset:10240
  ds_read_b64_tr_b16 v[70:71], v6 offset:10496
  s_waitcnt lgkmcnt(12)
  v_mfma_f32_32x32x16_bf16 v[32:47], v[48:51], v[136:139], v[32:47]
  v_fma_f32 v78, v78, v11, v11
  v_fma_f32 v79, v79, v11, v11
  v_rcp_f32 v72, v72
  v_rcp_f32 v73, v73
  v_rcp_f32 v74, v74
  s_waitcnt lgkmcnt(4)
  v_readfirstlane_b32 s28, v255
  s_cmp_eq_u32 s28, 8
  s_cbranch_scc1 L_wok_26
  s_mov_b32 s33, 0
L_wlp_27:
  ds_read_b32 v255, v12 offset:44
  s_waitcnt lgkmcnt(0)
  v_readfirstlane_b32 s28, v255
  s_cmp_eq_u32 s28, 8
  s_cbranch_scc1 L_wok_26
  s_add_u32 s33, s33, 1
  s_cmp_lt_u32 s33, 0x100000
  s_cbranch_scc1 L_wlp_27
L_wok_26:
  ds_read_b64_tr_b16 v[48:49], v6 offset:12288
  ds_read_b64_tr_b16 v[50:51], v6 offset:12544
  v_mfma_f32_32x32x16_bf16 v[32:47], v[52:55], v[140:143], v[32:47]
  v_rcp_f32 v75, v75
  v_rcp_f32 v76, v76
  v_rcp_f32 v77, v77
  v_rcp_f32 v78, v78
  ds_read_b64_tr_b16 v[52:53], v6 offset:14336
  ds_read_b64_tr_b16 v[54:55], v6 offset:14592
  s_add_u32 m0, s34, 36864
  s_add_u32 s30, s95, 2654208
  buffer_load_dwordx4 v2, s[8:11], s30 offen lds
  v_mfma_f32_32x32x16_bf16 v[32:47], v[56:59], v[144:147], v[32:47]
  v_rcp_f32 v79, v79
  v_mul_f32 v72, v16, v72
  v_mul_f32 v73, v17, v73
  v_mul_f32 v74, v18, v74
  ds_read_b64_tr_b16 v[56:57], v6 offset:16384
  ds_read_b64_tr_b16 v[58:59], v6 offset:16640
  v_mfma_f32_32x32x16_bf16 v[32:47], v[60:63], v[148:151], v[32:47]
  v_mul_f32 v75, v19, v75
  v_mul_f32 v76, v20, v76
  v_mul_f32 v77, v21, v77
  v_mul_f32 v78, v22, v78
  ds_read_b64_tr_b16 v[60:61], v6 offset:18432
  ds_read_b64_tr_b16 v[62:63], v6 offset:18688
  s_add_u32 m0, s34, 45056
  s_add_u32 s30, s95, 3244032
  buffer_load_dwordx4 v2, s[8:11], s30 offen lds
  s_waitcnt lgkmcnt(10)
  v_mfma_f32_32x32x16_bf16 v[32:47], v[64:67], v[152:155], v[32:47]
  v_mul_f32 v79, v23, v79
  v_cvt_pk_bf16_f32 v80, v72, v73
  v_cvt_pk_bf16_f32 v81, v74, v75
  v_cvt_pk_bf16_f32 v82, v76, v77
  ds_read_b64_tr_b16 v[64:65], v6 offset:20480
  ds_read_b64_tr_b16 v[66:67], v6 offset:20736
  s_waitcnt lgkmcnt(10)
  v_mfma_f32_32x32x16_bf16 v[32:47], v[68:71], v[156:159], v[32:47]
  v_cvt_pk_bf16_f32 v83, v78, v79
  s_add_u32 s28, s39, s36
  s_lshl_b32 s28, s28, 10
  buffer_store_dwordx4 v[80:83], v7, s[4:7], s28 offen offset:0 sc1
  v_mul_f32 v72, v24, v24
  v_mul_f32 v73, v25, v25
  v_mul_f32 v74, v26, v26
  ds_read_b64_tr_b16 v[68:69], v6 offset:22528
  ds_read_b64_tr_b16 v[70:71], v6 offset:22784
  s_add_u32 m0, s34, 53248
  s_add_u32 s30, s95, 3833856
  buffer_load_dwordx4 v2, s[8:11], s30 offen lds
  s_waitcnt lgkmcnt(10)
  v_mfma_f32_32x32x16_bf16 v[32:47], v[48:51], v[160:163], v[32:47]
  v_mul_f32 v75, v27, v27
  v_mul_f32 v76, v28, v28
  v_mul_f32 v77, v29, v29
  v_mul_f32 v78, v30, v30
  ds_read_b64_tr_b16 v[48:49], v6 offset:24576
  ds_read_b64_tr_b16 v[50:51], v6 offset:24832
  s_waitcnt lgkmcnt(10)
  v_mfma_f32_32x32x16_bf16 v[32:47], v[52:55], v[164:167], v[32:47]
  v_mul_f32 v79, v31, v31
  v_fma_f32 v72, v72, v10, v9
  v_fma_f32 v73, v73, v10, v9
  v_fma_f32 v74, v74, v10, v9
  ds_read_b64_tr_b16 v[52:53], v6 offset:26624
  ds_read_b64_tr_b16 v[54:55], v6 offset:26880
  s_add_u32 m0, s34, 61440
  s_add_u32 s30, s95, 4423680
  buffer_load_dwordx4 v2, s[8:11], s30 offen lds
  s_waitcnt lgkmcnt(10)
  v_mfma_f32_32x32x16_bf16 v[32:47], v[56:59], v[168:171], v[32:47]
  v_fma_f32 v75, v75, v10, v9
  v_fma_f32 v76, v76, v10, v9
  v_fma_f32 v77, v77, v10, v9
  v_fma_f32 v78, v78, v10, v9
  ds_read_b64_tr_b16 v[56:57], v6 offset:28672
  ds_read_b64_tr_b16 v[58:59], v6 offset:28928
  s_waitcnt lgkmcnt(10)
  v_mfma_f32_32x32x16_bf16 v[32:47], v[60:63], v[172:175], v[32:47]
  v_fma_f32 v79, v79, v10, v9
  v_mul_f32 v72, v24, v72
  v_mul_f32 v73, v25, v73
  v_mul_f32 v74, v26, v74
  ds_read_b64_tr_b16 v[60:61], v6 offset:30720
  ds_read_b64_tr_b16 v[62:63], v6 offset:30976
  s_add_u32 m0, s34, 69632
  s_add_u32 s30, s95, 5013504
  buffer_load_dwordx4 v2, s[8:11], s30 offen lds
  s_waitcnt lgkmcnt(10)
  v_mfma_f32_32x32x16_bf16 v[32:47], v[64:67], v[176:179], v[32:47]
  v_mul_f32 v75, v27, v75
  v_mul_f32 v76, v28, v76
  v_mul_f32 v77, v29, v77
  v_mul_f32 v78, v30, v78
  v_mul_f32 v79, v31, v79
  ds_read_b64_tr_b16 v[64:65], v6 offset:32768
  ds_read_b64_tr_b16 v[66:67], v6 offset:33024
  s_waitcnt lgkmcnt(10)
  v_mfma_f32_32x32x16_bf16 v[32:47], v[68:71], v[180:183], v[32:47]
  v_exp_f32 v72, v72
  v_exp_f32 v73, v73
  v_exp_f32 v74, v74
  v_exp_f32 v75, v75
  ds_read_b64_tr_b16 v[68:69], v6 offset:34816
  ds_read_b64_tr_b16 v[70:71], v6 offset:35072
  s_waitcnt lgkmcnt(10)
  v_mfma_f32_32x32x16_bf16 v[32:47], v[48:51], v[184:187], v[32:47]
  v_exp_f32 v76, v76
  v_exp_f32 v77, v77
  v_exp_f32 v78, v78
  v_exp_f32 v79, v79
  ds_read_b64_tr_b16 v[48:49], v6 offset:36864
  ds_read_b64_tr_b16 v[50:51], v6 offset:37120
  s_waitcnt lgkmcnt(10)
  v_mfma_f32_32x32x16_bf16 v[32:47], v[52:55], v[188:191], v[32:47]
  v_fma_f32 v72, v72, v11, v11
  v_fma_f32 v73, v73, v11, v11
  v_fma_f32 v74, v74, v11, v11
  v_fma_f32 v75, v75, v11, v11
  s_waitcnt vmcnt(6)
  s_mov_b64 exec, 1
  ds_add_u32 v12, v13 offset:48
  s_mov_b64 exec, -1
  ds_read_b64_tr_b16 v[52:53], v6 offset:38912
  ds_read_b64_tr_b16 v[54:55], v6 offset:39168
  s_waitcnt lgkmcnt(11)
  v_mfma_f32_32x32x16_bf16 v[32:47], v[56:59], v[192:195], v[32:47]
  v_fma_f32 v76, v76, v11, v11
  v_fma_f32 v77, v77, v11, v11
  v_fma_f32 v78, v78, v11, v11
  v_fma_f32 v79, v79, v11, v11
  ds_read_b64_tr_b16 v[56:57], v6 offset:40960
  ds_read_b64_tr_b16 v[58:59], v6 offset:41216
  s_waitcnt lgkmcnt(11)
  v_mfma_f32_32x32x16_bf16 v[32:47], v[60:63], v[196:199], v[32:47]
  v_rcp_f32 v72, v72
  v_rcp_f32 v73, v73
  v_rcp_f32 v74, v74
  v_rcp_f32 v75, v75
  v_rcp_f32 v76, v76
  ds_read_b64_tr_b16 v[60:61], v6 offset:43008
  ds_read_b64_tr_b16 v[62:63], v6 offset:43264
  s_waitcnt lgkmcnt(11)
  v_mfma_f32_32x32x16_bf16 v[32:47], v[64:67], v[200:203], v[32:47]
  v_rcp_f32 v77, v77
  v_rcp_f32 v78, v78
  v_rcp_f32 v79, v79
  v_mul_f32 v72, v24, v72
  ds_read_b32 v255, v12 offset:48
  ds_read_b64_tr_b16 v[64:65], v6 offset:45056
  ds_read_b64_tr_b16 v[66:67], v6 offset:45312
  s_waitcnt lgkmcnt(12)
  v_mfma_f32_32x32x16_bf16 v[32:47], v[68:71], v[204:207], v[32:47]
  v_mul_f32 v73, v25, v73
  v_mul_f32 v74, v26, v74
  v_mul_f32 v75, v27, v75
  v_mul_f32 v76, v28, v76
  ds_read_b64_tr_b16 v[68:69], v6 offset:47104
  ds_read_b64_tr_b16 v[70:71], v6 offset:47360
  s_waitcnt lgkmcnt(12)
  v_mfma_f32_32x32x16_bf16 v[32:47], v[48:51], v[208:211], v[32:47]
  v_mul_f32 v77, v29, v77
  v_mul_f32 v78, v30, v78
  v_mul_f32 v79, v31, v79
  v_cvt_pk_bf16_f32 v84, v72, v73
  s_waitcnt lgkmcnt(4)
  v_readfirstlane_b32 s28, v255
  s_cmp_eq_u32 s28, 8
  s_cbranch_scc1 L_wok_28
  s_mov_b32 s33, 0
L_wlp_29:
  ds_read_b32 v255, v12 offset:48
  s_waitcnt lgkmcnt(0)
  v_readfirstlane_b32 s28, v255
  s_cmp_eq_u32 s28, 8
  s_cbranch_scc1 L_wok_28
  s_add_u32 s33, s33, 1
  s_cmp_lt_u32 s33, 0x100000
  s_cbranch_scc1 L_wlp_29
L_wok_28:
  s_cmp_eq_u32 s18, 0
  s_cbranch_scc0 L_noall_30
  s_add_u32 s28, s59, 0
  v_mov_b32 v253, 8192
  v_mov_b32 v254, s28
  s_mov_b64 exec, 1
  buffer_store_dword v254, v253, s[4:7], s101 offen sc1
  s_mov_b64 exec, -1
L_noall_30:
  ds_read_b64_tr_b16 v[48:49], v4 offset:0
  ds_read_b64_tr_b16 v[50:51], v4 offset:256
  v_mfma_f32_32x32x16_bf16 v[32:47], v[52:55], v[212:215], v[32:47]
  v_cvt_pk_bf16_f32 v85, v74, v75
  v_cvt_pk_bf16_f32 v86, v76, v77
  v_cvt_pk_bf16_f32 v87, v78, v79
  s_add_u32 s28, s39, s36
  s_lshl_b32 s28, s28, 10
  buffer_store_dwordx4 v[84:87], v7, s[4:7], s28 offen offset:512 sc1
  ds_read_b64_tr_b16 v[52:53], v4 offset:2048
  ds_read_b64_tr_b16 v[54:55], v4 offset:2304
  s_add_u32 m0, s34, 73728
  s_add_u32 s30, s31, 512
  buffer_load_dwordx4 v2, s[8:11], s30 offen lds
  v_mfma_f32_32x32x16_bf16 v[32:47], v[56:59], v[216:219], v[32:47]
  s_add_u32 s37, s96, 2
  s_and_b32 s37, s37, 3
  s_lshl_b32 s37, s37, 1
  s_add_u32 s37, s37, s27
  s_add_u32 s37, s37, 0
  s_lshl_b32 s28, s37, 8
  v_mov_b32 v15, s28
  v_cndmask_b32 v15, v15, 0, s[24:25]
  v_add_u32 v15, v15, v8
  ds_read_b64 v[236:237], v15
  ds_read_b64_tr_b16 v[56:57], v4 offset:4096
  ds_read_b64_tr_b16 v[58:59], v4 offset:4352
  v_mfma_f32_32x32x16_bf16 v[32:47], v[60:63], v[220:223], v[32:47]
  ds_read_b64_tr_b16 v[60:61], v4 offset:6144
  ds_read_b64_tr_b16 v[62:63], v4 offset:6400
  s_add_u32 m0, s34, 81920
  s_add_u32 s30, s31, 590336
  buffer_load_dwordx4 v2, s[8:11], s30 offen lds
  s_waitcnt lgkmcnt(11)
  v_mfma_f32_32x32x16_bf16 v[32:47], v[64:67], v[224:227], v[32:47]
  ds_read_b64_tr_b16 v[64:65], v4 offset:8192
  ds_read_b64_tr_b16 v[66:67], v4 offset:8448
  s_waitcnt lgkmcnt(11)
  v_mfma_f32_32x32x16_bf16 v[32:47], v[68:71], v[228:231], v[32:47]
  s_waitcnt lgkmcnt(6)
  v_mfma_f32_32x32x16_bf16 v[32:47], v[236:239], v[232:235], v[32:47]
  ds_read_b64_tr_b16 v[68:69], v4 offset:10240
  ds_read_b64_tr_b16 v[70:71], v4 offset:10496
  s_add_u32 m0, s34, 90112
  s_add_u32 s30, s31, 1180160
  buffer_load_dwordx4 v2, s[8:11], s30 offen lds
  v_mfma_f32_32x32x16_bf16 v[16:31], v[48:51], v[88:91], 0
  ds_read_b64_tr_b16 v[48:49], v4 offset:12288
  ds_read_b64_tr_b16 v[50:51], v4 offset:12544
  v_mfma_f32_32x32x16_bf16 v[16:31], v[52:55], v[92:95], v[16:31]
  ds_read_b64_tr_b16 v[52:53], v4 offset:14336
  ds_read_b64_tr_b16 v[54:55], v4 offset:14592
  s_add_u32 m0, s34, 98304
  s_add_u32 s30, s31, 1769984
  buffer_load_dwordx4 v2, s[8:11], s30 offen lds
  s_waitcnt lgkmcnt(10)
  v_mfma_f32_32x32x16_bf16 v[16:31], v[56:59], v[96:99], v[16:31]
  ds_read_b64_tr_b16 v[56:57], v4 offset:16384
  ds_read_b64_tr_b16 v[58:59], v4 offset:16640
  s_waitcnt lgkmcnt(10)
  v_mfma_f32_32x32x16_bf16 v[16:31], v[60:63], v[100:103], v[16:31]
  v_mul_f32 v72, v32, v32
  v_mul_f32 v73, v33, v33
  v_mul_f32 v74, v34, v34
  v_mul_f32 v75, v35, v35
  v_mul_f32 v76, v36, v36
  ds_read_b64_tr_b16 v[60:61], v4 offset:18432
  ds_read_b64_tr_b16 v[62:63], v4 offset:18688
  s_add_u32 m0, s34, 106496
  s_add_u32 s30, s31, 2359808
  buffer_load_dwordx4 v2, s[8:11], s30 offen lds
  s_waitcnt lgkmcnt(10)
  v_mfma_f32_32x32x16_bf16 v[16:31], v[64:67], v[104:107], v[16:31]
  v_mul_f32 v77, v37, v37
  v_mul_f32 v78, v38, v38
  v_mul_f32 v79, v39, v39
  v_fma_f32 v72, v72, v10, v9
  ds_read_b64_tr_b16 v[64:65], v4 offset:20480
  ds_read_b64_tr_b16 v[66:67], v4 offset:20736
  s_waitcnt lgkmcnt(10)
  v_mfma_f32_32x32x16_bf16 v[16:31], v[68:71], v[108:111], v[16:31]
  v_fma_f32 v73, v73, v10, v9
  v_fma_f32 v74, v74, v10, v9
  v_fma_f32 v75, v75, v10, v9
  v_fma_f32 v76, v76, v10, v9
  ds_read_b64_tr_b16 v[68:69], v4 offset:22528
  ds_read_b64_tr_b16 v[70:71], v4 offset:22784
  s_waitcnt lgkmcnt(10)
  v_mfma_f32_32x32x16_bf16 v[16:31], v[48:51], v[112:115], v[16:31]
  v_fma_f32 v77, v77, v10, v9
  v_fma_f32 v78, v78, v10, v9
  v_fma_f32 v79, v79, v10, v9
  v_mul_f32 v72, v32, v72
  ds_read_b64_tr_b16 v[48:49], v4 offset:24576
  ds_read_b64_tr_b16 v[50:51], v4 offset:24832
  s_waitcnt lgkmcnt(10)
  v_mfma_f32_32x32x16_bf16 v[16:31], v[52:55], v[116:119], v[16:31]
  v_mul_f32 v73, v33, v73
  v_mul_f32 v74, v34, v74
  v_mul_f32 v75, v35, v75
  v_mul_f32 v76, v36, v76
  v_mul_f32 v77, v37, v77
  s_waitcnt vmcnt(6)
  s_mov_b64 exec, 1
  ds_add_u32 v12, v13 offset:52
  s_mov_b64 exec, -1
  ds_read_b64_tr_b16 v[52:53], v4 offset:26624
  ds_read_b64_tr_b16 v[54:55], v4 offset:26880
  s_waitcnt lgkmcnt(11)
  v_mfma_f32_32x32x16_bf16 v[16:31], v[56:59], v[120:123], v[16:31]
  v_mul_f32 v78, v38, v78
  v_mul_f32 v79, v39, v79
  v_exp_f32 v72, v72
  v_exp_f32 v73, v73
  ds_read_b64_tr_b16 v[56:57], v4 offset:28672
  ds_read_b64_tr_b16 v[58:59], v4 offset:28928
  s_waitcnt lgkmcnt(11)
  v_mfma_f32_32x32x16_bf16 v[16:31], v[60:63], v[124:127], v[16:31]
  v_exp_f32 v74, v74
  v_exp_f32 v75, v75
  v_exp_f32 v76, v76
  v_exp_f32 v77, v77
  ds_read_b64_tr_b16 v[60:61], v4 offset:30720
  ds_read_b64_tr_b16 v[62:63], v4 offset:30976
  s_waitcnt lgkmcnt(11)
  v_mfma_f32_32x32x16_bf16 v[16:31], v[64:67], v[128:131], v[16:31]
  v_exp_f32 v78, v78
  v_exp_f32 v79, v79
  v_fma_f32 v72, v72, v11, v11
  v_fma_f32 v73, v73, v11, v11
  ds_read_b32 v255, v12 offset:52
  ds_read_b64_tr_b16 v[64:65], v4 offset:32768
  ds_read_b64_tr_b16 v[66:67], v4 offset:33024
  s_waitcnt lgkmcnt(12)
  v_mfma_f32_32x32x16_bf16 v[16:31], v[68:71], v[132:135], v[16:31]
  v_fma_f32 v74, v74, v11, v11
  v_fma_f32 v75, v75, v11, v11
  v_fma_f32 v76, v76, v11, v11
  v_fma_f32 v77, v77, v11, v11
  ds_read_b64_tr_b16 v[68:69], v4 offset:34816
  ds_read_b64_tr_b16 v[70:71], v4 offset:35072
  s_waitcnt lgkmcnt(12)
  v_mfma_f32_32x32x16_bf16 v[16:31], v[48:51], v[136:139], v[16:31]
  v_fma_f32 v78, v78, v11, v11
  v_fma_f32 v79, v79, v11, v11
  v_rcp_f32 v72, v72
  v_rcp_f32 v73, v73
  v_rcp_f32 v74, v74
  s_waitcnt lgkmcnt(4)
  v_readfirstlane_b32 s28, v255
  s_cmp_eq_u32 s28, 8
  s_cbranch_scc1 L_wok_31
  s_mov_b32 s33, 0
L_wlp_32:
  ds_read_b32 v255, v12 offset:52
  s_waitcnt lgkmcnt(0)
  v_readfirstlane_b32 s28, v255
  s_cmp_eq_u32 s28, 8
  s_cbranch_scc1 L_wok_31
  s_add_u32 s33, s33, 1
  s_cmp_lt_u32 s33, 0x100000
  s_cbranch_scc1 L_wlp_32
L_wok_31:
  ds_read_b64_tr_b16 v[48:49], v4 offset:36864
  ds_read_b64_tr_b16 v[50:51], v4 offset:37120
  v_mfma_f32_32x32x16_bf16 v[16:31], v[52:55], v[140:143], v[16:31]
  v_rcp_f32 v75, v75
  v_rcp_f32 v76, v76
  v_rcp_f32 v77, v77
  v_rcp_f32 v78, v78
  ds_read_b64_tr_b16 v[52:53], v4 offset:38912
  ds_read_b64_tr_b16 v[54:55], v4 offset:39168
  s_add_u32 m0, s34, 110592
  s_add_u32 s30, s31, 2654720
  buffer_load_dwordx4 v2, s[8:11], s30 offen lds
  v_mfma_f32_32x32x16_bf16 v[16:31], v[56:59], v[144:147], v[16:31]
  v_rcp_f32 v79, v79
  v_mul_f32 v72, v32, v72
  v_mul_f32 v73, v33, v73
  v_mul_f32 v74, v34, v74
  ds_read_b64_tr_b16 v[56:57], v4 offset:40960
  ds_read_b64_tr_b16 v[58:59], v4 offset:41216
  v_mfma_f32_32x32x16_bf16 v[16:31], v[60:63], v[148:151], v[16:31]
  v_mul_f32 v75, v35, v75
  v_mul_f32 v76, v36, v76
  v_mul_f32 v77, v37, v77
  v_mul_f32 v78, v38, v78
  ds_read_b64_tr_b16 v[60:61], v4 offset:43008
  ds_read_b64_tr_b16 v[62:63], v4 offset:43264
  s_add_u32 m0, s34, 118784
  s_add_u32 s30, s31, 3244544
  buffer_load_dwordx4 v2, s[8:11], s30 offen lds
  s_waitcnt lgkmcnt(10)
  v_mfma_f32_32x32x16_bf16 v[16:31], v[64:67], v[152:155], v[16:31]
  v_mul_f32 v79, v39, v79
  v_cvt_pk_bf16_f32 v80, v72, v73
  v_cvt_pk_bf16_f32 v81, v74, v75
  v_cvt_pk_bf16_f32 v82, v76, v77
  ds_read_b64_tr_b16 v[64:65], v4 offset:45056
  ds_read_b64_tr_b16 v[66:67], v4 offset:45312
  s_waitcnt lgkmcnt(10)
  v_mfma_f32_32x32x16_bf16 v[16:31], v[68:71], v[156:159], v[16:31]
  v_cvt_pk_bf16_f32 v83, v78, v79
  s_add_u32 s28, s39, s37
  s_lshl_b32 s28, s28, 10
  buffer_store_dwordx4 v[80:83], v7, s[4:7], s28 offen offset:0 sc1
  v_mul_f32 v72, v40, v40
  v_mul_f32 v73, v41, v41
  v_mul_f32 v74, v42, v42
  ds_read_b64_tr_b16 v[68:69], v4 offset:47104
  ds_read_b64_tr_b16 v[70:71], v4 offset:47360
  s_add_u32 m0, s34, 126976
  s_add_u32 s30, s31, 3834368
  buffer_load_dwordx4 v2, s[8:11], s30 offen lds
  s_waitcnt lgkmcnt(10)
  v_mfma_f32_32x32x16_bf16 v[16:31], v[48:51], v[160:163], v[16:31]
  v_mul_f32 v75, v43, v43
  v_mul_f32 v76, v44, v44
  v_mul_f32 v77, v45, v45
  v_mul_f32 v78, v46, v46
  ds_read_b64_tr_b16 v[48:49], v5 offset:0
  ds_read_b64_tr_b16 v[50:51], v5 offset:256
  s_waitcnt lgkmcnt(10)
  v_mfma_f32_32x32x16_bf16 v[16:31], v[52:55], v[164:167], v[16:31]
  v_mul_f32 v79, v47, v47
  v_fma_f32 v72, v72, v10, v9
  v_fma_f32 v73, v73, v10, v9
  v_fma_f32 v74, v74, v10, v9
  ds_read_b64_tr_b16 v[52:53], v5 offset:2048
  ds_read_b64_tr_b16 v[54:55], v5 offset:2304
  s_add_u32 m0, s34, 135168
  s_add_u32 s30, s31, 4424192
  buffer_load_dwordx4 v2, s[8:11], s30 offen lds
  s_waitcnt lgkmcnt(10)
  v_mfma_f32_32x32x16_bf16 v[16:31], v[56:59], v[168:171], v[16:31]
  v_fma_f32 v75, v75, v10, v9
  v_fma_f32 v76, v76, v10, v9
  v_fma_f32 v77, v77, v10, v9
  v_fma_f32 v78, v78, v10, v9
  ds_read_b64_tr_b16 v[56:57], v5 offset:4096
  ds_read_b64_tr_b16 v[58:59], v5 offset:4352
  s_waitcnt lgkmcnt(10)
  v_mfma_f32_32x32x16_bf16 v[16:31], v[60:63], v[172:175], v[16:31]
  v_fma_f32 v79, v79, v10, v9
  v_mul_f32 v72, v40, v72
  v_mul_f32 v73, v41, v73
  v_mul_f32 v74, v42, v74
  ds_read_b64_tr_b16 v[60:61], v5 offset:6144
  ds_read_b64_tr_b16 v[62:63], v5 offset:6400
  s_add_u32 m0, s34, 143360
  s_add_u32 s30, s31, 5014016
  buffer_load_dwordx4 v2, s[8:11], s30 offen lds
  s_waitcnt lgkmcnt(10)
  v_mfma_f32_32x32x16_bf16 v[16:31], v[64:67], v[176:179], v[16:31]
  v_mul_f32 v75, v43, v75
  v_mul_f32 v76, v44, v76
  v_mul_f32 v77, v45, v77
  v_mul_f32 v78, v46, v78
  v_mul_f32 v79, v47, v79
  ds_read_b64_tr_b16 v[64:65], v5 offset:8192
  ds_read_b64_tr_b16 v[66:67], v5 offset:8448
  s_waitcnt lgkmcnt(10)
  v_mfma_f32_32x32x16_bf16 v[16:31], v[68:71], v[180:183], v[16:31]
  v_exp_f32 v72, v72
  v_exp_f32 v73, v73
  v_exp_f32 v74, v74
  v_exp_f32 v75, v75
  ds_read_b64_tr_b16 v[68:69], v5 offset:10240
  ds_read_b64_tr_b16 v[70:71], v5 offset:10496
  s_waitcnt lgkmcnt(10)
  v_mfma_f32_32x32x16_bf16 v[16:31], v[48:51], v[184:187], v[16:31]
  v_exp_f32 v76, v76
  v_exp_f32 v77, v77
  v_exp_f32 v78, v78
  v_exp_f32 v79, v79
  ds_read_b64_tr_b16 v[48:49], v5 offset:12288
  ds_read_b64_tr_b16 v[50:51], v5 offset:12544
  s_waitcnt lgkmcnt(10)
  v_mfma_f32_32x32x16_bf16 v[16:31], v[52:55], v[188:191], v[16:31]
  v_fma_f32 v72, v72, v11, v11
  v_fma_f32 v73, v73, v11, v11
  v_fma_f32 v74, v74, v11, v11
  v_fma_f32 v75, v75, v11, v11
  ds_read_b64_tr_b16 v[52:53], v5 offset:14336
  ds_read_b64_tr_b16 v[54:55], v5 offset:14592
  s_waitcnt lgkmcnt(10)
  v_mfma_f32_32x32x16_bf16 v[16:31], v[56:59], v[192:195], v[16:31]
  v_fma_f32 v76, v76, v11, v11
  v_fma_f32 v77, v77, v11, v11
  v_fma_f32 v78, v78, v11, v11
  v_fma_f32 v79, v79, v11, v11
  ds_read_b64_tr_b16 v[56:57], v5 offset:16384
  ds_read_b64_tr_b16 v[58:59], v5 offset:16640
  s_waitcnt lgkmcnt(10)
  v_mfma_f32_32x32x16_bf16 v[16:31], v[60:63], v[196:199], v[16:31]
  v_rcp_f32 v72, v72
  v_rcp_f32 v73, v73
  v_rcp_f32 v74, v74
  v_rcp_f32 v75, v75
  v_rcp_f32 v76, v76
  ds_read_b64_tr_b16 v[60:61], v5 offset:18432
  ds_read_b64_tr_b16 v[62:63], v5 offset:18688
  s_waitcnt lgkmcnt(10)
  v_mfma_f32_32x32x16_bf16 v[16:31], v[64:67], v[200:203], v[16:31]
  v_rcp_f32 v77, v77
  v_rcp_f32 v78, v78
  v_rcp_f32 v79, v79
  v_mul_f32 v72, v40, v72
  ds_read_b64_tr_b16 v[64:65], v5 offset:20480
  ds_read_b64_tr_b16 v[66:67], v5 offset:20736
  s_waitcnt lgkmcnt(10)
  v_mfma_f32_32x32x16_bf16 v[16:31], v[68:71], v[204:207], v[16:31]
  v_mul_f32 v73, v41, v73
  v_mul_f32 v74, v42, v74
  v_mul_f32 v75, v43, v75
  v_mul_f32 v76, v44, v76
  ds_read_b64_tr_b16 v[68:69], v5 offset:22528
  ds_read_b64_tr_b16 v[70:71], v5 offset:22784
  s_waitcnt lgkmcnt(10)
  v_mfma_f32_32x32x16_bf16 v[16:31], v[48:51], v[208:211], v[16:31]
  v_mul_f32 v77, v45, v77
  v_mul_f32 v78, v46, v78
  v_mul_f32 v79, v47, v79
  v_cvt_pk_bf16_f32 v84, v72, v73
  s_waitcnt vmcnt(6)
  s_barrier
  s_lshl_b32 s29, s27, 9
  v_add_u32 v4, s29, v4
  v_add_u32 v5, s29, v5
  v_add_u32 v6, s29, v6
  ds_read_b64_tr_b16 v[48:49], v5 offset:24576
  ds_read_b64_tr_b16 v[50:51], v5 offset:24832
  s_waitcnt lgkmcnt(10)
  v_mfma_f32_32x32x16_bf16 v[16:31], v[52:55], v[212:215], v[16:31]
  v_cvt_pk_bf16_f32 v85, v74, v75
  v_cvt_pk_bf16_f32 v86, v76, v77
  v_cvt_pk_bf16_f32 v87, v78, v79
  s_add_u32 s28, s39, s37
  s_lshl_b32 s28, s28, 10
  buffer_store_dwordx4 v[84:87], v7, s[4:7], s28 offen offset:512 sc1
  ds_read_b64_tr_b16 v[52:53], v5 offset:26624
  ds_read_b64_tr_b16 v[54:55], v5 offset:26880
  s_waitcnt lgkmcnt(10)
  v_mfma_f32_32x32x16_bf16 v[16:31], v[56:59], v[216:219], v[16:31]
  s_add_u32 s36, s96, 3
  s_and_b32 s36, s36, 3
  s_lshl_b32 s36, s36, 1
  s_add_u32 s36, s36, s27
  s_add_u32 s36, s36, 0
  s_lshl_b32 s28, s36, 8
  v_mov_b32 v15, s28
  v_cndmask_b32 v15, v15, 0, s[24:25]
  v_add_u32 v15, v15, v8
  ds_read_b64 v[236:237], v15
  ds_read_b64_tr_b16 v[56:57], v5 offset:28672
  ds_read_b64_tr_b16 v[58:59], v5 offset:28928
  s_waitcnt lgkmcnt(11)
  v_mfma_f32_32x32x16_bf16 v[16:31], v[60:63], v[220:223], v[16:31]
  ds_read_b64_tr_b16 v[60:61], v5 offset:30720
  ds_read_b64_tr_b16 v[62:63], v5 offset:30976
  s_waitcnt lgkmcnt(11)
  v_mfma_f32_32x32x16_bf16 v[16:31], v[64:67], v[224:227], v[16:31]
  ds_read_b64_tr_b16 v[64:65], v5 offset:32768
  ds_read_b64_tr_b16 v[66:67], v5 offset:33024
  s_waitcnt lgkmcnt(11)
  v_mfma_f32_32x32x16_bf16 v[16:31], v[68:71], v[228:231], v[16:31]
  s_waitcnt lgkmcnt(6)
  v_mfma_f32_32x32x16_bf16 v[16:31], v[236:239], v[232:235], v[16:31]
  ds_read_b64_tr_b16 v[68:69], v5 offset:34816
  ds_read_b64_tr_b16 v[70:71], v5 offset:35072
  v_mfma_f32_32x32x16_bf16 v[32:47], v[48:51], v[88:91], 0
  ds_read_b64_tr_b16 v[48:49], v5 offset:36864
  ds_read_b64_tr_b16 v[50:51], v5 offset:37120
  v_mfma_f32_32x32x16_bf16 v[32:47], v[52:55], v[92:95], v[32:47]
  ds_read_b64_tr_b16 v[52:53], v5 offset:38912
  ds_read_b64_tr_b16 v[54:55], v5 offset:39168
  s_waitcnt lgkmcnt(10)
  v_mfma_f32_32x32x16_bf16 v[32:47], v[56:59], v[96:99], v[32:47]
  ds_read_b64_tr_b16 v[56:57], v5 offset:40960
  ds_read_b64_tr_b16 v[58:59], v5 offset:41216
  s_waitcnt lgkmcnt(10)
  v_mfma_f32_32x32x16_bf16 v[32:47], v[60:63], v[100:103], v[32:47]
  v_mul_f32 v72, v16, v16
  v_mul_f32 v73, v17, v17
  v_mul_f32 v74, v18, v18
  v_mul_f32 v75, v19, v19
  v_mul_f32 v76, v20, v20
  ds_read_b64_tr_b16 v[60:61], v5 offset:43008
  ds_read_b64_tr_b16 v[62:63], v5 offset:43264
  s_waitcnt lgkmcnt(10)
  v_mfma_f32_32x32x16_bf16 v[32:47], v[64:67], v[104:107], v[32:47]
  v_mul_f32 v77, v21, v21
  v_mul_f32 v78, v22, v22
  v_mul_f32 v79, v23, v23
  v_fma_f32 v72, v72, v10, v9
  ds_read_b64_tr_b16 v[64:65], v5 offset:45056
  ds_read_b64_tr_b16 v[66:67], v5 offset:45312
  s_waitcnt lgkmcnt(10)
  v_mfma_f32_32x32x16_bf16 v[32:47], v[68:71], v[108:111], v[32:47]
  v_fma_f32 v73, v73, v10, v9
  v_fma_f32 v74, v74, v10, v9
  v_fma_f32 v75, v75, v10, v9
  v_fma_f32 v76, v76, v10, v9
  ds_read_b64_tr_b16 v[68:69], v5 offset:47104
  ds_read_b64_tr_b16 v[70:71], v5 offset:47360
  s_waitcnt lgkmcnt(10)
  v_mfma_f32_32x32x16_bf16 v[32:47], v[48:51], v[112:115], v[32:47]
  v_fma_f32 v77, v77, v10, v9
  v_fma_f32 v78, v78, v10, v9
  v_fma_f32 v79, v79, v10, v9
  v_mul_f32 v72, v16, v72
  ds_read_b64_tr_b16 v[48:49], v6 offset:0
  ds_read_b64_tr_b16 v[50:51], v6 offset:256
  s_waitcnt lgkmcnt(10)
  v_mfma_f32_32x32x16_bf16 v[32:47], v[52:55], v[116:119], v[32:47]
  v_mul_f32 v73, v17, v73
  v_mul_f32 v74, v18, v74
  v_mul_f32 v75, v19, v75
  v_mul_f32 v76, v20, v76
  v_mul_f32 v77, v21, v77
  ds_read_b64_tr_b16 v[52:53], v6 offset:2048
  ds_read_b64_tr_b16 v[54:55], v6 offset:2304
  s_waitcnt lgkmcnt(10)
  v_mfma_f32_32x32x16_bf16 v[32:47], v[56:59], v[120:123], v[32:47]
  v_mul_f32 v78, v22, v78
  v_mul_f32 v79, v23, v79
  v_exp_f32 v72, v72
  v_exp_f32 v73, v73
  ds_read_b64_tr_b16 v[56:57], v6 offset:4096
  ds_read_b64_tr_b16 v[58:59], v6 offset:4352
  s_waitcnt lgkmcnt(10)
  v_mfma_f32_32x32x16_bf16 v[32:47], v[60:63], v[124:127], v[32:47]
  v_exp_f32 v74, v74
  v_exp_f32 v75, v75
  v_exp_f32 v76, v76
  v_exp_f32 v77, v77
  ds_read_b64_tr_b16 v[60:61], v6 offset:6144
  ds_read_b64_tr_b16 v[62:63], v6 offset:6400
  s_waitcnt lgkmcnt(10)
  v_mfma_f32_32x32x16_bf16 v[32:47], v[64:67], v[128:131], v[32:47]
  v_exp_f32 v78, v78
  v_exp_f32 v79, v79
  v_fma_f32 v72, v72, v11, v11
  v_fma_f32 v73, v73, v11, v11
  ds_read_b64_tr_b16 v[64:65], v6 offset:8192
  ds_read_b64_tr_b16 v[66:67], v6 offset:8448
  s_waitcnt lgkmcnt(10)
  v_mfma_f32_32x32x16_bf16 v[32:47], v[68:71], v[132:135], v[32:47]
  v_fma_f32 v74, v74, v11, v11
  v_fma_f32 v75, v75, v11, v11
  v_fma_f32 v76, v76, v11, v11
  v_fma_f32 v77, v77, v11, v11
  ds_read_b64_tr_b16 v[68:69], v6 offset:10240
  ds_read_b64_tr_b16 v[70:71], v6 offset:10496
  s_waitcnt lgkmcnt(10)
  v_mfma_f32_32x32x16_bf16 v[32:47], v[48:51], v[136:139], v[32:47]
  v_fma_f32 v78, v78, v11, v11
  v_fma_f32 v79, v79, v11, v11
  v_rcp_f32 v72, v72
  v_rcp_f32 v73, v73
  v_rcp_f32 v74, v74
  s_waitcnt vmcnt(1)
  s_waitcnt vmcnt(0)
  s_barrier
  ds_read_b64_tr_b16 v[48:49], v6 offset:12288
  ds_read_b64_tr_b16 v[50:51], v6 offset:12544
  s_waitcnt lgkmcnt(10)
  v_mfma_f32_32x32x16_bf16 v[32:47], v[52:55], v[140:143], v[32:47]
  v_rcp_f32 v75, v75
  v_rcp_f32 v76, v76
  v_rcp_f32 v77, v77
  v_rcp_f32 v78, v78
  ds_read_b64_tr_b16 v[52:53], v6 offset:14336
  ds_read_b64_tr_b16 v[54:55], v6 offset:14592
  s_waitcnt lgkmcnt(10)
  v_mfma_f32_32x32x16_bf16 v[32:47], v[56:59], v[144:147], v[32:47]
  v_rcp_f32 v79, v79
  v_mul_f32 v72, v16, v72
  v_mul_f32 v73, v17, v73
  v_mul_f32 v74, v18, v74
  ds_read_b64_tr_b16 v[56:57], v6 offset:16384
  ds_read_b64_tr_b16 v[58:59], v6 offset:16640
  s_waitcnt lgkmcnt(10)
  v_mfma_f32_32x32x16_bf16 v[32:47], v[60:63], v[148:151], v[32:47]
  v_mul_f32 v75, v19, v75
  v_mul_f32 v76, v20, v76
  v_mul_f32 v77, v21, v77
  v_mul_f32 v78, v22, v78
  ds_read_b64_tr_b16 v[60:61], v6 offset:18432
  ds_read_b64_tr_b16 v[62:63], v6 offset:18688
  s_waitcnt lgkmcnt(10)
  v_mfma_f32_32x32x16_bf16 v[32:47], v[64:67], v[152:155], v[32:47]
  v_mul_f32 v79, v23, v79
  v_cvt_pk_bf16_f32 v80, v72, v73
  v_cvt_pk_bf16_f32 v81, v74, v75
  v_cvt_pk_bf16_f32 v82, v76, v77
  ds_read_b64_tr_b16 v[64:65], v6 offset:20480
  ds_read_b64_tr_b16 v[66:67], v6 offset:20736
  s_waitcnt lgkmcnt(10)
  v_mfma_f32_32x32x16_bf16 v[32:47], v[68:71], v[156:159], v[32:47]
  v_cvt_pk_bf16_f32 v83, v78, v79
  s_add_u32 s28, s39, s36
  s_lshl_b32 s28, s28, 10
  buffer_store_dwordx4 v[80:83], v7, s[4:7], s28 offen offset:0 sc1
  v_mul_f32 v72, v24, v24
  v_mul_f32 v73, v25, v25
  v_mul_f32 v74, v26, v26
  ds_read_b64_tr_b16 v[68:69], v6 offset:22528
  ds_read_b64_tr_b16 v[70:71], v6 offset:22784
  s_waitcnt lgkmcnt(10)
  v_mfma_f32_32x32x16_bf16 v[32:47], v[48:51], v[160:163], v[32:47]
  v_mul_f32 v75, v27, v27
  v_mul_f32 v76, v28, v28
  v_mul_f32 v77, v29, v29
  v_mul_f32 v78, v30, v30
  ds_read_b64_tr_b16 v[48:49], v6 offset:24576
  ds_read_b64_tr_b16 v[50:51], v6 offset:24832
  s_waitcnt lgkmcnt(10)
  v_mfma_f32_32x32x16_bf16 v[32:47], v[52:55], v[164:167], v[32:47]
  v_mul_f32 v79, v31, v31
  v_fma_f32 v72, v72, v10, v9
  v_fma_f32 v73, v73, v10, v9
  v_fma_f32 v74, v74, v10, v9
  ds_read_b64_tr_b16 v[52:53], v6 offset:26624
  ds_read_b64_tr_b16 v[54:55], v6 offset:26880
  s_waitcnt lgkmcnt(10)
  v_mfma_f32_32x32x16_bf16 v[32:47], v[56:59], v[168:171], v[32:47]
  v_fma_f32 v75, v75, v10, v9
  v_fma_f32 v76, v76, v10, v9
  v_fma_f32 v77, v77, v10, v9
  v_fma_f32 v78, v78, v10, v9
  ds_read_b64_tr_b16 v[56:57], v6 offset:28672
  ds_read_b64_tr_b16 v[58:59], v6 offset:28928
  s_waitcnt lgkmcnt(10)
  v_mfma_f32_32x32x16_bf16 v[32:47], v[60:63], v[172:175], v[32:47]
  v_fma_f32 v79, v79, v10, v9
  v_mul_f32 v72, v24, v72
  v_mul_f32 v73, v25, v73
  v_mul_f32 v74, v26, v74
  ds_read_b64_tr_b16 v[60:61], v6 offset:30720
  ds_read_b64_tr_b16 v[62:63], v6 offset:30976
  s_waitcnt lgkmcnt(10)
  v_mfma_f32_32x32x16_bf16 v[32:47], v[64:67], v[176:179], v[32:47]
  v_mul_f32 v75, v27, v75
  v_mul_f32 v76, v28, v76
  v_mul_f32 v77, v29, v77
  v_mul_f32 v78, v30, v78
  v_mul_f32 v79, v31, v79
  ds_read_b64_tr_b16 v[64:65], v6 offset:32768
  ds_read_b64_tr_b16 v[66:67], v6 offset:33024
  s_waitcnt lgkmcnt(10)
  v_mfma_f32_32x32x16_bf16 v[32:47], v[68:71], v[180:183], v[32:47]
  v_exp_f32 v72, v72
  v_exp_f32 v73, v73
  v_exp_f32 v74, v74
  v_exp_f32 v75, v75
  ds_read_b64_tr_b16 v[68:69], v6 offset:34816
  ds_read_b64_tr_b16 v[70:71], v6 offset:35072
  s_waitcnt lgkmcnt(10)
  v_mfma_f32_32x32x16_bf16 v[32:47], v[48:51], v[184:187], v[32:47]
  v_exp_f32 v76, v76
  v_exp_f32 v77, v77
  v_exp_f32 v78, v78
  v_exp_f32 v79, v79
  ds_read_b64_tr_b16 v[48:49], v6 offset:36864
  ds_read_b64_tr_b16 v[50:51], v6 offset:37120
  s_waitcnt lgkmcnt(10)
  v_mfma_f32_32x32x16_bf16 v[32:47], v[52:55], v[188:191], v[32:47]
  v_fma_f32 v72, v72, v11, v11
  v_fma_f32 v73, v73, v11, v11
  v_fma_f32 v74, v74, v11, v11
  v_fma_f32 v75, v75, v11, v11
  ds_read_b64_tr_b16 v[52:53], v6 offset:38912
  ds_read_b64_tr_b16 v[54:55], v6 offset:39168
  s_waitcnt lgkmcnt(10)
  v_mfma_f32_32x32x16_bf16 v[32:47], v[56:59], v[192:195], v[32:47]
  v_fma_f32 v76, v76, v11, v11
  v_fma_f32 v77, v77, v11, v11
  v_fma_f32 v78, v78, v11, v11
  v_fma_f32 v79, v79, v11, v11
  ds_read_b64_tr_b16 v[56:57], v6 offset:40960
  ds_read_b64_tr_b16 v[58:59], v6 offset:41216
  s_waitcnt lgkmcnt(10)
  v_mfma_f32_32x32x16_bf16 v[32:47], v[60:63], v[196:199], v[32:47]
  v_rcp_f32 v72, v72
  v_rcp_f32 v73, v73
  v_rcp_f32 v74, v74
  v_rcp_f32 v75, v75
  v_rcp_f32 v76, v76
  ds_read_b64_tr_b16 v[60:61], v6 offset:43008
  ds_read_b64_tr_b16 v[62:63], v6 offset:43264
  s_waitcnt lgkmcnt(10)
  v_mfma_f32_32x32x16_bf16 v[32:47], v[64:67], v[200:203], v[32:47]
  v_rcp_f32 v77, v77
  v_rcp_f32 v78, v78
  v_rcp_f32 v79, v79
  v_mul_f32 v72, v24, v72
  ds_read_b64_tr_b16 v[64:65], v6 offset:45056
  ds_read_b64_tr_b16 v[66:67], v6 offset:45312
  s_waitcnt lgkmcnt(10)
  v_mfma_f32_32x32x16_bf16 v[32:47], v[68:71], v[204:207], v[32:47]
  v_mul_f32 v73, v25, v73
  v_mul_f32 v74, v26, v74
  v_mul_f32 v75, v27, v75
  v_mul_f32 v76, v28, v76
  ds_read_b64_tr_b16 v[68:69], v6 offset:47104
  ds_read_b64_tr_b16 v[70:71], v6 offset:47360
  s_waitcnt lgkmcnt(10)
  v_mfma_f32_32x32x16_bf16 v[32:47], v[48:51], v[208:211], v[32:47]
  v_mul_f32 v77, v29, v77
  v_mul_f32 v78, v30, v78
  v_mul_f32 v79, v31, v79
  v_cvt_pk_bf16_f32 v84, v72, v73
  s_waitcnt lgkmcnt(8)
  v_mfma_f32_32x32x16_bf16 v[32:47], v[52:55], v[212:215], v[32:47]
  v_cvt_pk_bf16_f32 v85, v74, v75
  v_cvt_pk_bf16_f32 v86, v76, v77
  v_cvt_pk_bf16_f32 v87, v78, v79
  s_add_u32 s28, s39, s36
  s_lshl_b32 s28, s28, 10
  buffer_store_dwordx4 v[84:87], v7, s[4:7], s28 offen offset:512 sc1
  s_waitcnt lgkmcnt(6)
  v_mfma_f32_32x32x16_bf16 v[32:47], v[56:59], v[216:219], v[32:47]
  s_add_u32 s37, s96, 4
  s_and_b32 s37, s37, 3
  s_lshl_b32 s37, s37, 1
  s_add_u32 s37, s37, s27
  s_add_u32 s37, s37, 0
  s_cmp_eq_u32 s27, 1
  s_cselect_b32 s37, 0, 8
  s_lshl_b32 s28, s37, 8
  v_mov_b32 v15, s28
  v_cndmask_b32 v15, v15, 0, s[24:25]
  v_add_u32 v15, v15, v8
  ds_read_b64 v[236:237], v15
  s_waitcnt lgkmcnt(5)
  v_mfma_f32_32x32x16_bf16 v[32:47], v[60:63], v[220:223], v[32:47]
  s_waitcnt lgkmcnt(3)
  v_mfma_f32_32x32x16_bf16 v[32:47], v[64:67], v[224:227], v[32:47]
  s_waitcnt lgkmcnt(1)
  v_mfma_f32_32x32x16_bf16 v[32:47], v[68:71], v[228:231], v[32:47]
  s_waitcnt lgkmcnt(0)
  v_mfma_f32_32x32x16_bf16 v[32:47], v[236:239], v[232:235], v[32:47]
  s_nop 7
  s_nop 4
  v_mul_f32 v72, v32, v32
  v_mul_f32 v73, v33, v33
  v_mul_f32 v74, v34, v34
  v_mul_f32 v75, v35, v35
  v_mul_f32 v76, v36, v36
  v_mul_f32 v77, v37, v37
  v_mul_f32 v78, v38, v38
  v_mul_f32 v79, v39, v39
  v_fma_f32 v72, v72, v10, v9
  v_fma_f32 v73, v73, v10, v9
  v_fma_f32 v74, v74, v10, v9
  v_fma_f32 v75, v75, v10, v9
  v_fma_f32 v76, v76, v10, v9
  v_fma_f32 v77, v77, v10, v9
  v_fma_f32 v78, v78, v10, v9
  v_fma_f32 v79, v79, v10, v9
  v_mul_f32 v72, v32, v72
  v_mul_f32 v73, v33, v73
  v_mul_f32 v74, v34, v74
  v_mul_f32 v75, v35, v75
  v_mul_f32 v76, v36, v76
  v_mul_f32 v77, v37, v77
  v_mul_f32 v78, v38, v78
  v_mul_f32 v79, v39, v79
  v_exp_f32 v72, v72
  v_exp_f32 v73, v73
  v_exp_f32 v74, v74
  v_exp_f32 v75, v75
  v_exp_f32 v76, v76
  v_exp_f32 v77, v77
  v_exp_f32 v78, v78
  v_exp_f32 v79, v79
  v_fma_f32 v72, v72, v11, v11
  v_fma_f32 v73, v73, v11, v11
  v_fma_f32 v74, v74, v11, v11
  v_fma_f32 v75, v75, v11, v11
  v_fma_f32 v76, v76, v11, v11
  v_fma_f32 v77, v77, v11, v11
  v_fma_f32 v78, v78, v11, v11
  v_fma_f32 v79, v79, v11, v11
  v_rcp_f32 v72, v72
  v_rcp_f32 v73, v73
  v_rcp_f32 v74, v74
  v_rcp_f32 v75, v75
  v_rcp_f32 v76, v76
  v_rcp_f32 v77, v77
  v_rcp_f32 v78, v78
  v_rcp_f32 v79, v79
  v_mul_f32 v72, v32, v72
  v_mul_f32 v73, v33, v73
  v_mul_f32 v74, v34, v74
  v_mul_f32 v75, v35, v75
  v_mul_f32 v76, v36, v76
  v_mul_f32 v77, v37, v77
  v_mul_f32 v78, v38, v78
  v_mul_f32 v79, v39, v79
  v_cvt_pk_bf16_f32 v80, v72, v73
  v_cvt_pk_bf16_f32 v81, v74, v75
  v_cvt_pk_bf16_f32 v82, v76, v77
  v_cvt_pk_bf16_f32 v83, v78, v79
  s_add_u32 s28, s39, s37
  s_lshl_b32 s28, s28, 10
  buffer_store_dwordx4 v[80:83], v7, s[4:7], s28 offen offset:0 sc1
  v_mul_f32 v72, v40, v40
  v_mul_f32 v73, v41, v41
  v_mul_f32 v74, v42, v42
  v_mul_f32 v75, v43, v43
  v_mul_f32 v76, v44, v44
  v_mul_f32 v77, v45, v45
  v_mul_f32 v78, v46, v46
  v_mul_f32 v79, v47, v47
  v_fma_f32 v72, v72, v10, v9
  v_fma_f32 v73, v73, v10, v9
  v_fma_f32 v74, v74, v10, v9
  v_fma_f32 v75, v75, v10, v9
  v_fma_f32 v76, v76, v10, v9
  v_fma_f32 v77, v77, v10, v9
  v_fma_f32 v78, v78, v10, v9
  v_fma_f32 v79, v79, v10, v9
  v_mul_f32 v72, v40, v72
  v_mul_f32 v73, v41, v73
  v_mul_f32 v74, v42, v74
  v_mul_f32 v75, v43, v75
  v_mul_f32 v76, v44, v76
  v_mul_f32 v77, v45, v77
  v_mul_f32 v78, v46, v78
  v_mul_f32 v79, v47, v79
  v_exp_f32 v72, v72
  v_exp_f32 v73, v73
  v_exp_f32 v74, v74
  v_exp_f32 v75, v75
  v_exp_f32 v76, v76
  v_exp_f32 v77, v77
  v_exp_f32 v78, v78
  v_exp_f32 v79, v79
  v_fma_f32 v72, v72, v11, v11
  v_fma_f32 v73, v73, v11, v11
  v_fma_f32 v74, v74, v11, v11
  v_fma_f32 v75, v75, v11, v11
  v_fma_f32 v76, v76, v11, v11
  v_fma_f32 v77, v77, v11, v11
  v_fma_f32 v78, v78, v11, v11
  v_fma_f32 v79, v79, v11, v11
  v_rcp_f32 v72, v72
  v_rcp_f32 v73, v73
  v_rcp_f32 v74, v74
  v_rcp_f32 v75, v75
  v_rcp_f32 v76, v76
  v_rcp_f32 v77, v77
  v_rcp_f32 v78, v78
  v_rcp_f32 v79, v79
  v_mul_f32 v72, v40, v72
  v_mul_f32 v73, v41, v73
  v_mul_f32 v74, v42, v74
  v_mul_f32 v75, v43, v75
  v_mul_f32 v76, v44, v76
  v_mul_f32 v77, v45, v77
  v_mul_f32 v78, v46, v78
  v_mul_f32 v79, v47, v79
  v_cvt_pk_bf16_f32 v84, v72, v73
  v_cvt_pk_bf16_f32 v85, v74, v75
  v_cvt_pk_bf16_f32 v86, v76, v77
  v_cvt_pk_bf16_f32 v87, v78, v79
  s_add_u32 s28, s39, s37
  s_lshl_b32 s28, s28, 10
  buffer_store_dwordx4 v[84:87], v7, s[4:7], s28 offen offset:512 sc1
  s_lshr_b32 s26, s17, 2
  s_and_b32 s27, s17, 3
  s_mul_i32 s24, s26, 9
  s_add_u32 s24, s24, 1
  s_lshr_b32 s24, s24, 1
  s_and_b32 s25, s26, 1
  v_mov_b32 v2, v3
  v_add_u32 v3, 49152, v2
  v_add_u32 v4, 98304, v2
  s_lshl_b32 s28, s19, 11
  s_add_u32 s28, s28, 9216
  v_add_u32 v5, s28, v2
  v_add_u32 v6, 49152, v5
  v_add_u32 v7, 98304, v5
  v_lshrrev_b32 v174, 5, v1
  v_lshlrev_b32 v174, 4, v174
  v_bfe_u32 v175, v1, 4, 1
  v_lshl_add_u32 v174, v175, 2, v174
  v_bfe_u32 v175, v1, 2, 2
  v_add_u32 v174, v174, v175
  v_bfe_u32 v175, v1, 1, 1
  s_lshl_b32 s28, s19, 2
  v_add_u32 v175, s28, v175
  v_and_b32 v176, 7, v174
  v_lshlrev_b32 v176, 1, v176
  v_xor_b32 v175, v175, v176
  v_xor_b32 v176, 2, v175
  v_lshlrev_b32 v174, 8, v174
  v_and_b32 v177, 1, v1
  v_lshl_add_u32 v174, v177, 3, v174
  v_add_u32 v174, 9216, v174
  v_lshl_add_u32 v168, v175, 4, v174
  v_lshl_add_u32 v171, v176, 4, v174
  v_add_u32 v169, 49152, v168
  v_add_u32 v170, 98304, v168
  v_add_u32 v172, 49152, v171
  v_add_u32 v173, 98304, v171
  s_waitcnt vmcnt(0)
  v_mov_b32 v175, 151524
  v_mov_b32 v174, 1
  s_mov_b64 exec, 1
  ds_add_rtn_u32 v174, v175, v174
  s_waitcnt lgkmcnt(0)
  s_mov_b64 exec, -1
  v_readfirstlane_b32 s28, v174
  s_cmp_eq_u32 s28, 7
  s_cbranch_scc0 L_hnl_33
  s_add_u32 s28, s59, 3
  v_mov_b32 v253, 4
  v_mov_b32 v254, s28
  s_mov_b64 exec, 1
  buffer_store_dword v254, v253, s[4:7], s101 offen sc1
  s_mov_b64 exec, -1
L_hnl_33:
  s_barrier
  ds_read_b128 v[8:11], v5 offset:0
  ds_read_b128 v[12:15], v5 offset:1024
  ds_read_b128 v[16:19], v2 offset:0
  ds_read_b128 v[20:23], v2 offset:1024
  ds_read_b128 v[24:27], v2 offset:2048
  ds_read_b128 v[28:31], v2 offset:3072
  ds_read_b128 v[32:35], v2 offset:4096
  ds_read_b128 v[36:39], v2 offset:5120
  ds_read_b128 v[40:43], v2 offset:6144
  ds_read_b128 v[44:47], v2 offset:7168
  ds_read_b128 v[48:51], v2 offset:8192
  s_waitcnt lgkmcnt(0)
  v_mfma_f32_16x16x32_bf16 v[96:99], v[16:19], v[8:11], 0
  ds_read_b128 v[52:55], v5 offset:17408
  v_mfma_f32_16x16x32_bf16 v[100:103], v[16:19], v[12:15], 0
  ds_read_b128 v[56:59], v5 offset:18432
  v_mfma_f32_16x16x32_bf16 v[104:107], v[20:23], v[8:11], 0
  ds_read_b128 v[60:63], v2 offset:17408
  v_mfma_f32_16x16x32_bf16 v[108:111], v[20:23], v[12:15], 0
  ds_read_b128 v[64:67], v2 offset:18432
  v_mfma_f32_16x16x32_bf16 v[112:115], v[24:27], v[8:11], 0
  ds_read_b128 v[68:71], v2 offset:19456
  v_mfma_f32_16x16x32_bf16 v[116:119], v[24:27], v[12:15], 0
  ds_read_b128 v[72:75], v2 offset:20480
  v_mfma_f32_16x16x32_bf16 v[120:123], v[28:31], v[8:11], 0
  v_mfma_f32_16x16x32_bf16 v[124:127], v[28:31], v[12:15], 0
  ds_read_b128 v[76:79], v2 offset:21504
  v_mfma_f32_16x16x32_bf16 v[128:131], v[32:35], v[8:11], 0
  ds_read_b128 v[80:83], v2 offset:22528
  v_mfma_f32_16x16x32_bf16 v[132:135], v[32:35], v[12:15], 0
  ds_read_b128 v[84:87], v2 offset:23552
  v_mfma_f32_16x16x32_bf16 v[136:139], v[36:39], v[8:11], 0
  ds_read_b128 v[88:91], v2 offset:24576
  v_mfma_f32_16x16x32_bf16 v[140:143], v[36:39], v[12:15], 0
  ds_read_b128 v[92:95], v2 offset:25600
  v_mfma_f32_16x16x32_bf16 v[144:147], v[40:43], v[8:11], 0
  v_mfma_f32_16x16x32_bf16 v[148:151], v[40:43], v[12:15], 0
  v_mfma_f32_16x16x32_bf16 v[152:155], v[44:47], v[8:11], 0
  v_mfma_f32_16x16x32_bf16 v[156:159], v[44:47], v[12:15], 0
  v_mfma_f32_16x16x32_bf16 v[160:163], v[48:51], v[8:11], 0
  v_mfma_f32_16x16x32_bf16 v[164:167], v[48:51], v[12:15], 0
  s_waitcnt lgkmcnt(0)
  v_mfma_f32_16x16x32_bf16 v[96:99], v[60:63], v[52:55], v[96:99]
  ds_read_b128 v[8:11], v5 offset:34816
  v_mfma_f32_16x16x32_bf16 v[100:103], v[60:63], v[56:59], v[100:103]
  ds_read_b128 v[12:15], v5 offset:35840
  v_mfma_f32_16x16x32_bf16 v[104:107], v[64:67], v[52:55], v[104:107]
  ds_read_b128 v[16:19], v2 offset:34816
  v_mfma_f32_16x16x32_bf16 v[108:111], v[64:67], v[56:59], v[108:111]
  ds_read_b128 v[20:23], v2 offset:35840
  v_mfma_f32_16x16x32_bf16 v[112:115], v[68:71], v[52:55], v[112:115]
  ds_read_b128 v[24:27], v2 offset:36864
  v_mfma_f32_16x16x32_bf16 v[116:119], v[68:71], v[56:59], v[116:119]
  ds_read_b128 v[28:31], v2 offset:37888
  v_mfma_f32_16x16x32_bf16 v[120:123], v[72:75], v[52:55], v[120:123]
  v_mfma_f32_16x16x32_bf16 v[124:127], v[72:75], v[56:59], v[124:127]
  ds_read_b128 v[32:35], v2 offset:38912
  v_mfma_f32_16x16x32_bf16 v[128:131], v[76:79], v[52:55], v[128:131]
  ds_read_b128 v[36:39], v2 offset:39936
  v_mfma_f32_16x16x32_bf16 v[132:135], v[76:79], v[56:59], v[132:135]
  ds_read_b128 v[40:43], v2 offset:40960
  v_mfma_f32_16x16x32_bf16 v[136:139], v[80:83], v[52:55], v[136:139]
  ds_read_b128 v[44:47], v2 offset:41984
  v_mfma_f32_16x16x32_bf16 v[140:143], v[80:83], v[56:59], v[140:143]
  ds_read_b128 v[48:51], v2 offset:43008
  v_mfma_f32_16x16x32_bf16 v[144:147], v[84:87], v[52:55], v[144:147]
  v_mfma_f32_16x16x32_bf16 v[148:151], v[84:87], v[56:59], v[148:151]
  v_mfma_f32_16x16x32_bf16 v[152:155], v[88:91], v[52:55], v[152:155]
  v_mfma_f32_16x16x32_bf16 v[156:159], v[88:91], v[56:59], v[156:159]
  v_mfma_f32_16x16x32_bf16 v[160:163], v[92:95], v[52:55], v[160:163]
  v_mfma_f32_16x16x32_bf16 v[164:167], v[92:95], v[56:59], v[164:167]
  s_waitcnt lgkmcnt(0)
  s_barrier
  v_mfma_f32_16x16x32_bf16 v[96:99], v[16:19], v[8:11], v[96:99]
  ds_read_b128 v[52:55], v6 offset:3072
  v_mfma_f32_16x16x32_bf16 v[100:103], v[16:19], v[12:15], v[100:103]
  ds_read_b128 v[56:59], v6 offset:4096
  v_mfma_f32_16x16x32_bf16 v[104:107], v[20:23], v[8:11], v[104:107]
  ds_read_b128 v[60:63], v3 offset:3072
  v_mfma_f32_16x16x32_bf16 v[108:111], v[20:23], v[12:15], v[108:111]
  ds_read_b128 v[64:67], v3 offset:4096
  v_mfma_f32_16x16x32_bf16 v[112:115], v[24:27], v[8:11], v[112:115]
  ds_read_b128 v[68:71], v3 offset:5120
  v_mfma_f32_16x16x32_bf16 v[116:119], v[24:27], v[12:15], v[116:119]
  ds_read_b128 v[72:75], v3 offset:6144
  v_mfma_f32_16x16x32_bf16 v[120:123], v[28:31], v[8:11], v[120:123]
  v_mfma_f32_16x16x32_bf16 v[124:127], v[28:31], v[12:15], v[124:127]
  ds_read_b128 v[76:79], v3 offset:7168
  v_mfma_f32_16x16x32_bf16 v[128:131], v[32:35], v[8:11], v[128:131]
  ds_read_b128 v[80:83], v3 offset:8192
  v_mfma_f32_16x16x32_bf16 v[132:135], v[32:35], v[12:15], v[132:135]
  ds_read_b128 v[84:87], v3 offset:9216
  v_mfma_f32_16x16x32_bf16 v[136:139], v[36:39], v[8:11], v[136:139]
  ds_read_b128 v[88:91], v3 offset:10240
  v_mfma_f32_16x16x32_bf16 v[140:143], v[36:39], v[12:15], v[140:143]
  ds_read_b128 v[92:95], v3 offset:11264
  v_mfma_f32_16x16x32_bf16 v[144:147], v[40:43], v[8:11], v[144:147]
  v_mfma_f32_16x16x32_bf16 v[148:151], v[40:43], v[12:15], v[148:151]
  v_mfma_f32_16x16x32_bf16 v[152:155], v[44:47], v[8:11], v[152:155]
  v_mfma_f32_16x16x32_bf16 v[156:159], v[44:47], v[12:15], v[156:159]
  v_mfma_f32_16x16x32_bf16 v[160:163], v[48:51], v[8:11], v[160:163]
  v_mfma_f32_16x16x32_bf16 v[164:167], v[48:51], v[12:15], v[164:167]
  s_waitcnt lgkmcnt(0)
  v_mfma_f32_16x16x32_bf16 v[96:99], v[60:63], v[52:55], v[96:99]
  ds_read_b128 v[8:11], v6 offset:24576
  v_mfma_f32_16x16x32_bf16 v[100:103], v[60:63], v[56:59], v[100:103]
  ds_read_b128 v[12:15], v6 offset:25600
  v_mfma_f32_16x16x32_bf16 v[104:107], v[64:67], v[52:55], v[104:107]
  ds_read_b128 v[16:19], v3 offset:24576
  v_mfma_f32_16x16x32_bf16 v[108:111], v[64:67], v[56:59], v[108:111]
  ds_read_b128 v[20:23], v3 offset:25600
  v_mfma_f32_16x16x32_bf16 v[112:115], v[68:71], v[52:55], v[112:115]
  ds_read_b128 v[24:27], v3 offset:26624
  v_mfma_f32_16x16x32_bf16 v[116:119], v[68:71], v[56:59], v[116:119]
  ds_read_b128 v[28:31], v3 offset:27648
  v_mfma_f32_16x16x32_bf16 v[120:123], v[72:75], v[52:55], v[120:123]
  v_mfma_f32_16x16x32_bf16 v[124:127], v[72:75], v[56:59], v[124:127]
  ds_read_b128 v[32:35], v3 offset:28672
  v_mfma_f32_16x16x32_bf16 v[128:131], v[76:79], v[52:55], v[128:131]
  ds_read_b128 v[36:39], v3 offset:29696
  v_mfma_f32_16x16x32_bf16 v[132:135], v[76:79], v[56:59], v[132:135]
  ds_read_b128 v[40:43], v3 offset:30720
  v_mfma_f32_16x16x32_bf16 v[136:139], v[80:83], v[52:55], v[136:139]
  ds_read_b128 v[44:47], v3 offset:31744
  v_mfma_f32_16x16x32_bf16 v[140:143], v[80:83], v[56:59], v[140:143]
  ds_read_b128 v[48:51], v3 offset:32768
  v_mfma_f32_16x16x32_bf16 v[144:147], v[84:87], v[52:55], v[144:147]
  v_mfma_f32_16x16x32_bf16 v[148:151], v[84:87], v[56:59], v[148:151]
  v_mfma_f32_16x16x32_bf16 v[152:155], v[88:91], v[52:55], v[152:155]
  v_mfma_f32_16x16x32_bf16 v[156:159], v[88:91], v[56:59], v[156:159]
  v_mfma_f32_16x16x32_bf16 v[160:163], v[92:95], v[52:55], v[160:163]
  v_mfma_f32_16x16x32_bf16 v[164:167], v[92:95], v[56:59], v[164:167]
  s_waitcnt lgkmcnt(0)
  s_barrier
  v_mfma_f32_16x16x32_bf16 v[96:99], v[16:19], v[8:11], v[96:99]
  ds_read_b128 v[52:55], v6 offset:41984
  v_mfma_f32_16x16x32_bf16 v[100:103], v[16:19], v[12:15], v[100:103]
  ds_read_b128 v[56:59], v6 offset:43008
  v_mfma_f32_16x16x32_bf16 v[104:107], v[20:23], v[8:11], v[104:107]
  ds_read_b128 v[60:63], v3 offset:41984
  v_mfma_f32_16x16x32_bf16 v[108:111], v[20:23], v[12:15], v[108:111]
  ds_read_b128 v[64:67], v3 offset:43008
  v_mfma_f32_16x16x32_bf16 v[112:115], v[24:27], v[8:11], v[112:115]
  ds_read_b128 v[68:71], v3 offset:44032
  v_mfma_f32_16x16x32_bf16 v[116:119], v[24:27], v[12:15], v[116:119]
  ds_read_b128 v[72:75], v3 offset:45056
  v_mfma_f32_16x16x32_bf16 v[120:123], v[28:31], v[8:11], v[120:123]
  v_mfma_f32_16x16x32_bf16 v[124:127], v[28:31], v[12:15], v[124:127]
  ds_read_b128 v[76:79], v3 offset:46080
  v_mfma_f32_16x16x32_bf16 v[128:131], v[32:35], v[8:11], v[128:131]
  ds_read_b128 v[80:83], v3 offset:47104
  v_mfma_f32_16x16x32_bf16 v[132:135], v[32:35], v[12:15], v[132:135]
  ds_read_b128 v[84:87], v3 offset:48128
  v_mfma_f32_16x16x32_bf16 v[136:139], v[36:39], v[8:11], v[136:139]
  ds_read_b128 v[88:91], v4 offset:0
  v_mfma_f32_16x16x32_bf16 v[140:143], v[36:39], v[12:15], v[140:143]
  ds_read_b128 v[92:95], v4 offset:1024
  v_mfma_f32_16x16x32_bf16 v[144:147], v[40:43], v[8:11], v[144:147]
  v_mfma_f32_16x16x32_bf16 v[148:151], v[40:43], v[12:15], v[148:151]
  v_mfma_f32_16x16x32_bf16 v[152:155], v[44:47], v[8:11], v[152:155]
  v_mfma_f32_16x16x32_bf16 v[156:159], v[44:47], v[12:15], v[156:159]
  v_mfma_f32_16x16x32_bf16 v[160:163], v[48:51], v[8:11], v[160:163]
  v_mfma_f32_16x16x32_bf16 v[164:167], v[48:51], v[12:15], v[164:167]
  s_waitcnt lgkmcnt(0)
  v_mfma_f32_16x16x32_bf16 v[96:99], v[60:63], v[52:55], v[96:99]
  ds_read_b128 v[8:11], v7 offset:10240
  v_mfma_f32_16x16x32_bf16 v[100:103], v[60:63], v[56:59], v[100:103]
  ds_read_b128 v[12:15], v7 offset:11264
  v_mfma_f32_16x16x32_bf16 v[104:107], v[64:67], v[52:55], v[104:107]
  ds_read_b128 v[16:19], v4 offset:10240
  v_mfma_f32_16x16x32_bf16 v[108:111], v[64:67], v[56:59], v[108:111]
  ds_read_b128 v[20:23], v4 offset:11264
  v_mfma_f32_16x16x32_bf16 v[112:115], v[68:71], v[52:55], v[112:115]
  ds_read_b128 v[24:27], v4 offset:12288
  v_mfma_f32_16x16x32_bf16 v[116:119], v[68:71], v[56:59], v[116:119]
  ds_read_b128 v[28:31], v4 offset:13312
  v_mfma_f32_16x16x32_bf16 v[120:123], v[72:75], v[52:55], v[120:123]
  v_mfma_f32_16x16x32_bf16 v[124:127], v[72:75], v[56:59], v[124:127]
  ds_read_b128 v[32:35], v4 offset:14336
  v_mfma_f32_16x16x32_bf16 v[128:131], v[76:79], v[52:55], v[128:131]
  ds_read_b128 v[36:39], v4 offset:15360
  v_mfma_f32_16x16x32_bf16 v[132:135], v[76:79], v[56:59], v[132:135]
  ds_read_b128 v[40:43], v4 offset:16384
  v_mfma_f32_16x16x32_bf16 v[136:139], v[80:83], v[52:55], v[136:139]
  ds_read_b128 v[44:47], v4 offset:17408
  v_mfma_f32_16x16x32_bf16 v[140:143], v[80:83], v[56:59], v[140:143]
  ds_read_b128 v[48:51], v4 offset:18432
  v_mfma_f32_16x16x32_bf16 v[144:147], v[84:87], v[52:55], v[144:147]
  v_mfma_f32_16x16x32_bf16 v[148:151], v[84:87], v[56:59], v[148:151]
  v_mfma_f32_16x16x32_bf16 v[152:155], v[88:91], v[52:55], v[152:155]
  v_mfma_f32_16x16x32_bf16 v[156:159], v[88:91], v[56:59], v[156:159]
  v_mfma_f32_16x16x32_bf16 v[160:163], v[92:95], v[52:55], v[160:163]
  v_mfma_f32_16x16x32_bf16 v[164:167], v[92:95], v[56:59], v[164:167]
  s_waitcnt lgkmcnt(0)
  s_barrier
  v_mfma_f32_16x16x32_bf16 v[96:99], v[16:19], v[8:11], v[96:99]
  ds_read_b128 v[52:55], v7 offset:27648
  v_mfma_f32_16x16x32_bf16 v[100:103], v[16:19], v[12:15], v[100:103]
  ds_read_b128 v[56:59], v7 offset:28672
  v_mfma_f32_16x16x32_bf16 v[104:107], v[20:23], v[8:11], v[104:107]
  ds_read_b128 v[60:63], v4 offset:27648
  v_mfma_f32_16x16x32_bf16 v[108:111], v[20:23], v[12:15], v[108:111]
  ds_read_b128 v[64:67], v4 offset:28672
  v_mfma_f32_16x16x32_bf16 v[112:115], v[24:27], v[8:11], v[112:115]
  ds_read_b128 v[68:71], v4 offset:29696
  v_mfma_f32_16x16x32_bf16 v[116:119], v[24:27], v[12:15], v[116:119]
  ds_read_b128 v[72:75], v4 offset:30720
  v_mfma_f32_16x16x32_bf16 v[120:123], v[28:31], v[8:11], v[120:123]
  v_mfma_f32_16x16x32_bf16 v[124:127], v[28:31], v[12:15], v[124:127]
  ds_read_b128 v[76:79], v4 offset:31744
  v_mfma_f32_16x16x32_bf16 v[128:131], v[32:35], v[8:11], v[128:131]
  ds_read_b128 v[80:83], v4 offset:32768
  v_mfma_f32_16x16x32_bf16 v[132:135], v[32:35], v[12:15], v[132:135]
  ds_read_b128 v[84:87], v4 offset:33792
  v_mfma_f32_16x16x32_bf16 v[136:139], v[36:39], v[8:11], v[136:139]
  ds_read_b128 v[88:91], v4 offset:34816
  v_mfma_f32_16x16x32_bf16 v[140:143], v[36:39], v[12:15], v[140:143]
  ds_read_b128 v[92:95], v4 offset:35840
  v_mfma_f32_16x16x32_bf16 v[144:147], v[40:43], v[8:11], v[144:147]
  v_mfma_f32_16x16x32_bf16 v[148:151], v[40:43], v[12:15], v[148:151]
  v_mfma_f32_16x16x32_bf16 v[152:155], v[44:47], v[8:11], v[152:155]
  v_mfma_f32_16x16x32_bf16 v[156:159], v[44:47], v[12:15], v[156:159]
  v_mfma_f32_16x16x32_bf16 v[160:163], v[48:51], v[8:11], v[160:163]
  v_mfma_f32_16x16x32_bf16 v[164:167], v[48:51], v[12:15], v[164:167]
  s_waitcnt lgkmcnt(0)
  v_mfma_f32_16x16x32_bf16 v[96:99], v[60:63], v[52:55], v[96:99]
  ds_read_b128 v[8:11], v5 offset:0
  v_mfma_f32_16x16x32_bf16 v[100:103], v[60:63], v[56:59], v[100:103]
  ds_read_b128 v[12:15], v5 offset:1024
  v_mfma_f32_16x16x32_bf16 v[104:107], v[64:67], v[52:55], v[104:107]
  ds_read_b128 v[16:19], v2 offset:0
  v_mfma_f32_16x16x32_bf16 v[108:111], v[64:67], v[56:59], v[108:111]
  ds_read_b128 v[20:23], v2 offset:1024
  v_mfma_f32_16x16x32_bf16 v[112:115], v[68:71], v[52:55], v[112:115]
  ds_read_b128 v[24:27], v2 offset:2048
  v_mfma_f32_16x16x32_bf16 v[116:119], v[68:71], v[56:59], v[116:119]
  ds_read_b128 v[28:31], v2 offset:3072
  v_mfma_f32_16x16x32_bf16 v[120:123], v[72:75], v[52:55], v[120:123]
  v_mfma_f32_16x16x32_bf16 v[124:127], v[72:75], v[56:59], v[124:127]
  ds_read_b128 v[32:35], v2 offset:4096
  v_mfma_f32_16x16x32_bf16 v[128:131], v[76:79], v[52:55], v[128:131]
  ds_read_b128 v[36:39], v2 offset:5120
  v_mfma_f32_16x16x32_bf16 v[132:135], v[76:79], v[56:59], v[132:135]
  ds_read_b128 v[40:43], v2 offset:6144
  v_mfma_f32_16x16x32_bf16 v[136:139], v[80:83], v[52:55], v[136:139]
  ds_read_b128 v[44:47], v2 offset:7168
  v_mfma_f32_16x16x32_bf16 v[140:143], v[80:83], v[56:59], v[140:143]
  ds_read_b128 v[48:51], v2 offset:8192
  v_mfma_f32_16x16x32_bf16 v[144:147], v[84:87], v[52:55], v[144:147]
  v_mfma_f32_16x16x32_bf16 v[148:151], v[84:87], v[56:59], v[148:151]
  v_mfma_f32_16x16x32_bf16 v[152:155], v[88:91], v[52:55], v[152:155]
  v_mfma_f32_16x16x32_bf16 v[156:159], v[88:91], v[56:59], v[156:159]
  v_mfma_f32_16x16x32_bf16 v[160:163], v[92:95], v[52:55], v[160:163]
  v_mfma_f32_16x16x32_bf16 v[164:167], v[92:95], v[56:59], v[164:167]
  s_waitcnt lgkmcnt(0)
  s_barrier
  v_mfma_f32_16x16x32_bf16 v[96:99], v[16:19], v[8:11], v[96:99]
  ds_read_b128 v[52:55], v5 offset:17408
  v_mfma_f32_16x16x32_bf16 v[100:103], v[16:19], v[12:15], v[100:103]
  ds_read_b128 v[56:59], v5 offset:18432
  v_mfma_f32_16x16x32_bf16 v[104:107], v[20:23], v[8:11], v[104:107]
  ds_read_b128 v[60:63], v2 offset:17408
  v_mfma_f32_16x16x32_bf16 v[108:111], v[20:23], v[12:15], v[108:111]
  ds_read_b128 v[64:67], v2 offset:18432
  v_mfma_f32_16x16x32_bf16 v[112:115], v[24:27], v[8:11], v[112:115]
  ds_read_b128 v[68:71], v2 offset:19456
  v_mfma_f32_16x16x32_bf16 v[116:119], v[24:27], v[12:15], v[116:119]
  ds_read_b128 v[72:75], v2 offset:20480
  v_mfma_f32_16x16x32_bf16 v[120:123], v[28:31], v[8:11], v[120:123]
  v_mfma_f32_16x16x32_bf16 v[124:127], v[28:31], v[12:15], v[124:127]
  ds_read_b128 v[76:79], v2 offset:21504
  v_mfma_f32_16x16x32_bf16 v[128:131], v[32:35], v[8:11], v[128:131]
  ds_read_b128 v[80:83], v2 offset:22528
  v_mfma_f32_16x16x32_bf16 v[132:135], v[32:35], v[12:15], v[132:135]
  ds_read_b128 v[84:87], v2 offset:23552
  v_mfma_f32_16x16x32_bf16 v[136:139], v[36:39], v[8:11], v[136:139]
  ds_read_b128 v[88:91], v2 offset:24576
  v_mfma_f32_16x16x32_bf16 v[140:143], v[36:39], v[12:15], v[140:143]
  ds_read_b128 v[92:95], v2 offset:25600
  v_mfma_f32_16x16x32_bf16 v[144:147], v[40:43], v[8:11], v[144:147]
  v_mfma_f32_16x16x32_bf16 v[148:151], v[40:43], v[12:15], v[148:151]
  v_mfma_f32_16x16x32_bf16 v[152:155], v[44:47], v[8:11], v[152:155]
  v_mfma_f32_16x16x32_bf16 v[156:159], v[44:47], v[12:15], v[156:159]
  v_mfma_f32_16x16x32_bf16 v[160:163], v[48:51], v[8:11], v[160:163]
  v_mfma_f32_16x16x32_bf16 v[164:167], v[48:51], v[12:15], v[164:167]
  s_waitcnt lgkmcnt(0)
  v_mfma_f32_16x16x32_bf16 v[96:99], v[60:63], v[52:55], v[96:99]
  ds_read_b128 v[8:11], v5 offset:34816
  v_mfma_f32_16x16x32_bf16 v[100:103], v[60:63], v[56:59], v[100:103]
  ds_read_b128 v[12:15], v5 offset:35840
  v_mfma_f32_16x16x32_bf16 v[104:107], v[64:67], v[52:55], v[104:107]
  ds_read_b128 v[16:19], v2 offset:34816
  v_mfma_f32_16x16x32_bf16 v[108:111], v[64:67], v[56:59], v[108:111]
  ds_read_b128 v[20:23], v2 offset:35840
  v_mfma_f32_16x16x32_bf16 v[112:115], v[68:71], v[52:55], v[112:115]
  ds_read_b128 v[24:27], v2 offset:36864
  v_mfma_f32_16x16x32_bf16 v[116:119], v[68:71], v[56:59], v[116:119]
  ds_read_b128 v[28:31], v2 offset:37888
  v_mfma_f32_16x16x32_bf16 v[120:123], v[72:75], v[52:55], v[120:123]
  v_mfma_f32_16x16x32_bf16 v[124:127], v[72:75], v[56:59], v[124:127]
  ds_read_b128 v[32:35], v2 offset:38912
  v_mfma_f32_16x16x32_bf16 v[128:131], v[76:79], v[52:55], v[128:131]
  ds_read_b128 v[36:39], v2 offset:39936
  v_mfma_f32_16x16x32_bf16 v[132:135], v[76:79], v[56:59], v[132:135]
  ds_read_b128 v[40:43], v2 offset:40960
  v_mfma_f32_16x16x32_bf16 v[136:139], v[80:83], v[52:55], v[136:139]
  ds_read_b128 v[44:47], v2 offset:41984
  v_mfma_f32_16x16x32_bf16 v[140:143], v[80:83], v[56:59], v[140:143]
  ds_read_b128 v[48:51], v2 offset:43008
  v_mfma_f32_16x16x32_bf16 v[144:147], v[84:87], v[52:55], v[144:147]
  v_mfma_f32_16x16x32_bf16 v[148:151], v[84:87], v[56:59], v[148:151]
  v_mfma_f32_16x16x32_bf16 v[152:155], v[88:91], v[52:55], v[152:155]
  v_mfma_f32_16x16x32_bf16 v[156:159], v[88:91], v[56:59], v[156:159]
  v_mfma_f32_16x16x32_bf16 v[160:163], v[92:95], v[52:55], v[160:163]
  v_mfma_f32_16x16x32_bf16 v[164:167], v[92:95], v[56:59], v[164:167]
  s_waitcnt lgkmcnt(0)
  s_barrier
  v_mfma_f32_16x16x32_bf16 v[96:99], v[16:19], v[8:11], v[96:99]
  ds_read_b128 v[52:55], v6 offset:3072
  v_mfma_f32_16x16x32_bf16 v[100:103], v[16:19], v[12:15], v[100:103]
  ds_read_b128 v[56:59], v6 offset:4096
  v_mfma_f32_16x16x32_bf16 v[104:107], v[20:23], v[8:11], v[104:107]
  ds_read_b128 v[60:63], v3 offset:3072
  v_mfma_f32_16x16x32_bf16 v[108:111], v[20:23], v[12:15], v[108:111]
  ds_read_b128 v[64:67], v3 offset:4096
  v_mfma_f32_16x16x32_bf16 v[112:115], v[24:27], v[8:11], v[112:115]
  ds_read_b128 v[68:71], v3 offset:5120
  v_mfma_f32_16x16x32_bf16 v[116:119], v[24:27], v[12:15], v[116:119]
  ds_read_b128 v[72:75], v3 offset:6144
  v_mfma_f32_16x16x32_bf16 v[120:123], v[28:31], v[8:11], v[120:123]
  v_mfma_f32_16x16x32_bf16 v[124:127], v[28:31], v[12:15], v[124:127]
  ds_read_b128 v[76:79], v3 offset:7168
  v_mfma_f32_16x16x32_bf16 v[128:131], v[32:35], v[8:11], v[128:131]
  ds_read_b128 v[80:83], v3 offset:8192
  v_mfma_f32_16x16x32_bf16 v[132:135], v[32:35], v[12:15], v[132:135]
  ds_read_b128 v[84:87], v3 offset:9216
  v_mfma_f32_16x16x32_bf16 v[136:139], v[36:39], v[8:11], v[136:139]
  ds_read_b128 v[88:91], v3 offset:10240
  v_mfma_f32_16x16x32_bf16 v[140:143], v[36:39], v[12:15], v[140:143]
  ds_read_b128 v[92:95], v3 offset:11264
  v_mfma_f32_16x16x32_bf16 v[144:147], v[40:43], v[8:11], v[144:147]
  v_mfma_f32_16x16x32_bf16 v[148:151], v[40:43], v[12:15], v[148:151]
  v_mfma_f32_16x16x32_bf16 v[152:155], v[44:47], v[8:11], v[152:155]
  v_mfma_f32_16x16x32_bf16 v[156:159], v[44:47], v[12:15], v[156:159]
  v_mfma_f32_16x16x32_bf16 v[160:163], v[48:51], v[8:11], v[160:163]
  v_mfma_f32_16x16x32_bf16 v[164:167], v[48:51], v[12:15], v[164:167]
  s_waitcnt lgkmcnt(0)
  v_mfma_f32_16x16x32_bf16 v[96:99], v[60:63], v[52:55], v[96:99]
  ds_read_b128 v[8:11], v6 offset:24576
  v_mfma_f32_16x16x32_bf16 v[100:103], v[60:63], v[56:59], v[100:103]
  ds_read_b128 v[12:15], v6 offset:25600
  v_mfma_f32_16x16x32_bf16 v[104:107], v[64:67], v[52:55], v[104:107]
  ds_read_b128 v[16:19], v3 offset:24576
  v_mfma_f32_16x16x32_bf16 v[108:111], v[64:67], v[56:59], v[108:111]
  ds_read_b128 v[20:23], v3 offset:25600
  v_mfma_f32_16x16x32_bf16 v[112:115], v[68:71], v[52:55], v[112:115]
  ds_read_b128 v[24:27], v3 offset:26624
  v_mfma_f32_16x16x32_bf16 v[116:119], v[68:71], v[56:59], v[116:119]
  ds_read_b128 v[28:31], v3 offset:27648
  v_mfma_f32_16x16x32_bf16 v[120:123], v[72:75], v[52:55], v[120:123]
  v_mfma_f32_16x16x32_bf16 v[124:127], v[72:75], v[56:59], v[124:127]
  ds_read_b128 v[32:35], v3 offset:28672
  v_mfma_f32_16x16x32_bf16 v[128:131], v[76:79], v[52:55], v[128:131]
  ds_read_b128 v[36:39], v3 offset:29696
  v_mfma_f32_16x16x32_bf16 v[132:135], v[76:79], v[56:59], v[132:135]
  ds_read_b128 v[40:43], v3 offset:30720
  v_mfma_f32_16x16x32_bf16 v[136:139], v[80:83], v[52:55], v[136:139]
  ds_read_b128 v[44:47], v3 offset:31744
  v_mfma_f32_16x16x32_bf16 v[140:143], v[80:83], v[56:59], v[140:143]
  ds_read_b128 v[48:51], v3 offset:32768
  v_mfma_f32_16x16x32_bf16 v[144:147], v[84:87], v[52:55], v[144:147]
  v_mfma_f32_16x16x32_bf16 v[148:151], v[84:87], v[56:59], v[148:151]
  v_mfma_f32_16x16x32_bf16 v[152:155], v[88:91], v[52:55], v[152:155]
  v_mfma_f32_16x16x32_bf16 v[156:159], v[88:91], v[56:59], v[156:159]
  v_mfma_f32_16x16x32_bf16 v[160:163], v[92:95], v[52:55], v[160:163]
  v_mfma_f32_16x16x32_bf16 v[164:167], v[92:95], v[56:59], v[164:167]
  s_waitcnt lgkmcnt(0)
  s_barrier
  v_mfma_f32_16x16x32_bf16 v[96:99], v[16:19], v[8:11], v[96:99]
  ds_read_b128 v[52:55], v6 offset:41984
  v_mfma_f32_16x16x32_bf16 v[100:103], v[16:19], v[12:15], v[100:103]
  ds_read_b128 v[56:59], v6 offset:43008
  v_mfma_f32_16x16x32_bf16 v[104:107], v[20:23], v[8:11], v[104:107]
  ds_read_b128 v[60:63], v3 offset:41984
  v_mfma_f32_16x16x32_bf16 v[108:111], v[20:23], v[12:15], v[108:111]
  ds_read_b128 v[64:67], v3 offset:43008
  v_mfma_f32_16x16x32_bf16 v[112:115], v[24:27], v[8:11], v[112:115]
  ds_read_b128 v[68:71], v3 offset:44032
  v_mfma_f32_16x16x32_bf16 v[116:119], v[24:27], v[12:15], v[116:119]
  ds_read_b128 v[72:75], v3 offset:45056
  v_mfma_f32_16x16x32_bf16 v[120:123], v[28:31], v[8:11], v[120:123]
  v_mfma_f32_16x16x32_bf16 v[124:127], v[28:31], v[12:15], v[124:127]
  ds_read_b128 v[76:79], v3 offset:46080
  v_mfma_f32_16x16x32_bf16 v[128:131], v[32:35], v[8:11], v[128:131]
  ds_read_b128 v[80:83], v3 offset:47104
  v_mfma_f32_16x16x32_bf16 v[132:135], v[32:35], v[12:15], v[132:135]
  ds_read_b128 v[84:87], v3 offset:48128
  v_mfma_f32_16x16x32_bf16 v[136:139], v[36:39], v[8:11], v[136:139]
  ds_read_b128 v[88:91], v4 offset:0
  v_mfma_f32_16x16x32_bf16 v[140:143], v[36:39], v[12:15], v[140:143]
  ds_read_b128 v[92:95], v4 offset:1024
  v_mfma_f32_16x16x32_bf16 v[144:147], v[40:43], v[8:11], v[144:147]
  v_mfma_f32_16x16x32_bf16 v[148:151], v[40:43], v[12:15], v[148:151]
  v_mfma_f32_16x16x32_bf16 v[152:155], v[44:47], v[8:11], v[152:155]
  v_mfma_f32_16x16x32_bf16 v[156:159], v[44:47], v[12:15], v[156:159]
  v_mfma_f32_16x16x32_bf16 v[160:163], v[48:51], v[8:11], v[160:163]
  v_mfma_f32_16x16x32_bf16 v[164:167], v[48:51], v[12:15], v[164:167]
  s_waitcnt lgkmcnt(0)
  v_mfma_f32_16x16x32_bf16 v[96:99], v[60:63], v[52:55], v[96:99]
  ds_read_b128 v[8:11], v7 offset:10240
  v_mfma_f32_16x16x32_bf16 v[100:103], v[60:63], v[56:59], v[100:103]
  ds_read_b128 v[12:15], v7 offset:11264
  v_mfma_f32_16x16x32_bf16 v[104:107], v[64:67], v[52:55], v[104:107]
  ds_read_b128 v[16:19], v4 offset:10240
  v_mfma_f32_16x16x32_bf16 v[108:111], v[64:67], v[56:59], v[108:111]
  ds_read_b128 v[20:23], v4 offset:11264
  v_mfma_f32_16x16x32_bf16 v[112:115], v[68:71], v[52:55], v[112:115]
  ds_read_b128 v[24:27], v4 offset:12288
  v_mfma_f32_16x16x32_bf16 v[116:119], v[68:71], v[56:59], v[116:119]
  ds_read_b128 v[28:31], v4 offset:13312
  v_mfma_f32_16x16x32_bf16 v[120:123], v[72:75], v[52:55], v[120:123]
  v_mfma_f32_16x16x32_bf16 v[124:127], v[72:75], v[56:59], v[124:127]
  ds_read_b128 v[32:35], v4 offset:14336
  v_mfma_f32_16x16x32_bf16 v[128:131], v[76:79], v[52:55], v[128:131]
  ds_read_b128 v[36:39], v4 offset:15360
  v_mfma_f32_16x16x32_bf16 v[132:135], v[76:79], v[56:59], v[132:135]
  ds_read_b128 v[40:43], v4 offset:16384
  v_mfma_f32_16x16x32_bf16 v[136:139], v[80:83], v[52:55], v[136:139]
  ds_read_b128 v[44:47], v4 offset:17408
  v_mfma_f32_16x16x32_bf16 v[140:143], v[80:83], v[56:59], v[140:143]
  ds_read_b128 v[48:51], v4 offset:18432
  v_mfma_f32_16x16x32_bf16 v[144:147], v[84:87], v[52:55], v[144:147]
  v_mfma_f32_16x16x32_bf16 v[148:151], v[84:87], v[56:59], v[148:151]
  v_mfma_f32_16x16x32_bf16 v[152:155], v[88:91], v[52:55], v[152:155]
  v_mfma_f32_16x16x32_bf16 v[156:159], v[88:91], v[56:59], v[156:159]
  v_mfma_f32_16x16x32_bf16 v[160:163], v[92:95], v[52:55], v[160:163]
  v_mfma_f32_16x16x32_bf16 v[164:167], v[92:95], v[56:59], v[164:167]
  s_waitcnt lgkmcnt(0)
  s_barrier
  v_mfma_f32_16x16x32_bf16 v[96:99], v[16:19], v[8:11], v[96:99]
  ds_read_b128 v[52:55], v7 offset:27648
  v_mfma_f32_16x16x32_bf16 v[100:103], v[16:19], v[12:15], v[100:103]
  ds_read_b128 v[56:59], v7 offset:28672
  v_mfma_f32_16x16x32_bf16 v[104:107], v[20:23], v[8:11], v[104:107]
  ds_read_b128 v[60:63], v4 offset:27648
  v_mfma_f32_16x16x32_bf16 v[108:111], v[20:23], v[12:15], v[108:111]
  ds_read_b128 v[64:67], v4 offset:28672
  v_mfma_f32_16x16x32_bf16 v[112:115], v[24:27], v[8:11], v[112:115]
  ds_read_b128 v[68:71], v4 offset:29696
  v_mfma_f32_16x16x32_bf16 v[116:119], v[24:27], v[12:15], v[116:119]
  ds_read_b128 v[72:75], v4 offset:30720
  v_mfma_f32_16x16x32_bf16 v[120:123], v[28:31], v[8:11], v[120:123]
  v_mfma_f32_16x16x32_bf16 v[124:127], v[28:31], v[12:15], v[124:127]
  ds_read_b128 v[76:79], v4 offset:31744
  v_mfma_f32_16x16x32_bf16 v[128:131], v[32:35], v[8:11], v[128:131]
  ds_read_b128 v[80:83], v4 offset:32768
  v_mfma_f32_16x16x32_bf16 v[132:135], v[32:35], v[12:15], v[132:135]
  ds_read_b128 v[84:87], v4 offset:33792
  v_mfma_f32_16x16x32_bf16 v[136:139], v[36:39], v[8:11], v[136:139]
  ds_read_b128 v[88:91], v4 offset:34816
  v_mfma_f32_16x16x32_bf16 v[140:143], v[36:39], v[12:15], v[140:143]
  ds_read_b128 v[92:95], v4 offset:35840
  v_mfma_f32_16x16x32_bf16 v[144:147], v[40:43], v[8:11], v[144:147]
  v_mfma_f32_16x16x32_bf16 v[148:151], v[40:43], v[12:15], v[148:151]
  v_mfma_f32_16x16x32_bf16 v[152:155], v[44:47], v[8:11], v[152:155]
  v_mfma_f32_16x16x32_bf16 v[156:159], v[44:47], v[12:15], v[156:159]
  v_mfma_f32_16x16x32_bf16 v[160:163], v[48:51], v[8:11], v[160:163]
  v_mfma_f32_16x16x32_bf16 v[164:167], v[48:51], v[12:15], v[164:167]
  s_waitcnt lgkmcnt(0)
  v_mfma_f32_16x16x32_bf16 v[96:99], v[60:63], v[52:55], v[96:99]
  ds_read_b128 v[8:11], v5 offset:0
  v_mfma_f32_16x16x32_bf16 v[100:103], v[60:63], v[56:59], v[100:103]
  ds_read_b128 v[12:15], v5 offset:1024
  v_mfma_f32_16x16x32_bf16 v[104:107], v[64:67], v[52:55], v[104:107]
  ds_read_b128 v[16:19], v2 offset:0
  v_mfma_f32_16x16x32_bf16 v[108:111], v[64:67], v[56:59], v[108:111]
  ds_read_b128 v[20:23], v2 offset:1024
  v_mfma_f32_16x16x32_bf16 v[112:115], v[68:71], v[52:55], v[112:115]
  ds_read_b128 v[24:27], v2 offset:2048
  v_mfma_f32_16x16x32_bf16 v[116:119], v[68:71], v[56:59], v[116:119]
  ds_read_b128 v[28:31], v2 offset:3072
  v_mfma_f32_16x16x32_bf16 v[120:123], v[72:75], v[52:55], v[120:123]
  v_mfma_f32_16x16x32_bf16 v[124:127], v[72:75], v[56:59], v[124:127]
  ds_read_b128 v[32:35], v2 offset:4096
  v_mfma_f32_16x16x32_bf16 v[128:131], v[76:79], v[52:55], v[128:131]
  ds_read_b128 v[36:39], v2 offset:5120
  v_mfma_f32_16x16x32_bf16 v[132:135], v[76:79], v[56:59], v[132:135]
  ds_read_b128 v[40:43], v2 offset:6144
  v_mfma_f32_16x16x32_bf16 v[136:139], v[80:83], v[52:55], v[136:139]
  ds_read_b128 v[44:47], v2 offset:7168
  v_mfma_f32_16x16x32_bf16 v[140:143], v[80:83], v[56:59], v[140:143]
  ds_read_b128 v[48:51], v2 offset:8192
  v_mfma_f32_16x16x32_bf16 v[144:147], v[84:87], v[52:55], v[144:147]
  v_mfma_f32_16x16x32_bf16 v[148:151], v[84:87], v[56:59], v[148:151]
  v_mfma_f32_16x16x32_bf16 v[152:155], v[88:91], v[52:55], v[152:155]
  v_mfma_f32_16x16x32_bf16 v[156:159], v[88:91], v[56:59], v[156:159]
  v_mfma_f32_16x16x32_bf16 v[160:163], v[92:95], v[52:55], v[160:163]
  v_mfma_f32_16x16x32_bf16 v[164:167], v[92:95], v[56:59], v[164:167]
  s_waitcnt lgkmcnt(0)
  s_barrier
  v_mfma_f32_16x16x32_bf16 v[96:99], v[16:19], v[8:11], v[96:99]
  ds_read_b128 v[52:55], v5 offset:17408
  v_mfma_f32_16x16x32_bf16 v[100:103], v[16:19], v[12:15], v[100:103]
  ds_read_b128 v[56:59], v5 offset:18432
  v_mfma_f32_16x16x32_bf16 v[104:107], v[20:23], v[8:11], v[104:107]
  ds_read_b128 v[60:63], v2 offset:17408
  v_mfma_f32_16x16x32_bf16 v[108:111], v[20:23], v[12:15], v[108:111]
  ds_read_b128 v[64:67], v2 offset:18432
  v_mfma_f32_16x16x32_bf16 v[112:115], v[24:27], v[8:11], v[112:115]
  ds_read_b128 v[68:71], v2 offset:19456
  v_mfma_f32_16x16x32_bf16 v[116:119], v[24:27], v[12:15], v[116:119]
  ds_read_b128 v[72:75], v2 offset:20480
  v_mfma_f32_16x16x32_bf16 v[120:123], v[28:31], v[8:11], v[120:123]
  v_mfma_f32_16x16x32_bf16 v[124:127], v[28:31], v[12:15], v[124:127]
  ds_read_b128 v[76:79], v2 offset:21504
  v_mfma_f32_16x16x32_bf16 v[128:131], v[32:35], v[8:11], v[128:131]
  ds_read_b128 v[80:83], v2 offset:22528
  v_mfma_f32_16x16x32_bf16 v[132:135], v[32:35], v[12:15], v[132:135]
  ds_read_b128 v[84:87], v2 offset:23552
  v_mfma_f32_16x16x32_bf16 v[136:139], v[36:39], v[8:11], v[136:139]
  ds_read_b128 v[88:91], v2 offset:24576
  v_mfma_f32_16x16x32_bf16 v[140:143], v[36:39], v[12:15], v[140:143]
  ds_read_b128 v[92:95], v2 offset:25600
  v_mfma_f32_16x16x32_bf16 v[144:147], v[40:43], v[8:11], v[144:147]
  v_mfma_f32_16x16x32_bf16 v[148:151], v[40:43], v[12:15], v[148:151]
  v_mfma_f32_16x16x32_bf16 v[152:155], v[44:47], v[8:11], v[152:155]
  v_mfma_f32_16x16x32_bf16 v[156:159], v[44:47], v[12:15], v[156:159]
  v_mfma_f32_16x16x32_bf16 v[160:163], v[48:51], v[8:11], v[160:163]
  v_mfma_f32_16x16x32_bf16 v[164:167], v[48:51], v[12:15], v[164:167]
  s_waitcnt lgkmcnt(0)
  v_mfma_f32_16x16x32_bf16 v[96:99], v[60:63], v[52:55], v[96:99]
  ds_read_b128 v[8:11], v5 offset:34816
  v_mfma_f32_16x16x32_bf16 v[100:103], v[60:63], v[56:59], v[100:103]
  ds_read_b128 v[12:15], v5 offset:35840
  v_mfma_f32_16x16x32_bf16 v[104:107], v[64:67], v[52:55], v[104:107]
  ds_read_b128 v[16:19], v2 offset:34816
  v_mfma_f32_16x16x32_bf16 v[108:111], v[64:67], v[56:59], v[108:111]
  ds_read_b128 v[20:23], v2 offset:35840
  v_mfma_f32_16x16x32_bf16 v[112:115], v[68:71], v[52:55], v[112:115]
  ds_read_b128 v[24:27], v2 offset:36864
  v_mfma_f32_16x16x32_bf16 v[116:119], v[68:71], v[56:59], v[116:119]
  ds_read_b128 v[28:31], v2 offset:37888
  v_mfma_f32_16x16x32_bf16 v[120:123], v[72:75], v[52:55], v[120:123]
  v_mfma_f32_16x16x32_bf16 v[124:127], v[72:75], v[56:59], v[124:127]
  ds_read_b128 v[32:35], v2 offset:38912
  v_mfma_f32_16x16x32_bf16 v[128:131], v[76:79], v[52:55], v[128:131]
  ds_read_b128 v[36:39], v2 offset:39936
  v_mfma_f32_16x16x32_bf16 v[132:135], v[76:79], v[56:59], v[132:135]
  ds_read_b128 v[40:43], v2 offset:40960
  v_mfma_f32_16x16x32_bf16 v[136:139], v[80:83], v[52:55], v[136:139]
  ds_read_b128 v[44:47], v2 offset:41984
  v_mfma_f32_16x16x32_bf16 v[140:143], v[80:83], v[56:59], v[140:143]
  ds_read_b128 v[48:51], v2 offset:43008
  v_mfma_f32_16x16x32_bf16 v[144:147], v[84:87], v[52:55], v[144:147]
  v_mfma_f32_16x16x32_bf16 v[148:151], v[84:87], v[56:59], v[148:151]
  v_mfma_f32_16x16x32_bf16 v[152:155], v[88:91], v[52:55], v[152:155]
  v_mfma_f32_16x16x32_bf16 v[156:159], v[88:91], v[56:59], v[156:159]
  v_mfma_f32_16x16x32_bf16 v[160:163], v[92:95], v[52:55], v[160:163]
  v_mfma_f32_16x16x32_bf16 v[164:167], v[92:95], v[56:59], v[164:167]
  s_waitcnt lgkmcnt(0)
  s_barrier
  v_mfma_f32_16x16x32_bf16 v[96:99], v[16:19], v[8:11], v[96:99]
  ds_read_b128 v[52:55], v6 offset:3072
  v_mfma_f32_16x16x32_bf16 v[100:103], v[16:19], v[12:15], v[100:103]
  ds_read_b128 v[56:59], v6 offset:4096
  v_mfma_f32_16x16x32_bf16 v[104:107], v[20:23], v[8:11], v[104:107]
  ds_read_b128 v[60:63], v3 offset:3072
  v_mfma_f32_16x16x32_bf16 v[108:111], v[20:23], v[12:15], v[108:111]
  ds_read_b128 v[64:67], v3 offset:4096
  v_mfma_f32_16x16x32_bf16 v[112:115], v[24:27], v[8:11], v[112:115]
  ds_read_b128 v[68:71], v3 offset:5120
  v_mfma_f32_16x16x32_bf16 v[116:119], v[24:27], v[12:15], v[116:119]
  ds_read_b128 v[72:75], v3 offset:6144
  v_mfma_f32_16x16x32_bf16 v[120:123], v[28:31], v[8:11], v[120:123]
  v_mfma_f32_16x16x32_bf16 v[124:127], v[28:31], v[12:15], v[124:127]
  ds_read_b128 v[76:79], v3 offset:7168
  v_mfma_f32_16x16x32_bf16 v[128:131], v[32:35], v[8:11], v[128:131]
  ds_read_b128 v[80:83], v3 offset:8192
  v_mfma_f32_16x16x32_bf16 v[132:135], v[32:35], v[12:15], v[132:135]
  ds_read_b128 v[84:87], v3 offset:9216
  v_mfma_f32_16x16x32_bf16 v[136:139], v[36:39], v[8:11], v[136:139]
  ds_read_b128 v[88:91], v3 offset:10240
  v_mfma_f32_16x16x32_bf16 v[140:143], v[36:39], v[12:15], v[140:143]
  ds_read_b128 v[92:95], v3 offset:11264
  v_mfma_f32_16x16x32_bf16 v[144:147], v[40:43], v[8:11], v[144:147]
  v_mfma_f32_16x16x32_bf16 v[148:151], v[40:43], v[12:15], v[148:151]
  v_mfma_f32_16x16x32_bf16 v[152:155], v[44:47], v[8:11], v[152:155]
  v_mfma_f32_16x16x32_bf16 v[156:159], v[44:47], v[12:15], v[156:159]
  v_mfma_f32_16x16x32_bf16 v[160:163], v[48:51], v[8:11], v[160:163]
  v_mfma_f32_16x16x32_bf16 v[164:167], v[48:51], v[12:15], v[164:167]
  s_waitcnt lgkmcnt(0)
  v_mfma_f32_16x16x32_bf16 v[96:99], v[60:63], v[52:55], v[96:99]
  ds_read_b128 v[8:11], v6 offset:24576
  v_mfma_f32_16x16x32_bf16 v[100:103], v[60:63], v[56:59], v[100:103]
  ds_read_b128 v[12:15], v6 offset:25600
  v_mfma_f32_16x16x32_bf16 v[104:107], v[64:67], v[52:55], v[104:107]
  ds_read_b128 v[16:19], v3 offset:24576
  v_mfma_f32_16x16x32_bf16 v[108:111], v[64:67], v[56:59], v[108:111]
  ds_read_b128 v[20:23], v3 offset:25600
  v_mfma_f32_16x16x32_bf16 v[112:115], v[68:71], v[52:55], v[112:115]
  ds_read_b128 v[24:27], v3 offset:26624
  v_mfma_f32_16x16x32_bf16 v[116:119], v[68:71], v[56:59], v[116:119]
  ds_read_b128 v[28:31], v3 offset:27648
  v_mfma_f32_16x16x32_bf16 v[120:123], v[72:75], v[52:55], v[120:123]
  v_mfma_f32_16x16x32_bf16 v[124:127], v[72:75], v[56:59], v[124:127]
  ds_read_b128 v[32:35], v3 offset:28672
  v_mfma_f32_16x16x32_bf16 v[128:131], v[76:79], v[52:55], v[128:131]
  ds_read_b128 v[36:39], v3 offset:29696
  v_mfma_f32_16x16x32_bf16 v[132:135], v[76:79], v[56:59], v[132:135]
  ds_read_b128 v[40:43], v3 offset:30720
  v_mfma_f32_16x16x32_bf16 v[136:139], v[80:83], v[52:55], v[136:139]
  ds_read_b128 v[44:47], v3 offset:31744
  v_mfma_f32_16x16x32_bf16 v[140:143], v[80:83], v[56:59], v[140:143]
  ds_read_b128 v[48:51], v3 offset:32768
  v_mfma_f32_16x16x32_bf16 v[144:147], v[84:87], v[52:55], v[144:147]
  v_mfma_f32_16x16x32_bf16 v[148:151], v[84:87], v[56:59], v[148:151]
  v_mfma_f32_16x16x32_bf16 v[152:155], v[88:91], v[52:55], v[152:155]
  v_mfma_f32_16x16x32_bf16 v[156:159], v[88:91], v[56:59], v[156:159]
  v_mfma_f32_16x16x32_bf16 v[160:163], v[92:95], v[52:55], v[160:163]
  v_mfma_f32_16x16x32_bf16 v[164:167], v[92:95], v[56:59], v[164:167]
  s_waitcnt lgkmcnt(0)
  s_barrier
  v_mfma_f32_16x16x32_bf16 v[96:99], v[16:19], v[8:11], v[96:99]
  ds_read_b128 v[52:55], v6 offset:41984
  v_mfma_f32_16x16x32_bf16 v[100:103], v[16:19], v[12:15], v[100:103]
  ds_read_b128 v[56:59], v6 offset:43008
  v_mfma_f32_16x16x32_bf16 v[104:107], v[20:23], v[8:11], v[104:107]
  ds_read_b128 v[60:63], v3 offset:41984
  v_mfma_f32_16x16x32_bf16 v[108:111], v[20:23], v[12:15], v[108:111]
  ds_read_b128 v[64:67], v3 offset:43008
  v_mfma_f32_16x16x32_bf16 v[112:115], v[24:27], v[8:11], v[112:115]
  ds_read_b128 v[68:71], v3 offset:44032
  v_mfma_f32_16x16x32_bf16 v[116:119], v[24:27], v[12:15], v[116:119]
  ds_read_b128 v[72:75], v3 offset:45056
  v_mfma_f32_16x16x32_bf16 v[120:123], v[28:31], v[8:11], v[120:123]
  v_mfma_f32_16x16x32_bf16 v[124:127], v[28:31], v[12:15], v[124:127]
  ds_read_b128 v[76:79], v3 offset:46080
  v_mfma_f32_16x16x32_bf16 v[128:131], v[32:35], v[8:11], v[128:131]
  ds_read_b128 v[80:83], v3 offset:47104
  v_mfma_f32_16x16x32_bf16 v[132:135], v[32:35], v[12:15], v[132:135]
  ds_read_b128 v[84:87], v3 offset:48128
  v_mfma_f32_16x16x32_bf16 v[136:139], v[36:39], v[8:11], v[136:139]
  ds_read_b128 v[88:91], v4 offset:0
  v_mfma_f32_16x16x32_bf16 v[140:143], v[36:39], v[12:15], v[140:143]
  ds_read_b128 v[92:95], v4 offset:1024
  v_mfma_f32_16x16x32_bf16 v[144:147], v[40:43], v[8:11], v[144:147]
  v_mfma_f32_16x16x32_bf16 v[148:151], v[40:43], v[12:15], v[148:151]
  v_mfma_f32_16x16x32_bf16 v[152:155], v[44:47], v[8:11], v[152:155]
  v_mfma_f32_16x16x32_bf16 v[156:159], v[44:47], v[12:15], v[156:159]
  v_mfma_f32_16x16x32_bf16 v[160:163], v[48:51], v[8:11], v[160:163]
  v_mfma_f32_16x16x32_bf16 v[164:167], v[48:51], v[12:15], v[164:167]
  s_waitcnt lgkmcnt(0)
  v_mfma_f32_16x16x32_bf16 v[96:99], v[60:63], v[52:55], v[96:99]
  ds_read_b128 v[8:11], v7 offset:10240
  v_mfma_f32_16x16x32_bf16 v[100:103], v[60:63], v[56:59], v[100:103]
  ds_read_b128 v[12:15], v7 offset:11264
  v_mfma_f32_16x16x32_bf16 v[104:107], v[64:67], v[52:55], v[104:107]
  ds_read_b128 v[16:19], v4 offset:10240
  v_mfma_f32_16x16x32_bf16 v[108:111], v[64:67], v[56:59], v[108:111]
  ds_read_b128 v[20:23], v4 offset:11264
  v_mfma_f32_16x16x32_bf16 v[112:115], v[68:71], v[52:55], v[112:115]
  ds_read_b128 v[24:27], v4 offset:12288
  v_mfma_f32_16x16x32_bf16 v[116:119], v[68:71], v[56:59], v[116:119]
  ds_read_b128 v[28:31], v4 offset:13312
  v_mfma_f32_16x16x32_bf16 v[120:123], v[72:75], v[52:55], v[120:123]
  v_mfma_f32_16x16x32_bf16 v[124:127], v[72:75], v[56:59], v[124:127]
  ds_read_b128 v[32:35], v4 offset:14336
  v_mfma_f32_16x16x32_bf16 v[128:131], v[76:79], v[52:55], v[128:131]
  ds_read_b128 v[36:39], v4 offset:15360
  v_mfma_f32_16x16x32_bf16 v[132:135], v[76:79], v[56:59], v[132:135]
  ds_read_b128 v[40:43], v4 offset:16384
  v_mfma_f32_16x16x32_bf16 v[136:139], v[80:83], v[52:55], v[136:139]
  ds_read_b128 v[44:47], v4 offset:17408
  v_mfma_f32_16x16x32_bf16 v[140:143], v[80:83], v[56:59], v[140:143]
  ds_read_b128 v[48:51], v4 offset:18432
  v_mfma_f32_16x16x32_bf16 v[144:147], v[84:87], v[52:55], v[144:147]
  v_mfma_f32_16x16x32_bf16 v[148:151], v[84:87], v[56:59], v[148:151]
  v_mfma_f32_16x16x32_bf16 v[152:155], v[88:91], v[52:55], v[152:155]
  v_mfma_f32_16x16x32_bf16 v[156:159], v[88:91], v[56:59], v[156:159]
  v_mfma_f32_16x16x32_bf16 v[160:163], v[92:95], v[52:55], v[160:163]
  v_mfma_f32_16x16x32_bf16 v[164:167], v[92:95], v[56:59], v[164:167]
  s_waitcnt lgkmcnt(0)
  s_barrier
  v_mfma_f32_16x16x32_bf16 v[96:99], v[16:19], v[8:11], v[96:99]
  ds_read_b128 v[52:55], v7 offset:27648
  v_mfma_f32_16x16x32_bf16 v[100:103], v[16:19], v[12:15], v[100:103]
  ds_read_b128 v[56:59], v7 offset:28672
  v_mfma_f32_16x16x32_bf16 v[104:107], v[20:23], v[8:11], v[104:107]
  ds_read_b128 v[60:63], v4 offset:27648
  v_mfma_f32_16x16x32_bf16 v[108:111], v[20:23], v[12:15], v[108:111]
  ds_read_b128 v[64:67], v4 offset:28672
  v_mfma_f32_16x16x32_bf16 v[112:115], v[24:27], v[8:11], v[112:115]
  ds_read_b128 v[68:71], v4 offset:29696
  v_mfma_f32_16x16x32_bf16 v[116:119], v[24:27], v[12:15], v[116:119]
  ds_read_b128 v[72:75], v4 offset:30720
  v_mfma_f32_16x16x32_bf16 v[120:123], v[28:31], v[8:11], v[120:123]
  v_mfma_f32_16x16x32_bf16 v[124:127], v[28:31], v[12:15], v[124:127]
  ds_read_b128 v[76:79], v4 offset:31744
  v_mfma_f32_16x16x32_bf16 v[128:131], v[32:35], v[8:11], v[128:131]
  ds_read_b128 v[80:83], v4 offset:32768
  v_mfma_f32_16x16x32_bf16 v[132:135], v[32:35], v[12:15], v[132:135]
  ds_read_b128 v[84:87], v4 offset:33792
  v_mfma_f32_16x16x32_bf16 v[136:139], v[36:39], v[8:11], v[136:139]
  ds_read_b128 v[88:91], v4 offset:34816
  v_mfma_f32_16x16x32_bf16 v[140:143], v[36:39], v[12:15], v[140:143]
  ds_read_b128 v[92:95], v4 offset:35840
  v_mfma_f32_16x16x32_bf16 v[144:147], v[40:43], v[8:11], v[144:147]
  v_mfma_f32_16x16x32_bf16 v[148:151], v[40:43], v[12:15], v[148:151]
  v_mfma_f32_16x16x32_bf16 v[152:155], v[44:47], v[8:11], v[152:155]
  v_mfma_f32_16x16x32_bf16 v[156:159], v[44:47], v[12:15], v[156:159]
  v_mfma_f32_16x16x32_bf16 v[160:163], v[48:51], v[8:11], v[160:163]
  v_mfma_f32_16x16x32_bf16 v[164:167], v[48:51], v[12:15], v[164:167]
  s_waitcnt lgkmcnt(0)
  v_mfma_f32_16x16x32_bf16 v[96:99], v[60:63], v[52:55], v[96:99]
  ds_read_b128 v[8:11], v5 offset:0
  v_mfma_f32_16x16x32_bf16 v[100:103], v[60:63], v[56:59], v[100:103]
  ds_read_b128 v[12:15], v5 offset:1024
  v_mfma_f32_16x16x32_bf16 v[104:107], v[64:67], v[52:55], v[104:107]
  ds_read_b128 v[16:19], v2 offset:0
  v_mfma_f32_16x16x32_bf16 v[108:111], v[64:67], v[56:59], v[108:111]
  ds_read_b128 v[20:23], v2 offset:1024
  v_mfma_f32_16x16x32_bf16 v[112:115], v[68:71], v[52:55], v[112:115]
  ds_read_b128 v[24:27], v2 offset:2048
  v_mfma_f32_16x16x32_bf16 v[116:119], v[68:71], v[56:59], v[116:119]
  ds_read_b128 v[28:31], v2 offset:3072
  v_mfma_f32_16x16x32_bf16 v[120:123], v[72:75], v[52:55], v[120:123]
  v_mfma_f32_16x16x32_bf16 v[124:127], v[72:75], v[56:59], v[124:127]
  ds_read_b128 v[32:35], v2 offset:4096
  v_mfma_f32_16x16x32_bf16 v[128:131], v[76:79], v[52:55], v[128:131]
  ds_read_b128 v[36:39], v2 offset:5120
  v_mfma_f32_16x16x32_bf16 v[132:135], v[76:79], v[56:59], v[132:135]
  ds_read_b128 v[40:43], v2 offset:6144
  v_mfma_f32_16x16x32_bf16 v[136:139], v[80:83], v[52:55], v[136:139]
  ds_read_b128 v[44:47], v2 offset:7168
  v_mfma_f32_16x16x32_bf16 v[140:143], v[80:83], v[56:59], v[140:143]
  ds_read_b128 v[48:51], v2 offset:8192
  v_mfma_f32_16x16x32_bf16 v[144:147], v[84:87], v[52:55], v[144:147]
  v_mfma_f32_16x16x32_bf16 v[148:151], v[84:87], v[56:59], v[148:151]
  v_mfma_f32_16x16x32_bf16 v[152:155], v[88:91], v[52:55], v[152:155]
  v_mfma_f32_16x16x32_bf16 v[156:159], v[88:91], v[56:59], v[156:159]
  v_mfma_f32_16x16x32_bf16 v[160:163], v[92:95], v[52:55], v[160:163]
  v_mfma_f32_16x16x32_bf16 v[164:167], v[92:95], v[56:59], v[164:167]
  s_waitcnt lgkmcnt(0)
  s_barrier
  v_mfma_f32_16x16x32_bf16 v[96:99], v[16:19], v[8:11], v[96:99]
  ds_read_b128 v[52:55], v5 offset:17408
  v_mfma_f32_16x16x32_bf16 v[100:103], v[16:19], v[12:15], v[100:103]
  ds_read_b128 v[56:59], v5 offset:18432
  v_mfma_f32_16x16x32_bf16 v[104:107], v[20:23], v[8:11], v[104:107]
  ds_read_b128 v[60:63], v2 offset:17408
  v_mfma_f32_16x16x32_bf16 v[108:111], v[20:23], v[12:15], v[108:111]
  ds_read_b128 v[64:67], v2 offset:18432
  v_mfma_f32_16x16x32_bf16 v[112:115], v[24:27], v[8:11], v[112:115]
  ds_read_b128 v[68:71], v2 offset:19456
  v_mfma_f32_16x16x32_bf16 v[116:119], v[24:27], v[12:15], v[116:119]
  ds_read_b128 v[72:75], v2 offset:20480
  v_mfma_f32_16x16x32_bf16 v[120:123], v[28:31], v[8:11], v[120:123]
  v_mfma_f32_16x16x32_bf16 v[124:127], v[28:31], v[12:15], v[124:127]
  ds_read_b128 v[76:79], v2 offset:21504
  v_mfma_f32_16x16x32_bf16 v[128:131], v[32:35], v[8:11], v[128:131]
  ds_read_b128 v[80:83], v2 offset:22528
  v_mfma_f32_16x16x32_bf16 v[132:135], v[32:35], v[12:15], v[132:135]
  ds_read_b128 v[84:87], v2 offset:23552
  v_mfma_f32_16x16x32_bf16 v[136:139], v[36:39], v[8:11], v[136:139]
  ds_read_b128 v[88:91], v2 offset:24576
  v_mfma_f32_16x16x32_bf16 v[140:143], v[36:39], v[12:15], v[140:143]
  ds_read_b128 v[92:95], v2 offset:25600
  v_mfma_f32_16x16x32_bf16 v[144:147], v[40:43], v[8:11], v[144:147]
  v_mfma_f32_16x16x32_bf16 v[148:151], v[40:43], v[12:15], v[148:151]
  v_mfma_f32_16x16x32_bf16 v[152:155], v[44:47], v[8:11], v[152:155]
  v_mfma_f32_16x16x32_bf16 v[156:159], v[44:47], v[12:15], v[156:159]
  v_mfma_f32_16x16x32_bf16 v[160:163], v[48:51], v[8:11], v[160:163]
  v_mfma_f32_16x16x32_bf16 v[164:167], v[48:51], v[12:15], v[164:167]
  s_waitcnt lgkmcnt(0)
  v_mfma_f32_16x16x32_bf16 v[96:99], v[60:63], v[52:55], v[96:99]
  ds_read_b128 v[8:11], v5 offset:34816
  v_mfma_f32_16x16x32_bf16 v[100:103], v[60:63], v[56:59], v[100:103]
  ds_read_b128 v[12:15], v5 offset:35840
  v_mfma_f32_16x16x32_bf16 v[104:107], v[64:67], v[52:55], v[104:107]
  ds_read_b128 v[16:19], v2 offset:34816
  v_mfma_f32_16x16x32_bf16 v[108:111], v[64:67], v[56:59], v[108:111]
  ds_read_b128 v[20:23], v2 offset:35840
  v_mfma_f32_16x16x32_bf16 v[112:115], v[68:71], v[52:55], v[112:115]
  ds_read_b128 v[24:27], v2 offset:36864
  v_mfma_f32_16x16x32_bf16 v[116:119], v[68:71], v[56:59], v[116:119]
  ds_read_b128 v[28:31], v2 offset:37888
  v_mfma_f32_16x16x32_bf16 v[120:123], v[72:75], v[52:55], v[120:123]
  v_mfma_f32_16x16x32_bf16 v[124:127], v[72:75], v[56:59], v[124:127]
  ds_read_b128 v[32:35], v2 offset:38912
  v_mfma_f32_16x16x32_bf16 v[128:131], v[76:79], v[52:55], v[128:131]
  ds_read_b128 v[36:39], v2 offset:39936
  v_mfma_f32_16x16x32_bf16 v[132:135], v[76:79], v[56:59], v[132:135]
  ds_read_b128 v[40:43], v2 offset:40960
  v_mfma_f32_16x16x32_bf16 v[136:139], v[80:83], v[52:55], v[136:139]
  ds_read_b128 v[44:47], v2 offset:41984
  v_mfma_f32_16x16x32_bf16 v[140:143], v[80:83], v[56:59], v[140:143]
  ds_read_b128 v[48:51], v2 offset:43008
  v_mfma_f32_16x16x32_bf16 v[144:147], v[84:87], v[52:55], v[144:147]
  v_mfma_f32_16x16x32_bf16 v[148:151], v[84:87], v[56:59], v[148:151]
  v_mfma_f32_16x16x32_bf16 v[152:155], v[88:91], v[52:55], v[152:155]
  v_mfma_f32_16x16x32_bf16 v[156:159], v[88:91], v[56:59], v[156:159]
  v_mfma_f32_16x16x32_bf16 v[160:163], v[92:95], v[52:55], v[160:163]
  v_mfma_f32_16x16x32_bf16 v[164:167], v[92:95], v[56:59], v[164:167]
  s_waitcnt lgkmcnt(0)
  s_barrier
  v_mfma_f32_16x16x32_bf16 v[96:99], v[16:19], v[8:11], v[96:99]
  ds_read_b128 v[52:55], v6 offset:3072
  v_mfma_f32_16x16x32_bf16 v[100:103], v[16:19], v[12:15], v[100:103]
  ds_read_b128 v[56:59], v6 offset:4096
  v_mfma_f32_16x16x32_bf16 v[104:107], v[20:23], v[8:11], v[104:107]
  ds_read_b128 v[60:63], v3 offset:3072
  v_mfma_f32_16x16x32_bf16 v[108:111], v[20:23], v[12:15], v[108:111]
  ds_read_b128 v[64:67], v3 offset:4096
  v_mfma_f32_16x16x32_bf16 v[112:115], v[24:27], v[8:11], v[112:115]
  ds_read_b128 v[68:71], v3 offset:5120
  v_mfma_f32_16x16x32_bf16 v[116:119], v[24:27], v[12:15], v[116:119]
  ds_read_b128 v[72:75], v3 offset:6144
  v_mfma_f32_16x16x32_bf16 v[120:123], v[28:31], v[8:11], v[120:123]
  v_mfma_f32_16x16x32_bf16 v[124:127], v[28:31], v[12:15], v[124:127]
  ds_read_b128 v[76:79], v3 offset:7168
  v_mfma_f32_16x16x32_bf16 v[128:131], v[32:35], v[8:11], v[128:131]
  ds_read_b128 v[80:83], v3 offset:8192
  v_mfma_f32_16x16x32_bf16 v[132:135], v[32:35], v[12:15], v[132:135]
  ds_read_b128 v[84:87], v3 offset:9216
  v_mfma_f32_16x16x32_bf16 v[136:139], v[36:39], v[8:11], v[136:139]
  ds_read_b128 v[88:91], v3 offset:10240
  v_mfma_f32_16x16x32_bf16 v[140:143], v[36:39], v[12:15], v[140:143]
  ds_read_b128 v[92:95], v3 offset:11264
  v_mfma_f32_16x16x32_bf16 v[144:147], v[40:43], v[8:11], v[144:147]
  v_mfma_f32_16x16x32_bf16 v[148:151], v[40:43], v[12:15], v[148:151]
  v_mfma_f32_16x16x32_bf16 v[152:155], v[44:47], v[8:11], v[152:155]
  v_mfma_f32_16x16x32_bf16 v[156:159], v[44:47], v[12:15], v[156:159]
  v_mfma_f32_16x16x32_bf16 v[160:163], v[48:51], v[8:11], v[160:163]
  v_mfma_f32_16x16x32_bf16 v[164:167], v[48:51], v[12:15], v[164:167]
  s_waitcnt lgkmcnt(0)
  v_mfma_f32_16x16x32_bf16 v[96:99], v[60:63], v[52:55], v[96:99]
  ds_read_b128 v[8:11], v6 offset:24576
  v_mfma_f32_16x16x32_bf16 v[100:103], v[60:63], v[56:59], v[100:103]
  ds_read_b128 v[12:15], v6 offset:25600
  v_mfma_f32_16x16x32_bf16 v[104:107], v[64:67], v[52:55], v[104:107]
  ds_read_b128 v[16:19], v3 offset:24576
  v_mfma_f32_16x16x32_bf16 v[108:111], v[64:67], v[56:59], v[108:111]
  ds_read_b128 v[20:23], v3 offset:25600
  v_mfma_f32_16x16x32_bf16 v[112:115], v[68:71], v[52:55], v[112:115]
  ds_read_b128 v[24:27], v3 offset:26624
  v_mfma_f32_16x16x32_bf16 v[116:119], v[68:71], v[56:59], v[116:119]
  ds_read_b128 v[28:31], v3 offset:27648
  v_mfma_f32_16x16x32_bf16 v[120:123], v[72:75], v[52:55], v[120:123]
  v_mfma_f32_16x16x32_bf16 v[124:127], v[72:75], v[56:59], v[124:127]
  ds_read_b128 v[32:35], v3 offset:28672
  v_mfma_f32_16x16x32_bf16 v[128:131], v[76:79], v[52:55], v[128:131]
  ds_read_b128 v[36:39], v3 offset:29696
  v_mfma_f32_16x16x32_bf16 v[132:135], v[76:79], v[56:59], v[132:135]
  ds_read_b128 v[40:43], v3 offset:30720
  v_mfma_f32_16x16x32_bf16 v[136:139], v[80:83], v[52:55], v[136:139]
  ds_read_b128 v[44:47], v3 offset:31744
  v_mfma_f32_16x16x32_bf16 v[140:143], v[80:83], v[56:59], v[140:143]
  ds_read_b128 v[48:51], v3 offset:32768
  v_mfma_f32_16x16x32_bf16 v[144:147], v[84:87], v[52:55], v[144:147]
  v_mfma_f32_16x16x32_bf16 v[148:151], v[84:87], v[56:59], v[148:151]
  v_mfma_f32_16x16x32_bf16 v[152:155], v[88:91], v[52:55], v[152:155]
  v_mfma_f32_16x16x32_bf16 v[156:159], v[88:91], v[56:59], v[156:159]
  v_mfma_f32_16x16x32_bf16 v[160:163], v[92:95], v[52:55], v[160:163]
  v_mfma_f32_16x16x32_bf16 v[164:167], v[92:95], v[56:59], v[164:167]
  s_waitcnt lgkmcnt(0)
  s_barrier
  v_mfma_f32_16x16x32_bf16 v[96:99], v[16:19], v[8:11], v[96:99]
  ds_read_b128 v[52:55], v6 offset:41984
  v_mfma_f32_16x16x32_bf16 v[100:103], v[16:19], v[12:15], v[100:103]
  ds_read_b128 v[56:59], v6 offset:43008
  v_mfma_f32_16x16x32_bf16 v[104:107], v[20:23], v[8:11], v[104:107]
  ds_read_b128 v[60:63], v3 offset:41984
  v_mfma_f32_16x16x32_bf16 v[108:111], v[20:23], v[12:15], v[108:111]
  ds_read_b128 v[64:67], v3 offset:43008
  v_mfma_f32_16x16x32_bf16 v[112:115], v[24:27], v[8:11], v[112:115]
  ds_read_b128 v[68:71], v3 offset:44032
  v_mfma_f32_16x16x32_bf16 v[116:119], v[24:27], v[12:15], v[116:119]
  ds_read_b128 v[72:75], v3 offset:45056
  v_mfma_f32_16x16x32_bf16 v[120:123], v[28:31], v[8:11], v[120:123]
  v_mfma_f32_16x16x32_bf16 v[124:127], v[28:31], v[12:15], v[124:127]
  ds_read_b128 v[76:79], v3 offset:46080
  v_mfma_f32_16x16x32_bf16 v[128:131], v[32:35], v[8:11], v[128:131]
  ds_read_b128 v[80:83], v3 offset:47104
  v_mfma_f32_16x16x32_bf16 v[132:135], v[32:35], v[12:15], v[132:135]
  ds_read_b128 v[84:87], v3 offset:48128
  v_mfma_f32_16x16x32_bf16 v[136:139], v[36:39], v[8:11], v[136:139]
  ds_read_b128 v[88:91], v4 offset:0
  v_mfma_f32_16x16x32_bf16 v[140:143], v[36:39], v[12:15], v[140:143]
  ds_read_b128 v[92:95], v4 offset:1024
  v_mfma_f32_16x16x32_bf16 v[144:147], v[40:43], v[8:11], v[144:147]
  v_mfma_f32_16x16x32_bf16 v[148:151], v[40:43], v[12:15], v[148:151]
  v_mfma_f32_16x16x32_bf16 v[152:155], v[44:47], v[8:11], v[152:155]
  v_mfma_f32_16x16x32_bf16 v[156:159], v[44:47], v[12:15], v[156:159]
  v_mfma_f32_16x16x32_bf16 v[160:163], v[48:51], v[8:11], v[160:163]
  v_mfma_f32_16x16x32_bf16 v[164:167], v[48:51], v[12:15], v[164:167]
  s_waitcnt lgkmcnt(0)
  v_mfma_f32_16x16x32_bf16 v[96:99], v[60:63], v[52:55], v[96:99]
  ds_read_b128 v[8:11], v7 offset:10240
  v_mfma_f32_16x16x32_bf16 v[100:103], v[60:63], v[56:59], v[100:103]
  ds_read_b128 v[12:15], v7 offset:11264
  v_mfma_f32_16x16x32_bf16 v[104:107], v[64:67], v[52:55], v[104:107]
  ds_read_b128 v[16:19], v4 offset:10240
  v_mfma_f32_16x16x32_bf16 v[108:111], v[64:67], v[56:59], v[108:111]
  ds_read_b128 v[20:23], v4 offset:11264
  v_mfma_f32_16x16x32_bf16 v[112:115], v[68:71], v[52:55], v[112:115]
  ds_read_b128 v[24:27], v4 offset:12288
  v_mfma_f32_16x16x32_bf16 v[116:119], v[68:71], v[56:59], v[116:119]
  ds_read_b128 v[28:31], v4 offset:13312
  v_mfma_f32_16x16x32_bf16 v[120:123], v[72:75], v[52:55], v[120:123]
  v_mfma_f32_16x16x32_bf16 v[124:127], v[72:75], v[56:59], v[124:127]
  ds_read_b128 v[32:35], v4 offset:14336
  v_mfma_f32_16x16x32_bf16 v[128:131], v[76:79], v[52:55], v[128:131]
  ds_read_b128 v[36:39], v4 offset:15360
  v_mfma_f32_16x16x32_bf16 v[132:135], v[76:79], v[56:59], v[132:135]
  ds_read_b128 v[40:43], v4 offset:16384
  v_mfma_f32_16x16x32_bf16 v[136:139], v[80:83], v[52:55], v[136:139]
  ds_read_b128 v[44:47], v4 offset:17408
  v_mfma_f32_16x16x32_bf16 v[140:143], v[80:83], v[56:59], v[140:143]
  ds_read_b128 v[48:51], v4 offset:18432
  v_mfma_f32_16x16x32_bf16 v[144:147], v[84:87], v[52:55], v[144:147]
  v_mfma_f32_16x16x32_bf16 v[148:151], v[84:87], v[56:59], v[148:151]
  v_mfma_f32_16x16x32_bf16 v[152:155], v[88:91], v[52:55], v[152:155]
  v_mfma_f32_16x16x32_bf16 v[156:159], v[88:91], v[56:59], v[156:159]
  v_mfma_f32_16x16x32_bf16 v[160:163], v[92:95], v[52:55], v[160:163]
  v_mfma_f32_16x16x32_bf16 v[164:167], v[92:95], v[56:59], v[164:167]
  s_waitcnt lgkmcnt(0)
  s_barrier
  v_mfma_f32_16x16x32_bf16 v[96:99], v[16:19], v[8:11], v[96:99]
  ds_read_b128 v[52:55], v7 offset:27648
  v_mfma_f32_16x16x32_bf16 v[100:103], v[16:19], v[12:15], v[100:103]
  ds_read_b128 v[56:59], v7 offset:28672
  v_mfma_f32_16x16x32_bf16 v[104:107], v[20:23], v[8:11], v[104:107]
  ds_read_b128 v[60:63], v4 offset:27648
  v_mfma_f32_16x16x32_bf16 v[108:111], v[20:23], v[12:15], v[108:111]
  ds_read_b128 v[64:67], v4 offset:28672
  v_mfma_f32_16x16x32_bf16 v[112:115], v[24:27], v[8:11], v[112:115]
  ds_read_b128 v[68:71], v4 offset:29696
  v_mfma_f32_16x16x32_bf16 v[116:119], v[24:27], v[12:15], v[116:119]
  ds_read_b128 v[72:75], v4 offset:30720
  v_mfma_f32_16x16x32_bf16 v[120:123], v[28:31], v[8:11], v[120:123]
  v_mfma_f32_16x16x32_bf16 v[124:127], v[28:31], v[12:15], v[124:127]
  ds_read_b128 v[76:79], v4 offset:31744
  v_mfma_f32_16x16x32_bf16 v[128:131], v[32:35], v[8:11], v[128:131]
  ds_read_b128 v[80:83], v4 offset:32768
  v_mfma_f32_16x16x32_bf16 v[132:135], v[32:35], v[12:15], v[132:135]
  ds_read_b128 v[84:87], v4 offset:33792
  v_mfma_f32_16x16x32_bf16 v[136:139], v[36:39], v[8:11], v[136:139]
  ds_read_b128 v[88:91], v4 offset:34816
  v_mfma_f32_16x16x32_bf16 v[140:143], v[36:39], v[12:15], v[140:143]
  ds_read_b128 v[92:95], v4 offset:35840
  v_mfma_f32_16x16x32_bf16 v[144:147], v[40:43], v[8:11], v[144:147]
  v_mfma_f32_16x16x32_bf16 v[148:151], v[40:43], v[12:15], v[148:151]
  v_mfma_f32_16x16x32_bf16 v[152:155], v[44:47], v[8:11], v[152:155]
  v_mfma_f32_16x16x32_bf16 v[156:159], v[44:47], v[12:15], v[156:159]
  v_mfma_f32_16x16x32_bf16 v[160:163], v[48:51], v[8:11], v[160:163]
  v_mfma_f32_16x16x32_bf16 v[164:167], v[48:51], v[12:15], v[164:167]
  s_waitcnt lgkmcnt(0)
  v_mfma_f32_16x16x32_bf16 v[96:99], v[60:63], v[52:55], v[96:99]
  ds_read_b128 v[8:11], v5 offset:0
  v_mfma_f32_16x16x32_bf16 v[100:103], v[60:63], v[56:59], v[100:103]
  ds_read_b128 v[12:15], v5 offset:1024
  v_mfma_f32_16x16x32_bf16 v[104:107], v[64:67], v[52:55], v[104:107]
  ds_read_b128 v[16:19], v2 offset:0
  v_mfma_f32_16x16x32_bf16 v[108:111], v[64:67], v[56:59], v[108:111]
  ds_read_b128 v[20:23], v2 offset:1024
  v_mfma_f32_16x16x32_bf16 v[112:115], v[68:71], v[52:55], v[112:115]
  ds_read_b128 v[24:27], v2 offset:2048
  v_mfma_f32_16x16x32_bf16 v[116:119], v[68:71], v[56:59], v[116:119]
  ds_read_b128 v[28:31], v2 offset:3072
  v_mfma_f32_16x16x32_bf16 v[120:123], v[72:75], v[52:55], v[120:123]
  v_mfma_f32_16x16x32_bf16 v[124:127], v[72:75], v[56:59], v[124:127]
  ds_read_b128 v[32:35], v2 offset:4096
  v_mfma_f32_16x16x32_bf16 v[128:131], v[76:79], v[52:55], v[128:131]
  ds_read_b128 v[36:39], v2 offset:5120
  v_mfma_f32_16x16x32_bf16 v[132:135], v[76:79], v[56:59], v[132:135]
  ds_read_b128 v[40:43], v2 offset:6144
  v_mfma_f32_16x16x32_bf16 v[136:139], v[80:83], v[52:55], v[136:139]
  ds_read_b128 v[44:47], v2 offset:7168
  v_mfma_f32_16x16x32_bf16 v[140:143], v[80:83], v[56:59], v[140:143]
  ds_read_b128 v[48:51], v2 offset:8192
  v_mfma_f32_16x16x32_bf16 v[144:147], v[84:87], v[52:55], v[144:147]
  v_mfma_f32_16x16x32_bf16 v[148:151], v[84:87], v[56:59], v[148:151]
  v_mfma_f32_16x16x32_bf16 v[152:155], v[88:91], v[52:55], v[152:155]
  v_mfma_f32_16x16x32_bf16 v[156:159], v[88:91], v[56:59], v[156:159]
  v_mfma_f32_16x16x32_bf16 v[160:163], v[92:95], v[52:55], v[160:163]
  v_mfma_f32_16x16x32_bf16 v[164:167], v[92:95], v[56:59], v[164:167]
  s_waitcnt lgkmcnt(0)
  s_barrier
  v_mfma_f32_16x16x32_bf16 v[96:99], v[16:19], v[8:11], v[96:99]
  ds_read_b128 v[52:55], v5 offset:17408
  v_mfma_f32_16x16x32_bf16 v[100:103], v[16:19], v[12:15], v[100:103]
  ds_read_b128 v[56:59], v5 offset:18432
  v_mfma_f32_16x16x32_bf16 v[104:107], v[20:23], v[8:11], v[104:107]
  ds_read_b128 v[60:63], v2 offset:17408
  v_mfma_f32_16x16x32_bf16 v[108:111], v[20:23], v[12:15], v[108:111]
  ds_read_b128 v[64:67], v2 offset:18432
  v_mfma_f32_16x16x32_bf16 v[112:115], v[24:27], v[8:11], v[112:115]
  ds_read_b128 v[68:71], v2 offset:19456
  v_mfma_f32_16x16x32_bf16 v[116:119], v[24:27], v[12:15], v[116:119]
  ds_read_b128 v[72:75], v2 offset:20480
  v_mfma_f32_16x16x32_bf16 v[120:123], v[28:31], v[8:11], v[120:123]
  v_mfma_f32_16x16x32_bf16 v[124:127], v[28:31], v[12:15], v[124:127]
  ds_read_b128 v[76:79], v2 offset:21504
  v_mfma_f32_16x16x32_bf16 v[128:131], v[32:35], v[8:11], v[128:131]
  ds_read_b128 v[80:83], v2 offset:22528
  v_mfma_f32_16x16x32_bf16 v[132:135], v[32:35], v[12:15], v[132:135]
  ds_read_b128 v[84:87], v2 offset:23552
  v_mfma_f32_16x16x32_bf16 v[136:139], v[36:39], v[8:11], v[136:139]
  ds_read_b128 v[88:91], v2 offset:24576
  v_mfma_f32_16x16x32_bf16 v[140:143], v[36:39], v[12:15], v[140:143]
  ds_read_b128 v[92:95], v2 offset:25600
  v_mfma_f32_16x16x32_bf16 v[144:147], v[40:43], v[8:11], v[144:147]
  v_mfma_f32_16x16x32_bf16 v[148:151], v[40:43], v[12:15], v[148:151]
  v_mfma_f32_16x16x32_bf16 v[152:155], v[44:47], v[8:11], v[152:155]
  v_mfma_f32_16x16x32_bf16 v[156:159], v[44:47], v[12:15], v[156:159]
  v_mfma_f32_16x16x32_bf16 v[160:163], v[48:51], v[8:11], v[160:163]
  v_mfma_f32_16x16x32_bf16 v[164:167], v[48:51], v[12:15], v[164:167]
  s_waitcnt lgkmcnt(0)
  v_mfma_f32_16x16x32_bf16 v[96:99], v[60:63], v[52:55], v[96:99]
  ds_read_b128 v[8:11], v5 offset:34816
  v_mfma_f32_16x16x32_bf16 v[100:103], v[60:63], v[56:59], v[100:103]
  ds_read_b128 v[12:15], v5 offset:35840
  v_mfma_f32_16x16x32_bf16 v[104:107], v[64:67], v[52:55], v[104:107]
  ds_read_b128 v[16:19], v2 offset:34816
  v_mfma_f32_16x16x32_bf16 v[108:111], v[64:67], v[56:59], v[108:111]
  ds_read_b128 v[20:23], v2 offset:35840
  v_mfma_f32_16x16x32_bf16 v[112:115], v[68:71], v[52:55], v[112:115]
  ds_read_b128 v[24:27], v2 offset:36864
  v_mfma_f32_16x16x32_bf16 v[116:119], v[68:71], v[56:59], v[116:119]
  ds_read_b128 v[28:31], v2 offset:37888
  v_mfma_f32_16x16x32_bf16 v[120:123], v[72:75], v[52:55], v[120:123]
  v_mfma_f32_16x16x32_bf16 v[124:127], v[72:75], v[56:59], v[124:127]
  ds_read_b128 v[32:35], v2 offset:38912
  v_mfma_f32_16x16x32_bf16 v[128:131], v[76:79], v[52:55], v[128:131]
  ds_read_b128 v[36:39], v2 offset:39936
  v_mfma_f32_16x16x32_bf16 v[132:135], v[76:79], v[56:59], v[132:135]
  ds_read_b128 v[40:43], v2 offset:40960
  v_mfma_f32_16x16x32_bf16 v[136:139], v[80:83], v[52:55], v[136:139]
  ds_read_b128 v[44:47], v2 offset:41984
  v_mfma_f32_16x16x32_bf16 v[140:143], v[80:83], v[56:59], v[140:143]
  ds_read_b128 v[48:51], v2 offset:43008
  v_mfma_f32_16x16x32_bf16 v[144:147], v[84:87], v[52:55], v[144:147]
  v_mfma_f32_16x16x32_bf16 v[148:151], v[84:87], v[56:59], v[148:151]
  v_mfma_f32_16x16x32_bf16 v[152:155], v[88:91], v[52:55], v[152:155]
  v_mfma_f32_16x16x32_bf16 v[156:159], v[88:91], v[56:59], v[156:159]
  v_mfma_f32_16x16x32_bf16 v[160:163], v[92:95], v[52:55], v[160:163]
  v_mfma_f32_16x16x32_bf16 v[164:167], v[92:95], v[56:59], v[164:167]
  s_waitcnt lgkmcnt(0)
  s_barrier
  v_mfma_f32_16x16x32_bf16 v[96:99], v[16:19], v[8:11], v[96:99]
  ds_read_b128 v[52:55], v6 offset:3072
  v_mfma_f32_16x16x32_bf16 v[100:103], v[16:19], v[12:15], v[100:103]
  ds_read_b128 v[56:59], v6 offset:4096
  v_mfma_f32_16x16x32_bf16 v[104:107], v[20:23], v[8:11], v[104:107]
  ds_read_b128 v[60:63], v3 offset:3072
  v_mfma_f32_16x16x32_bf16 v[108:111], v[20:23], v[12:15], v[108:111]
  ds_read_b128 v[64:67], v3 offset:4096
  v_mfma_f32_16x16x32_bf16 v[112:115], v[24:27], v[8:11], v[112:115]
  ds_read_b128 v[68:71], v3 offset:5120
  v_mfma_f32_16x16x32_bf16 v[116:119], v[24:27], v[12:15], v[116:119]
  ds_read_b128 v[72:75], v3 offset:6144
  v_mfma_f32_16x16x32_bf16 v[120:123], v[28:31], v[8:11], v[120:123]
  v_mfma_f32_16x16x32_bf16 v[124:127], v[28:31], v[12:15], v[124:127]
  ds_read_b128 v[76:79], v3 offset:7168
  v_mfma_f32_16x16x32_bf16 v[128:131], v[32:35], v[8:11], v[128:131]
  ds_read_b128 v[80:83], v3 offset:8192
  v_mfma_f32_16x16x32_bf16 v[132:135], v[32:35], v[12:15], v[132:135]
  ds_read_b128 v[84:87], v3 offset:9216
  v_mfma_f32_16x16x32_bf16 v[136:139], v[36:39], v[8:11], v[136:139]
  ds_read_b128 v[88:91], v3 offset:10240
  v_mfma_f32_16x16x32_bf16 v[140:143], v[36:39], v[12:15], v[140:143]
  ds_read_b128 v[92:95], v3 offset:11264
  v_mfma_f32_16x16x32_bf16 v[144:147], v[40:43], v[8:11], v[144:147]
  v_mfma_f32_16x16x32_bf16 v[148:151], v[40:43], v[12:15], v[148:151]
  v_mfma_f32_16x16x32_bf16 v[152:155], v[44:47], v[8:11], v[152:155]
  v_mfma_f32_16x16x32_bf16 v[156:159], v[44:47], v[12:15], v[156:159]
  v_mfma_f32_16x16x32_bf16 v[160:163], v[48:51], v[8:11], v[160:163]
  v_mfma_f32_16x16x32_bf16 v[164:167], v[48:51], v[12:15], v[164:167]
  s_waitcnt lgkmcnt(0)
  v_mfma_f32_16x16x32_bf16 v[96:99], v[60:63], v[52:55], v[96:99]
  ds_read_b64_tr_b16 v[8:9], v169 offset:24576
  v_mfma_f32_16x16x32_bf16 v[100:103], v[60:63], v[56:59], v[100:103]
  ds_read_b64_tr_b16 v[10:11], v169 offset:26624
  v_mfma_f32_16x16x32_bf16 v[104:107], v[64:67], v[52:55], v[104:107]
  ds_read_b64_tr_b16 v[12:13], v172 offset:24576
  v_mfma_f32_16x16x32_bf16 v[108:111], v[64:67], v[56:59], v[108:111]
  ds_read_b64_tr_b16 v[14:15], v172 offset:26624
  v_mfma_f32_16x16x32_bf16 v[112:115], v[68:71], v[52:55], v[112:115]
  ds_read_b128 v[16:19], v3 offset:24576
  v_mfma_f32_16x16x32_bf16 v[116:119], v[68:71], v[56:59], v[116:119]
  ds_read_b128 v[20:23], v3 offset:25600
  v_mfma_f32_16x16x32_bf16 v[120:123], v[72:75], v[52:55], v[120:123]
  ds_read_b128 v[24:27], v3 offset:26624
  v_mfma_f32_16x16x32_bf16 v[124:127], v[72:75], v[56:59], v[124:127]
  ds_read_b128 v[28:31], v3 offset:27648
  v_mfma_f32_16x16x32_bf16 v[128:131], v[76:79], v[52:55], v[128:131]
  ds_read_b128 v[32:35], v3 offset:28672
  v_mfma_f32_16x16x32_bf16 v[132:135], v[76:79], v[56:59], v[132:135]
  ds_read_b128 v[36:39], v3 offset:29696
  v_mfma_f32_16x16x32_bf16 v[136:139], v[80:83], v[52:55], v[136:139]
  ds_read_b128 v[40:43], v3 offset:30720
  v_mfma_f32_16x16x32_bf16 v[140:143], v[80:83], v[56:59], v[140:143]
  ds_read_b128 v[44:47], v3 offset:31744
  v_mfma_f32_16x16x32_bf16 v[144:147], v[84:87], v[52:55], v[144:147]
  ds_read_b128 v[48:51], v3 offset:32768
  v_mfma_f32_16x16x32_bf16 v[148:151], v[84:87], v[56:59], v[148:151]
  v_mfma_f32_16x16x32_bf16 v[152:155], v[88:91], v[52:55], v[152:155]
  v_mfma_f32_16x16x32_bf16 v[156:159], v[88:91], v[56:59], v[156:159]
  v_mfma_f32_16x16x32_bf16 v[160:163], v[92:95], v[52:55], v[160:163]
  v_mfma_f32_16x16x32_bf16 v[164:167], v[92:95], v[56:59], v[164:167]
  s_waitcnt lgkmcnt(0)
  s_barrier
  v_mfma_f32_16x16x32_bf16 v[96:99], v[16:19], v[8:11], v[96:99]
  ds_read_b64_tr_b16 v[52:53], v169 offset:41984
  v_mfma_f32_16x16x32_bf16 v[100:103], v[16:19], v[12:15], v[100:103]
  ds_read_b64_tr_b16 v[54:55], v169 offset:44032
  v_mfma_f32_16x16x32_bf16 v[104:107], v[20:23], v[8:11], v[104:107]
  ds_read_b64_tr_b16 v[56:57], v172 offset:41984
  v_mfma_f32_16x16x32_bf16 v[108:111], v[20:23], v[12:15], v[108:111]
  ds_read_b64_tr_b16 v[58:59], v172 offset:44032
  v_mfma_f32_16x16x32_bf16 v[112:115], v[24:27], v[8:11], v[112:115]
  ds_read_b128 v[60:63], v3 offset:41984
  v_mfma_f32_16x16x32_bf16 v[116:119], v[24:27], v[12:15], v[116:119]
  ds_read_b128 v[64:67], v3 offset:43008
  v_mfma_f32_16x16x32_bf16 v[120:123], v[28:31], v[8:11], v[120:123]
  ds_read_b128 v[68:71], v3 offset:44032
  v_mfma_f32_16x16x32_bf16 v[124:127], v[28:31], v[12:15], v[124:127]
  ds_read_b128 v[72:75], v3 offset:45056
  v_mfma_f32_16x16x32_bf16 v[128:131], v[32:35], v[8:11], v[128:131]
  ds_read_b128 v[76:79], v3 offset:46080
  v_mfma_f32_16x16x32_bf16 v[132:135], v[32:35], v[12:15], v[132:135]
  ds_read_b128 v[80:83], v3 offset:47104
  v_mfma_f32_16x16x32_bf16 v[136:139], v[36:39], v[8:11], v[136:139]
  ds_read_b128 v[84:87], v3 offset:48128
  v_mfma_f32_16x16x32_bf16 v[140:143], v[36:39], v[12:15], v[140:143]
  ds_read_b128 v[88:91], v4 offset:0
  v_mfma_f32_16x16x32_bf16 v[144:147], v[40:43], v[8:11], v[144:147]
  ds_read_b128 v[92:95], v4 offset:1024
  v_mfma_f32_16x16x32_bf16 v[148:151], v[40:43], v[12:15], v[148:151]
  v_mfma_f32_16x16x32_bf16 v[152:155], v[44:47], v[8:11], v[152:155]
  v_mfma_f32_16x16x32_bf16 v[156:159], v[44:47], v[12:15], v[156:159]
  v_mfma_f32_16x16x32_bf16 v[160:163], v[48:51], v[8:11], v[160:163]
  v_mfma_f32_16x16x32_bf16 v[164:167], v[48:51], v[12:15], v[164:167]
  s_waitcnt lgkmcnt(0)
  v_mfma_f32_16x16x32_bf16 v[96:99], v[60:63], v[52:55], v[96:99]
  ds_read_b64_tr_b16 v[8:9], v170 offset:10240
  v_mfma_f32_16x16x32_bf16 v[100:103], v[60:63], v[56:59], v[100:103]
  ds_read_b64_tr_b16 v[10:11], v170 offset:12288
  v_mfma_f32_16x16x32_bf16 v[104:107], v[64:67], v[52:55], v[104:107]
  ds_read_b64_tr_b16 v[12:13], v173 offset:10240
  v_mfma_f32_16x16x32_bf16 v[108:111], v[64:67], v[56:59], v[108:111]
  ds_read_b64_tr_b16 v[14:15], v173 offset:12288
  v_mfma_f32_16x16x32_bf16 v[112:115], v[68:71], v[52:55], v[112:115]
  ds_read_b128 v[16:19], v4 offset:10240
  v_mfma_f32_16x16x32_bf16 v[116:119], v[68:71], v[56:59], v[116:119]
  ds_read_b128 v[20:23], v4 offset:11264
  v_mfma_f32_16x16x32_bf16 v[120:123], v[72:75], v[52:55], v[120:123]
  ds_read_b128 v[24:27], v4 offset:12288
  v_mfma_f32_16x16x32_bf16 v[124:127], v[72:75], v[56:59], v[124:127]
  ds_read_b128 v[28:31], v4 offset:13312
  v_mfma_f32_16x16x32_bf16 v[128:131], v[76:79], v[52:55], v[128:131]
  ds_read_b128 v[32:35], v4 offset:14336
  v_mfma_f32_16x16x32_bf16 v[132:135], v[76:79], v[56:59], v[132:135]
  ds_read_b128 v[36:39], v4 offset:15360
  v_mfma_f32_16x16x32_bf16 v[136:139], v[80:83], v[52:55], v[136:139]
  ds_read_b128 v[40:43], v4 offset:16384
  v_mfma_f32_16x16x32_bf16 v[140:143], v[80:83], v[56:59], v[140:143]
  ds_read_b128 v[44:47], v4 offset:17408
  v_mfma_f32_16x16x32_bf16 v[144:147], v[84:87], v[52:55], v[144:147]
  ds_read_b128 v[48:51], v4 offset:18432
  v_mfma_f32_16x16x32_bf16 v[148:151], v[84:87], v[56:59], v[148:151]
  v_mfma_f32_16x16x32_bf16 v[152:155], v[88:91], v[52:55], v[152:155]
  v_mfma_f32_16x16x32_bf16 v[156:159], v[88:91], v[56:59], v[156:159]
  v_mfma_f32_16x16x32_bf16 v[160:163], v[92:95], v[52:55], v[160:163]
  v_mfma_f32_16x16x32_bf16 v[164:167], v[92:95], v[56:59], v[164:167]
  s_waitcnt lgkmcnt(0)
  s_barrier
  v_mfma_f32_16x16x32_bf16 v[96:99], v[16:19], v[8:11], v[96:99]
  ds_read_b64_tr_b16 v[52:53], v170 offset:27648
  v_mfma_f32_16x16x32_bf16 v[100:103], v[16:19], v[12:15], v[100:103]
  ds_read_b64_tr_b16 v[54:55], v170 offset:29696
  v_mfma_f32_16x16x32_bf16 v[104:107], v[20:23], v[8:11], v[104:107]
  ds_read_b64_tr_b16 v[56:57], v173 offset:27648
  v_mfma_f32_16x16x32_bf16 v[108:111], v[20:23], v[12:15], v[108:111]
  ds_read_b64_tr_b16 v[58:59], v173 offset:29696
  v_mfma_f32_16x16x32_bf16 v[112:115], v[24:27], v[8:11], v[112:115]
  ds_read_b128 v[60:63], v4 offset:27648
  v_mfma_f32_16x16x32_bf16 v[116:119], v[24:27], v[12:15], v[116:119]
  ds_read_b128 v[64:67], v4 offset:28672
  v_mfma_f32_16x16x32_bf16 v[120:123], v[28:31], v[8:11], v[120:123]
  ds_read_b128 v[68:71], v4 offset:29696
  v_mfma_f32_16x16x32_bf16 v[124:127], v[28:31], v[12:15], v[124:127]
  ds_read_b128 v[72:75], v4 offset:30720
  v_mfma_f32_16x16x32_bf16 v[128:131], v[32:35], v[8:11], v[128:131]
  ds_read_b128 v[76:79], v4 offset:31744
  v_mfma_f32_16x16x32_bf16 v[132:135], v[32:35], v[12:15], v[132:135]
  ds_read_b128 v[80:83], v4 offset:32768
  v_mfma_f32_16x16x32_bf16 v[136:139], v[36:39], v[8:11], v[136:139]
  ds_read_b128 v[84:87], v4 offset:33792
  v_mfma_f32_16x16x32_bf16 v[140:143], v[36:39], v[12:15], v[140:143]
  ds_read_b128 v[88:91], v4 offset:34816
  v_mfma_f32_16x16x32_bf16 v[144:147], v[40:43], v[8:11], v[144:147]
  ds_read_b128 v[92:95], v4 offset:35840
  v_mfma_f32_16x16x32_bf16 v[148:151], v[40:43], v[12:15], v[148:151]
  v_mfma_f32_16x16x32_bf16 v[152:155], v[44:47], v[8:11], v[152:155]
  v_mfma_f32_16x16x32_bf16 v[156:159], v[44:47], v[12:15], v[156:159]
  v_mfma_f32_16x16x32_bf16 v[160:163], v[48:51], v[8:11], v[160:163]
  v_mfma_f32_16x16x32_bf16 v[164:167], v[48:51], v[12:15], v[164:167]
  s_cmp_eq_u32 s25, 1
  s_cbranch_scc1 L_c39_34
  s_waitcnt lgkmcnt(0)
  v_mfma_f32_16x16x32_bf16 v[96:99], v[60:63], v[52:55], v[96:99]
  ds_read_b64_tr_b16 v[8:9], v168 offset:0
  v_mfma_f32_16x16x32_bf16 v[100:103], v[60:63], v[56:59], v[100:103]
  ds_read_b64_tr_b16 v[10:11], v168 offset:2048
  v_mfma_f32_16x16x32_bf16 v[104:107], v[64:67], v[52:55], v[104:107]
  ds_read_b64_tr_b16 v[12:13], v171 offset:0
  v_mfma_f32_16x16x32_bf16 v[108:111], v[64:67], v[56:59], v[108:111]
  ds_read_b64_tr_b16 v[14:15], v171 offset:2048
  v_mfma_f32_16x16x32_bf16 v[112:115], v[68:71], v[52:55], v[112:115]
  ds_read_b128 v[16:19], v2 offset:0
  v_mfma_f32_16x16x32_bf16 v[116:119], v[68:71], v[56:59], v[116:119]
  ds_read_b128 v[20:23], v2 offset:1024
  v_mfma_f32_16x16x32_bf16 v[120:123], v[72:75], v[52:55], v[120:123]
  ds_read_b128 v[24:27], v2 offset:2048
  v_mfma_f32_16x16x32_bf16 v[124:127], v[72:75], v[56:59], v[124:127]
  ds_read_b128 v[28:31], v2 offset:3072
  v_mfma_f32_16x16x32_bf16 v[128:131], v[76:79], v[52:55], v[128:131]
  ds_read_b128 v[32:35], v2 offset:4096
  v_mfma_f32_16x16x32_bf16 v[132:135], v[76:79], v[56:59], v[132:135]
  ds_read_b128 v[36:39], v2 offset:5120
  v_mfma_f32_16x16x32_bf16 v[136:139], v[80:83], v[52:55], v[136:139]
  ds_read_b128 v[40:43], v2 offset:6144
  v_mfma_f32_16x16x32_bf16 v[140:143], v[80:83], v[56:59], v[140:143]
  ds_read_b128 v[44:47], v2 offset:7168
  v_mfma_f32_16x16x32_bf16 v[144:147], v[84:87], v[52:55], v[144:147]
  ds_read_b128 v[48:51], v2 offset:8192
  v_mfma_f32_16x16x32_bf16 v[148:151], v[84:87], v[56:59], v[148:151]
  v_mfma_f32_16x16x32_bf16 v[152:155], v[88:91], v[52:55], v[152:155]
  v_mfma_f32_16x16x32_bf16 v[156:159], v[88:91], v[56:59], v[156:159]
  v_mfma_f32_16x16x32_bf16 v[160:163], v[92:95], v[52:55], v[160:163]
  v_mfma_f32_16x16x32_bf16 v[164:167], v[92:95], v[56:59], v[164:167]
  s_waitcnt lgkmcnt(0)
  s_barrier
  v_mfma_f32_16x16x32_bf16 v[96:99], v[16:19], v[8:11], v[96:99]
  v_mfma_f32_16x16x32_bf16 v[100:103], v[16:19], v[12:15], v[100:103]
  v_mfma_f32_16x16x32_bf16 v[104:107], v[20:23], v[8:11], v[104:107]
  v_mfma_f32_16x16x32_bf16 v[108:111], v[20:23], v[12:15], v[108:111]
  v_mfma_f32_16x16x32_bf16 v[112:115], v[24:27], v[8:11], v[112:115]
  v_mfma_f32_16x16x32_bf16 v[116:119], v[24:27], v[12:15], v[116:119]
  v_mfma_f32_16x16x32_bf16 v[120:123], v[28:31], v[8:11], v[120:123]
  v_mfma_f32_16x16x32_bf16 v[124:127], v[28:31], v[12:15], v[124:127]
  v_mfma_f32_16x16x32_bf16 v[128:131], v[32:35], v[8:11], v[128:131]
  v_mfma_f32_16x16x32_bf16 v[132:135], v[32:35], v[12:15], v[132:135]
  v_mfma_f32_16x16x32_bf16 v[136:139], v[36:39], v[8:11], v[136:139]
  v_mfma_f32_16x16x32_bf16 v[140:143], v[36:39], v[12:15], v[140:143]
  v_mfma_f32_16x16x32_bf16 v[144:147], v[40:43], v[8:11], v[144:147]
  v_mfma_f32_16x16x32_bf16 v[148:151], v[40:43], v[12:15], v[148:151]
  v_mfma_f32_16x16x32_bf16 v[152:155], v[44:47], v[8:11], v[152:155]
  v_mfma_f32_16x16x32_bf16 v[156:159], v[44:47], v[12:15], v[156:159]
  v_mfma_f32_16x16x32_bf16 v[160:163], v[48:51], v[8:11], v[160:163]
  v_mfma_f32_16x16x32_bf16 v[164:167], v[48:51], v[12:15], v[164:167]
  s_branch L_cepi_35
L_c39_34:
  s_waitcnt lgkmcnt(0)
  v_mfma_f32_16x16x32_bf16 v[96:99], v[60:63], v[52:55], v[96:99]
  v_mfma_f32_16x16x32_bf16 v[100:103], v[60:63], v[56:59], v[100:103]
  v_mfma_f32_16x16x32_bf16 v[104:107], v[64:67], v[52:55], v[104:107]
  v_mfma_f32_16x16x32_bf16 v[108:111], v[64:67], v[56:59], v[108:111]
  v_mfma_f32_16x16x32_bf16 v[112:115], v[68:71], v[52:55], v[112:115]
  v_mfma_f32_16x16x32_bf16 v[116:119], v[68:71], v[56:59], v[116:119]
  v_mfma_f32_16x16x32_bf16 v[120:123], v[72:75], v[52:55], v[120:123]
  v_mfma_f32_16x16x32_bf16 v[124:127], v[72:75], v[56:59], v[124:127]
  v_mfma_f32_16x16x32_bf16 v[128:131], v[76:79], v[52:55], v[128:131]
  v_mfma_f32_16x16x32_bf16 v[132:135], v[76:79], v[56:59], v[132:135]
  v_mfma_f32_16x16x32_bf16 v[136:139], v[80:83], v[52:55], v[136:139]
  v_mfma_f32_16x16x32_bf16 v[140:143], v[80:83], v[56:59], v[140:143]
  v_mfma_f32_16x16x32_bf16 v[144:147], v[84:87], v[52:55], v[144:147]
  v_mfma_f32_16x16x32_bf16 v[148:151], v[84:87], v[56:59], v[148:151]
  v_mfma_f32_16x16x32_bf16 v[152:155], v[88:91], v[52:55], v[152:155]
  v_mfma_f32_16x16x32_bf16 v[156:159], v[88:91], v[56:59], v[156:159]
  v_mfma_f32_16x16x32_bf16 v[160:163], v[92:95], v[52:55], v[160:163]
  v_mfma_f32_16x16x32_bf16 v[164:167], v[92:95], v[56:59], v[164:167]
  s_barrier
L_cepi_35:
  s_cmp_eq_u32 s19, s26
  s_cbranch_scc1 L_own_36
  s_andn2_b32 s28, s2, 3
  s_or_b32 s28, s28, s19
  s_lshl_b32 s30, s28, 7
  s_add_u32 s30, s30, 0x33e8000
  s_lshl_b32 s28, s28, 2
  s_add_u32 s28, s28, s26
  s_mul_i32 s28, s28, 9216
  s_add_u32 s28, s28, 0x21e4000
  v_cvt_pk_bf16_f32 v28, v96, v97
  v_cvt_pk_bf16_f32 v29, v98, v99
  v_cvt_pk_bf16_f32 v30, v100, v101
  v_cvt_pk_bf16_f32 v31, v102, v103
  buffer_store_dwordx4 v[28:31], v2, s[4:7], s28 offen offset:0 sc1
  v_cvt_pk_bf16_f32 v32, v104, v105
  v_cvt_pk_bf16_f32 v33, v106, v107
  v_cvt_pk_bf16_f32 v34, v108, v109
  v_cvt_pk_bf16_f32 v35, v110, v111
  buffer_store_dwordx4 v[32:35], v2, s[4:7], s28 offen offset:1024 sc1
  v_cvt_pk_bf16_f32 v36, v112, v113
  v_cvt_pk_bf16_f32 v37, v114, v115
  v_cvt_pk_bf16_f32 v38, v116, v117
  v_cvt_pk_bf16_f32 v39, v118, v119
  buffer_store_dwordx4 v[36:39], v2, s[4:7], s28 offen offset:2048 sc1
  v_cvt_pk_bf16_f32 v40, v120, v121
  v_cvt_pk_bf16_f32 v41, v122, v123
  v_cvt_pk_bf16_f32 v42, v124, v125
  v_cvt_pk_bf16_f32 v43, v126, v127
  buffer_store_dwordx4 v[40:43], v2, s[4:7], s28 offen offset:3072 sc1
  v_cvt_pk_bf16_f32 v44, v128, v129
  v_cvt_pk_bf16_f32 v45, v130, v131
  v_cvt_pk_bf16_f32 v46, v132, v133
  v_cvt_pk_bf16_f32 v47, v134, v135
  s_add_u32 s28, s28, 4096
  buffer_store_dwordx4 v[44:47], v2, s[4:7], s28 offen offset:0 sc1
  v_cvt_pk_bf16_f32 v48, v136, v137
  v_cvt_pk_bf16_f32 v49, v138, v139
  v_cvt_pk_bf16_f32 v50, v140, v141
  v_cvt_pk_bf16_f32 v51, v142, v143
  buffer_store_dwordx4 v[48:51], v2, s[4:7], s28 offen offset:1024 sc1
  v_cvt_pk_bf16_f32 v52, v144, v145
  v_cvt_pk_bf16_f32 v53, v146, v147
  v_cvt_pk_bf16_f32 v54, v148, v149
  v_cvt_pk_bf16_f32 v55, v150, v151
  buffer_store_dwordx4 v[52:55], v2, s[4:7], s28 offen offset:2048 sc1
  v_cvt_pk_bf16_f32 v56, v152, v153
  v_cvt_pk_bf16_f32 v57, v154, v155
  v_cvt_pk_bf16_f32 v58, v156, v157
  v_cvt_pk_bf16_f32 v59, v158, v159
  buffer_store_dwordx4 v[56:59], v2, s[4:7], s28 offen offset:3072 sc1
  v_cvt_pk_bf16_f32 v60, v160, v161
  v_cvt_pk_bf16_f32 v61, v162, v163
  v_cvt_pk_bf16_f32 v62, v164, v165
  v_cvt_pk_bf16_f32 v63, v166, v167
  s_add_u32 s28, s28, 4096
  buffer_store_dwordx4 v[60:63], v2, s[4:7], s28 offen offset:0 sc1
  s_lshl_b32 s29, s26, 2
  s_add_u32 s30, s30, s29
  s_waitcnt vmcnt(0)
  s_add_u32 s28, s59, 0
  v_mov_b32 v253, 0
  v_mov_b32 v254, s28
  s_mov_b64 exec, 1
  buffer_store_dword v254, v253, s[4:7], s30 offen sc1
  s_mov_b64 exec, -1
  s_branch L_sent_37
L_own_36:
  v_add_u32 v3, 143360, v2
  s_nop 4
  ds_write_b128 v3, v[96:99] offset:0
  ds_write_b128 v3, v[100:103] offset:1024
  ds_write_b128 v3, v[104:107] offset:2048
  ds_write_b128 v3, v[108:111] offset:3072
  ds_write_b128 v3, v[112:115] offset:4096
  ds_write_b128 v3, v[116:119] offset:5120
  ds_write_b128 v3, v[120:123] offset:6144
  ds_write_b128 v3, v[124:127] offset:7168
  ds_write_b128 v3, v[128:131] offset:8192
  ds_write_b128 v3, v[132:135] offset:9216
  ds_write_b128 v3, v[136:139] offset:10240
  ds_write_b128 v3, v[140:143] offset:11264
  ds_write_b128 v3, v[144:147] offset:12288
  ds_write_b128 v3, v[148:151] offset:13312
  ds_write_b128 v3, v[152:155] offset:14336
  ds_write_b128 v3, v[156:159] offset:15360
  ds_write_b128 v3, v[160:163] offset:16384
  ds_write_b128 v3, v[164:167] offset:17408
  s_waitcnt lgkmcnt(0)
L_sent_37:
  v_mov_b32 v3, v2
  s_load_dwordx4 s[52:55], s[0:1], 56
  v_and_b32 v4, 15, v1
  s_lshl_b32 s28, s16, 7
  s_lshl_b32 s29, s26, 5
  s_add_u32 s28, s28, s29
  v_add_u32 v4, s28, v4
  v_mul_u32_u24 v4, 1152, v4
  v_lshrrev_b32 v5, 4, v1
  v_lshlrev_b32 v5, 3, v5
  s_mul_i32 s28, s27, 288
  s_lshl_b32 s29, s18, 5
  s_add_u32 s28, s28, s29
  v_add_u32 v5, s28, v5
  v_add_u32 v4, v4, v5
  v_add_u32 v6, 18432, v4
  s_lshl_b32 s30, s18, 11
  v_add_u32 v7, s30, v3
  v_add_u32 v7, 143360, v7
  v_and_b32 v8, 3, v1
  v_min_u32 v8, 2, v8
  s_add_u32 s28, s26, 1
  v_add_u32 v8, s28, v8
  v_and_b32 v8, 3, v8
  v_lshlrev_b32 v8, 2, v8
  s_lshl_b32 s34, s2, 7
  s_add_u32 s34, s34, 0x33e8000
  s_mul_i32 s35, s2, 36864
  s_lshl_b32 s30, s18, 10
  s_add_u32 s35, s35, s30
  s_add_u32 s35, s35, 0x21e4000
  s_waitcnt lgkmcnt(0)
  s_mov_b32 s44, s52
  s_and_b32 s45, s53, 0xffff
  s_mov_b32 s46, 0x480
  s_mov_b32 s47, 0x00020000
  s_mov_b32 s48, s54
  s_and_b32 s49, s55, 0xffff
  s_mov_b32 s50, 0x240000
  s_mov_b32 s51, 0x00020000
  buffer_load_dwordx2 v[16:17], v4, s[40:43], 0 offen offset:0
  buffer_load_dwordx2 v[18:19], v6, s[40:43], 0 offen offset:0
  buffer_load_dwordx2 v[24:25], v5, s[44:47], 0 offen offset:0
  s_cmp_eq_u32 s18, 0
  s_cbranch_scc0 L_f8_38
  buffer_load_dwordx2 v[20:21], v4, s[40:43], 0 offen offset:256
  buffer_load_dwordx2 v[22:23], v6, s[40:43], 0 offen offset:256
  buffer_load_dwordx2 v[26:27], v5, s[44:47], 0 offen offset:256
L_f8_38:
  s_barrier
  ds_read_b128 v[64:67], v7 offset:0
  ds_read_b128 v[68:71], v7 offset:1024
  s_cmp_eq_u32 s18, 0
  s_cbranch_scc0 L_f8_39
  ds_read_b128 v[72:75], v7 offset:16384
  ds_read_b128 v[76:79], v7 offset:17408
L_f8_39:
  s_mov_b32 s33, 0
L_xpoll_40:
  buffer_load_dword v9, v8, s[4:7], s34 offen sc1
  s_waitcnt vmcnt(0)
  s_add_u32 s28, s59, 0
  v_subrev_u32 v9, s28, v9
  v_cmp_ge_u32 vcc, 0, v9
  s_nop 1
  s_cmp_eq_u64 vcc, -1
  s_cbranch_scc1 L_spinout_41
  s_sleep 2
  s_add_u32 s33, s33, 1
  s_cmp_lt_u32 s33, 0x40000
  s_cbranch_scc1 L_xpoll_40
L_spinout_41:
  s_add_u32 s29, s26, 1
  s_and_b32 s29, s29, 3
  s_mul_i32 s29, s29, 9216
  s_add_u32 s29, s29, s35
  buffer_load_dwordx4 v[32:35], v3, s[4:7], s29 offen sc1
  s_add_u32 s29, s26, 2
  s_and_b32 s29, s29, 3
  s_mul_i32 s29, s29, 9216
  s_add_u32 s29, s29, s35
  buffer_load_dwordx4 v[36:39], v3, s[4:7], s29 offen sc1
  s_add_u32 s29, s26, 3
  s_and_b32 s29, s29, 3
  s_mul_i32 s29, s29, 9216
  s_add_u32 s29, s29, s35
  buffer_load_dwordx4 v[40:43], v3, s[4:7], s29 offen sc1
  s_cmp_eq_u32 s18, 0
  s_cbranch_scc0 L_f8_42
  s_add_u32 s29, s26, 1
  s_and_b32 s29, s29, 3
  s_mul_i32 s29, s29, 9216
  s_add_u32 s29, s29, s35
  s_add_u32 s29, s29, 8192
  buffer_load_dwordx4 v[44:47], v3, s[4:7], s29 offen sc1
  s_add_u32 s29, s26, 2
  s_and_b32 s29, s29, 3
  s_mul_i32 s29, s29, 9216
  s_add_u32 s29, s29, s35
  s_add_u32 s29, s29, 8192
  buffer_load_dwordx4 v[48:51], v3, s[4:7], s29 offen sc1
  s_add_u32 s29, s26, 3
  s_and_b32 s29, s29, 3
  s_mul_i32 s29, s29, 9216
  s_add_u32 s29, s29, s35
  s_add_u32 s29, s29, 8192
  buffer_load_dwordx4 v[52:55], v3, s[4:7], s29 offen sc1
L_f8_42:
  s_waitcnt lgkmcnt(0)
  v_lshlrev_b32 v10, 16, v16
  v_and_b32 v11, 0xffff0000, v16
  v_add_f32 v64, v64, v10
  v_add_f32 v65, v65, v11
  v_lshlrev_b32 v10, 16, v24
  v_and_b32 v11, 0xffff0000, v24
  v_add_f32 v64, v64, v10
  v_add_f32 v65, v65, v11
  v_lshlrev_b32 v10, 16, v17
  v_and_b32 v11, 0xffff0000, v17
  v_add_f32 v66, v66, v10
  v_add_f32 v67, v67, v11
  v_lshlrev_b32 v10, 16, v25
  v_and_b32 v11, 0xffff0000, v25
  v_add_f32 v66, v66, v10
  v_add_f32 v67, v67, v11
  v_lshlrev_b32 v10, 16, v18
  v_and_b32 v11, 0xffff0000, v18
  v_add_f32 v68, v68, v10
  v_add_f32 v69, v69, v11
  v_lshlrev_b32 v10, 16, v24
  v_and_b32 v11, 0xffff0000, v24
  v_add_f32 v68, v68, v10
  v_add_f32 v69, v69, v11
  v_lshlrev_b32 v10, 16, v19
  v_and_b32 v11, 0xffff0000, v19
  v_add_f32 v70, v70, v10
  v_add_f32 v71, v71, v11
  v_lshlrev_b32 v10, 16, v25
  v_and_b32 v11, 0xffff0000, v25
  v_add_f32 v70, v70, v10
  v_add_f32 v71, v71, v11
  s_cmp_eq_u32 s18, 0
  s_cbranch_scc0 L_f8_43
  v_lshlrev_b32 v10, 16, v20
  v_and_b32 v11, 0xffff0000, v20
  v_add_f32 v72, v72, v10
  v_add_f32 v73, v73, v11
  v_lshlrev_b32 v10, 16, v26
  v_and_b32 v11, 0xffff0000, v26
  v_add_f32 v72, v72, v10
  v_add_f32 v73, v73, v11
  v_lshlrev_b32 v10, 16, v21
  v_and_b32 v11, 0xffff0000, v21
  v_add_f32 v74, v74, v10
  v_add_f32 v75, v75, v11
  v_lshlrev_b32 v10, 16, v27
  v_and_b32 v11, 0xffff0000, v27
  v_add_f32 v74, v74, v10
  v_add_f32 v75, v75, v11
  v_lshlrev_b32 v10, 16, v22
  v_and_b32 v11, 0xffff0000, v22
  v_add_f32 v76, v76, v10
  v_add_f32 v77, v77, v11
  v_lshlrev_b32 v10, 16, v26
  v_and_b32 v11, 0xffff0000, v26
  v_add_f32 v76, v76, v10
  v_add_f32 v77, v77, v11
  v_lshlrev_b32 v10, 16, v23
  v_and_b32 v11, 0xffff0000, v23
  v_add_f32 v78, v78, v10
  v_add_f32 v79, v79, v11
  v_lshlrev_b32 v10, 16, v27
  v_and_b32 v11, 0xffff0000, v27
  v_add_f32 v78, v78, v10
  v_add_f32 v79, v79, v11
L_f8_43:
  s_waitcnt vmcnt(0)
  v_lshlrev_b32 v10, 16, v32
  v_and_b32 v11, 0xffff0000, v32
  v_add_f32 v64, v64, v10
  v_add_f32 v65, v65, v11
  v_lshlrev_b32 v10, 16, v33
  v_and_b32 v11, 0xffff0000, v33
  v_add_f32 v66, v66, v10
  v_add_f32 v67, v67, v11
  v_lshlrev_b32 v10, 16, v34
  v_and_b32 v11, 0xffff0000, v34
  v_add_f32 v68, v68, v10
  v_add_f32 v69, v69, v11
  v_lshlrev_b32 v10, 16, v35
  v_and_b32 v11, 0xffff0000, v35
  v_add_f32 v70, v70, v10
  v_add_f32 v71, v71, v11
  v_lshlrev_b32 v10, 16, v36
  v_and_b32 v11, 0xffff0000, v36
  v_add_f32 v64, v64, v10
  v_add_f32 v65, v65, v11
  v_lshlrev_b32 v10, 16, v37
  v_and_b32 v11, 0xffff0000, v37
  v_add_f32 v66, v66, v10
  v_add_f32 v67, v67, v11
  v_lshlrev_b32 v10, 16, v38
  v_and_b32 v11, 0xffff0000, v38
  v_add_f32 v68, v68, v10
  v_add_f32 v69, v69, v11
  v_lshlrev_b32 v10, 16, v39
  v_and_b32 v11, 0xffff0000, v39
  v_add_f32 v70, v70, v10
  v_add_f32 v71, v71, v11
  v_lshlrev_b32 v10, 16, v40
  v_and_b32 v11, 0xffff0000, v40
  v_add_f32 v64, v64, v10
  v_add_f32 v65, v65, v11
  v_lshlrev_b32 v10, 16, v41
  v_and_b32 v11, 0xffff0000, v41
  v_add_f32 v66, v66, v10
  v_add_f32 v67, v67, v11
  v_lshlrev_b32 v10, 16, v42
  v_and_b32 v11, 0xffff0000, v42
  v_add_f32 v68, v68, v10
  v_add_f32 v69, v69, v11
  v_lshlrev_b32 v10, 16, v43
  v_and_b32 v11, 0xffff0000, v43
  v_add_f32 v70, v70, v10
  v_add_f32 v71, v71, v11
  v_cvt_pk_bf16_f32 v16, v64, v65
  v_cvt_pk_bf16_f32 v17, v66, v67
  v_cvt_pk_bf16_f32 v18, v68, v69
  v_cvt_pk_bf16_f32 v19, v70, v71
  buffer_store_dwordx2 v[16:17], v4, s[48:51], 0 offen offset:0
  buffer_store_dwordx2 v[18:19], v6, s[48:51], 0 offen offset:0
  s_cmp_eq_u32 s18, 0
  s_cbranch_scc0 L_f8_44
  v_lshlrev_b32 v10, 16, v44
  v_and_b32 v11, 0xffff0000, v44
  v_add_f32 v72, v72, v10
  v_add_f32 v73, v73, v11
  v_lshlrev_b32 v10, 16, v45
  v_and_b32 v11, 0xffff0000, v45
  v_add_f32 v74, v74, v10
  v_add_f32 v75, v75, v11
  v_lshlrev_b32 v10, 16, v46
  v_and_b32 v11, 0xffff0000, v46
  v_add_f32 v76, v76, v10
  v_add_f32 v77, v77, v11
  v_lshlrev_b32 v10, 16, v47
  v_and_b32 v11, 0xffff0000, v47
  v_add_f32 v78, v78, v10
  v_add_f32 v79, v79, v11
  v_lshlrev_b32 v10, 16, v48
  v_and_b32 v11, 0xffff0000, v48
  v_add_f32 v72, v72, v10
  v_add_f32 v73, v73, v11
  v_lshlrev_b32 v10, 16, v49
  v_and_b32 v11, 0xffff0000, v49
  v_add_f32 v74, v74, v10
  v_add_f32 v75, v75, v11
  v_lshlrev_b32 v10, 16, v50
  v_and_b32 v11, 0xffff0000, v50
  v_add_f32 v76, v76, v10
  v_add_f32 v77, v77, v11
  v_lshlrev_b32 v10, 16, v51
  v_and_b32 v11, 0xffff0000, v51
  v_add_f32 v78, v78, v10
  v_add_f32 v79, v79, v11
  v_lshlrev_b32 v10, 16, v52
  v_and_b32 v11, 0xffff0000, v52
  v_add_f32 v72, v72, v10
  v_add_f32 v73, v73, v11
  v_lshlrev_b32 v10, 16, v53
  v_and_b32 v11, 0xffff0000, v53
  v_add_f32 v74, v74, v10
  v_add_f32 v75, v75, v11
  v_lshlrev_b32 v10, 16, v54
  v_and_b32 v11, 0xffff0000, v54
  v_add_f32 v76, v76, v10
  v_add_f32 v77, v77, v11
  v_lshlrev_b32 v10, 16, v55
  v_and_b32 v11, 0xffff0000, v55
  v_add_f32 v78, v78, v10
  v_add_f32 v79, v79, v11
  v_cvt_pk_bf16_f32 v20, v72, v73
  v_cvt_pk_bf16_f32 v21, v74, v75
  v_cvt_pk_bf16_f32 v22, v76, v77
  v_cvt_pk_bf16_f32 v23, v78, v79
  buffer_store_dwordx2 v[20:21], v4, s[48:51], 0 offen offset:256
  buffer_store_dwordx2 v[22:23], v6, s[48:51], 0 offen offset:256
L_f8_44:
  s_endpgm
L_k1_g1:
  s_mul_i32 s36, s17, 36
  s_add_u32 s36, s36, 32
  v_add_u32 v72, s36, v11
  v_lshrrev_b32 v73, 1, v72
  v_and_b32 v74, 1, v72
  v_mul_u32_u24 v74, 144, v74
  v_cmp_eq_u32 vcc, 1, v72
  v_mov_b32 v75, 288
  s_nop 0
  v_cndmask_b32 v73, v73, v75, vcc
  v_cndmask_b32 v74, v74, 0, vcc
  s_mul_i32 s37, s19, 144
  v_lshlrev_b32 v75, 3, v14
  v_add_u32 v75, s37, v75
  v_mad_u32_u24 v75, v75, v73, v74
  v_cvt_f32_u32 v76, v75
  v_mul_f32 v76, 0x3ae38e39, v76
  v_cvt_u32_f32 v76, v76
  v_mul_u32_u24 v76, 576, v76
  v_sub_u32 v75, v75, v76
  v_mul_u32_u24 v77, 15, v73
  v_cvt_f32_u32 v76, v77
  v_mul_f32 v76, 0x3ae38e39, v76
  v_cvt_u32_f32 v76, v76
  v_mul_u32_u24 v76, 576, v76
  v_sub_u32 v77, v77, v76
  v_cvt_f32_u32 v78, v73
  v_mul_f32 v78, 0x3ae38e39, v78
  v_cos_f32 v78, v78
  v_mov_b32 v79, 0
  v_add_f32 v78, v78, v78
  v_mov_b32 v74, 0x3f803f80
  v_cvt_f32_u32 v80, v75
  v_add_u32 v75, v75, v73
  v_mul_f32 v80, 0x3ae38e39, v80
  v_subrev_u32 v76, 576, v75
  v_cos_f32 v80, v80
  v_min_u32 v75, v75, v76
  v_cvt_f32_u32 v81, v75
  v_add_u32 v75, v75, v77
  v_mul_f32 v81, 0x3ae38e39, v81
  v_subrev_u32 v76, 576, v75
  v_cos_f32 v81, v81
  v_min_u32 v75, v75, v76
  v_fma_f32 v82, v78, v81, -v80
  v_fma_f32 v83, v78, v82, -v81
  v_cvt_pk_bf16_f32 v16, v80, v81
  v_fma_f32 v84, v78, v83, -v82
  v_fma_f32 v85, v78, v84, -v83
  v_cvt_pk_bf16_f32 v17, v82, v83
  v_fma_f32 v86, v78, v85, -v84
  v_fma_f32 v87, v78, v86, -v85
  v_cvt_pk_bf16_f32 v18, v84, v85
  v_cvt_pk_bf16_f32 v19, v86, v87
  v_dot2c_f32_bf16 v79, v16, v74
  v_dot2c_f32_bf16 v79, v17, v74
  v_dot2c_f32_bf16 v79, v18, v74
  v_dot2c_f32_bf16 v79, v19, v74
  s_add_u32 s31, s31, 1
  s_cmp_eq_u32 s31, 9
  s_cselect_b32 s31, 0, s31
  s_lshl_b32 s32, s31, 10
  s_add_u32 s32, s32, s3
  s_lshl_b32 s94, s31, 7
  s_add_u32 s94, s94, s34
  s_add_u32 m0, s32, 0
  s_add_u32 s30, s94, 0
  buffer_load_dwordx4 v8, s[40:43], s30 offen lds
  v_cvt_f32_u32 v80, v75
  v_add_u32 v75, v75, v73
  v_mul_f32 v80, 0x3ae38e39, v80
  v_subrev_u32 v76, 576, v75
  v_cos_f32 v80, v80
  v_min_u32 v75, v75, v76
  v_cvt_f32_u32 v81, v75
  v_add_u32 v75, v75, v77
  v_mul_f32 v81, 0x3ae38e39, v81
  v_subrev_u32 v76, 576, v75
  v_cos_f32 v81, v81
  v_min_u32 v75, v75, v76
  v_fma_f32 v82, v78, v81, -v80
  v_fma_f32 v83, v78, v82, -v81
  v_cvt_pk_bf16_f32 v20, v80, v81
  v_fma_f32 v84, v78, v83, -v82
  v_fma_f32 v85, v78, v84, -v83
  v_cvt_pk_bf16_f32 v21, v82, v83
  v_fma_f32 v86, v78, v85, -v84
  v_fma_f32 v87, v78, v86, -v85
  v_cvt_pk_bf16_f32 v22, v84, v85
  v_cvt_pk_bf16_f32 v23, v86, v87
  v_dot2c_f32_bf16 v79, v20, v74
  v_dot2c_f32_bf16 v79, v21, v74
  v_dot2c_f32_bf16 v79, v22, v74
  v_dot2c_f32_bf16 v79, v23, v74
  s_add_u32 m0, s32, 9216
  s_add_u32 s30, s94, 9216
  buffer_load_dwordx4 v9, s[40:43], s30 offen lds
  v_cvt_f32_u32 v80, v75
  v_add_u32 v75, v75, v73
  v_mul_f32 v80, 0x3ae38e39, v80
  v_subrev_u32 v76, 576, v75
  v_cos_f32 v80, v80
  v_min_u32 v75, v75, v76
  v_cvt_f32_u32 v81, v75
  v_add_u32 v75, v75, v77
  v_mul_f32 v81, 0x3ae38e39, v81
  v_subrev_u32 v76, 576, v75
  v_cos_f32 v81, v81
  v_min_u32 v75, v75, v76
  v_fma_f32 v82, v78, v81, -v80
  v_fma_f32 v83, v78, v82, -v81
  v_cvt_pk_bf16_f32 v24, v80, v81
  v_fma_f32 v84, v78, v83, -v82
  v_fma_f32 v85, v78, v84, -v83
  v_cvt_pk_bf16_f32 v25, v82, v83
  v_fma_f32 v86, v78, v85, -v84
  v_fma_f32 v87, v78, v86, -v85
  v_cvt_pk_bf16_f32 v26, v84, v85
  v_cvt_pk_bf16_f32 v27, v86, v87
  v_dot2c_f32_bf16 v79, v24, v74
  v_dot2c_f32_bf16 v79, v25, v74
  v_dot2c_f32_bf16 v79, v26, v74
  v_dot2c_f32_bf16 v79, v27, v74
  s_add_u32 s31, s31, 1
  s_cmp_eq_u32 s31, 9
  s_cselect_b32 s31, 0, s31
  s_lshl_b32 s32, s31, 10
  s_add_u32 s32, s32, s3
  s_lshl_b32 s94, s31, 7
  s_add_u32 s94, s94, s34
  s_add_u32 m0, s32, 0
  s_add_u32 s30, s94, 0
  buffer_load_dwordx4 v8, s[40:43], s30 offen lds
  s_add_u32 m0, s32, 9216
  s_add_u32 s30, s94, 9216
  buffer_load_dwordx4 v9, s[40:43], s30 offen lds
  v_cvt_f32_u32 v80, v75
  v_add_u32 v75, v75, v73
  v_mul_f32 v80, 0x3ae38e39, v80
  v_subrev_u32 v76, 576, v75
  v_cos_f32 v80, v80
  v_min_u32 v75, v75, v76
  v_cvt_f32_u32 v81, v75
  v_add_u32 v75, v75, v77
  v_mul_f32 v81, 0x3ae38e39, v81
  v_subrev_u32 v76, 576, v75
  v_cos_f32 v81, v81
  v_min_u32 v75, v75, v76
  v_fma_f32 v82, v78, v81, -v80
  v_fma_f32 v83, v78, v82, -v81
  v_cvt_pk_bf16_f32 v28, v80, v81
  v_fma_f32 v84, v78, v83, -v82
  v_fma_f32 v85, v78, v84, -v83
  v_cvt_pk_bf16_f32 v29, v82, v83
  v_fma_f32 v86, v78, v85, -v84
  v_fma_f32 v87, v78, v86, -v85
  v_cvt_pk_bf16_f32 v30, v84, v85
  v_cvt_pk_bf16_f32 v31, v86, v87
  v_dot2c_f32_bf16 v79, v28, v74
  v_dot2c_f32_bf16 v79, v29, v74
  v_dot2c_f32_bf16 v79, v30, v74
  v_dot2c_f32_bf16 v79, v31, v74
  s_add_u32 s31, s31, 1
  s_cmp_eq_u32 s31, 9
  s_cselect_b32 s31, 0, s31
  s_lshl_b32 s32, s31, 10
  s_add_u32 s32, s32, s3
  s_lshl_b32 s94, s31, 7
  s_add_u32 s94, s94, s34
  s_add_u32 m0, s32, 0
  s_add_u32 s30, s94, 0
  buffer_load_dwordx4 v8, s[40:43], s30 offen lds
  v_cvt_f32_u32 v80, v75
  v_add_u32 v75, v75, v73
  v_mul_f32 v80, 0x3ae38e39, v80
  v_subrev_u32 v76, 576, v75
  v_cos_f32 v80, v80
  v_min_u32 v75, v75, v76
  v_cvt_f32_u32 v81, v75
  v_add_u32 v75, v75, v77
  v_mul_f32 v81, 0x3ae38e39, v81
  v_subrev_u32 v76, 576, v75
  v_cos_f32 v81, v81
  v_min_u32 v75, v75, v76
  v_fma_f32 v82, v78, v81, -v80
  v_fma_f32 v83, v78, v82, -v81
  v_cvt_pk_bf16_f32 v32, v80, v81
  v_fma_f32 v84, v78, v83, -v82
  v_fma_f32 v85, v78, v84, -v83
  v_cvt_pk_bf16_f32 v33, v82, v83
  v_fma_f32 v86, v78, v85, -v84
  v_fma_f32 v87, v78, v86, -v85
  v_cvt_pk_bf16_f32 v34, v84, v85
  v_cvt_pk_bf16_f32 v35, v86, v87
  v_dot2c_f32_bf16 v79, v32, v74
  v_dot2c_f32_bf16 v79, v33, v74
  v_dot2c_f32_bf16 v79, v34, v74
  v_dot2c_f32_bf16 v79, v35, v74
  s_add_u32 m0, s32, 9216
  s_add_u32 s30, s94, 9216
  buffer_load_dwordx4 v9, s[40:43], s30 offen lds
  v_cvt_f32_u32 v80, v75
  v_add_u32 v75, v75, v73
  v_mul_f32 v80, 0x3ae38e39, v80
  v_subrev_u32 v76, 576, v75
  v_cos_f32 v80, v80
  v_min_u32 v75, v75, v76
  v_cvt_f32_u32 v81, v75
  v_add_u32 v75, v75, v77
  v_mul_f32 v81, 0x3ae38e39, v81
  v_subrev_u32 v76, 576, v75
  v_cos_f32 v81, v81
  v_min_u32 v75, v75, v76
  v_fma_f32 v82, v78, v81, -v80
  v_fma_f32 v83, v78, v82, -v81
  v_cvt_pk_bf16_f32 v36, v80, v81
  v_fma_f32 v84, v78, v83, -v82
  v_fma_f32 v85, v78, v84, -v83
  v_cvt_pk_bf16_f32 v37, v82, v83
  v_fma_f32 v86, v78, v85, -v84
  v_fma_f32 v87, v78, v86, -v85
  v_cvt_pk_bf16_f32 v38, v84, v85
  v_cvt_pk_bf16_f32 v39, v86, v87
  v_dot2c_f32_bf16 v79, v36, v74
  v_dot2c_f32_bf16 v79, v37, v74
  v_dot2c_f32_bf16 v79, v38, v74
  v_dot2c_f32_bf16 v79, v39, v74
  s_add_u32 s31, s31, 1
  s_cmp_eq_u32 s31, 9
  s_cselect_b32 s31, 0, s31
  s_lshl_b32 s32, s31, 10
  s_add_u32 s32, s32, s3
  s_lshl_b32 s94, s31, 7
  s_add_u32 s94, s94, s34
  s_add_u32 m0, s32, 0
  s_add_u32 s30, s94, 0
  buffer_load_dwordx4 v8, s[40:43], s30 offen lds
  s_add_u32 m0, s32, 9216
  s_add_u32 s30, s94, 9216
  buffer_load_dwordx4 v9, s[40:43], s30 offen lds
  v_cvt_f32_u32 v80, v75
  v_add_u32 v75, v75, v73
  v_mul_f32 v80, 0x3ae38e39, v80
  v_subrev_u32 v76, 576, v75
  v_cos_f32 v80, v80
  v_min_u32 v75, v75, v76
  v_cvt_f32_u32 v81, v75
  v_add_u32 v75, v75, v77
  v_mul_f32 v81, 0x3ae38e39, v81
  v_subrev_u32 v76, 576, v75
  v_cos_f32 v81, v81
  v_min_u32 v75, v75, v76
  v_fma_f32 v82, v78, v81, -v80
  v_fma_f32 v83, v78, v82, -v81
  v_cvt_pk_bf16_f32 v40, v80, v81
  v_fma_f32 v84, v78, v83, -v82
  v_fma_f32 v85, v78, v84, -v83
  v_cvt_pk_bf16_f32 v41, v82, v83
  v_fma_f32 v86, v78, v85, -v84
  v_fma_f32 v87, v78, v86, -v85
  v_cvt_pk_bf16_f32 v42, v84, v85
  v_cvt_pk_bf16_f32 v43, v86, v87
  v_dot2c_f32_bf16 v79, v40, v74
  v_dot2c_f32_bf16 v79, v41, v74
  v_dot2c_f32_bf16 v79, v42, v74
  v_dot2c_f32_bf16 v79, v43, v74
  s_add_u32 s31, s31, 1
  s_cmp_eq_u32 s31, 9
  s_cselect_b32 s31, 0, s31
  s_lshl_b32 s32, s31, 10
  s_add_u32 s32, s32, s3
  s_lshl_b32 s94, s31, 7
  s_add_u32 s94, s94, s34
  s_add_u32 m0, s32, 0
  s_add_u32 s30, s94, 0
  buffer_load_dwordx4 v8, s[40:43], s30 offen lds
  v_cvt_f32_u32 v80, v75
  v_add_u32 v75, v75, v73
  v_mul_f32 v80, 0x3ae38e39, v80
  v_subrev_u32 v76, 576, v75
  v_cos_f32 v80, v80
  v_min_u32 v75, v75, v76
  v_cvt_f32_u32 v81, v75
  v_add_u32 v75, v75, v77
  v_mul_f32 v81, 0x3ae38e39, v81
  v_subrev_u32 v76, 576, v75
  v_cos_f32 v81, v81
  v_min_u32 v75, v75, v76
  v_fma_f32 v82, v78, v81, -v80
  v_fma_f32 v83, v78, v82, -v81
  v_cvt_pk_bf16_f32 v44, v80, v81
  v_fma_f32 v84, v78, v83, -v82
  v_fma_f32 v85, v78, v84, -v83
  v_cvt_pk_bf16_f32 v45, v82, v83
  v_fma_f32 v86, v78, v85, -v84
  v_fma_f32 v87, v78, v86, -v85
  v_cvt_pk_bf16_f32 v46, v84, v85
  v_cvt_pk_bf16_f32 v47, v86, v87
  v_dot2c_f32_bf16 v79, v44, v74
  v_dot2c_f32_bf16 v79, v45, v74
  v_dot2c_f32_bf16 v79, v46, v74
  v_dot2c_f32_bf16 v79, v47, v74
  s_add_u32 m0, s32, 9216
  s_add_u32 s30, s94, 9216
  buffer_load_dwordx4 v9, s[40:43], s30 offen lds
  v_cvt_f32_u32 v80, v75
  v_add_u32 v75, v75, v73
  v_mul_f32 v80, 0x3ae38e39, v80
  v_subrev_u32 v76, 576, v75
  v_cos_f32 v80, v80
  v_min_u32 v75, v75, v76
  v_cvt_f32_u32 v81, v75
  v_add_u32 v75, v75, v77
  v_mul_f32 v81, 0x3ae38e39, v81
  v_subrev_u32 v76, 576, v75
  v_cos_f32 v81, v81
  v_min_u32 v75, v75, v76
  v_fma_f32 v82, v78, v81, -v80
  v_fma_f32 v83, v78, v82, -v81
  v_cvt_pk_bf16_f32 v48, v80, v81
  v_fma_f32 v84, v78, v83, -v82
  v_fma_f32 v85, v78, v84, -v83
  v_cvt_pk_bf16_f32 v49, v82, v83
  v_fma_f32 v86, v78, v85, -v84
  v_fma_f32 v87, v78, v86, -v85
  v_cvt_pk_bf16_f32 v50, v84, v85
  v_cvt_pk_bf16_f32 v51, v86, v87
  v_dot2c_f32_bf16 v79, v48, v74
  v_dot2c_f32_bf16 v79, v49, v74
  v_dot2c_f32_bf16 v79, v50, v74
  v_dot2c_f32_bf16 v79, v51, v74
  s_add_u32 s31, s31, 1
  s_cmp_eq_u32 s31, 9
  s_cselect_b32 s31, 0, s31
  s_lshl_b32 s32, s31, 10
  s_add_u32 s32, s32, s3
  s_lshl_b32 s94, s31, 7
  s_add_u32 s94, s94, s34
  s_add_u32 m0, s32, 0
  s_add_u32 s30, s94, 0
  buffer_load_dwordx4 v8, s[40:43], s30 offen lds
  s_add_u32 m0, s32, 9216
  s_add_u32 s30, s94, 9216
  buffer_load_dwordx4 v9, s[40:43], s30 offen lds
  s_lshl_b32 s36, s19, 8
  s_add_u32 s36, s36, 162816
  v_lshlrev_b32 v12, 2, v1
  v_add_u32 v12, s36, v12
  ds_write_b32 v12, v79
  s_lshl_b32 s36, s18, 8
  s_add_u32 s36, s36, s2
  s_sub_u32 s36, s36, 1024
  s_cmp_ge_u32 s36, 62
  s_cbranch_scc1 L_tab_end_45
  v_lshrrev_b32 v112, 4, v1
  v_and_b32 v113, 15, v1
  s_cmp_lt_u32 s36, 6
  s_cbranch_scc1 L_tab_t0_48
  s_cmp_lt_u32 s36, 22
  s_cbranch_scc1 L_tab_t1_49
  s_cmp_lt_u32 s36, 38
  s_cbranch_scc1 L_tab_t2_50
  s_cmp_lt_u32 s36, 54
  s_cbranch_scc1 L_tab_t3_51
  s_branch L_tab_t4_52
L_tab_t0_48:
  s_cmp_ge_u32 s36, 3
  s_cselect_b32 s37, 1, 0
  s_mul_i32 s38, s37, 3
  s_sub_u32 s38, s36, s38
  s_lshl_b32 s39, s38, 9
  s_cmp_eq_u32 s38, 2
  s_cselect_b32 s39, 1536, s39
  s_lshl_b32 s37, s37, 4
  v_add_u32 v115, s37, v113
  v_lshlrev_b32 v115, 6, v115
  v_lshlrev_b32 v114, 3, v112
  v_add_u32 v116, 0, v114
  v_mul_u32_u24 v116, v116, v115
  v_add_u32 v116, s39, v116
  v_and_b32 v116, 2047, v116
  v_cvt_f32_u32 v116, v116
  v_mul_f32 v116, 0x3a000000, v116
  v_cos_f32 v104, v116
  v_add_u32 v116, 1, v114
  v_mul_u32_u24 v116, v116, v115
  v_add_u32 v116, s39, v116
  v_and_b32 v116, 2047, v116
  v_cvt_f32_u32 v116, v116
  v_mul_f32 v116, 0x3a000000, v116
  v_cos_f32 v105, v116
  v_add_u32 v116, 2, v114
  v_mul_u32_u24 v116, v116, v115
  v_add_u32 v116, s39, v116
  v_and_b32 v116, 2047, v116
  v_cvt_f32_u32 v116, v116
  v_mul_f32 v116, 0x3a000000, v116
  v_cos_f32 v106, v116
  v_add_u32 v116, 3, v114
  v_mul_u32_u24 v116, v116, v115
  v_add_u32 v116, s39, v116
  v_and_b32 v116, 2047, v116
  v_cvt_f32_u32 v116, v116
  v_mul_f32 v116, 0x3a000000, v116
  v_cos_f32 v107, v116
  v_add_u32 v116, 4, v114
  v_mul_u32_u24 v116, v116, v115
  v_add_u32 v116, s39, v116
  v_and_b32 v116, 2047, v116
  v_cvt_f32_u32 v116, v116
  v_mul_f32 v116, 0x3a000000, v116
  v_cos_f32 v108, v116
  v_add_u32 v116, 5, v114
  v_mul_u32_u24 v116, v116, v115
  v_add_u32 v116, s39, v116
  v_and_b32 v116, 2047, v116
  v_cvt_f32_u32 v116, v116
  v_mul_f32 v116, 0x3a000000, v116
  v_cos_f32 v109, v116
  v_add_u32 v116, 6, v114
  v_mul_u32_u24 v116, v116, v115
  v_add_u32 v116, s39, v116
  v_and_b32 v116, 2047, v116
  v_cvt_f32_u32 v116, v116
  v_mul_f32 v116, 0x3a000000, v116
  v_cos_f32 v110, v116
  v_add_u32 v116, 7, v114
  v_mul_u32_u24 v116, v116, v115
  v_add_u32 v116, s39, v116
  v_and_b32 v116, 2047, v116
  v_cvt_f32_u32 v116, v116
  v_mul_f32 v116, 0x3a000000, v116
  v_cos_f32 v111, v116
  s_nop 0
  v_mul_f32 v104, 0x3e000000, v104
  v_mul_f32 v105, 0x3e000000, v105
  v_mul_f32 v106, 0x3e000000, v106
  v_mul_f32 v107, 0x3e000000, v107
  v_mul_f32 v108, 0x3e000000, v108
  v_mul_f32 v109, 0x3e000000, v109
  v_mul_f32 v110, 0x3e000000, v110
  v_mul_f32 v111, 0x3e000000, v111
  s_branch L_tab_s16_46
L_tab_t1_49:
  s_sub_u32 s37, s36, 6
  s_and_b32 s39, s37, 1
  s_lshl_b32 s39, s39, 9
  s_lshr_b32 s38, s37, 3
  s_lshl_b32 s38, s38, 4
  v_add_u32 v115, s38, v113
  s_bfe_u32 s38, s37, 0x20001
  s_lshl_b32 s38, s38, 4
  v_lshlrev_b32 v114, 2, v112
  v_add_u32 v114, s38, v114
  s_branch L_tab_s32_47
L_tab_t2_50:
  s_sub_u32 s37, s36, 22
  s_and_b32 s39, s37, 1
  s_lshl_b32 s39, s39, 9
  s_lshr_b32 s38, s37, 2
  s_lshl_b32 s38, s38, 4
  v_add_u32 v115, s38, v113
  v_lshlrev_b32 v115, 5, v115
  s_bfe_u32 s38, s37, 0x10001
  s_lshl_b32 s38, s38, 5
  v_lshlrev_b32 v114, 2, v112
  v_add_u32 v114, s38, v114
  v_add_u32 v116, 0, v114
  v_mul_u32_u24 v116, v116, v115
  v_add_u32 v116, s39, v116
  v_and_b32 v116, 2047, v116
  v_cvt_f32_u32 v116, v116
  v_mul_f32 v116, 0x3a000000, v116
  v_cos_f32 v104, v116
  v_add_u32 v116, 1, v114
  v_mul_u32_u24 v116, v116, v115
  v_add_u32 v116, s39, v116
  v_and_b32 v116, 2047, v116
  v_cvt_f32_u32 v116, v116
  v_mul_f32 v116, 0x3a000000, v116
  v_cos_f32 v105, v116
  v_add_u32 v116, 2, v114
  v_mul_u32_u24 v116, v116, v115
  v_add_u32 v116, s39, v116
  v_and_b32 v116, 2047, v116
  v_cvt_f32_u32 v116, v116
  v_mul_f32 v116, 0x3a000000, v116
  v_cos_f32 v106, v116
  v_add_u32 v116, 3, v114
  v_mul_u32_u24 v116, v116, v115
  v_add_u32 v116, s39, v116
  v_and_b32 v116, 2047, v116
  v_cvt_f32_u32 v116, v116
  v_mul_f32 v116, 0x3a000000, v116
  v_cos_f32 v107, v116
  v_add_u32 v116, 16, v114
  v_mul_u32_u24 v116, v116, v115
  v_add_u32 v116, s39, v116
  v_and_b32 v116, 2047, v116
  v_cvt_f32_u32 v116, v116
  v_mul_f32 v116, 0x3a000000, v116
  v_cos_f32 v108, v116
  v_add_u32 v116, 17, v114
  v_mul_u32_u24 v116, v116, v115
  v_add_u32 v116, s39, v116
  v_and_b32 v116, 2047, v116
  v_cvt_f32_u32 v116, v116
  v_mul_f32 v116, 0x3a000000, v116
  v_cos_f32 v109, v116
  v_add_u32 v116, 18, v114
  v_mul_u32_u24 v116, v116, v115
  v_add_u32 v116, s39, v116
  v_and_b32 v116, 2047, v116
  v_cvt_f32_u32 v116, v116
  v_mul_f32 v116, 0x3a000000, v116
  v_cos_f32 v110, v116
  v_add_u32 v116, 19, v114
  v_mul_u32_u24 v116, v116, v115
  v_add_u32 v116, s39, v116
  v_and_b32 v116, 2047, v116
  v_cvt_f32_u32 v116, v116
  v_mul_f32 v116, 0x3a000000, v116
  v_cos_f32 v111, v116
  s_branch L_tab_s16_46
L_tab_t3_51:
  s_sub_u32 s37, s36, 38
  s_and_b32 s39, s37, 1
  s_mul_i32 s39, s39, 1536
  s_bfe_u32 s38, s37, 0x20001
  s_lshl_b32 s38, s38, 4
  v_add_u32 v115, s38, v113
  s_lshr_b32 s38, s37, 3
  s_lshl_b32 s38, s38, 4
  v_lshlrev_b32 v114, 2, v112
  v_add_u32 v114, s38, v114
L_tab_s32_47:
  v_add_u32 v116, 0, v114
  v_mul_u32_u24 v116, v116, v115
  v_add_u32 v116, s39, v116
  v_and_b32 v116, 2047, v116
  v_cvt_f32_u32 v116, v116
  v_mul_f32 v116, 0x3a000000, v116
  v_cos_f32 v120, v116
  v_add_u32 v116, 1, v114
  v_mul_u32_u24 v116, v116, v115
  v_add_u32 v116, s39, v116
  v_and_b32 v116, 2047, v116
  v_cvt_f32_u32 v116, v116
  v_mul_f32 v116, 0x3a000000, v116
  v_cos_f32 v121, v116
  v_add_u32 v116, 2, v114
  v_mul_u32_u24 v116, v116, v115
  v_add_u32 v116, s39, v116
  v_and_b32 v116, 2047, v116
  v_cvt_f32_u32 v116, v116
  v_mul_f32 v116, 0x3a000000, v116
  v_cos_f32 v122, v116
  v_add_u32 v116, 3, v114
  v_mul_u32_u24 v116, v116, v115
  v_add_u32 v116, s39, v116
  v_and_b32 v116, 2047, v116
  v_cvt_f32_u32 v116, v116
  v_mul_f32 v116, 0x3a000000, v116
  v_cos_f32 v123, v116
  s_nop 0
  v_mul_f32 v120, 0x3e000000, v120
  v_mul_f32 v121, 0x3e000000, v121
  v_mul_f32 v122, 0x3e000000, v122
  v_mul_f32 v123, 0x3e000000, v123
  s_branch L_tab_fin_53
L_tab_t4_52:
  s_sub_u32 s37, s36, 54
  s_and_b32 s39, s37, 1
  s_mul_i32 s39, s39, 1536
  s_lshr_b32 s38, s37, 2
  s_lshl_b32 s38, s38, 4
  v_add_u32 v115, s38, v113
  v_lshlrev_b32 v115, 6, v115
  s_bfe_u32 s38, s37, 0x10001
  s_lshl_b32 s38, s38, 4
  v_lshlrev_b32 v114, 2, v112
  v_add_u32 v114, s38, v114
  v_add_u32 v116, 0, v114
  v_mul_u32_u24 v116, v116, v115
  v_add_u32 v116, s39, v116
  v_and_b32 v116, 2047, v116
  v_cvt_f32_u32 v116, v116
  v_mul_f32 v116, 0x3a000000, v116
  v_cos_f32 v104, v116
  v_add_u32 v116, 1, v114
  v_mul_u32_u24 v116, v116, v115
  v_add_u32 v116, s39, v116
  v_and_b32 v116, 2047, v116
  v_cvt_f32_u32 v116, v116
  v_mul_f32 v116, 0x3a000000, v116
  v_cos_f32 v105, v116
  v_add_u32 v116, 2, v114
  v_mul_u32_u24 v116, v116, v115
  v_add_u32 v116, s39, v116
  v_and_b32 v116, 2047, v116
  v_cvt_f32_u32 v116, v116
  v_mul_f32 v116, 0x3a000000, v116
  v_cos_f32 v106, v116
  v_add_u32 v116, 3, v114
  v_mul_u32_u24 v116, v116, v115
  v_add_u32 v116, s39, v116
  v_and_b32 v116, 2047, v116
  v_cvt_f32_u32 v116, v116
  v_mul_f32 v116, 0x3a000000, v116
  v_cos_f32 v107, v116
  v_add_u32 v116, 0, v114
  v_mul_u32_u24 v116, v116, v115
  v_add_u32 v116, s39, v116
  v_add_u32 v116, 512, v116
  v_and_b32 v116, 2047, v116
  v_cvt_f32_u32 v116, v116
  v_mul_f32 v116, 0x3a000000, v116
  v_cos_f32 v108, v116
  v_add_u32 v116, 1, v114
  v_mul_u32_u24 v116, v116, v115
  v_add_u32 v116, s39, v116
  v_add_u32 v116, 512, v116
  v_and_b32 v116, 2047, v116
  v_cvt_f32_u32 v116, v116
  v_mul_f32 v116, 0x3a000000, v116
  v_cos_f32 v109, v116
  v_add_u32 v116, 2, v114
  v_mul_u32_u24 v116, v116, v115
  v_add_u32 v116, s39, v116
  v_add_u32 v116, 512, v116
  v_and_b32 v116, 2047, v116
  v_cvt_f32_u32 v116, v116
  v_mul_f32 v116, 0x3a000000, v116
  v_cos_f32 v110, v116
  v_add_u32 v116, 3, v114
  v_mul_u32_u24 v116, v116, v115
  v_add_u32 v116, s39, v116
  v_add_u32 v116, 512, v116
  v_and_b32 v116, 2047, v116
  v_cvt_f32_u32 v116, v116
  v_mul_f32 v116, 0x3a000000, v116
  v_cos_f32 v111, v116
L_tab_s16_46:
  s_nop 0
  v_cvt_pk_f16_f32 v120, v104, v105
  v_cvt_pk_f16_f32 v121, v106, v107
  v_cvt_pk_f16_f32 v122, v108, v109
  v_cvt_pk_f16_f32 v123, v110, v111
L_tab_fin_53:
  s_lshl_b32 s37, s36, 10
  s_add_u32 s37, s37, 0x21d4000
  v_lshlrev_b32 v112, 4, v1
  buffer_store_dwordx4 v[120:123], v112, s[4:7], s37 offen sc1
L_tab_end_45:
  s_cmp_ge_u32 s18, 3
  s_cselect_b32 s38, 3, 0
  s_sub_u32 s38, s18, s38
  s_lshl_b32 s38, s38, 12
  s_add_u32 s38, s38, 151552
  s_lshl_b32 s56, s18, 8
  s_add_u32 s56, s56, s2
  s_mul_hi_u32 s32, s56, 0x1c71c71d
  s_mul_i32 s28, s32, 9
  s_sub_u32 s28, s56, s28
  s_mul_i32 s3, s32, 36864
  s_lshl_b32 s57, s28, 7
  s_add_u32 s3, s3, s57
  v_lshrrev_b32 v4, 3, v1
  v_mul_u32_u24 v4, 1152, v4
  v_and_b32 v5, 7, v1
  v_lshl_add_u32 v248, v5, 4, v4
  s_mul_i32 s32, s32, 36
  s_lshl_b32 s28, s28, 2
  s_add_u32 s32, s32, s28
  s_lshl_b32 s32, s32, 10
  s_add_u32 s32, s32, 0x1c22000
  s_mov_b32 s100, s56
  s_and_b32 s56, s2, 31
  s_lshr_b32 s57, s2, 5
  s_lshr_b32 s28, s56, 4
  s_lshl_b32 s28, s28, 4
  s_and_b32 s36, s56, 15
  s_lshl_b32 s36, s36, 7
  s_add_u32 s28, s28, s36
  s_mul_i32 s28, s28, 578
  s_mul_i32 s36, s57, 72
  s_add_u32 s28, s28, s36
  v_mul_u32_u24 v4, 13108, v0
  v_lshrrev_b32 v4, 16, v4
  v_mul_u32_u24 v5, 5, v4
  v_sub_u32 v5, v0, v5
  v_lshrrev_b32 v6, 4, v4
  v_lshlrev_b32 v6, 5, v6
  v_and_b32 v7, 15, v4
  v_add_u32 v6, v6, v7
  v_mul_u32_u24 v6, 578, v6
  v_lshl_add_u32 v6, v5, 4, v6
  v_and_b32 v4, 1, v4
  v_lshlrev_b32 v4, 1, v4
  v_sub_u32 v6, v6, v4
  v_add_u32 v249, s28, v6
  s_mul_i32 s57, s57, 294912
  s_lshl_b32 s56, s56, 8
  s_add_u32 s56, s56, s57
  s_add_u32 s56, s56, 0x19e0000
  s_lshl_b32 s36, s19, 5
  v_add_u32 v13, s36, v11
  v_bfe_u32 v12, v13, 1, 3
  v_lshrrev_b32 v10, 3, v13
  v_mul_u32_u24 v10, 9216, v10
  v_and_b32 v9, 7, v13
  v_lshl_add_u32 v10, v9, 7, v10
  v_add_u32 v4, 0, v14
  v_xor_b32 v4, v4, v12
  v_lshl_add_u32 v4, v4, 4, v10
  v_add_u32 v5, 2, v14
  v_xor_b32 v5, v5, v12
  v_lshl_add_u32 v5, v5, 4, v10
  v_add_u32 v6, 4, v14
  v_xor_b32 v6, v6, v12
  v_lshl_add_u32 v6, v6, 4, v10
  v_add_u32 v7, 6, v14
  v_xor_b32 v7, v7, v12
  v_lshl_add_u32 v7, v7, 4, v10
  v_lshlrev_b32 v9, 5, v13
  v_add_u32 v9, 151552, v9
  v_lshl_add_u32 v8, v14, 3, v9
  s_waitcnt vmcnt(0) lgkmcnt(0)
  s_barrier
  v_mov_b32 v253, 0
  buffer_load_dword v255, v253, s[20:23], 0 offen sc1
  v_mul_u32_u24 v12, 1152, v11
  s_cmp_lt_u32 s100, 1296
  s_cbranch_scc0 L_skip_54
  buffer_load_dword v254, v12, s[52:55], s3 offen
L_skip_54:
  ds_read_b128 v[160:163], v6 offset:4096
  ds_read_b128 v[164:167], v7 offset:4096
  ds_read_b128 v[168:171], v4 offset:5120
  ds_read_b128 v[172:175], v5 offset:5120
  ds_read_b128 v[176:179], v6 offset:5120
  ds_read_b128 v[180:183], v7 offset:5120
  ds_read_b128 v[184:187], v4 offset:6144
  ds_read_b128 v[188:191], v5 offset:6144
  ds_read_b128 v[192:195], v6 offset:6144
  ds_read_b128 v[196:199], v7 offset:6144
  ds_read_b128 v[200:203], v4 offset:7168
  ds_read_b128 v[204:207], v5 offset:7168
  ds_read_b128 v[208:211], v6 offset:7168
  ds_read_b128 v[212:215], v7 offset:7168
  ds_read_b128 v[216:219], v4 offset:8192
  ds_read_b128 v[220:223], v5 offset:8192
  ds_read_b128 v[224:227], v6 offset:8192
  ds_read_b128 v[228:231], v7 offset:8192
  v_mov_b32 v80, 0
  v_mov_b32 v81, 0
  v_mov_b32 v82, 0
  v_mov_b32 v83, 0
  v_mov_b32 v84, 0
  v_mov_b32 v85, 0
  v_mov_b32 v86, 0
  v_mov_b32 v87, 0
  v_mov_b32 v79, 0x3f803f80
  ds_read_b128 v[88:91], v4 offset:0
  s_waitcnt lgkmcnt(15)
  v_dot2c_f32_bf16 v80, v160, v79
  v_dot2c_f32_bf16 v84, v160, v160
  v_dot2c_f32_bf16 v81, v161, v79
  v_dot2c_f32_bf16 v85, v161, v161
  v_dot2c_f32_bf16 v82, v162, v79
  v_dot2c_f32_bf16 v86, v162, v162
  v_dot2c_f32_bf16 v83, v163, v79
  v_dot2c_f32_bf16 v87, v163, v163
  ds_read_b128 v[92:95], v5 offset:0
  s_waitcnt lgkmcnt(15)
  v_dot2c_f32_bf16 v80, v164, v79
  v_dot2c_f32_bf16 v84, v164, v164
  v_dot2c_f32_bf16 v81, v165, v79
  v_dot2c_f32_bf16 v85, v165, v165
  v_dot2c_f32_bf16 v82, v166, v79
  v_dot2c_f32_bf16 v86, v166, v166
  v_dot2c_f32_bf16 v83, v167, v79
  v_dot2c_f32_bf16 v87, v167, v167
  ds_read_b128 v[96:99], v6 offset:0
  s_waitcnt lgkmcnt(15)
  v_dot2c_f32_bf16 v80, v168, v79
  v_dot2c_f32_bf16 v84, v168, v168
  v_dot2c_f32_bf16 v81, v169, v79
  v_dot2c_f32_bf16 v85, v169, v169
  v_dot2c_f32_bf16 v82, v170, v79
  v_dot2c_f32_bf16 v86, v170, v170
  v_dot2c_f32_bf16 v83, v171, v79
  v_dot2c_f32_bf16 v87, v171, v171
  ds_read_b128 v[100:103], v7 offset:0
  s_waitcnt lgkmcnt(15)
  v_dot2c_f32_bf16 v80, v172, v79
  v_dot2c_f32_bf16 v84, v172, v172
  v_dot2c_f32_bf16 v81, v173, v79
  v_dot2c_f32_bf16 v85, v173, v173
  v_dot2c_f32_bf16 v82, v174, v79
  v_dot2c_f32_bf16 v86, v174, v174
  v_dot2c_f32_bf16 v83, v175, v79
  v_dot2c_f32_bf16 v87, v175, v175
  ds_read_b128 v[104:107], v4 offset:1024
  s_waitcnt lgkmcnt(15)
  v_dot2c_f32_bf16 v80, v176, v79
  v_dot2c_f32_bf16 v84, v176, v176
  v_dot2c_f32_bf16 v81, v177, v79
  v_dot2c_f32_bf16 v85, v177, v177
  v_dot2c_f32_bf16 v82, v178, v79
  v_dot2c_f32_bf16 v86, v178, v178
  v_dot2c_f32_bf16 v83, v179, v79
  v_dot2c_f32_bf16 v87, v179, v179
  ds_read_b128 v[108:111], v5 offset:1024
  s_waitcnt lgkmcnt(15)
  v_dot2c_f32_bf16 v80, v180, v79
  v_dot2c_f32_bf16 v84, v180, v180
  v_dot2c_f32_bf16 v81, v181, v79
  v_dot2c_f32_bf16 v85, v181, v181
  v_dot2c_f32_bf16 v82, v182, v79
  v_dot2c_f32_bf16 v86, v182, v182
  v_dot2c_f32_bf16 v83, v183, v79
  v_dot2c_f32_bf16 v87, v183, v183
  ds_read_b128 v[112:115], v6 offset:1024
  s_waitcnt lgkmcnt(15)
  v_dot2c_f32_bf16 v80, v184, v79
  v_dot2c_f32_bf16 v84, v184, v184
  v_dot2c_f32_bf16 v81, v185, v79
  v_dot2c_f32_bf16 v85, v185, v185
  v_dot2c_f32_bf16 v82, v186, v79
  v_dot2c_f32_bf16 v86, v186, v186
  v_dot2c_f32_bf16 v83, v187, v79
  v_dot2c_f32_bf16 v87, v187, v187
  ds_read_b128 v[116:119], v7 offset:1024
  s_waitcnt lgkmcnt(15)
  v_dot2c_f32_bf16 v80, v188, v79
  v_dot2c_f32_bf16 v84, v188, v188
  v_dot2c_f32_bf16 v81, v189, v79
  v_dot2c_f32_bf16 v85, v189, v189
  v_dot2c_f32_bf16 v82, v190, v79
  v_dot2c_f32_bf16 v86, v190, v190
  v_dot2c_f32_bf16 v83, v191, v79
  v_dot2c_f32_bf16 v87, v191, v191
  ds_read_b128 v[120:123], v4 offset:2048
  s_waitcnt lgkmcnt(15)
  v_dot2c_f32_bf16 v80, v192, v79
  v_dot2c_f32_bf16 v84, v192, v192
  v_dot2c_f32_bf16 v81, v193, v79
  v_dot2c_f32_bf16 v85, v193, v193
  v_dot2c_f32_bf16 v82, v194, v79
  v_dot2c_f32_bf16 v86, v194, v194
  v_dot2c_f32_bf16 v83, v195, v79
  v_dot2c_f32_bf16 v87, v195, v195
  ds_read_b128 v[124:127], v5 offset:2048
  s_waitcnt lgkmcnt(15)
  v_dot2c_f32_bf16 v80, v196, v79
  v_dot2c_f32_bf16 v84, v196, v196
  v_dot2c_f32_bf16 v81, v197, v79
  v_dot2c_f32_bf16 v85, v197, v197
  v_dot2c_f32_bf16 v82, v198, v79
  v_dot2c_f32_bf16 v86, v198, v198
  v_dot2c_f32_bf16 v83, v199, v79
  v_dot2c_f32_bf16 v87, v199, v199
  ds_read_b128 v[128:131], v6 offset:2048
  s_waitcnt lgkmcnt(15)
  v_dot2c_f32_bf16 v80, v200, v79
  v_dot2c_f32_bf16 v84, v200, v200
  v_dot2c_f32_bf16 v81, v201, v79
  v_dot2c_f32_bf16 v85, v201, v201
  v_dot2c_f32_bf16 v82, v202, v79
  v_dot2c_f32_bf16 v86, v202, v202
  v_dot2c_f32_bf16 v83, v203, v79
  v_dot2c_f32_bf16 v87, v203, v203
  ds_read_b128 v[132:135], v7 offset:2048
  s_waitcnt lgkmcnt(15)
  v_dot2c_f32_bf16 v80, v204, v79
  v_dot2c_f32_bf16 v84, v204, v204
  v_dot2c_f32_bf16 v81, v205, v79
  v_dot2c_f32_bf16 v85, v205, v205
  v_dot2c_f32_bf16 v82, v206, v79
  v_dot2c_f32_bf16 v86, v206, v206
  v_dot2c_f32_bf16 v83, v207, v79
  v_dot2c_f32_bf16 v87, v207, v207
  ds_read_b128 v[136:139], v4 offset:3072
  s_waitcnt lgkmcnt(15)
  v_dot2c_f32_bf16 v80, v208, v79
  v_dot2c_f32_bf16 v84, v208, v208
  v_dot2c_f32_bf16 v81, v209, v79
  v_dot2c_f32_bf16 v85, v209, v209
  v_dot2c_f32_bf16 v82, v210, v79
  v_dot2c_f32_bf16 v86, v210, v210
  v_dot2c_f32_bf16 v83, v211, v79
  v_dot2c_f32_bf16 v87, v211, v211
  ds_read_b128 v[140:143], v5 offset:3072
  s_waitcnt lgkmcnt(15)
  v_dot2c_f32_bf16 v80, v212, v79
  v_dot2c_f32_bf16 v84, v212, v212
  v_dot2c_f32_bf16 v81, v213, v79
  v_dot2c_f32_bf16 v85, v213, v213
  v_dot2c_f32_bf16 v82, v214, v79
  v_dot2c_f32_bf16 v86, v214, v214
  v_dot2c_f32_bf16 v83, v215, v79
  v_dot2c_f32_bf16 v87, v215, v215
  ds_read_b128 v[144:147], v6 offset:3072
  s_waitcnt lgkmcnt(15)
  v_dot2c_f32_bf16 v80, v216, v79
  v_dot2c_f32_bf16 v84, v216, v216
  v_dot2c_f32_bf16 v81, v217, v79
  v_dot2c_f32_bf16 v85, v217, v217
  v_dot2c_f32_bf16 v82, v218, v79
  v_dot2c_f32_bf16 v86, v218, v218
  v_dot2c_f32_bf16 v83, v219, v79
  v_dot2c_f32_bf16 v87, v219, v219
  ds_read_b128 v[148:151], v7 offset:3072
  s_waitcnt lgkmcnt(15)
  v_dot2c_f32_bf16 v80, v220, v79
  v_dot2c_f32_bf16 v84, v220, v220
  v_dot2c_f32_bf16 v81, v221, v79
  v_dot2c_f32_bf16 v85, v221, v221
  v_dot2c_f32_bf16 v82, v222, v79
  v_dot2c_f32_bf16 v86, v222, v222
  v_dot2c_f32_bf16 v83, v223, v79
  v_dot2c_f32_bf16 v87, v223, v223
  ds_read_b128 v[152:155], v4 offset:4096
  s_waitcnt lgkmcnt(15)
  v_dot2c_f32_bf16 v80, v224, v79
  v_dot2c_f32_bf16 v84, v224, v224
  v_dot2c_f32_bf16 v81, v225, v79
  v_dot2c_f32_bf16 v85, v225, v225
  v_dot2c_f32_bf16 v82, v226, v79
  v_dot2c_f32_bf16 v86, v226, v226
  v_dot2c_f32_bf16 v83, v227, v79
  v_dot2c_f32_bf16 v87, v227, v227
  ds_read_b128 v[156:159], v5 offset:4096
  s_waitcnt lgkmcnt(15)
  v_dot2c_f32_bf16 v80, v228, v79
  v_dot2c_f32_bf16 v84, v228, v228
  v_dot2c_f32_bf16 v81, v229, v79
  v_dot2c_f32_bf16 v85, v229, v229
  v_dot2c_f32_bf16 v82, v230, v79
  v_dot2c_f32_bf16 v86, v230, v230
  v_dot2c_f32_bf16 v83, v231, v79
  v_dot2c_f32_bf16 v87, v231, v231
  s_nop 2
  v_add_f32 v80, v80, v81
  v_add_f32 v82, v82, v83
  v_add_f32 v84, v84, v85
  v_add_f32 v86, v86, v87
  v_add_f32 v80, v80, v82
  v_add_f32 v81, v84, v86
  ds_write_b64 v8, v[80:81] offset:16
  v_bfe_u32 v13, v1, 2, 2
  v_lshlrev_b32 v12, 6, v13
  v_bfe_u32 v13, v1, 4, 1
  v_lshl_add_u32 v12, v13, 5, v12
  v_and_b32 v13, 3, v1
  v_lshl_add_u32 v12, v13, 3, v12
  v_lshl_add_u32 v12, v14, 10, v12
  v_add_u32 v12, 512, v12
  s_lshr_b32 s36, s19, 1
  s_mul_i32 s36, s36, 36864
  s_and_b32 s37, s19, 1
  s_mul_i32 s37, s37, 18432
  s_add_u32 s36, s36, s37
  v_add_u32 v13, s36, v3
  s_lshl_b32 s29, s27, 6
  s_add_u32 s35, s35, s29
  s_mul_i32 s34, s18, 73728
  s_add_u32 s35, s35, s34
  s_lshl_b32 s34, s18, 10
  s_mul_i32 s29, s27, 640
  s_sub_u32 s31, s35, s29
  s_and_b32 s96, s16, 3
  s_add_u32 s29, s96, 0
  s_and_b32 s29, s29, 3
  s_lshl_b32 s29, s29, 7
  s_add_u32 s92, s35, s29
  s_add_u32 s29, s96, 1
  s_and_b32 s29, s29, 3
  s_lshl_b32 s29, s29, 7
  s_add_u32 s93, s35, s29
  s_add_u32 s29, s96, 2
  s_and_b32 s29, s29, 3
  s_lshl_b32 s29, s29, 7
  s_add_u32 s94, s35, s29
  s_add_u32 s29, s96, 3
  s_and_b32 s29, s29, 3
  s_lshl_b32 s29, s29, 7
  s_add_u32 s95, s35, s29
  s_waitcnt lgkmcnt(0)
  s_barrier
  ds_read_b128 v[72:75], v9
  ds_read_b128 v[76:79], v9 offset:16
  ds_write_b128 v13, v[16:19] offset:1024
  ds_write_b128 v13, v[20:23] offset:3072
  ds_write_b128 v13, v[24:27] offset:5120
  ds_write_b128 v13, v[28:31] offset:7168
  ds_write_b128 v13, v[32:35] offset:9216
  ds_write_b128 v13, v[36:39] offset:11264
  ds_write_b128 v13, v[40:43] offset:13312
  ds_write_b128 v13, v[44:47] offset:15360
  ds_write_b128 v13, v[48:51] offset:17408
  v_mov_b32 v4, v12
  v_add_u32 v5, 49152, v12
  v_add_u32 v6, 98304, v12
  v_add_u32 v13, 1024, v3
  s_waitcnt lgkmcnt(0)
  s_barrier
  s_waitcnt vmcnt(0)
  v_readfirstlane_b32 s59, v255
  s_cmp_lg_u32 s59, 0
  s_cbranch_scc1 L_nok_55
  s_mov_b32 s28, 0
L_nlp_56:
  s_sleep 8
  buffer_load_dword v255, v253, s[20:23], 0 offen sc1
  s_waitcnt vmcnt(0)
  v_readfirstlane_b32 s59, v255
  s_cmp_lg_u32 s59, 0
  s_cbranch_scc1 L_nok_55
  s_add_u32 s28, s28, 1
  s_cmp_lt_u32 s28, 0x40000
  s_cbranch_scc1 L_nlp_56
L_nok_55:
  ds_read_b128 v[48:51], v13 offset:0
  ds_read_b128 v[52:55], v13 offset:2048
  ds_read_b128 v[56:59], v13 offset:4096
  ds_read_b128 v[60:63], v13 offset:6144
  ds_read_b128 v[64:67], v13 offset:8192
  ds_read_b128 v[68:71], v13 offset:10240
  s_waitcnt lgkmcnt(5)
  v_mfma_f32_32x32x16_bf16 v[16:31], v[88:91], v[48:51], 0
  s_cmp_lt_u32 s18, 5
  s_cbranch_scc0 L_skip_57
  s_add_u32 m0, s34, 151552
  s_nop 0
  buffer_load_dwordx4 v249, s[44:47], 0 offen lds
  s_add_u32 m0, s34, 156672
  s_nop 0
  buffer_load_dwordx4 v249, s[48:51], 0 offen lds
L_skip_57:
  s_add_u32 m0, s34, 73728
  s_add_u32 s30, s92, 0
  buffer_load_dwordx4 v2, s[8:11], s30 offen lds
  s_add_u32 m0, s34, 81920
  s_add_u32 s30, s92, 589824
  buffer_load_dwordx4 v2, s[8:11], s30 offen lds
  s_add_u32 m0, s34, 90112
  s_add_u32 s30, s92, 1179648
  buffer_load_dwordx4 v2, s[8:11], s30 offen lds
  ds_read_b128 v[48:51], v13 offset:12288
  s_waitcnt lgkmcnt(5)
  v_mfma_f32_32x32x16_bf16 v[16:31], v[92:95], v[52:55], v[16:31]
  s_add_u32 m0, s34, 98304
  s_add_u32 s30, s92, 1769472
  buffer_load_dwordx4 v2, s[8:11], s30 offen lds
  v_add_f32 v72, v72, v74
  v_add_f32 v76, v76, v78
  v_add_f32 v73, v73, v75
  ds_read_b128 v[52:55], v13 offset:14336
  s_waitcnt lgkmcnt(5)
  v_mfma_f32_32x32x16_bf16 v[16:31], v[96:99], v[56:59], v[16:31]
  v_add_f32 v77, v77, v79
  v_add_f32 v72, v72, v76
  v_add_f32 v73, v73, v77
  v_mul_f32 v72, 0x3ae38e39, v72
  ds_read_b128 v[56:59], v13 offset:16384
  s_waitcnt lgkmcnt(5)
  v_mfma_f32_32x32x16_bf16 v[16:31], v[100:103], v[60:63], v[16:31]
  v_mul_f32 v73, 0x3ae38e39, v73
  v_fma_f32 v73, -v72, v72, v73
  v_max_f32 v73, 0, v73
  ds_read_b128 v[60:63], v13 offset:18432
  s_waitcnt lgkmcnt(5)
  v_mfma_f32_32x32x16_bf16 v[16:31], v[104:107], v[64:67], v[16:31]
  v_cvt_pk_bf16_f32 v74, -v72, v73
  v_and_b32 v73, 0xffff0000, v74
  v_add_f32 v73, 0x3727c5ac, v73
  v_cvt_pk_bf16_f32 v73, v73, v73
  ds_read_b128 v[64:67], v13 offset:20480
  s_waitcnt lgkmcnt(5)
  v_mfma_f32_32x32x16_bf16 v[16:31], v[108:111], v[68:71], v[16:31]
  v_lshlrev_b32 v73, 16, v73
  v_sqrt_f32 v73, v73
  v_and_b32 v74, 0xffff, v74
  v_cvt_pk_bf16_f32 v73, v73, v73
  ds_read_b128 v[68:71], v13 offset:22528
  s_waitcnt lgkmcnt(5)
  v_mfma_f32_32x32x16_bf16 v[16:31], v[112:115], v[48:51], v[16:31]
  v_lshl_or_b32 v232, v74, 16, v74
  v_and_b32 v75, 0xffff0000, v73
  v_or_b32 v233, v75, v74
  ds_read_b128 v[48:51], v13 offset:24576
  s_waitcnt lgkmcnt(5)
  v_mfma_f32_32x32x16_bf16 v[16:31], v[116:119], v[52:55], v[16:31]
  v_rcp_f32 v72, v75
  v_lshrrev_b32 v76, 3, v9
  v_add_u32 v76, 128512, v76
  v_mul_f32 v73, 0x3d2aaaab, v72
  ds_read_b128 v[52:55], v13 offset:26624
  s_waitcnt lgkmcnt(5)
  v_mfma_f32_32x32x16_bf16 v[16:31], v[120:123], v[56:59], v[16:31]
  ds_write_b32 v76, v73
  v_mov_b32 v234, 0
  v_mov_b32 v235, 0
  v_mov_b32 v238, 0
  ds_read_b128 v[56:59], v13 offset:28672
  s_waitcnt lgkmcnt(6)
  v_mfma_f32_32x32x16_bf16 v[16:31], v[124:127], v[60:63], v[16:31]
  v_mov_b32 v239, 0
  v_cndmask_b32 v232, v232, 0, s[24:25]
  v_cndmask_b32 v233, v233, 0, s[24:25]
  ds_read_b128 v[60:63], v13 offset:30720
  s_waitcnt lgkmcnt(6)
  v_mfma_f32_32x32x16_bf16 v[16:31], v[128:131], v[64:67], v[16:31]
  v_mul_f32 v9, 0xc0135761, v72
  v_mul_f32 v10, v72, v72
  v_mul_f32 v10, v10, v72
  v_mul_f32 v10, 0xbdd2d3e8, v10
  ds_read_b128 v[64:67], v13 offset:32768
  s_waitcnt lgkmcnt(6)
  v_mfma_f32_32x32x16_bf16 v[16:31], v[132:135], v[68:71], v[16:31]
  s_lshr_b32 s29, s33, 4
  v_bfe_u32 v73, v1, 4, 1
  v_add_u32 v73, s29, v73
  s_mov_b32 s29, 147456
  ds_read_b128 v[68:71], v13 offset:34816
  s_waitcnt lgkmcnt(6)
  v_mfma_f32_32x32x16_bf16 v[16:31], v[136:139], v[48:51], v[16:31]
  v_mul_lo_u32 v7, v73, s29
  v_lshl_add_u32 v7, v14, 8, v7
  v_and_b32 v73, 15, v1
  s_waitcnt lgkmcnt(4)
  s_barrier
  v_add_u32 v13, 36864, v13
  ds_read_b128 v[48:51], v13 offset:0
  v_mfma_f32_32x32x16_bf16 v[16:31], v[140:143], v[52:55], v[16:31]
  v_lshl_add_u32 v7, v73, 4, v7
  v_add_u32 v7, 0x360000, v7
  v_add_u32 v73, 32, v11
  s_mul_i32 s29, s17, 36
  ds_read_b128 v[52:55], v13 offset:2048
  s_add_u32 m0, s34, 110592
  s_add_u32 s30, s92, 2654208
  buffer_load_dwordx4 v2, s[8:11], s30 offen lds
  s_waitcnt lgkmcnt(5)
  v_mfma_f32_32x32x16_bf16 v[16:31], v[144:147], v[56:59], v[16:31]
  v_add_u32 v12, s29, v73
  v_lshlrev_b32 v12, 12, v12
  v_lshl_add_u32 v12, v14, 4, v12
  s_lshl_b32 s29, s33, 1
  ds_read_b128 v[56:59], v13 offset:4096
  s_waitcnt lgkmcnt(5)
  v_mfma_f32_32x32x16_bf16 v[16:31], v[148:151], v[60:63], v[16:31]
  s_add_u32 s29, s29, 0x1560000
  v_add_u32 v12, s29, v12
  v_cmp_gt_u32 vcc, 36, v73
  s_mul_i32 s39, s17, 9
  s_nop 0
  v_cndmask_b32 v12, v15, v12, vcc
  ds_read_b128 v[60:63], v13 offset:6144
  s_add_u32 m0, s34, 118784
  s_add_u32 s30, s92, 3244032
  buffer_load_dwordx4 v2, s[8:11], s30 offen lds
  s_waitcnt lgkmcnt(5)
  v_mfma_f32_32x32x16_bf16 v[16:31], v[152:155], v[64:67], v[16:31]
  v_lshlrev_b32 v73, 2, v11
  v_add_u32 v73, 162816, v73
  ds_read_b32 v80, v73 offset:0
  ds_read_b32 v81, v73 offset:128
  ds_read_b128 v[64:67], v13 offset:8192
  s_waitcnt lgkmcnt(7)
  v_mfma_f32_32x32x16_bf16 v[16:31], v[156:159], v[68:71], v[16:31]
  ds_read_b32 v82, v73 offset:256
  ds_read_b32 v83, v73 offset:384
  ds_read_b32 v84, v73 offset:512
  ds_read_b32 v85, v73 offset:640
  ds_read_b128 v[68:71], v13 offset:10240
  s_add_u32 m0, s34, 126976
  s_add_u32 s30, s92, 3833856
  buffer_load_dwordx4 v2, s[8:11], s30 offen lds
  s_waitcnt lgkmcnt(11)
  v_mfma_f32_32x32x16_bf16 v[16:31], v[160:163], v[48:51], v[16:31]
  ds_read_b32 v86, v73 offset:768
  ds_read_b32 v87, v73 offset:896
  v_mov_b32 v11, v75
  ds_read_b128 v[48:51], v13 offset:12288
  s_waitcnt lgkmcnt(13)
  v_mfma_f32_32x32x16_bf16 v[16:31], v[164:167], v[52:55], v[16:31]
  v_and_b32 v8, 31, v1
  v_lshlrev_b32 v8, 3, v8
  v_add_u32 v8, 147968, v8
  v_mov_b32 v73, 151424
  ds_read_b128 v[52:55], v13 offset:14336
  s_add_u32 m0, s34, 135168
  s_add_u32 s30, s92, 4423680
  buffer_load_dwordx4 v2, s[8:11], s30 offen lds
  s_waitcnt lgkmcnt(13)
  v_mfma_f32_32x32x16_bf16 v[16:31], v[168:171], v[56:59], v[16:31]
  v_cndmask_b32 v8, v8, v73, s[24:25]
  s_waitcnt lgkmcnt(2)
  v_add_f32 v80, v80, v81
  v_add_f32 v80, v80, v82
  ds_read_b128 v[56:59], v13 offset:16384
  v_mfma_f32_32x32x16_bf16 v[16:31], v[172:175], v[60:63], v[16:31]
  v_add_f32 v80, v80, v83
  v_add_f32 v80, v80, v84
  v_add_f32 v80, v80, v85
  ds_read_b128 v[60:63], v13 offset:18432
  v_mfma_f32_32x32x16_bf16 v[16:31], v[176:179], v[64:67], v[16:31]
  v_add_f32 v80, v80, v86
  v_add_f32 v80, v80, v87
  v_cvt_pk_bf16_f32 v81, v80, v80
  v_lshlrev_b32 v81, 16, v81
  ds_read_b128 v[64:67], v13 offset:20480
  v_mfma_f32_32x32x16_bf16 v[16:31], v[180:183], v[68:71], v[16:31]
  v_sub_f32 v81, v80, v81
  v_cvt_pk_bf16_f32 v236, v80, v81
  v_and_b32 v80, 0xffff0000, v236
  v_sub_f32 v81, v81, v80
  ds_read_b128 v[68:71], v13 offset:22528
  s_waitcnt lgkmcnt(5)
  v_mfma_f32_32x32x16_bf16 v[16:31], v[184:187], v[48:51], v[16:31]
  v_cvt_pk_bf16_f32 v237, v81, 0
  v_cndmask_b32 v236, v236, 0, s[24:25]
  v_cndmask_b32 v237, v237, 0, s[24:25]
  ds_read_b128 v[48:51], v13 offset:24576
  s_waitcnt lgkmcnt(5)
  v_mfma_f32_32x32x16_bf16 v[16:31], v[188:191], v[52:55], v[16:31]
  ds_read_b128 v[52:55], v13 offset:26624
  s_waitcnt lgkmcnt(5)
  v_mfma_f32_32x32x16_bf16 v[16:31], v[192:195], v[56:59], v[16:31]
  v_and_b32 v76, 15, v0
  v_mul_u32_u24 v77, 80, v76
  v_and_b32 v78, 1, v0
  ds_read_b128 v[56:59], v13 offset:28672
  s_waitcnt lgkmcnt(5)
  v_mfma_f32_32x32x16_bf16 v[16:31], v[196:199], v[60:63], v[16:31]
  v_lshl_add_u32 v77, v78, 1, v77
  v_lshrrev_b32 v78, 4, v0
  ds_read_b128 v[60:63], v13 offset:30720
  s_waitcnt lgkmcnt(5)
  v_mfma_f32_32x32x16_bf16 v[16:31], v[200:203], v[64:67], v[16:31]
  v_lshl_add_u32 v77, v78, 1, v77
  v_add_u32 v77, 151552, v77
  v_lshlrev_b32 v76, 4, v76
  ds_read_b128 v[64:67], v13 offset:32768
  s_waitcnt lgkmcnt(5)
  v_mfma_f32_32x32x16_bf16 v[16:31], v[204:207], v[68:71], v[16:31]
  v_lshl_add_u32 v76, v78, 13, v76
  v_cmp_gt_u32 vcc, 80, v0
  v_add_u32 v78, 262144, v76
  s_nop 0
  v_cndmask_b32 v78, v15, v78, vcc
  ds_read_b128 v[68:71], v13 offset:34816
  s_waitcnt lgkmcnt(5)
  v_mfma_f32_32x32x16_bf16 v[16:31], v[208:211], v[48:51], v[16:31]
  s_waitcnt vmcnt(4)
  s_waitcnt vmcnt(8)
  s_barrier
  ds_read_b64_tr_b16 v[48:49], v5 offset:24576
  ds_read_b64_tr_b16 v[50:51], v5 offset:24832
  s_waitcnt lgkmcnt(6)
  v_mfma_f32_32x32x16_bf16 v[16:31], v[212:215], v[52:55], v[16:31]
  ds_read_u16 v240, v77 offset:0
  ds_read_u16 v80, v77 offset:5120
  ds_read_u16 v241, v77 offset:1280
  ds_read_u16 v81, v77 offset:6400
  ds_read_u16 v242, v77 offset:2560
  ds_read_u16 v82, v77 offset:7680
  ds_read_b64_tr_b16 v[52:53], v5 offset:26624
  ds_read_b64_tr_b16 v[54:55], v5 offset:26880
  s_add_u32 m0, s34, 0
  s_add_u32 s30, s93, 0
  buffer_load_dwordx4 v2, s[8:11], s30 offen lds
  s_waitcnt lgkmcnt(13)
  v_mfma_f32_32x32x16_bf16 v[16:31], v[216:219], v[56:59], v[16:31]
  ds_read_u16 v243, v77 offset:3840
  ds_read_u16 v83, v77 offset:8960
  ds_read_u16 v244, v77 offset:64
  ds_read_u16 v84, v77 offset:5184
  ds_read_u16 v245, v77 offset:1344
  ds_read_b64_tr_b16 v[56:57], v5 offset:28672
  ds_read_b64_tr_b16 v[58:59], v5 offset:28928
  s_waitcnt lgkmcnt(15)
  v_mfma_f32_32x32x16_bf16 v[16:31], v[220:223], v[60:63], v[16:31]
  ds_read_u16 v85, v77 offset:6464
  ds_read_u16 v246, v77 offset:2624
  ds_read_u16 v86, v77 offset:7744
  ds_read_u16 v247, v77 offset:3904
  ds_read_u16 v87, v77 offset:9024
  s_waitcnt lgkmcnt(0)
  ds_read_b64_tr_b16 v[60:61], v5 offset:30720
  ds_read_b64_tr_b16 v[62:63], v5 offset:30976
  s_add_u32 m0, s34, 8192
  s_add_u32 s30, s93, 589824
  buffer_load_dwordx4 v2, s[8:11], s30 offen lds
  v_mfma_f32_32x32x16_bf16 v[16:31], v[224:227], v[64:67], v[16:31]
  v_lshl_or_b32 v240, v80, 16, v240
  v_lshl_or_b32 v241, v81, 16, v241
  v_lshl_or_b32 v242, v82, 16, v242
  v_lshl_or_b32 v243, v83, 16, v243
  v_lshl_or_b32 v244, v84, 16, v244
  ds_read_b64_tr_b16 v[64:65], v5 offset:32768
  ds_read_b64_tr_b16 v[66:67], v5 offset:33024
  v_mfma_f32_32x32x16_bf16 v[16:31], v[228:231], v[68:71], v[16:31]
  v_lshl_or_b32 v245, v85, 16, v245
  v_lshl_or_b32 v246, v86, 16, v246
  v_lshl_or_b32 v247, v87, 16, v247
  buffer_store_dwordx4 v[240:243], v76, s[4:7], s56 offen sc1
  s_cmp_lt_u32 s18, 2
  s_cbranch_scc0 L_skip_58
  buffer_store_dwordx4 v[244:247], v78, s[4:7], s56 offen sc1
L_skip_58:
  v_mfma_f32_32x32x16_bf16 v[16:31], v[232:235], v[236:239], v[16:31]
  ds_read_b64_tr_b16 v[68:69], v5 offset:34816
  ds_read_b64_tr_b16 v[70:71], v5 offset:35072
  s_add_u32 m0, s34, 16384
  s_add_u32 s30, s93, 1179648
  buffer_load_dwordx4 v2, s[8:11], s30 offen lds
  v_mfma_f32_32x32x16_bf16 v[32:47], v[48:51], v[88:91], 0
  v_lshrrev_b32 v249, 5, v1
  v_lshlrev_b32 v249, 4, v249
  v_bfe_u32 v250, v1, 4, 1
  ds_read_b64_tr_b16 v[48:49], v5 offset:36864
  ds_read_b64_tr_b16 v[50:51], v5 offset:37120
  v_mfma_f32_32x32x16_bf16 v[32:47], v[52:55], v[92:95], v[32:47]
  v_lshl_add_u32 v249, v250, 2, v249
  v_bfe_u32 v250, v1, 2, 2
  v_add_u32 v249, v249, v250
  ds_read_b64_tr_b16 v[52:53], v5 offset:38912
  ds_read_b64_tr_b16 v[54:55], v5 offset:39168
  s_add_u32 m0, s34, 24576
  s_add_u32 s30, s93, 1769472
  buffer_load_dwordx4 v2, s[8:11], s30 offen lds
  v_mfma_f32_32x32x16_bf16 v[32:47], v[56:59], v[96:99], v[32:47]
  v_lshlrev_b32 v249, 7, v249
  v_and_b32 v250, 3, v1
  v_lshl_add_u32 v249, v250, 3, v249
  ds_read_b64_tr_b16 v[56:57], v5 offset:40960
  ds_read_b64_tr_b16 v[58:59], v5 offset:41216
  s_waitcnt lgkmcnt(10)
  v_mfma_f32_32x32x16_bf16 v[32:47], v[60:63], v[100:103], v[32:47]
  v_add_u32 v249, s38, v249
  s_cmp_ge_u32 s18, 3
  s_cselect_b32 s57, 2, 1
  s_cmp_lt_u32 s100, 1296
  s_cselect_b32 s57, s57, 0
  ds_read_b64_tr_b16 v[60:61], v5 offset:43008
  ds_read_b64_tr_b16 v[62:63], v5 offset:43264
  s_waitcnt lgkmcnt(10)
  v_mfma_f32_32x32x16_bf16 v[32:47], v[64:67], v[104:107], v[32:47]
  s_lshl_b32 s28, s19, 7
  v_lshlrev_b32 v72, 4, v14
  v_add_u32 v72, s28, v72
  v_add_u32 v72, 147456, v72
  ds_read_b128 v[240:243], v72 offset:0
  ds_read_b128 v[244:247], v72 offset:32
  ds_read_b64_tr_b16 v[64:65], v5 offset:45056
  ds_read_b64_tr_b16 v[66:67], v5 offset:45312
  s_waitcnt lgkmcnt(12)
  v_mfma_f32_32x32x16_bf16 v[32:47], v[68:71], v[108:111], v[32:47]
  ds_read_b128 v[76:79], v72 offset:64
  ds_read_b128 v[84:87], v72 offset:96
  s_waitcnt lgkmcnt(0)
  v_mul_f32 v16, v16, v240
  v_mul_f32 v17, v17, v241
  ds_read_b64_tr_b16 v[68:69], v5 offset:47104
  ds_read_b64_tr_b16 v[70:71], v5 offset:47360
  v_mfma_f32_32x32x16_bf16 v[32:47], v[48:51], v[112:115], v[32:47]
  v_mul_f32 v18, v18, v242
  v_mul_f32 v19, v19, v243
  v_mul_f32 v20, v20, v244
  v_mul_f32 v21, v21, v245
  v_mul_f32 v22, v22, v246
  ds_read_b64_tr_b16 v[48:49], v6 offset:0
  ds_read_b64_tr_b16 v[50:51], v6 offset:256
  v_mfma_f32_32x32x16_bf16 v[32:47], v[52:55], v[116:119], v[32:47]
  v_mul_f32 v23, v23, v247
  v_mul_f32 v24, v24, v76
  v_mul_f32 v25, v25, v77
  v_mul_f32 v26, v26, v78
  v_mul_f32 v27, v27, v79
  ds_read_b64_tr_b16 v[52:53], v6 offset:2048
  ds_read_b64_tr_b16 v[54:55], v6 offset:2304
  v_mfma_f32_32x32x16_bf16 v[32:47], v[56:59], v[120:123], v[32:47]
  v_mul_f32 v28, v28, v84
  v_mul_f32 v29, v29, v85
  v_mul_f32 v30, v30, v86
  v_mul_f32 v31, v31, v87
  v_cvt_pk_f16_f32 v80, v16, v17
  s_and_b32 s28, s2, 0xc3
  v_and_b32 v253, 15, v1
  v_lshlrev_b32 v253, 2, v253
  v_or_b32 v253, s28, v253
  v_lshlrev_b32 v253, 4, v253
  v_add_u32 v253, 0x33e4000, v253
  s_cmp_lt_u32 s18, 5
  s_cbranch_scc0 L_skip_59
  buffer_load_dword v254, v253, s[4:7], 0 offen sc1
L_skip_59:
  ds_read_b64_tr_b16 v[56:57], v6 offset:4096
  ds_read_b64_tr_b16 v[58:59], v6 offset:4352
  v_mfma_f32_32x32x16_bf16 v[32:47], v[60:63], v[124:127], v[32:47]
  v_cvt_pk_f16_f32 v81, v18, v19
  v_cvt_pk_f16_f32 v82, v20, v21
  v_cvt_pk_f16_f32 v83, v22, v23
  v_cvt_pk_f16_f32 v84, v24, v25
  v_cvt_pk_f16_f32 v85, v26, v27
  s_lshl_b32 s28, s18, 4
  v_and_b32 v251, 15, v1
  v_add_u32 v251, s28, v251
  v_lshrrev_b32 v252, 4, v1
  ds_read_b64_tr_b16 v[60:61], v6 offset:6144
  ds_read_b64_tr_b16 v[62:63], v6 offset:6400
  v_mfma_f32_32x32x16_bf16 v[32:47], v[64:67], v[128:131], v[32:47]
  v_cvt_pk_f16_f32 v86, v28, v29
  v_cvt_pk_f16_f32 v87, v30, v31
  s_nop 0
  s_nop 0
  v_permlane32_swap_b32 v80, v82
  v_mul_u32_u24 v252, 4608, v252
  v_lshl_add_u32 v252, v251, 4, v252
  ds_read_b64_tr_b16 v[64:65], v6 offset:8192
  ds_read_b64_tr_b16 v[66:67], v6 offset:8448
  s_waitcnt lgkmcnt(10)
  v_mfma_f32_32x32x16_bf16 v[32:47], v[68:71], v[132:135], v[32:47]
  v_permlane32_swap_b32 v81, v83
  v_permlane32_swap_b32 v84, v86
  v_permlane32_swap_b32 v85, v87
  buffer_store_dwordx4 v[80:83], v12, s[4:7], 0 offen offset:0 sc1
  buffer_store_dwordx4 v[84:87], v12, s[4:7], 0 offen offset:32 sc1
  v_cmp_gt_u32 vcc, 72, v251
  s_nop 1
  v_cndmask_b32 v252, v15, v252, vcc
  ds_read_b64_tr_b16 v[68:69], v6 offset:10240
  ds_read_b64_tr_b16 v[70:71], v6 offset:10496
  s_waitcnt lgkmcnt(10)
  v_mfma_f32_32x32x16_bf16 v[32:47], v[48:51], v[136:139], v[32:47]
  s_waitcnt vmcnt(7)
  s_barrier
  ds_read_b64_tr_b16 v[48:49], v6 offset:12288
  ds_read_b64_tr_b16 v[50:51], v6 offset:12544
  s_waitcnt lgkmcnt(10)
  v_mfma_f32_32x32x16_bf16 v[32:47], v[52:55], v[140:143], v[32:47]
  s_cmp_eq_u32 s57, 1
  s_cbranch_scc0 L_skip_60
  s_add_u32 m0, s38, 0
  s_add_u32 s28, s3, 0
  buffer_load_dwordx4 v248, s[52:55], s28 offen lds
  s_add_u32 m0, s38, 1024
  s_add_u32 s28, s3, 9216
  buffer_load_dwordx4 v248, s[52:55], s28 offen lds
L_skip_60:
  ds_read_b64_tr_b16 v[52:53], v6 offset:14336
  ds_read_b64_tr_b16 v[54:55], v6 offset:14592
  s_add_u32 m0, s34, 36864
  s_add_u32 s30, s93, 2654208
  buffer_load_dwordx4 v2, s[8:11], s30 offen lds
  s_waitcnt lgkmcnt(10)
  v_mfma_f32_32x32x16_bf16 v[32:47], v[56:59], v[144:147], v[32:47]
  s_cmp_eq_u32 s57, 1
  s_cbranch_scc0 L_skip_61
  s_add_u32 m0, s38, 2048
  s_add_u32 s28, s3, 18432
  buffer_load_dwordx4 v248, s[52:55], s28 offen lds
  s_add_u32 m0, s38, 3072
  s_add_u32 s28, s3, 27648
  buffer_load_dwordx4 v248, s[52:55], s28 offen lds
L_skip_61:
  ds_read_b64_tr_b16 v[56:57], v6 offset:16384
  ds_read_b64_tr_b16 v[58:59], v6 offset:16640
  s_waitcnt lgkmcnt(10)
  v_mfma_f32_32x32x16_bf16 v[32:47], v[60:63], v[148:151], v[32:47]
  ds_read_b64_tr_b16 v[60:61], v6 offset:18432
  ds_read_b64_tr_b16 v[62:63], v6 offset:18688
  s_add_u32 m0, s34, 45056
  s_add_u32 s30, s93, 3244032
  buffer_load_dwordx4 v2, s[8:11], s30 offen lds
  s_waitcnt lgkmcnt(10)
  v_mfma_f32_32x32x16_bf16 v[32:47], v[64:67], v[152:155], v[32:47]
  ds_read_b64_tr_b16 v[64:65], v6 offset:20480
  ds_read_b64_tr_b16 v[66:67], v6 offset:20736
  s_waitcnt lgkmcnt(10)
  v_mfma_f32_32x32x16_bf16 v[32:47], v[68:71], v[156:159], v[32:47]
  ds_read_b64_tr_b16 v[68:69], v6 offset:22528
  ds_read_b64_tr_b16 v[70:71], v6 offset:22784
  s_add_u32 m0, s34, 53248
  s_add_u32 s30, s93, 3833856
  buffer_load_dwordx4 v2, s[8:11], s30 offen lds
  s_waitcnt lgkmcnt(10)
  v_mfma_f32_32x32x16_bf16 v[32:47], v[48:51], v[160:163], v[32:47]
  ds_read_b64_tr_b16 v[48:49], v6 offset:24576
  ds_read_b64_tr_b16 v[50:51], v6 offset:24832
  s_waitcnt lgkmcnt(10)
  v_mfma_f32_32x32x16_bf16 v[32:47], v[52:55], v[164:167], v[32:47]
  ds_read_b64_tr_b16 v[52:53], v6 offset:26624
  ds_read_b64_tr_b16 v[54:55], v6 offset:26880
  s_add_u32 m0, s34, 61440
  s_add_u32 s30, s93, 4423680
  buffer_load_dwordx4 v2, s[8:11], s30 offen lds
  s_waitcnt lgkmcnt(10)
  v_mfma_f32_32x32x16_bf16 v[32:47], v[56:59], v[168:171], v[32:47]
  ds_read_b64_tr_b16 v[56:57], v6 offset:28672
  ds_read_b64_tr_b16 v[58:59], v6 offset:28928
  s_waitcnt lgkmcnt(10)
  v_mfma_f32_32x32x16_bf16 v[32:47], v[60:63], v[172:175], v[32:47]
  ds_read_b64_tr_b16 v[60:61], v6 offset:30720
  ds_read_b64_tr_b16 v[62:63], v6 offset:30976
  s_waitcnt lgkmcnt(10)
  v_mfma_f32_32x32x16_bf16 v[32:47], v[64:67], v[176:179], v[32:47]
  ds_read_b64_tr_b16 v[64:65], v6 offset:32768
  ds_read_b64_tr_b16 v[66:67], v6 offset:33024
  s_waitcnt lgkmcnt(10)
  v_mfma_f32_32x32x16_bf16 v[32:47], v[68:71], v[180:183], v[32:47]
  ds_read_b64_tr_b16 v[68:69], v6 offset:34816
  ds_read_b64_tr_b16 v[70:71], v6 offset:35072
  s_waitcnt lgkmcnt(10)
  v_mfma_f32_32x32x16_bf16 v[32:47], v[48:51], v[184:187], v[32:47]
  ds_read_b64_tr_b16 v[48:49], v6 offset:36864
  ds_read_b64_tr_b16 v[50:51], v6 offset:37120
  s_waitcnt lgkmcnt(10)
  v_mfma_f32_32x32x16_bf16 v[32:47], v[52:55], v[188:191], v[32:47]
  s_cmp_lt_u32 s18, 5
  s_cbranch_scc0 L_csskip_62
  s_waitcnt vmcnt(6)
  v_cmp_eq_u32 vcc, s59, v254
  s_nop 1
  s_cmp_eq_u64 vcc, -1
  s_cbranch_scc1 L_csok_64
  s_mov_b32 s33, 0
L_cspoll_63:
  s_sleep 4
  buffer_load_dword v254, v253, s[4:7], 0 offen sc1
  s_waitcnt vmcnt(0)
  v_cmp_eq_u32 vcc, s59, v254
  s_nop 1
  s_cmp_eq_u64 vcc, -1
  s_cbranch_scc1 L_csok_64
  s_add_u32 s33, s33, 1
  s_cmp_lt_u32 s33, 0x40000
  s_cbranch_scc1 L_cspoll_63
L_csok_64:
  s_mul_i32 s28, s17, 18432
  s_add_u32 s28, s28, 0x33f4000
  s_mul_i32 s29, s17, 576
  v_lshlrev_b32 v253, 3, v251
  buffer_load_dwordx2 v[254:255], v253, s[12:15], s29 offen
  buffer_load_dwordx4 v[72:75], v252, s[4:7], s28 offen offset:0 sc1
  buffer_load_dwordx4 v[76:79], v252, s[4:7], s28 offen offset:1152 sc1
  buffer_load_dwordx4 v[80:83], v252, s[4:7], s28 offen offset:2304 sc1
  buffer_load_dwordx4 v[84:87], v252, s[4:7], s28 offen offset:3456 sc1
L_csskip_62:
  ds_read_b64_tr_b16 v[52:53], v6 offset:38912
  ds_read_b64_tr_b16 v[54:55], v6 offset:39168
  s_waitcnt lgkmcnt(10)
  v_mfma_f32_32x32x16_bf16 v[32:47], v[56:59], v[192:195], v[32:47]
  ds_read_b64_tr_b16 v[56:57], v6 offset:40960
  ds_read_b64_tr_b16 v[58:59], v6 offset:41216
  s_waitcnt lgkmcnt(10)
  v_mfma_f32_32x32x16_bf16 v[32:47], v[60:63], v[196:199], v[32:47]
  ds_read_b64_tr_b16 v[60:61], v6 offset:43008
  ds_read_b64_tr_b16 v[62:63], v6 offset:43264
  s_waitcnt lgkmcnt(10)
  v_mfma_f32_32x32x16_bf16 v[32:47], v[64:67], v[200:203], v[32:47]
  ds_read_b64_tr_b16 v[64:65], v6 offset:45056
  ds_read_b64_tr_b16 v[66:67], v6 offset:45312
  s_waitcnt lgkmcnt(10)
  v_mfma_f32_32x32x16_bf16 v[32:47], v[68:71], v[204:207], v[32:47]
  s_waitcnt vmcnt(3)
  ds_read_b64_tr_b16 v[240:241], v249 offset:0
  ds_read_b64_tr_b16 v[242:243], v249 offset:1024
  ds_read_b64_tr_b16 v[68:69], v6 offset:47104
  ds_read_b64_tr_b16 v[70:71], v6 offset:47360
  s_waitcnt lgkmcnt(12)
  v_mfma_f32_32x32x16_bf16 v[32:47], v[48:51], v[208:211], v[32:47]
  ds_read_b64_tr_b16 v[244:245], v249 offset:32
  ds_read_b64_tr_b16 v[246:247], v249 offset:1056
  s_waitcnt vmcnt(6)
  s_barrier
  ds_read_b64_tr_b16 v[48:49], v4 offset:0
  ds_read_b64_tr_b16 v[50:51], v4 offset:256
  s_waitcnt lgkmcnt(14)
  v_mfma_f32_32x32x16_bf16 v[32:47], v[52:55], v[212:215], v[32:47]
  s_waitcnt lgkmcnt(2)
  s_cmp_eq_u32 s57, 1
  s_cbranch_scc0 L_skip_65
  buffer_store_dwordx4 v[240:243], v3, s[4:7], s32 offen offset:0 sc1
  buffer_store_dwordx4 v[244:247], v3, s[4:7], s32 offen offset:1024 sc1
L_skip_65:
  s_nop 0
  ds_read_b64_tr_b16 v[52:53], v4 offset:2048
  ds_read_b64_tr_b16 v[54:55], v4 offset:2304
  s_add_u32 m0, s34, 73728
  s_add_u32 s30, s94, 0
  buffer_load_dwordx4 v2, s[8:11], s30 offen lds
  v_mfma_f32_32x32x16_bf16 v[32:47], v[56:59], v[216:219], v[32:47]
  ds_read_b64_tr_b16 v[240:241], v249 offset:64
  ds_read_b64_tr_b16 v[242:243], v249 offset:1088
  ds_read_b64_tr_b16 v[56:57], v4 offset:4096
  ds_read_b64_tr_b16 v[58:59], v4 offset:4352
  v_mfma_f32_32x32x16_bf16 v[32:47], v[60:63], v[220:223], v[32:47]
  ds_read_b64_tr_b16 v[244:245], v249 offset:96
  ds_read_b64_tr_b16 v[246:247], v249 offset:1120
  s_waitcnt lgkmcnt(0)
  ds_read_b64_tr_b16 v[60:61], v4 offset:6144
  ds_read_b64_tr_b16 v[62:63], v4 offset:6400
  s_add_u32 m0, s34, 81920
  s_add_u32 s30, s94, 589824
  buffer_load_dwordx4 v2, s[8:11], s30 offen lds
  v_mfma_f32_32x32x16_bf16 v[32:47], v[64:67], v[224:227], v[32:47]
  s_cmp_eq_u32 s57, 1
  s_cbranch_scc0 L_skip_66
  buffer_store_dwordx4 v[240:243], v3, s[4:7], s32 offen offset:2048 sc1
  buffer_store_dwordx4 v[244:247], v3, s[4:7], s32 offen offset:3072 sc1
L_skip_66:
  s_nop 0
  ds_read_b64_tr_b16 v[64:65], v4 offset:8192
  ds_read_b64_tr_b16 v[66:67], v4 offset:8448
  v_mfma_f32_32x32x16_bf16 v[32:47], v[68:71], v[228:231], v[32:47]
  ds_read_b64_tr_b16 v[68:69], v4 offset:10240
  ds_read_b64_tr_b16 v[70:71], v4 offset:10496
  s_add_u32 m0, s34, 90112
  s_add_u32 s30, s94, 1179648
  buffer_load_dwordx4 v2, s[8:11], s30 offen lds
  v_mfma_f32_32x32x16_bf16 v[16:31], v[48:51], v[88:91], 0
  ds_read_b64_tr_b16 v[48:49], v4 offset:12288
  ds_read_b64_tr_b16 v[50:51], v4 offset:12544
  v_mfma_f32_32x32x16_bf16 v[16:31], v[52:55], v[92:95], v[16:31]
  ds_read_b64_tr_b16 v[52:53], v4 offset:14336
  ds_read_b64_tr_b16 v[54:55], v4 offset:14592
  s_add_u32 m0, s34, 98304
  s_add_u32 s30, s94, 1769472
  buffer_load_dwordx4 v2, s[8:11], s30 offen lds
  v_mfma_f32_32x32x16_bf16 v[16:31], v[56:59], v[96:99], v[16:31]
  ds_read_b64_tr_b16 v[56:57], v4 offset:16384
  ds_read_b64_tr_b16 v[58:59], v4 offset:16640
  s_waitcnt lgkmcnt(10)
  v_mfma_f32_32x32x16_bf16 v[16:31], v[60:63], v[100:103], v[16:31]
  s_waitcnt vmcnt(4)
  v_add_f32 v72, v72, v76
  v_add_f32 v73, v73, v77
  v_add_f32 v74, v74, v78
  v_add_f32 v75, v75, v79
  v_add_f32 v72, v72, v80
  v_add_f32 v73, v73, v81
  v_add_f32 v74, v74, v82
  v_add_f32 v75, v75, v83
  ds_read_b64_tr_b16 v[60:61], v4 offset:18432
  ds_read_b64_tr_b16 v[62:63], v4 offset:18688
  s_waitcnt lgkmcnt(10)
  v_mfma_f32_32x32x16_bf16 v[16:31], v[64:67], v[104:107], v[16:31]
  v_add_f32 v72, v72, v84
  v_add_f32 v73, v73, v85
  v_add_f32 v74, v74, v86
  v_add_f32 v75, v75, v87
  v_mov_b32 v76, v72
  v_mov_b32 v77, v73
  v_mov_b32 v78, v74
  v_mov_b32 v79, v75
  ds_read_b64_tr_b16 v[64:65], v4 offset:20480
  ds_read_b64_tr_b16 v[66:67], v4 offset:20736
  s_waitcnt lgkmcnt(10)
  v_mfma_f32_32x32x16_bf16 v[16:31], v[68:71], v[108:111], v[16:31]
  s_nop 0
  v_permlane32_swap_b32 v72, v76
  v_permlane32_swap_b32 v73, v77
  v_permlane32_swap_b32 v74, v78
  v_permlane32_swap_b32 v75, v79
  v_add_f32 v72, v72, v76
  v_add_f32 v73, v73, v77
  v_add_f32 v74, v74, v78
  v_add_f32 v75, v75, v79
  ds_read_b64_tr_b16 v[68:69], v4 offset:22528
  ds_read_b64_tr_b16 v[70:71], v4 offset:22784
  s_waitcnt lgkmcnt(10)
  v_mfma_f32_32x32x16_bf16 v[16:31], v[48:51], v[112:115], v[16:31]
  v_mov_b32 v76, v72
  v_mov_b32 v77, v73
  v_mov_b32 v78, v74
  v_mov_b32 v79, v75
  s_nop 0
  v_permlane16_swap_b32 v72, v76
  v_permlane16_swap_b32 v73, v77
  v_permlane16_swap_b32 v74, v78
  ds_read_b64_tr_b16 v[48:49], v4 offset:24576
  ds_read_b64_tr_b16 v[50:51], v4 offset:24832
  s_waitcnt lgkmcnt(10)
  v_mfma_f32_32x32x16_bf16 v[16:31], v[52:55], v[116:119], v[16:31]
  v_permlane16_swap_b32 v75, v79
  v_add_f32 v72, v72, v76
  v_add_f32 v73, v73, v77
  v_add_f32 v74, v74, v78
  v_add_f32 v75, v75, v79
  v_lshlrev_b32 v76, 16, v254
  v_and_b32 v77, 0xffff0000, v254
  v_lshlrev_b32 v78, 16, v255
  v_and_b32 v79, 0xffff0000, v255
  ds_read_b64_tr_b16 v[52:53], v4 offset:26624
  ds_read_b64_tr_b16 v[54:55], v4 offset:26880
  s_waitcnt lgkmcnt(10)
  v_mfma_f32_32x32x16_bf16 v[16:31], v[56:59], v[120:123], v[16:31]
  v_cvt_pk_bf16_f32 v253, v72, v72
  v_lshlrev_b32 v253, 16, v253
  v_sub_f32 v253, v72, v253
  v_cvt_pk_bf16_f32 v80, v72, v253
  v_and_b32 v72, 0xffff0000, v80
  v_sub_f32 v253, v253, v72
  v_cvt_pk_bf16_f32 v81, v253, v76
  v_cvt_pk_bf16_f32 v253, v73, v73
  ds_read_b64_tr_b16 v[56:57], v4 offset:28672
  ds_read_b64_tr_b16 v[58:59], v4 offset:28928
  s_waitcnt lgkmcnt(10)
  v_mfma_f32_32x32x16_bf16 v[16:31], v[60:63], v[124:127], v[16:31]
  v_lshlrev_b32 v253, 16, v253
  v_sub_f32 v253, v73, v253
  v_cvt_pk_bf16_f32 v82, v73, v253
  v_and_b32 v73, 0xffff0000, v82
  v_sub_f32 v253, v253, v73
  v_cvt_pk_bf16_f32 v83, v253, v77
  v_cvt_pk_bf16_f32 v253, v74, v74
  v_lshlrev_b32 v253, 16, v253
  v_sub_f32 v253, v74, v253
  ds_read_b64_tr_b16 v[60:61], v4 offset:30720
  ds_read_b64_tr_b16 v[62:63], v4 offset:30976
  s_waitcnt lgkmcnt(10)
  v_mfma_f32_32x32x16_bf16 v[16:31], v[64:67], v[128:131], v[16:31]
  v_cvt_pk_bf16_f32 v84, v74, v253
  v_and_b32 v74, 0xffff0000, v84
  v_sub_f32 v253, v253, v74
  v_cvt_pk_bf16_f32 v85, v253, v78
  v_cvt_pk_bf16_f32 v253, v75, v75
  v_lshlrev_b32 v253, 16, v253
  v_sub_f32 v253, v75, v253
  v_cvt_pk_bf16_f32 v86, v75, v253
  ds_read_b64_tr_b16 v[64:65], v4 offset:32768
  ds_read_b64_tr_b16 v[66:67], v4 offset:33024
  s_waitcnt lgkmcnt(10)
  v_mfma_f32_32x32x16_bf16 v[16:31], v[68:71], v[132:135], v[16:31]
  v_and_b32 v75, 0xffff0000, v86
  v_sub_f32 v253, v253, v75
  v_cvt_pk_bf16_f32 v87, v253, v79
  v_lshlrev_b32 v253, 5, v251
  v_add_u32 v253, 147968, v253
  v_and_b32 v252, 48, v1
  v_lshl_add_u32 v252, v252, 3, v251
  v_cmp_gt_u32 vcc, 72, v252
  s_and_saveexec_b64 s[28:29], vcc
  ds_write_b128 v253, v[80:83]
  ds_write_b128 v253, v[84:87] offset:16
  s_mov_b64 exec, -1
  ds_read_b64_tr_b16 v[68:69], v4 offset:34816
  ds_read_b64_tr_b16 v[70:71], v4 offset:35072
  s_waitcnt lgkmcnt(12)
  v_mfma_f32_32x32x16_bf16 v[16:31], v[48:51], v[136:139], v[16:31]
  s_waitcnt vmcnt(4)
  s_waitcnt lgkmcnt(2)
  s_barrier
  ds_read_b64_tr_b16 v[48:49], v4 offset:36864
  ds_read_b64_tr_b16 v[50:51], v4 offset:37120
  v_mfma_f32_32x32x16_bf16 v[16:31], v[52:55], v[140:143], v[16:31]
  s_add_u32 s37, s96, 0
  s_and_b32 s37, s37, 3
  s_lshl_b32 s37, s37, 1
  s_add_u32 s37, s37, s27
  s_add_u32 s37, s37, 1
  s_lshl_b32 s28, s37, 8
  v_mov_b32 v15, s28
  v_cndmask_b32 v15, v15, 0, s[24:25]
  v_add_u32 v15, v15, v8
  ds_read_b64 v[236:237], v15
  s_waitcnt lgkmcnt(0)
  s_cmp_eq_u32 s57, 2
  s_cbranch_scc0 L_skip_67
  s_add_u32 m0, s38, 0
  s_add_u32 s28, s3, 0
  buffer_load_dwordx4 v248, s[52:55], s28 offen lds
  s_add_u32 m0, s38, 1024
  s_add_u32 s28, s3, 9216
  buffer_load_dwordx4 v248, s[52:55], s28 offen lds
L_skip_67:
  ds_read_b64_tr_b16 v[52:53], v4 offset:38912
  ds_read_b64_tr_b16 v[54:55], v4 offset:39168
  s_add_u32 m0, s34, 110592
  s_add_u32 s30, s94, 2654208
  buffer_load_dwordx4 v2, s[8:11], s30 offen lds
  v_mfma_f32_32x32x16_bf16 v[16:31], v[56:59], v[144:147], v[16:31]
  v_mfma_f32_32x32x16_bf16 v[32:47], v[236:239], v[232:235], v[32:47]
  s_cmp_eq_u32 s57, 2
  s_cbranch_scc0 L_skip_68
  s_add_u32 m0, s38, 2048
  s_add_u32 s28, s3, 18432
  buffer_load_dwordx4 v248, s[52:55], s28 offen lds
  s_add_u32 m0, s38, 3072
  s_add_u32 s28, s3, 27648
  buffer_load_dwordx4 v248, s[52:55], s28 offen lds
L_skip_68:
  ds_read_b64_tr_b16 v[56:57], v4 offset:40960
  ds_read_b64_tr_b16 v[58:59], v4 offset:41216
  v_mfma_f32_32x32x16_bf16 v[16:31], v[60:63], v[148:151], v[16:31]
  ds_read_b64_tr_b16 v[60:61], v4 offset:43008
  ds_read_b64_tr_b16 v[62:63], v4 offset:43264
  s_add_u32 m0, s34, 118784
  s_add_u32 s30, s94, 3244032
  buffer_load_dwordx4 v2, s[8:11], s30 offen lds
  v_mfma_f32_32x32x16_bf16 v[16:31], v[64:67], v[152:155], v[16:31]
  ds_read_b64_tr_b16 v[64:65], v4 offset:45056
  ds_read_b64_tr_b16 v[66:67], v4 offset:45312
  v_mfma_f32_32x32x16_bf16 v[16:31], v[68:71], v[156:159], v[16:31]
  v_mul_f32 v72, v32, v32
  v_mul_f32 v73, v33, v33
  v_mul_f32 v74, v34, v34
  v_mul_f32 v75, v35, v35
  v_mul_f32 v76, v36, v36
  v_mul_f32 v77, v37, v37
  v_mul_f32 v78, v38, v38
  ds_read_b64_tr_b16 v[68:69], v4 offset:47104
  ds_read_b64_tr_b16 v[70:71], v4 offset:47360
  s_add_u32 m0, s34, 126976
  s_add_u32 s30, s94, 3833856
  buffer_load_dwordx4 v2, s[8:11], s30 offen lds
  v_mfma_f32_32x32x16_bf16 v[16:31], v[48:51], v[160:163], v[16:31]
  v_mul_f32 v79, v39, v39
  v_fma_f32 v72, v72, v10, v9
  v_fma_f32 v73, v73, v10, v9
  v_fma_f32 v74, v74, v10, v9
  v_fma_f32 v75, v75, v10, v9
  v_fma_f32 v76, v76, v10, v9
  ds_read_b64_tr_b16 v[48:49], v5 offset:0
  ds_read_b64_tr_b16 v[50:51], v5 offset:256
  s_waitcnt lgkmcnt(10)
  v_mfma_f32_32x32x16_bf16 v[16:31], v[52:55], v[164:167], v[16:31]
  v_fma_f32 v77, v77, v10, v9
  v_fma_f32 v78, v78, v10, v9
  v_fma_f32 v79, v79, v10, v9
  v_mul_f32 v72, v32, v72
  v_mul_f32 v73, v33, v73
  v_mul_f32 v74, v34, v74
  v_mul_f32 v75, v35, v75
  ds_read_b64_tr_b16 v[52:53], v5 offset:2048
  ds_read_b64_tr_b16 v[54:55], v5 offset:2304
  s_add_u32 m0, s34, 135168
  s_add_u32 s30, s94, 4423680
  buffer_load_dwordx4 v2, s[8:11], s30 offen lds
  s_waitcnt lgkmcnt(10)
  v_mfma_f32_32x32x16_bf16 v[16:31], v[56:59], v[168:171], v[16:31]
  v_mul_f32 v76, v36, v76
  v_mul_f32 v77, v37, v77
  v_mul_f32 v78, v38, v78
  v_mul_f32 v79, v39, v79
  v_exp_f32 v72, v72
  v_exp_f32 v73, v73
  ds_read_b64_tr_b16 v[56:57], v5 offset:4096
  ds_read_b64_tr_b16 v[58:59], v5 offset:4352
  s_waitcnt lgkmcnt(10)
  v_mfma_f32_32x32x16_bf16 v[16:31], v[60:63], v[172:175], v[16:31]
  v_exp_f32 v74, v74
  v_exp_f32 v75, v75
  v_exp_f32 v76, v76
  v_exp_f32 v77, v77
  v_exp_f32 v78, v78
  v_exp_f32 v79, v79
  v_fma_f32 v72, v72, v11, v11
  ds_read_b64_tr_b16 v[60:61], v5 offset:6144
  ds_read_b64_tr_b16 v[62:63], v5 offset:6400
  s_waitcnt lgkmcnt(10)
  v_mfma_f32_32x32x16_bf16 v[16:31], v[64:67], v[176:179], v[16:31]
  v_fma_f32 v73, v73, v11, v11
  v_fma_f32 v74, v74, v11, v11
  v_fma_f32 v75, v75, v11, v11
  v_fma_f32 v76, v76, v11, v11
  v_fma_f32 v77, v77, v11, v11
  v_fma_f32 v78, v78, v11, v11
  ds_read_b64_tr_b16 v[64:65], v5 offset:8192
  ds_read_b64_tr_b16 v[66:67], v5 offset:8448
  s_waitcnt lgkmcnt(10)
  v_mfma_f32_32x32x16_bf16 v[16:31], v[68:71], v[180:183], v[16:31]
  v_fma_f32 v79, v79, v11, v11
  v_rcp_f32 v72, v72
  v_rcp_f32 v73, v73
  v_rcp_f32 v74, v74
  v_rcp_f32 v75, v75
  v_rcp_f32 v76, v76
  ds_read_b64_tr_b16 v[68:69], v5 offset:10240
  ds_read_b64_tr_b16 v[70:71], v5 offset:10496
  s_waitcnt lgkmcnt(10)
  v_mfma_f32_32x32x16_bf16 v[16:31], v[48:51], v[184:187], v[16:31]
  v_rcp_f32 v77, v77
  v_rcp_f32 v78, v78
  v_rcp_f32 v79, v79
  v_mul_f32 v72, v32, v72
  v_mul_f32 v73, v33, v73
  v_mul_f32 v74, v34, v74
  v_mul_f32 v75, v35, v75
  ds_read_b64_tr_b16 v[48:49], v5 offset:12288
  ds_read_b64_tr_b16 v[50:51], v5 offset:12544
  s_waitcnt lgkmcnt(10)
  v_mfma_f32_32x32x16_bf16 v[16:31], v[52:55], v[188:191], v[16:31]
  v_mul_f32 v76, v36, v76
  v_mul_f32 v77, v37, v77
  v_mul_f32 v78, v38, v78
  v_mul_f32 v79, v39, v79
  v_cvt_pk_bf16_f32 v80, v72, v73
  v_cvt_pk_bf16_f32 v81, v74, v75
  v_mov_b32 v12, 151488
  v_mov_b32 v13, 1
  s_waitcnt vmcnt(4)
  s_mov_b64 exec, 1
  ds_add_u32 v12, v13 offset:40
  s_mov_b64 exec, -1
  ds_read_b64_tr_b16 v[52:53], v5 offset:14336
  ds_read_b64_tr_b16 v[54:55], v5 offset:14592
  s_waitcnt lgkmcnt(11)
  v_mfma_f32_32x32x16_bf16 v[16:31], v[56:59], v[192:195], v[16:31]
  v_cvt_pk_bf16_f32 v82, v76, v77
  v_cvt_pk_bf16_f32 v83, v78, v79
  s_add_u32 s28, s39, s37
  s_lshl_b32 s28, s28, 10
  buffer_store_dwordx4 v[80:83], v7, s[4:7], s28 offen offset:0 sc1
  v_mul_f32 v72, v40, v40
  v_mul_f32 v73, v41, v41
  v_mul_f32 v74, v42, v42
  v_mul_f32 v75, v43, v43
  s_waitcnt vmcnt(4)
  ds_read_b64_tr_b16 v[240:241], v249 offset:0
  ds_read_b64_tr_b16 v[242:243], v249 offset:1024
  ds_read_b64_tr_b16 v[56:57], v5 offset:16384
  ds_read_b64_tr_b16 v[58:59], v5 offset:16640
  s_waitcnt lgkmcnt(13)
  v_mfma_f32_32x32x16_bf16 v[16:31], v[60:63], v[196:199], v[16:31]
  v_mul_f32 v76, v44, v44
  v_mul_f32 v77, v45, v45
  v_mul_f32 v78, v46, v46
  v_mul_f32 v79, v47, v47
  v_fma_f32 v72, v72, v10, v9
  v_fma_f32 v73, v73, v10, v9
  ds_read_b64_tr_b16 v[244:245], v249 offset:32
  ds_read_b64_tr_b16 v[246:247], v249 offset:1056
  s_waitcnt lgkmcnt(0)
  ds_read_b64_tr_b16 v[60:61], v5 offset:18432
  ds_read_b64_tr_b16 v[62:63], v5 offset:18688
  v_mfma_f32_32x32x16_bf16 v[16:31], v[64:67], v[200:203], v[16:31]
  v_fma_f32 v74, v74, v10, v9
  v_fma_f32 v75, v75, v10, v9
  v_fma_f32 v76, v76, v10, v9
  v_fma_f32 v77, v77, v10, v9
  v_fma_f32 v78, v78, v10, v9
  v_fma_f32 v79, v79, v10, v9
  v_mul_f32 v72, v40, v72
  s_cmp_eq_u32 s57, 2
  s_cbranch_scc0 L_skip_69
  buffer_store_dwordx4 v[240:243], v3, s[4:7], s32 offen offset:0 sc1
  buffer_store_dwordx4 v[244:247], v3, s[4:7], s32 offen offset:1024 sc1
L_skip_69:
  s_nop 0
  ds_read_b64_tr_b16 v[240:241], v249 offset:64
  ds_read_b32 v255, v12 offset:40
  ds_read_b64_tr_b16 v[64:65], v5 offset:20480
  ds_read_b64_tr_b16 v[66:67], v5 offset:20736
  v_mfma_f32_32x32x16_bf16 v[16:31], v[68:71], v[204:207], v[16:31]
  v_mul_f32 v73, v41, v73
  v_mul_f32 v74, v42, v74
  v_mul_f32 v75, v43, v75
  v_mul_f32 v76, v44, v76
  v_mul_f32 v77, v45, v77
  v_mul_f32 v78, v46, v78
  ds_read_b64_tr_b16 v[242:243], v249 offset:1088
  ds_read_b64_tr_b16 v[244:245], v249 offset:96
  ds_read_b64_tr_b16 v[246:247], v249 offset:1120
  ds_read_b64_tr_b16 v[68:69], v5 offset:22528
  ds_read_b64_tr_b16 v[70:71], v5 offset:22784
  v_mfma_f32_32x32x16_bf16 v[16:31], v[48:51], v[208:211], v[16:31]
  v_mul_f32 v79, v47, v79
  v_exp_f32 v72, v72
  v_exp_f32 v73, v73
  v_exp_f32 v74, v74
  v_exp_f32 v75, v75
  v_exp_f32 v76, v76
  s_waitcnt lgkmcnt(2)
  s_cmp_eq_u32 s57, 2
  s_cbranch_scc0 L_skip_70
  buffer_store_dwordx4 v[240:243], v3, s[4:7], s32 offen offset:2048 sc1
  buffer_store_dwordx4 v[244:247], v3, s[4:7], s32 offen offset:3072 sc1
L_skip_70:
  s_nop 0
  v_readfirstlane_b32 s28, v255
  s_cmp_eq_u32 s28, 8
  s_cbranch_scc1 L_wok_71
  s_mov_b32 s33, 0
L_wlp_72:
  ds_read_b32 v255, v12 offset:40
  s_waitcnt lgkmcnt(0)
  v_readfirstlane_b32 s28, v255
  s_cmp_eq_u32 s28, 8
  s_cbranch_scc1 L_wok_71
  s_add_u32 s33, s33, 1
  s_cmp_lt_u32 s33, 0x100000
  s_cbranch_scc1 L_wlp_72
L_wok_71:
  ds_read_b64_tr_b16 v[48:49], v5 offset:24576
  ds_read_b64_tr_b16 v[50:51], v5 offset:24832
  v_mfma_f32_32x32x16_bf16 v[16:31], v[52:55], v[212:215], v[16:31]
  v_exp_f32 v77, v77
  v_exp_f32 v78, v78
  v_exp_f32 v79, v79
  v_fma_f32 v72, v72, v11, v11
  v_fma_f32 v73, v73, v11, v11
  v_fma_f32 v74, v74, v11, v11
  v_fma_f32 v75, v75, v11, v11
  ds_read_b64_tr_b16 v[52:53], v5 offset:26624
  ds_read_b64_tr_b16 v[54:55], v5 offset:26880
  s_add_u32 m0, s34, 0
  s_add_u32 s30, s95, 0
  buffer_load_dwordx4 v2, s[8:11], s30 offen lds
  v_mfma_f32_32x32x16_bf16 v[16:31], v[56:59], v[216:219], v[16:31]
  v_fma_f32 v76, v76, v11, v11
  v_fma_f32 v77, v77, v11, v11
  v_fma_f32 v78, v78, v11, v11
  v_fma_f32 v79, v79, v11, v11
  v_rcp_f32 v72, v72
  v_rcp_f32 v73, v73
  s_add_u32 s36, s96, 1
  s_and_b32 s36, s36, 3
  s_lshl_b32 s36, s36, 1
  s_add_u32 s36, s36, s27
  s_add_u32 s36, s36, 1
  s_lshl_b32 s28, s36, 8
  v_mov_b32 v15, s28
  v_cndmask_b32 v15, v15, 0, s[24:25]
  v_add_u32 v15, v15, v8
  ds_read_b64 v[236:237], v15
  ds_read_b64_tr_b16 v[56:57], v5 offset:28672
  ds_read_b64_tr_b16 v[58:59], v5 offset:28928
  v_mfma_f32_32x32x16_bf16 v[16:31], v[60:63], v[220:223], v[16:31]
  v_rcp_f32 v74, v74
  v_rcp_f32 v75, v75
  v_rcp_f32 v76, v76
  v_rcp_f32 v77, v77
  v_rcp_f32 v78, v78
  v_rcp_f32 v79, v79
  v_mul_f32 v72, v40, v72
  ds_read_b64_tr_b16 v[60:61], v5 offset:30720
  ds_read_b64_tr_b16 v[62:63], v5 offset:30976
  s_add_u32 m0, s34, 8192
  s_add_u32 s30, s95, 589824
  buffer_load_dwordx4 v2, s[8:11], s30 offen lds
  v_mfma_f32_32x32x16_bf16 v[16:31], v[64:67], v[224:227], v[16:31]
  v_mul_f32 v73, v41, v73
  v_mul_f32 v74, v42, v74
  v_mul_f32 v75, v43, v75
  v_mul_f32 v76, v44, v76
  v_mul_f32 v77, v45, v77
  v_mul_f32 v78, v46, v78
  ds_read_b64_tr_b16 v[64:65], v5 offset:32768
  ds_read_b64_tr_b16 v[66:67], v5 offset:33024
  s_waitcnt lgkmcnt(11)
  v_mfma_f32_32x32x16_bf16 v[16:31], v[68:71], v[228:231], v[16:31]
  v_mul_f32 v79, v47, v79
  v_cvt_pk_bf16_f32 v84, v72, v73
  v_cvt_pk_bf16_f32 v85, v74, v75
  v_cvt_pk_bf16_f32 v86, v76, v77
  v_cvt_pk_bf16_f32 v87, v78, v79
  s_add_u32 s28, s39, s37
  s_lshl_b32 s28, s28, 10
  buffer_store_dwordx4 v[84:87], v7, s[4:7], s28 offen offset:512 sc1
  s_waitcnt lgkmcnt(6)
  v_mfma_f32_32x32x16_bf16 v[16:31], v[236:239], v[232:235], v[16:31]
  ds_read_b64_tr_b16 v[68:69], v5 offset:34816
  ds_read_b64_tr_b16 v[70:71], v5 offset:35072
  s_add_u32 m0, s34, 16384
  s_add_u32 s30, s95, 1179648
  buffer_load_dwordx4 v2, s[8:11], s30 offen lds
  v_mfma_f32_32x32x16_bf16 v[32:47], v[48:51], v[88:91], 0
  ds_read_b64_tr_b16 v[48:49], v5 offset:36864
  ds_read_b64_tr_b16 v[50:51], v5 offset:37120
  v_mfma_f32_32x32x16_bf16 v[32:47], v[52:55], v[92:95], v[32:47]
  ds_read_b64_tr_b16 v[52:53], v5 offset:38912
  ds_read_b64_tr_b16 v[54:55], v5 offset:39168
  s_add_u32 m0, s34, 24576
  s_add_u32 s30, s95, 1769472
  buffer_load_dwordx4 v2, s[8:11], s30 offen lds
  s_waitcnt lgkmcnt(10)
  v_mfma_f32_32x32x16_bf16 v[32:47], v[56:59], v[96:99], v[32:47]
  ds_read_b64_tr_b16 v[56:57], v5 offset:40960
  ds_read_b64_tr_b16 v[58:59], v5 offset:41216
  s_waitcnt lgkmcnt(10)
  v_mfma_f32_32x32x16_bf16 v[32:47], v[60:63], v[100:103], v[32:47]
  v_mul_f32 v72, v16, v16
  v_mul_f32 v73, v17, v17
  v_mul_f32 v74, v18, v18
  v_mul_f32 v75, v19, v19
  v_mul_f32 v76, v20, v20
  ds_read_b64_tr_b16 v[60:61], v5 offset:43008
  ds_read_b64_tr_b16 v[62:63], v5 offset:43264
  s_waitcnt lgkmcnt(10)
  v_mfma_f32_32x32x16_bf16 v[32:47], v[64:67], v[104:107], v[32:47]
  v_mul_f32 v77, v21, v21
  v_mul_f32 v78, v22, v22
  v_mul_f32 v79, v23, v23
  v_fma_f32 v72, v72, v10, v9
  ds_read_b64_tr_b16 v[64:65], v5 offset:45056
  ds_read_b64_tr_b16 v[66:67], v5 offset:45312
  s_waitcnt lgkmcnt(10)
  v_mfma_f32_32x32x16_bf16 v[32:47], v[68:71], v[108:111], v[32:47]
  v_fma_f32 v73, v73, v10, v9
  v_fma_f32 v74, v74, v10, v9
  v_fma_f32 v75, v75, v10, v9
  v_fma_f32 v76, v76, v10, v9
  ds_read_b64_tr_b16 v[68:69], v5 offset:47104
  ds_read_b64_tr_b16 v[70:71], v5 offset:47360
  s_waitcnt lgkmcnt(10)
  v_mfma_f32_32x32x16_bf16 v[32:47], v[48:51], v[112:115], v[32:47]
  v_fma_f32 v77, v77, v10, v9
  v_fma_f32 v78, v78, v10, v9
  v_fma_f32 v79, v79, v10, v9
  v_mul_f32 v72, v16, v72
  ds_read_b64_tr_b16 v[48:49], v6 offset:0
  ds_read_b64_tr_b16 v[50:51], v6 offset:256
  s_waitcnt lgkmcnt(10)
  v_mfma_f32_32x32x16_bf16 v[32:47], v[52:55], v[116:119], v[32:47]
  v_mul_f32 v73, v17, v73
  v_mul_f32 v74, v18, v74
  v_mul_f32 v75, v19, v75
  v_mul_f32 v76, v20, v76
  v_mul_f32 v77, v21, v77
  s_waitcnt vmcnt(6)
  s_mov_b64 exec, 1
  ds_add_u32 v12, v13 offset:44
  s_mov_b64 exec, -1
  ds_read_b64_tr_b16 v[52:53], v6 offset:2048
  ds_read_b64_tr_b16 v[54:55], v6 offset:2304
  s_waitcnt lgkmcnt(11)
  v_mfma_f32_32x32x16_bf16 v[32:47], v[56:59], v[120:123], v[32:47]
  v_mul_f32 v78, v22, v78
  v_mul_f32 v79, v23, v79
  v_exp_f32 v72, v72
  v_exp_f32 v73, v73
  ds_read_b64_tr_b16 v[56:57], v6 offset:4096
  ds_read_b64_tr_b16 v[58:59], v6 offset:4352
  s_waitcnt lgkmcnt(11)
  v_mfma_f32_32x32x16_bf16 v[32:47], v[60:63], v[124:127], v[32:47]
  v_exp_f32 v74, v74
  v_exp_f32 v75, v75
  v_exp_f32 v76, v76
  v_exp_f32 v77, v77
  ds_read_b64_tr_b16 v[60:61], v6 offset:6144
  ds_read_b64_tr_b16 v[62:63], v6 offset:6400
  s_waitcnt lgkmcnt(11)
  v_mfma_f32_32x32x16_bf16 v[32:47], v[64:67], v[128:131], v[32:47]
  v_exp_f32 v78, v78
  v_exp_f32 v79, v79
  v_fma_f32 v72, v72, v11, v11
  v_fma_f32 v73, v73, v11, v11
  ds_read_b32 v255, v12 offset:44
  ds_read_b64_tr_b16 v[64:65], v6 offset:8192
  ds_read_b64_tr_b16 v[66:67], v6 offset:8448
  s_waitcnt lgkmcnt(12)
  v_mfma_f32_32x32x16_bf16 v[32:47], v[68:71], v[132:135], v[32:47]
  v_fma_f32 v74, v74, v11, v11
  v_fma_f32 v75, v75, v11, v11
  v_fma_f32 v76, v76, v11, v11
  v_fma_f32 v77, v77, v11, v11
  ds_read_b64_tr_b16 v[68:69], v6 offset:10240
  ds_read_b64_tr_b16 v[70:71], v6 offset:10496
  s_waitcnt lgkmcnt(12)
  v_mfma_f32_32x32x16_bf16 v[32:47], v[48:51], v[136:139], v[32:47]
  v_fma_f32 v78, v78, v11, v11
  v_fma_f32 v79, v79, v11, v11
  v_rcp_f32 v72, v72
  v_rcp_f32 v73, v73
  v_rcp_f32 v74, v74
  s_waitcnt lgkmcnt(4)
  v_readfirstlane_b32 s28, v255
  s_cmp_eq_u32 s28, 8
  s_cbranch_scc1 L_wok_73
  s_mov_b32 s33, 0
L_wlp_74:
  ds_read_b32 v255, v12 offset:44
  s_waitcnt lgkmcnt(0)
  v_readfirstlane_b32 s28, v255
  s_cmp_eq_u32 s28, 8
  s_cbranch_scc1 L_wok_73
  s_add_u32 s33, s33, 1
  s_cmp_lt_u32 s33, 0x100000
  s_cbranch_scc1 L_wlp_74
L_wok_73:
  ds_read_b64_tr_b16 v[48:49], v6 offset:12288
  ds_read_b64_tr_b16 v[50:51], v6 offset:12544
  v_mfma_f32_32x32x16_bf16 v[32:47], v[52:55], v[140:143], v[32:47]
  v_rcp_f32 v75, v75
  v_rcp_f32 v76, v76
  v_rcp_f32 v77, v77
  v_rcp_f32 v78, v78
  ds_read_b64_tr_b16 v[52:53], v6 offset:14336
  ds_read_b64_tr_b16 v[54:55], v6 offset:14592
  s_add_u32 m0, s34, 36864
  s_add_u32 s30, s95, 2654208
  buffer_load_dwordx4 v2, s[8:11], s30 offen lds
  v_mfma_f32_32x32x16_bf16 v[32:47], v[56:59], v[144:147], v[32:47]
  v_rcp_f32 v79, v79
  v_mul_f32 v72, v16, v72
  v_mul_f32 v73, v17, v73
  v_mul_f32 v74, v18, v74
  ds_read_b64_tr_b16 v[56:57], v6 offset:16384
  ds_read_b64_tr_b16 v[58:59], v6 offset:16640
  v_mfma_f32_32x32x16_bf16 v[32:47], v[60:63], v[148:151], v[32:47]
  v_mul_f32 v75, v19, v75
  v_mul_f32 v76, v20, v76
  v_mul_f32 v77, v21, v77
  v_mul_f32 v78, v22, v78
  ds_read_b64_tr_b16 v[60:61], v6 offset:18432
  ds_read_b64_tr_b16 v[62:63], v6 offset:18688
  s_add_u32 m0, s34, 45056
  s_add_u32 s30, s95, 3244032
  buffer_load_dwordx4 v2, s[8:11], s30 offen lds
  s_waitcnt lgkmcnt(10)
  v_mfma_f32_32x32x16_bf16 v[32:47], v[64:67], v[152:155], v[32:47]
  v_mul_f32 v79, v23, v79
  v_cvt_pk_bf16_f32 v80, v72, v73
  v_cvt_pk_bf16_f32 v81, v74, v75
  v_cvt_pk_bf16_f32 v82, v76, v77
  ds_read_b64_tr_b16 v[64:65], v6 offset:20480
  ds_read_b64_tr_b16 v[66:67], v6 offset:20736
  s_waitcnt lgkmcnt(10)
  v_mfma_f32_32x32x16_bf16 v[32:47], v[68:71], v[156:159], v[32:47]
  v_cvt_pk_bf16_f32 v83, v78, v79
  s_add_u32 s28, s39, s36
  s_lshl_b32 s28, s28, 10
  buffer_store_dwordx4 v[80:83], v7, s[4:7], s28 offen offset:0 sc1
  v_mul_f32 v72, v24, v24
  v_mul_f32 v73, v25, v25
  v_mul_f32 v74, v26, v26
  ds_read_b64_tr_b16 v[68:69], v6 offset:22528
  ds_read_b64_tr_b16 v[70:71], v6 offset:22784
  s_add_u32 m0, s34, 53248
  s_add_u32 s30, s95, 3833856
  buffer_load_dwordx4 v2, s[8:11], s30 offen lds
  s_waitcnt lgkmcnt(10)
  v_mfma_f32_32x32x16_bf16 v[32:47], v[48:51], v[160:163], v[32:47]
  v_mul_f32 v75, v27, v27
  v_mul_f32 v76, v28, v28
  v_mul_f32 v77, v29, v29
  v_mul_f32 v78, v30, v30
  ds_read_b64_tr_b16 v[48:49], v6 offset:24576
  ds_read_b64_tr_b16 v[50:51], v6 offset:24832
  s_waitcnt lgkmcnt(10)
  v_mfma_f32_32x32x16_bf16 v[32:47], v[52:55], v[164:167], v[32:47]
  v_mul_f32 v79, v31, v31
  v_fma_f32 v72, v72, v10, v9
  v_fma_f32 v73, v73, v10, v9
  v_fma_f32 v74, v74, v10, v9
  ds_read_b64_tr_b16 v[52:53], v6 offset:26624
  ds_read_b64_tr_b16 v[54:55], v6 offset:26880
  s_add_u32 m0, s34, 61440
  s_add_u32 s30, s95, 4423680
  buffer_load_dwordx4 v2, s[8:11], s30 offen lds
  s_waitcnt lgkmcnt(10)
  v_mfma_f32_32x32x16_bf16 v[32:47], v[56:59], v[168:171], v[32:47]
  v_fma_f32 v75, v75, v10, v9
  v_fma_f32 v76, v76, v10, v9
  v_fma_f32 v77, v77, v10, v9
  v_fma_f32 v78, v78, v10, v9
  ds_read_b64_tr_b16 v[56:57], v6 offset:28672
  ds_read_b64_tr_b16 v[58:59], v6 offset:28928
  s_waitcnt lgkmcnt(10)
  v_mfma_f32_32x32x16_bf16 v[32:47], v[60:63], v[172:175], v[32:47]
  v_fma_f32 v79, v79, v10, v9
  v_mul_f32 v72, v24, v72
  v_mul_f32 v73, v25, v73
  v_mul_f32 v74, v26, v74
  ds_read_b64_tr_b16 v[60:61], v6 offset:30720
  ds_read_b64_tr_b16 v[62:63], v6 offset:30976
  s_waitcnt lgkmcnt(10)
  v_mfma_f32_32x32x16_bf16 v[32:47], v[64:67], v[176:179], v[32:47]
  v_mul_f32 v75, v27, v75
  v_mul_f32 v76, v28, v76
  v_mul_f32 v77, v29, v77
  v_mul_f32 v78, v30, v78
  v_mul_f32 v79, v31, v79
  ds_read_b64_tr_b16 v[64:65], v6 offset:32768
  ds_read_b64_tr_b16 v[66:67], v6 offset:33024
  s_waitcnt lgkmcnt(10)
  v_mfma_f32_32x32x16_bf16 v[32:47], v[68:71], v[180:183], v[32:47]
  v_exp_f32 v72, v72
  v_exp_f32 v73, v73
  v_exp_f32 v74, v74
  v_exp_f32 v75, v75
  ds_read_b64_tr_b16 v[68:69], v6 offset:34816
  ds_read_b64_tr_b16 v[70:71], v6 offset:35072
  s_waitcnt lgkmcnt(10)
  v_mfma_f32_32x32x16_bf16 v[32:47], v[48:51], v[184:187], v[32:47]
  v_exp_f32 v76, v76
  v_exp_f32 v77, v77
  v_exp_f32 v78, v78
  v_exp_f32 v79, v79
  ds_read_b64_tr_b16 v[48:49], v6 offset:36864
  ds_read_b64_tr_b16 v[50:51], v6 offset:37120
  s_waitcnt lgkmcnt(10)
  v_mfma_f32_32x32x16_bf16 v[32:47], v[52:55], v[188:191], v[32:47]
  v_fma_f32 v72, v72, v11, v11
  v_fma_f32 v73, v73, v11, v11
  v_fma_f32 v74, v74, v11, v11
  v_fma_f32 v75, v75, v11, v11
  s_waitcnt vmcnt(5)
  s_mov_b64 exec, 1
  ds_add_u32 v12, v13 offset:48
  s_mov_b64 exec, -1
  ds_read_b64_tr_b16 v[52:53], v6 offset:38912
  ds_read_b64_tr_b16 v[54:55], v6 offset:39168
  s_waitcnt lgkmcnt(11)
  v_mfma_f32_32x32x16_bf16 v[32:47], v[56:59], v[192:195], v[32:47]
  v_fma_f32 v76, v76, v11, v11
  v_fma_f32 v77, v77, v11, v11
  v_fma_f32 v78, v78, v11, v11
  v_fma_f32 v79, v79, v11, v11
  ds_read_b64_tr_b16 v[56:57], v6 offset:40960
  ds_read_b64_tr_b16 v[58:59], v6 offset:41216
  s_waitcnt lgkmcnt(11)
  v_mfma_f32_32x32x16_bf16 v[32:47], v[60:63], v[196:199], v[32:47]
  v_rcp_f32 v72, v72
  v_rcp_f32 v73, v73
  v_rcp_f32 v74, v74
  v_rcp_f32 v75, v75
  v_rcp_f32 v76, v76
  ds_read_b64_tr_b16 v[60:61], v6 offset:43008
  ds_read_b64_tr_b16 v[62:63], v6 offset:43264
  s_waitcnt lgkmcnt(11)
  v_mfma_f32_32x32x16_bf16 v[32:47], v[64:67], v[200:203], v[32:47]
  v_rcp_f32 v77, v77
  v_rcp_f32 v78, v78
  v_rcp_f32 v79, v79
  v_mul_f32 v72, v24, v72
  ds_read_b32 v255, v12 offset:48
  ds_read_b64_tr_b16 v[64:65], v6 offset:45056
  ds_read_b64_tr_b16 v[66:67], v6 offset:45312
  s_waitcnt lgkmcnt(12)
  v_mfma_f32_32x32x16_bf16 v[32:47], v[68:71], v[204:207], v[32:47]
  v_mul_f32 v73, v25, v73
  v_mul_f32 v74, v26, v74
  v_mul_f32 v75, v27, v75
  v_mul_f32 v76, v28, v76
  ds_read_b64_tr_b16 v[68:69], v6 offset:47104
  ds_read_b64_tr_b16 v[70:71], v6 offset:47360
  s_waitcnt lgkmcnt(12)
  v_mfma_f32_32x32x16_bf16 v[32:47], v[48:51], v[208:211], v[32:47]
  v_mul_f32 v77, v29, v77
  v_mul_f32 v78, v30, v78
  v_mul_f32 v79, v31, v79
  v_cvt_pk_bf16_f32 v84, v72, v73
  s_waitcnt lgkmcnt(4)
  v_readfirstlane_b32 s28, v255
  s_cmp_eq_u32 s28, 8
  s_cbranch_scc1 L_wok_75
  s_mov_b32 s33, 0
L_wlp_76:
  ds_read_b32 v255, v12 offset:48
  s_waitcnt lgkmcnt(0)
  v_readfirstlane_b32 s28, v255
  s_cmp_eq_u32 s28, 8
  s_cbranch_scc1 L_wok_75
  s_add_u32 s33, s33, 1
  s_cmp_lt_u32 s33, 0x100000
  s_cbranch_scc1 L_wlp_76
L_wok_75:
  ds_read_b64_tr_b16 v[48:49], v4 offset:0
  ds_read_b64_tr_b16 v[50:51], v4 offset:256
  v_mfma_f32_32x32x16_bf16 v[32:47], v[52:55], v[212:215], v[32:47]
  v_cvt_pk_bf16_f32 v85, v74, v75
  v_cvt_pk_bf16_f32 v86, v76, v77
  v_cvt_pk_bf16_f32 v87, v78, v79
  s_add_u32 s28, s39, s36
  s_lshl_b32 s28, s28, 10
  buffer_store_dwordx4 v[84:87], v7, s[4:7], s28 offen offset:512 sc1
  ds_read_b64_tr_b16 v[52:53], v4 offset:2048
  ds_read_b64_tr_b16 v[54:55], v4 offset:2304
  s_add_u32 m0, s34, 73728
  s_add_u32 s30, s31, 512
  buffer_load_dwordx4 v2, s[8:11], s30 offen lds
  v_mfma_f32_32x32x16_bf16 v[32:47], v[56:59], v[216:219], v[32:47]
  s_add_u32 s37, s96, 2
  s_and_b32 s37, s37, 3
  s_lshl_b32 s37, s37, 1
  s_add_u32 s37, s37, s27
  s_add_u32 s37, s37, 1
  s_lshl_b32 s28, s37, 8
  v_mov_b32 v15, s28
  v_cndmask_b32 v15, v15, 0, s[24:25]
  v_add_u32 v15, v15, v8
  ds_read_b64 v[236:237], v15
  ds_read_b64_tr_b16 v[56:57], v4 offset:4096
  ds_read_b64_tr_b16 v[58:59], v4 offset:4352
  v_mfma_f32_32x32x16_bf16 v[32:47], v[60:63], v[220:223], v[32:47]
  ds_read_b64_tr_b16 v[60:61], v4 offset:6144
  ds_read_b64_tr_b16 v[62:63], v4 offset:6400
  s_add_u32 m0, s34, 81920
  s_add_u32 s30, s31, 590336
  buffer_load_dwordx4 v2, s[8:11], s30 offen lds
  s_waitcnt lgkmcnt(11)
  v_mfma_f32_32x32x16_bf16 v[32:47], v[64:67], v[224:227], v[32:47]
  ds_read_b64_tr_b16 v[64:65], v4 offset:8192
  ds_read_b64_tr_b16 v[66:67], v4 offset:8448
  s_waitcnt lgkmcnt(11)
  v_mfma_f32_32x32x16_bf16 v[32:47], v[68:71], v[228:231], v[32:47]
  s_waitcnt lgkmcnt(6)
  v_mfma_f32_32x32x16_bf16 v[32:47], v[236:239], v[232:235], v[32:47]
  ds_read_b64_tr_b16 v[68:69], v4 offset:10240
  ds_read_b64_tr_b16 v[70:71], v4 offset:10496
  s_add_u32 m0, s34, 90112
  s_add_u32 s30, s31, 1180160
  buffer_load_dwordx4 v2, s[8:11], s30 offen lds
  v_mfma_f32_32x32x16_bf16 v[16:31], v[48:51], v[88:91], 0
  ds_read_b64_tr_b16 v[48:49], v4 offset:12288
  ds_read_b64_tr_b16 v[50:51], v4 offset:12544
  v_mfma_f32_32x32x16_bf16 v[16:31], v[52:55], v[92:95], v[16:31]
  ds_read_b64_tr_b16 v[52:53], v4 offset:14336
  ds_read_b64_tr_b16 v[54:55], v4 offset:14592
  s_add_u32 m0, s34, 98304
  s_add_u32 s30, s31, 1769984
  buffer_load_dwordx4 v2, s[8:11], s30 offen lds
  s_waitcnt lgkmcnt(10)
  v_mfma_f32_32x32x16_bf16 v[16:31], v[56:59], v[96:99], v[16:31]
  ds_read_b64_tr_b16 v[56:57], v4 offset:16384
  ds_read_b64_tr_b16 v[58:59], v4 offset:16640
  s_waitcnt lgkmcnt(10)
  v_mfma_f32_32x32x16_bf16 v[16:31], v[60:63], v[100:103], v[16:31]
  v_mul_f32 v72, v32, v32
  v_mul_f32 v73, v33, v33
  v_mul_f32 v74, v34, v34
  v_mul_f32 v75, v35, v35
  v_mul_f32 v76, v36, v36
  ds_read_b64_tr_b16 v[60:61], v4 offset:18432
  ds_read_b64_tr_b16 v[62:63], v4 offset:18688
  s_waitcnt lgkmcnt(10)
  v_mfma_f32_32x32x16_bf16 v[16:31], v[64:67], v[104:107], v[16:31]
  v_mul_f32 v77, v37, v37
  v_mul_f32 v78, v38, v38
  v_mul_f32 v79, v39, v39
  v_fma_f32 v72, v72, v10, v9
  ds_read_b64_tr_b16 v[64:65], v4 offset:20480
  ds_read_b64_tr_b16 v[66:67], v4 offset:20736
  s_waitcnt lgkmcnt(10)
  v_mfma_f32_32x32x16_bf16 v[16:31], v[68:71], v[108:111], v[16:31]
  v_fma_f32 v73, v73, v10, v9
  v_fma_f32 v74, v74, v10, v9
  v_fma_f32 v75, v75, v10, v9
  v_fma_f32 v76, v76, v10, v9
  ds_read_b64_tr_b16 v[68:69], v4 offset:22528
  ds_read_b64_tr_b16 v[70:71], v4 offset:22784
  s_waitcnt lgkmcnt(10)
  v_mfma_f32_32x32x16_bf16 v[16:31], v[48:51], v[112:115], v[16:31]
  v_fma_f32 v77, v77, v10, v9
  v_fma_f32 v78, v78, v10, v9
  v_fma_f32 v79, v79, v10, v9
  v_mul_f32 v72, v32, v72
  ds_read_b64_tr_b16 v[48:49], v4 offset:24576
  ds_read_b64_tr_b16 v[50:51], v4 offset:24832
  s_waitcnt lgkmcnt(10)
  v_mfma_f32_32x32x16_bf16 v[16:31], v[52:55], v[116:119], v[16:31]
  v_mul_f32 v73, v33, v73
  v_mul_f32 v74, v34, v74
  v_mul_f32 v75, v35, v75
  v_mul_f32 v76, v36, v76
  v_mul_f32 v77, v37, v77
  s_waitcnt vmcnt(5)
  s_mov_b64 exec, 1
  ds_add_u32 v12, v13 offset:52
  s_mov_b64 exec, -1
  ds_read_b64_tr_b16 v[52:53], v4 offset:26624
  ds_read_b64_tr_b16 v[54:55], v4 offset:26880
  s_waitcnt lgkmcnt(11)
  v_mfma_f32_32x32x16_bf16 v[16:31], v[56:59], v[120:123], v[16:31]
  v_mul_f32 v78, v38, v78
  v_mul_f32 v79, v39, v79
  v_exp_f32 v72, v72
  v_exp_f32 v73, v73
  ds_read_b64_tr_b16 v[56:57], v4 offset:28672
  ds_read_b64_tr_b16 v[58:59], v4 offset:28928
  s_waitcnt lgkmcnt(11)
  v_mfma_f32_32x32x16_bf16 v[16:31], v[60:63], v[124:127], v[16:31]
  v_exp_f32 v74, v74
  v_exp_f32 v75, v75
  v_exp_f32 v76, v76
  v_exp_f32 v77, v77
  ds_read_b64_tr_b16 v[60:61], v4 offset:30720
  ds_read_b64_tr_b16 v[62:63], v4 offset:30976
  s_waitcnt lgkmcnt(11)
  v_mfma_f32_32x32x16_bf16 v[16:31], v[64:67], v[128:131], v[16:31]
  v_exp_f32 v78, v78
  v_exp_f32 v79, v79
  v_fma_f32 v72, v72, v11, v11
  v_fma_f32 v73, v73, v11, v11
  ds_read_b32 v255, v12 offset:52
  ds_read_b64_tr_b16 v[64:65], v4 offset:32768
  ds_read_b64_tr_b16 v[66:67], v4 offset:33024
  s_waitcnt lgkmcnt(12)
  v_mfma_f32_32x32x16_bf16 v[16:31], v[68:71], v[132:135], v[16:31]
  v_fma_f32 v74, v74, v11, v11
  v_fma_f32 v75, v75, v11, v11
  v_fma_f32 v76, v76, v11, v11
  v_fma_f32 v77, v77, v11, v11
  ds_read_b64_tr_b16 v[68:69], v4 offset:34816
  ds_read_b64_tr_b16 v[70:71], v4 offset:35072
  s_waitcnt lgkmcnt(12)
  v_mfma_f32_32x32x16_bf16 v[16:31], v[48:51], v[136:139], v[16:31]
  v_fma_f32 v78, v78, v11, v11
  v_fma_f32 v79, v79, v11, v11
  v_rcp_f32 v72, v72
  v_rcp_f32 v73, v73
  v_rcp_f32 v74, v74
  s_waitcnt lgkmcnt(4)
  v_readfirstlane_b32 s28, v255
  s_cmp_eq_u32 s28, 8
  s_cbranch_scc1 L_wok_77
  s_mov_b32 s33, 0
L_wlp_78:
  ds_read_b32 v255, v12 offset:52
  s_waitcnt lgkmcnt(0)
  v_readfirstlane_b32 s28, v255
  s_cmp_eq_u32 s28, 8
  s_cbranch_scc1 L_wok_77
  s_add_u32 s33, s33, 1
  s_cmp_lt_u32 s33, 0x100000
  s_cbranch_scc1 L_wlp_78
L_wok_77:
  s_cmp_eq_u32 s18, 4
  s_cbranch_scc0 L_skip_79
  s_mov_b32 s29, 0x33e5000
  buffer_load_dword v248, v3, s[4:7], s29 offen offset:0 sc1
  buffer_load_dword v249, v3, s[4:7], s29 offen offset:1024 sc1
  buffer_load_dword v250, v3, s[4:7], s29 offen offset:2048 sc1
  buffer_load_dword v251, v3, s[4:7], s29 offen offset:3072 sc1
L_skip_79:
  ds_read_b64_tr_b16 v[48:49], v4 offset:36864
  ds_read_b64_tr_b16 v[50:51], v4 offset:37120
  v_mfma_f32_32x32x16_bf16 v[16:31], v[52:55], v[140:143], v[16:31]
  v_rcp_f32 v75, v75
  v_rcp_f32 v76, v76
  v_rcp_f32 v77, v77
  v_rcp_f32 v78, v78
  ds_read_b64_tr_b16 v[52:53], v4 offset:38912
  ds_read_b64_tr_b16 v[54:55], v4 offset:39168
  s_add_u32 m0, s34, 110592
  s_add_u32 s30, s31, 2654720
  buffer_load_dwordx4 v2, s[8:11], s30 offen lds
  v_mfma_f32_32x32x16_bf16 v[16:31], v[56:59], v[144:147], v[16:31]
  v_rcp_f32 v79, v79
  v_mul_f32 v72, v32, v72
  v_mul_f32 v73, v33, v73
  v_mul_f32 v74, v34, v74
  ds_read_b64_tr_b16 v[56:57], v4 offset:40960
  ds_read_b64_tr_b16 v[58:59], v4 offset:41216
  v_mfma_f32_32x32x16_bf16 v[16:31], v[60:63], v[148:151], v[16:31]
  v_mul_f32 v75, v35, v75
  v_mul_f32 v76, v36, v76
  v_mul_f32 v77, v37, v77
  v_mul_f32 v78, v38, v78
  ds_read_b64_tr_b16 v[60:61], v4 offset:43008
  ds_read_b64_tr_b16 v[62:63], v4 offset:43264
  s_add_u32 m0, s34, 118784
  s_add_u32 s30, s31, 3244544
  buffer_load_dwordx4 v2, s[8:11], s30 offen lds
  s_waitcnt lgkmcnt(10)
  v_mfma_f32_32x32x16_bf16 v[16:31], v[64:67], v[152:155], v[16:31]
  v_mul_f32 v79, v39, v79
  v_cvt_pk_bf16_f32 v80, v72, v73
  v_cvt_pk_bf16_f32 v81, v74, v75
  v_cvt_pk_bf16_f32 v82, v76, v77
  ds_read_b64_tr_b16 v[64:65], v4 offset:45056
  ds_read_b64_tr_b16 v[66:67], v4 offset:45312
  s_waitcnt lgkmcnt(10)
  v_mfma_f32_32x32x16_bf16 v[16:31], v[68:71], v[156:159], v[16:31]
  v_cvt_pk_bf16_f32 v83, v78, v79
  s_add_u32 s28, s39, s37
  s_lshl_b32 s28, s28, 10
  buffer_store_dwordx4 v[80:83], v7, s[4:7], s28 offen offset:0 sc1
  v_mul_f32 v72, v40, v40
  v_mul_f32 v73, v41, v41
  v_mul_f32 v74, v42, v42
  ds_read_b64_tr_b16 v[68:69], v4 offset:47104
  ds_read_b64_tr_b16 v[70:71], v4 offset:47360
  s_add_u32 m0, s34, 126976
  s_add_u32 s30, s31, 3834368
  buffer_load_dwordx4 v2, s[8:11], s30 offen lds
  s_waitcnt lgkmcnt(10)
  v_mfma_f32_32x32x16_bf16 v[16:31], v[48:51], v[160:163], v[16:31]
  v_mul_f32 v75, v43, v43
  v_mul_f32 v76, v44, v44
  v_mul_f32 v77, v45, v45
  v_mul_f32 v78, v46, v46
  ds_read_b64_tr_b16 v[48:49], v5 offset:0
  ds_read_b64_tr_b16 v[50:51], v5 offset:256
  s_waitcnt lgkmcnt(10)
  v_mfma_f32_32x32x16_bf16 v[16:31], v[52:55], v[164:167], v[16:31]
  v_mul_f32 v79, v47, v47
  v_fma_f32 v72, v72, v10, v9
  v_fma_f32 v73, v73, v10, v9
  v_fma_f32 v74, v74, v10, v9
  ds_read_b64_tr_b16 v[52:53], v5 offset:2048
  ds_read_b64_tr_b16 v[54:55], v5 offset:2304
  s_add_u32 m0, s34, 135168
  s_add_u32 s30, s31, 4424192
  buffer_load_dwordx4 v2, s[8:11], s30 offen lds
  s_waitcnt lgkmcnt(10)
  v_mfma_f32_32x32x16_bf16 v[16:31], v[56:59], v[168:171], v[16:31]
  v_fma_f32 v75, v75, v10, v9
  v_fma_f32 v76, v76, v10, v9
  v_fma_f32 v77, v77, v10, v9
  v_fma_f32 v78, v78, v10, v9
  ds_read_b64_tr_b16 v[56:57], v5 offset:4096
  ds_read_b64_tr_b16 v[58:59], v5 offset:4352
  s_waitcnt lgkmcnt(10)
  v_mfma_f32_32x32x16_bf16 v[16:31], v[60:63], v[172:175], v[16:31]
  v_fma_f32 v79, v79, v10, v9
  v_mul_f32 v72, v40, v72
  v_mul_f32 v73, v41, v73
  v_mul_f32 v74, v42, v74
  ds_read_b64_tr_b16 v[60:61], v5 offset:6144
  ds_read_b64_tr_b16 v[62:63], v5 offset:6400
  s_waitcnt lgkmcnt(10)
  v_mfma_f32_32x32x16_bf16 v[16:31], v[64:67], v[176:179], v[16:31]
  v_mul_f32 v75, v43, v75
  v_mul_f32 v76, v44, v76
  v_mul_f32 v77, v45, v77
  v_mul_f32 v78, v46, v78
  v_mul_f32 v79, v47, v79
  ds_read_b64_tr_b16 v[64:65], v5 offset:8192
  ds_read_b64_tr_b16 v[66:67], v5 offset:8448
  s_waitcnt lgkmcnt(10)
  v_mfma_f32_32x32x16_bf16 v[16:31], v[68:71], v[180:183], v[16:31]
  v_exp_f32 v72, v72
  v_exp_f32 v73, v73
  v_exp_f32 v74, v74
  v_exp_f32 v75, v75
  ds_read_b64_tr_b16 v[68:69], v5 offset:10240
  ds_read_b64_tr_b16 v[70:71], v5 offset:10496
  s_waitcnt lgkmcnt(10)
  v_mfma_f32_32x32x16_bf16 v[16:31], v[48:51], v[184:187], v[16:31]
  v_exp_f32 v76, v76
  v_exp_f32 v77, v77
  v_exp_f32 v78, v78
  v_exp_f32 v79, v79
  ds_read_b64_tr_b16 v[48:49], v5 offset:12288
  ds_read_b64_tr_b16 v[50:51], v5 offset:12544
  s_waitcnt lgkmcnt(10)
  v_mfma_f32_32x32x16_bf16 v[16:31], v[52:55], v[188:191], v[16:31]
  v_fma_f32 v72, v72, v11, v11
  v_fma_f32 v73, v73, v11, v11
  v_fma_f32 v74, v74, v11, v11
  v_fma_f32 v75, v75, v11, v11
  ds_read_b64_tr_b16 v[52:53], v5 offset:14336
  ds_read_b64_tr_b16 v[54:55], v5 offset:14592
  s_waitcnt lgkmcnt(10)
  v_mfma_f32_32x32x16_bf16 v[16:31], v[56:59], v[192:195], v[16:31]
  v_fma_f32 v76, v76, v11, v11
  v_fma_f32 v77, v77, v11, v11
  v_fma_f32 v78, v78, v11, v11
  v_fma_f32 v79, v79, v11, v11
  ds_read_b64_tr_b16 v[56:57], v5 offset:16384
  ds_read_b64_tr_b16 v[58:59], v5 offset:16640
  s_waitcnt lgkmcnt(10)
  v_mfma_f32_32x32x16_bf16 v[16:31], v[60:63], v[196:199], v[16:31]
  v_rcp_f32 v72, v72
  v_rcp_f32 v73, v73
  v_rcp_f32 v74, v74
  v_rcp_f32 v75, v75
  v_rcp_f32 v76, v76
  ds_read_b64_tr_b16 v[60:61], v5 offset:18432
  ds_read_b64_tr_b16 v[62:63], v5 offset:18688
  s_waitcnt lgkmcnt(10)
  v_mfma_f32_32x32x16_bf16 v[16:31], v[64:67], v[200:203], v[16:31]
  v_rcp_f32 v77, v77
  v_rcp_f32 v78, v78
  v_rcp_f32 v79, v79
  v_mul_f32 v72, v40, v72
  ds_read_b64_tr_b16 v[64:65], v5 offset:20480
  ds_read_b64_tr_b16 v[66:67], v5 offset:20736
  s_waitcnt lgkmcnt(10)
  v_mfma_f32_32x32x16_bf16 v[16:31], v[68:71], v[204:207], v[16:31]
  v_mul_f32 v73, v41, v73
  v_mul_f32 v74, v42, v74
  v_mul_f32 v75, v43, v75
  v_mul_f32 v76, v44, v76
  ds_read_b64_tr_b16 v[68:69], v5 offset:22528
  ds_read_b64_tr_b16 v[70:71], v5 offset:22784
  s_waitcnt lgkmcnt(10)
  v_mfma_f32_32x32x16_bf16 v[16:31], v[48:51], v[208:211], v[16:31]
  v_mul_f32 v77, v45, v77
  v_mul_f32 v78, v46, v78
  v_mul_f32 v79, v47, v79
  v_cvt_pk_bf16_f32 v84, v72, v73
  s_waitcnt lgkmcnt(8)
  v_mfma_f32_32x32x16_bf16 v[16:31], v[52:55], v[212:215], v[16:31]
  v_cvt_pk_bf16_f32 v85, v74, v75
  v_cvt_pk_bf16_f32 v86, v76, v77
  v_cvt_pk_bf16_f32 v87, v78, v79
  s_add_u32 s28, s39, s37
  s_lshl_b32 s28, s28, 10
  buffer_store_dwordx4 v[84:87], v7, s[4:7], s28 offen offset:512 sc1
  s_waitcnt lgkmcnt(6)
  v_mfma_f32_32x32x16_bf16 v[16:31], v[56:59], v[216:219], v[16:31]
  s_add_u32 s36, s96, 3
  s_and_b32 s36, s36, 3
  s_lshl_b32 s36, s36, 1
  s_add_u32 s36, s36, s27
  s_add_u32 s36, s36, 1
  s_lshl_b32 s28, s36, 8
  v_mov_b32 v15, s28
  v_cndmask_b32 v15, v15, 0, s[24:25]
  v_add_u32 v15, v15, v8
  ds_read_b64 v[236:237], v15
  s_waitcnt lgkmcnt(5)
  v_mfma_f32_32x32x16_bf16 v[16:31], v[60:63], v[220:223], v[16:31]
  s_waitcnt lgkmcnt(3)
  v_mfma_f32_32x32x16_bf16 v[16:31], v[64:67], v[224:227], v[16:31]
  s_waitcnt lgkmcnt(1)
  v_mfma_f32_32x32x16_bf16 v[16:31], v[68:71], v[228:231], v[16:31]
  s_waitcnt lgkmcnt(0)
  v_mfma_f32_32x32x16_bf16 v[16:31], v[236:239], v[232:235], v[16:31]
  s_nop 7
  s_nop 4
  s_cmp_eq_u32 s18, 4
  s_cbranch_scc0 L_aok_80
  s_waitcnt vmcnt(6)
  s_add_u32 s28, s59, 0
  v_subrev_u32 v248, s28, v248
  v_subrev_u32 v249, s28, v249
  v_subrev_u32 v250, s28, v250
  v_subrev_u32 v251, s28, v251
  v_max_u32 v248, v248, v249
  v_max_u32 v248, v248, v250
  v_max_u32 v248, v248, v251
  v_cmp_ge_u32 vcc, 0, v248
  s_nop 1
  s_cmp_eq_u64 vcc, -1
  s_cbranch_scc1 L_aok_80
  s_mov_b32 s33, 0
L_aspin_81:
  s_mov_b32 s29, 0x33e5000
  buffer_load_dword v248, v3, s[4:7], s29 offen offset:0 sc1
  buffer_load_dword v249, v3, s[4:7], s29 offen offset:1024 sc1
  buffer_load_dword v250, v3, s[4:7], s29 offen offset:2048 sc1
  buffer_load_dword v251, v3, s[4:7], s29 offen offset:3072 sc1
  s_waitcnt vmcnt(0)
  s_add_u32 s28, s59, 0
  v_subrev_u32 v248, s28, v248
  v_subrev_u32 v249, s28, v249
  v_subrev_u32 v250, s28, v250
  v_subrev_u32 v251, s28, v251
  v_max_u32 v248, v248, v249
  v_max_u32 v248, v248, v250
  v_max_u32 v248, v248, v251
  v_cmp_ge_u32 vcc, 0, v248
  s_nop 1
  s_cmp_eq_u64 vcc, -1
  s_cbranch_scc1 L_spinout_82
  s_sleep 8
  s_add_u32 s33, s33, 1
  s_cmp_lt_u32 s33, 0x40000
  s_cbranch_scc1 L_aspin_81
L_spinout_82:
L_aok_80:
  s_cmp_eq_u32 s18, 5
  s_cbranch_scc0 L_skip_83
  s_mov_b32 s29, 0x33e6000
  buffer_load_dword v232, v3, s[4:7], s29 offen offset:0 sc1
  buffer_load_dword v233, v3, s[4:7], s29 offen offset:1024 sc1
  buffer_load_dword v234, v3, s[4:7], s29 offen offset:2048 sc1
  buffer_load_dword v235, v3, s[4:7], s29 offen offset:3072 sc1
L_skip_83:
  s_cmp_lt_u32 s2, 145
  s_cbranch_scc0 L_nofft_84
  s_and_b32 s52, s19, 1
  s_lshr_b32 s53, s19, 1
  s_lshl_b32 s54, s2, 1
  s_add_u32 s54, s54, s53
  s_waitcnt vmcnt(6)
  s_barrier
  s_min_u32 s55, s54, 288
  s_lshl_b32 s55, s55, 13
  s_lshl_b32 s56, s52, 12
  s_add_u32 s55, s55, s56
  s_add_u32 s55, s55, 0x19e0000
  buffer_load_dwordx4 v[196:199], v3, s[4:7], s55 offen offset:0 sc1
  v_mul_f32 v72, v16, v16
  buffer_load_dwordx4 v[200:203], v3, s[4:7], s55 offen offset:1024 sc1
  v_mul_f32 v73, v17, v17
  buffer_load_dwordx4 v[204:207], v3, s[4:7], s55 offen offset:2048 sc1
  v_mul_f32 v74, v18, v18
  buffer_load_dwordx4 v[208:211], v3, s[4:7], s55 offen offset:3072 sc1
  v_mul_f32 v75, v19, v19
  s_mov_b32 s55, 0x21d9800
  buffer_load_dwordx4 v[88:91], v3, s[4:7], s55 offen offset:0 sc1
  v_mul_f32 v76, v20, v20
  buffer_load_dwordx4 v[92:95], v3, s[4:7], s55 offen offset:1024 sc1
  v_mul_f32 v77, v21, v21
  s_mul_i32 s55, s52, 3072
  s_add_u32 s55, s55, 0x21d4000
  buffer_load_dwordx4 v[184:187], v3, s[4:7], s55 offen offset:0 sc1
  v_mul_f32 v78, v22, v22
  buffer_load_dwordx4 v[188:191], v3, s[4:7], s55 offen offset:1024 sc1
  v_mul_f32 v79, v23, v23
  s_mov_b32 s55, 0x21e1800
  buffer_load_dwordx4 v[244:247], v3, s[4:7], s55 offen offset:0 sc1
  v_fma_f32 v72, v72, v10, v9
  buffer_load_dwordx4 v[248:251], v3, s[4:7], s55 offen offset:1024 sc1
  v_fma_f32 v73, v73, v10, v9
  s_lshl_b32 s44, s54, 13
  s_add_u32 s45, s44, 4096
  s_cmp_eq_u32 s54, 0
  s_cselect_b32 s45, 0x7ff00000, s45
  s_cmp_eq_u32 s54, 288
  s_cselect_b32 s45, 0x7ff00000, s45
  s_cselect_b32 s44, 4096, s44
  s_cmp_gt_u32 s54, 288
  s_cselect_b32 s44, 0x7ff00000, s44
  s_cselect_b32 s45, 0x7ff00000, s45
  s_cmp_eq_u32 s53, 0
  s_mov_b32 s48, 159744
  s_mov_b32 s49, 69632
  s_cselect_b32 s48, 151552, s48
  s_cselect_b32 s49, 155648, s49
  s_cmp_eq_u32 s52, 0
  s_cselect_b32 s50, s44, s45
  s_cselect_b32 s51, s48, s49
  s_lshl_b32 s46, s53, 3
  s_lshl_b32 s47, s52, 2
  s_add_u32 s46, s46, 151488
  s_add_u32 s47, s47, s46
  v_mov_b32 v13, s47
  s_xor_b32 s47, s47, 4
  v_mov_b32 v14, s47
  s_lshl_b32 s46, s53, 2
  s_add_u32 s46, s46, 151504
  v_mov_b32 v15, s46
  v_fma_f32 v74, v74, v10, v9
  v_and_b32 v50, 15, v1
  v_fma_f32 v75, v75, v10, v9
  s_lshl_b32 s56, s52, 4
  v_fma_f32 v76, v76, v10, v9
  v_add_u32 v50, s56, v50
  v_fma_f32 v77, v77, v10, v9
  v_cvt_f32_u32 v50, v50
  v_fma_f32 v78, v78, v10, v9
  v_mul_f32 v50, 0xba000000, v50
  v_fma_f32 v79, v79, v10, v9
  v_lshrrev_b32 v51, 4, v1
  v_mul_f32 v72, v16, v72
  v_lshlrev_b32 v51, 2, v51
  v_mul_f32 v73, v17, v73
  v_cvt_f32_u32 v51, v51
  v_mul_f32 v74, v18, v74
  v_mul_f32 v51, v51, v50
  v_mul_f32 v75, v19, v75
  v_fmamk_f32 v156, v50, 0x0, v51
  v_mul_f32 v76, v20, v76
  v_fmamk_f32 v157, v50, 0x3f800000, v51
  v_mul_f32 v77, v21, v77
  v_fmamk_f32 v158, v50, 0x40000000, v51
  v_mul_f32 v78, v22, v78
  v_fmamk_f32 v159, v50, 0x40400000, v51
  v_mul_f32 v79, v23, v79
  v_cos_f32 v152, v156
  v_exp_f32 v72, v72
  v_cos_f32 v153, v157
  v_exp_f32 v73, v73
  v_cos_f32 v154, v158
  v_exp_f32 v74, v74
  v_cos_f32 v155, v159
  v_exp_f32 v75, v75
  v_sin_f32 v156, v156
  v_exp_f32 v76, v76
  v_sin_f32 v157, v157
  v_exp_f32 v77, v77
  v_sin_f32 v158, v158
  v_exp_f32 v78, v78
  v_sin_f32 v159, v159
  v_exp_f32 v79, v79
  v_fmamk_f32 v164, v50, 0x41800000, v51
  v_fma_f32 v72, v72, v11, v11
  v_fmamk_f32 v165, v50, 0x41880000, v51
  v_fma_f32 v73, v73, v11, v11
  v_fmamk_f32 v166, v50, 0x41900000, v51
  v_fma_f32 v74, v74, v11, v11
  v_fmamk_f32 v167, v50, 0x41980000, v51
  v_fma_f32 v75, v75, v11, v11
  v_cos_f32 v160, v164
  v_fma_f32 v76, v76, v11, v11
  v_cos_f32 v161, v165
  v_fma_f32 v77, v77, v11, v11
  v_cos_f32 v162, v166
  v_fma_f32 v78, v78, v11, v11
  v_cos_f32 v163, v167
  v_fma_f32 v79, v79, v11, v11
  v_sin_f32 v164, v164
  v_rcp_f32 v72, v72
  v_sin_f32 v165, v165
  v_rcp_f32 v73, v73
  v_sin_f32 v166, v166
  v_rcp_f32 v74, v74
  v_sin_f32 v167, v167
  v_rcp_f32 v75, v75
  v_fmamk_f32 v172, v50, 0x42000000, v51
  v_rcp_f32 v76, v76
  v_fmamk_f32 v173, v50, 0x42040000, v51
  v_rcp_f32 v77, v77
  v_fmamk_f32 v174, v50, 0x42080000, v51
  v_rcp_f32 v78, v78
  v_fmamk_f32 v175, v50, 0x420c0000, v51
  v_rcp_f32 v79, v79
  v_cos_f32 v168, v172
  v_mul_f32 v72, v16, v72
  v_cos_f32 v169, v173
  v_mul_f32 v73, v17, v73
  v_cos_f32 v170, v174
  v_mul_f32 v74, v18, v74
  v_cos_f32 v171, v175
  v_mul_f32 v75, v19, v75
  v_sin_f32 v172, v172
  v_mul_f32 v76, v20, v76
  v_sin_f32 v173, v173
  v_mul_f32 v77, v21, v77
  v_sin_f32 v174, v174
  v_mul_f32 v78, v22, v78
  v_sin_f32 v175, v175
  v_mul_f32 v79, v23, v79
  v_fmamk_f32 v180, v50, 0x42400000, v51
  v_cvt_pk_bf16_f32 v80, v72, v73
  v_fmamk_f32 v181, v50, 0x42440000, v51
  v_cvt_pk_bf16_f32 v81, v74, v75
  v_fmamk_f32 v182, v50, 0x42480000, v51
  v_cvt_pk_bf16_f32 v82, v76, v77
  v_fmamk_f32 v183, v50, 0x424c0000, v51
  v_cvt_pk_bf16_f32 v83, v78, v79
  v_cos_f32 v176, v180
  s_add_u32 s28, s39, s36
  s_lshl_b32 s28, s28, 10
  buffer_store_dwordx4 v[80:83], v7, s[4:7], s28 offen offset:0 sc1
  s_cmp_eq_u32 s18, 5
  s_cbranch_scc0 L_aok_86
  s_waitcnt vmcnt(11)
  s_add_u32 s28, s59, 0
  v_subrev_u32 v232, s28, v232
  v_subrev_u32 v233, s28, v233
  v_subrev_u32 v234, s28, v234
  v_subrev_u32 v235, s28, v235
  v_max_u32 v232, v232, v233
  v_max_u32 v232, v232, v234
  v_max_u32 v232, v232, v235
  v_cmp_ge_u32 vcc, 0, v232
  s_nop 1
  s_cmp_eq_u64 vcc, -1
  s_cbranch_scc1 L_aok_86
  s_mov_b32 s33, 0
L_aspin_87:
  s_mov_b32 s29, 0x33e6000
  buffer_load_dword v232, v3, s[4:7], s29 offen offset:0 sc1
  buffer_load_dword v233, v3, s[4:7], s29 offen offset:1024 sc1
  buffer_load_dword v234, v3, s[4:7], s29 offen offset:2048 sc1
  buffer_load_dword v235, v3, s[4:7], s29 offen offset:3072 sc1
  s_waitcnt vmcnt(0)
  s_add_u32 s28, s59, 0
  v_subrev_u32 v232, s28, v232
  v_subrev_u32 v233, s28, v233
  v_subrev_u32 v234, s28, v234
  v_subrev_u32 v235, s28, v235
  v_max_u32 v232, v232, v233
  v_max_u32 v232, v232, v234
  v_max_u32 v232, v232, v235
  v_cmp_ge_u32 vcc, 0, v232
  s_nop 1
  s_cmp_eq_u64 vcc, -1
  s_cbranch_scc1 L_spinout_88
  s_sleep 8
  s_add_u32 s33, s33, 1
  s_cmp_lt_u32 s33, 0x40000
  s_cbranch_scc1 L_aspin_87
L_spinout_88:
L_aok_86:
  s_waitcnt vmcnt(12)
  s_waitcnt vmcnt(11)
  s_barrier
  v_add_u32 v53, s50, v3
  s_mov_b32 s46, 0x1560000
  s_mov_b32 m0, s51
  s_nop 0
  buffer_load_dwordx4 v53, s[4:7], s46 offen offset:0 sc1 lds
  buffer_load_dwordx4 v53, s[4:7], s46 offen offset:1024 sc1 lds
  buffer_load_dwordx4 v53, s[4:7], s46 offen offset:2048 sc1 lds
  buffer_load_dwordx4 v53, s[4:7], s46 offen offset:3072 sc1 lds
  v_cos_f32 v177, v181
  v_mul_f32 v72, v24, v24
  v_cos_f32 v178, v182
  v_mul_f32 v73, v25, v25
  v_cos_f32 v179, v183
  v_mul_f32 v74, v26, v26
  v_sin_f32 v180, v180
  v_mul_f32 v75, v27, v27
  v_sin_f32 v181, v181
  v_mul_f32 v76, v28, v28
  v_sin_f32 v182, v182
  v_mul_f32 v77, v29, v29
  v_sin_f32 v183, v183
  v_mul_f32 v78, v30, v30
  s_waitcnt vmcnt(11)
  v_mul_f32 v79, v31, v31
  v_mov_b32 v52, 0x7fff7fff
  v_fma_f32 v72, v72, v10, v9
  v_and_b32 v48, v196, v52
  v_fma_f32 v73, v73, v10, v9
  v_and_b32 v49, v197, v52
  v_fma_f32 v74, v74, v10, v9
  v_pk_max_u16 v48, v48, v49
  v_fma_f32 v75, v75, v10, v9
  v_and_b32 v49, v198, v52
  v_fma_f32 v76, v76, v10, v9
  v_pk_max_u16 v48, v48, v49
  v_fma_f32 v77, v77, v10, v9
  v_and_b32 v49, v199, v52
  v_fma_f32 v78, v78, v10, v9
  v_pk_max_u16 v48, v48, v49
  v_fma_f32 v79, v79, v10, v9
  v_and_b32 v49, v200, v52
  v_mul_f32 v72, v24, v72
  v_pk_max_u16 v48, v48, v49
  v_mul_f32 v73, v25, v73
  v_and_b32 v49, v201, v52
  v_mul_f32 v74, v26, v74
  v_pk_max_u16 v48, v48, v49
  v_mul_f32 v75, v27, v75
  v_and_b32 v49, v202, v52
  v_mul_f32 v76, v28, v76
  v_pk_max_u16 v48, v48, v49
  v_mul_f32 v77, v29, v77
  v_and_b32 v49, v203, v52
  v_mul_f32 v78, v30, v78
  v_pk_max_u16 v48, v48, v49
  v_mul_f32 v79, v31, v79
  v_and_b32 v49, v204, v52
  v_exp_f32 v72, v72
  v_pk_max_u16 v48, v48, v49
  v_exp_f32 v73, v73
  v_and_b32 v49, v205, v52
  v_exp_f32 v74, v74
  v_pk_max_u16 v48, v48, v49
  v_exp_f32 v75, v75
  v_and_b32 v49, v206, v52
  v_exp_f32 v76, v76
  v_pk_max_u16 v48, v48, v49
  v_exp_f32 v77, v77
  v_and_b32 v49, v207, v52
  v_exp_f32 v78, v78
  v_pk_max_u16 v48, v48, v49
  v_exp_f32 v79, v79
  v_and_b32 v49, v208, v52
  v_fma_f32 v72, v72, v11, v11
  v_pk_max_u16 v48, v48, v49
  v_fma_f32 v73, v73, v11, v11
  v_and_b32 v49, v209, v52
  v_fma_f32 v74, v74, v11, v11
  v_pk_max_u16 v48, v48, v49
  v_fma_f32 v75, v75, v11, v11
  v_and_b32 v49, v210, v52
  v_fma_f32 v76, v76, v11, v11
  v_pk_max_u16 v48, v48, v49
  v_fma_f32 v77, v77, v11, v11
  v_and_b32 v49, v211, v52
  v_fma_f32 v78, v78, v11, v11
  v_pk_max_u16 v48, v48, v49
  v_fma_f32 v79, v79, v11, v11
  v_lshrrev_b32 v49, 16, v48
  v_rcp_f32 v72, v72
  v_and_b32 v48, 0xffff, v48
  v_rcp_f32 v73, v73
  v_max_u32 v48, v48, v49
  v_rcp_f32 v74, v74
  ds_max_u32 v15, v48
  v_rcp_f32 v75, v75
  v_mov_b32 v49, 1
  v_rcp_f32 v76, v76
  ds_write_b32 v13, v49
  v_rcp_f32 v77, v77
  s_waitcnt vmcnt(7)
  v_rcp_f32 v78, v78
  v_and_b32 v12, 1, v1
  v_rcp_f32 v79, v79
  v_mov_b32 v52, 0xffff
  v_mul_f32 v72, v24, v72
  v_mul_u32_u24 v12, 0x8000, v12
  v_mul_f32 v73, v25, v73
  v_lshl_or_b32 v12, v12, 16, v12
  v_mul_f32 v74, v26, v74
  v_bfi_b32 v104, v52, v88, v92
  v_mul_f32 v75, v27, v75
  v_bfi_b32 v108, v52, v92, v88
  v_mul_f32 v76, v28, v76
  v_xor_b32 v108, 0x80000000, v108
  v_mul_f32 v77, v29, v77
  v_xor_b32 v192, 0x80008000, v188
  v_mul_f32 v78, v30, v78
  v_bfi_b32 v105, v52, v89, v93
  v_mul_f32 v79, v31, v79
  v_bfi_b32 v109, v52, v93, v89
  v_cvt_pk_bf16_f32 v84, v72, v73
  v_xor_b32 v105, 0x80008000, v105
  v_cvt_pk_bf16_f32 v85, v74, v75
  v_xor_b32 v109, 0x8000, v109
  v_cvt_pk_bf16_f32 v86, v76, v77
  v_xor_b32 v193, 0x80008000, v189
  v_cvt_pk_bf16_f32 v87, v78, v79
  v_bfi_b32 v106, v52, v90, v94
  s_add_u32 s28, s39, s36
  s_lshl_b32 s28, s28, 10
  buffer_store_dwordx4 v[84:87], v7, s[4:7], s28 offen offset:512 sc1
  v_bfi_b32 v110, v52, v94, v90
  v_xor_b32 v110, 0x80000000, v110
  v_xor_b32 v194, 0x80008000, v190
  v_bfi_b32 v107, v52, v91, v95
  v_bfi_b32 v111, v52, v95, v91
  v_xor_b32 v107, 0x80008000, v107
  v_xor_b32 v111, 0x8000, v111
  v_xor_b32 v195, 0x80008000, v191
  v_xor_b32 v120, 0x80000000, v88
  v_xor_b32 v121, 0x80000000, v89
  v_xor_b32 v122, 0x80000000, v90
  v_xor_b32 v123, 0x80000000, v91
  v_xor_b32 v124, 0x80000000, v92
  v_xor_b32 v125, 0x80000000, v93
  v_xor_b32 v126, 0x80000000, v94
  v_xor_b32 v127, 0x80000000, v95
  v_xor_b32 v136, 0x80000000, v104
  v_xor_b32 v137, 0x80000000, v105
  v_xor_b32 v138, 0x80000000, v106
  v_xor_b32 v139, 0x80000000, v107
  v_xor_b32 v140, 0x80000000, v108
  v_xor_b32 v141, 0x80000000, v109
  v_xor_b32 v142, 0x80000000, v110
  v_xor_b32 v143, 0x80000000, v111
  v_xor_b32 v96, v12, v88
  v_xor_b32 v97, v12, v89
  v_xor_b32 v98, v12, v90
  v_xor_b32 v99, v12, v91
  v_xor_b32 v100, v12, v92
  v_xor_b32 v101, v12, v93
  v_xor_b32 v102, v12, v94
  v_xor_b32 v103, v12, v95
  v_xor_b32 v112, v12, v104
  v_xor_b32 v113, v12, v105
  v_xor_b32 v114, v12, v106
  v_xor_b32 v115, v12, v107
  v_xor_b32 v116, v12, v108
  v_xor_b32 v117, v12, v109
  v_xor_b32 v118, v12, v110
  v_xor_b32 v119, v12, v111
  v_xor_b32 v128, v12, v120
  v_xor_b32 v129, v12, v121
  v_xor_b32 v130, v12, v122
  v_xor_b32 v131, v12, v123
  v_xor_b32 v132, v12, v124
  v_xor_b32 v133, v12, v125
  v_xor_b32 v134, v12, v126
  v_xor_b32 v135, v12, v127
  v_xor_b32 v144, v12, v136
  v_xor_b32 v145, v12, v137
  v_xor_b32 v146, v12, v138
  v_xor_b32 v147, v12, v139
  v_xor_b32 v148, v12, v140
  v_xor_b32 v149, v12, v141
  v_xor_b32 v150, v12, v142
  v_xor_b32 v151, v12, v143
  s_lshr_b32 s26, s17, 2
  s_and_b32 s27, s17, 3
  s_mul_i32 s24, s26, 9
  s_add_u32 s24, s24, 1
  s_lshr_b32 s24, s24, 1
  s_and_b32 s25, s26, 1
  v_lshrrev_b32 v6, 4, v1
  s_and_b32 s28, s19, 1
  s_lshl_b32 s28, s28, 2
  v_add_u32 v5, s28, v6
  v_lshlrev_b32 v5, 1, v5
  v_and_b32 v7, 15, v1
  v_xor_b32 v5, v5, v7
  v_lshlrev_b32 v5, 4, v5
  v_lshl_add_u32 v4, v6, 12, v5
  v_mov_b32 v6, 0
  s_lshl_b32 s37, s24, 5
  s_lshl_b32 s28, s19, 2
  s_add_u32 s37, s37, s28
  s_lshl_b32 s37, s37, 12
  s_lshl_b32 s28, s16, 8
  s_add_u32 s37, s37, s28
  s_add_u32 s37, s37, 0x17a0000
  s_and_b32 s28, s2, 63
  v_and_b32 v5, 3, v1
  v_lshlrev_b32 v5, 6, v5
  v_add_u32 v5, s28, v5
  v_lshlrev_b32 v5, 4, v5
  v_add_u32 v5, 0x33e4004, v5
  s_lshl_b32 s38, s19, 10
  s_mul_i32 s34, s26, 1327104
  s_mul_i32 s28, s27, 9216
  s_add_u32 s28, s28, s38
  s_add_u32 s34, s34, s28
  s_add_u32 s34, s34, 0x1c22000
  s_add_u32 s35, s28, 0x2132000
  s_lshl_b32 s36, s16, 3
  s_add_u32 s36, s36, s19
  s_mul_i32 s36, s36, 144
  s_mul_i32 s28, s26, 36
  s_add_u32 s36, s36, s28
  s_lshl_b32 s36, s36, 10
  s_add_u32 s36, s36, 0x360000
  s_lshl_b32 s96, s96, 1
  s_add_u32 s28, s27, 0
  s_and_b32 s28, s28, 3
  s_mul_i32 s12, s28, 9
  s_and_b32 s28, s28, 1
  s_add_u32 s92, s12, s28
  s_cmp_eq_u32 s28, 0
  s_cselect_b32 s28, 8, 0
  s_add_u32 s12, s12, s28
  s_add_u32 s28, s27, 1
  s_and_b32 s28, s28, 3
  s_mul_i32 s13, s28, 9
  s_and_b32 s28, s28, 1
  s_add_u32 s93, s13, s28
  s_cmp_eq_u32 s28, 0
  s_cselect_b32 s28, 8, 0
  s_add_u32 s13, s13, s28
  s_add_u32 s28, s27, 2
  s_and_b32 s28, s28, 3
  s_mul_i32 s14, s28, 9
  s_and_b32 s28, s28, 1
  s_add_u32 s94, s14, s28
  s_cmp_eq_u32 s28, 0
  s_cselect_b32 s28, 8, 0
  s_add_u32 s14, s14, s28
  s_add_u32 s28, s27, 3
  s_and_b32 s28, s28, 3
  s_mul_i32 s15, s28, 9
  s_and_b32 s28, s28, 1
  s_add_u32 s95, s15, s28
  s_cmp_eq_u32 s28, 0
  s_cselect_b32 s28, 8, 0
  s_add_u32 s15, s15, s28
  s_mul_i32 s28, s24, 36864
  s_add_u32 s35, s35, s28
  buffer_load_dword v2, v5, s[4:7], 0 offen sc1
  v_lshrrev_b32 v85, 4, v1
  v_bfe_u32 v86, v1, 2, 2
  v_lshl_add_u32 v86, v85, 3, v86
  v_lshlrev_b32 v80, 7, v86
  v_and_b32 v86, 3, v1
  v_lshl_add_u32 v80, v86, 3, v80
  v_add_u32 v81, s49, v80
  v_add_u32 v80, s48, v80
  s_waitcnt vmcnt(2)
  v_mov_b32 v87, 2
  ds_write_b32 v13, v87
  s_mov_b32 s33, 0
L_pw_89:
  ds_read_b32 v87, v14
  s_waitcnt lgkmcnt(0)
  v_readfirstlane_b32 s28, v87
  s_cmp_ge_u32 s28, 2
  s_cbranch_scc1 L_spinout_90
  s_add_u32 s33, s33, 1
  s_cmp_lt_u32 s33, 0x40000
  s_cbranch_scc1 L_pw_89
L_spinout_90:
  ds_read_b32 v85, v15
  ds_read_b64_tr_b16 v[212:213], v80 offset:0
  ds_read_b64_tr_b16 v[214:215], v80 offset:512
  ds_read_b64_tr_b16 v[216:217], v81 offset:0
  ds_read_b64_tr_b16 v[218:219], v81 offset:512
  ds_read_b64_tr_b16 v[220:221], v80 offset:32
  ds_read_b64_tr_b16 v[222:223], v80 offset:544
  ds_read_b64_tr_b16 v[224:225], v81 offset:32
  ds_read_b64_tr_b16 v[226:227], v81 offset:544
  ds_read_b64_tr_b16 v[228:229], v80 offset:64
  ds_read_b64_tr_b16 v[230:231], v80 offset:576
  ds_read_b64_tr_b16 v[232:233], v81 offset:64
  ds_read_b64_tr_b16 v[234:235], v81 offset:576
  ds_read_b64_tr_b16 v[236:237], v80 offset:96
  ds_read_b64_tr_b16 v[238:239], v80 offset:608
  ds_read_b64_tr_b16 v[240:241], v81 offset:96
  ds_read_b64_tr_b16 v[242:243], v81 offset:608
  s_waitcnt lgkmcnt(0)
  v_mov_b32 v87, 3
  ds_write_b32 v13, v87
  v_mfma_f32_16x16x32_f16 v[16:19], v[212:215], v[184:187], 0
  v_lshrrev_b32 v85, 7, v85
  v_mfma_f32_16x16x32_f16 v[20:23], v[212:215], v[188:191], 0
  v_sub_u32 v15, 247, v85
  v_mfma_f32_16x16x32_f16 v[16:19], v[216:219], v[192:195], v[16:19]
  v_max_i32 v15, 1, v15
  v_mfma_f32_16x16x32_f16 v[20:23], v[216:219], v[184:187], v[20:23]
  v_lshlrev_b32 v15, 23, v15
  v_mfma_f32_16x16x32_f16 v[24:27], v[220:223], v[184:187], 0
  v_subrev_u32 v85, 126, v85
  v_mfma_f32_16x16x32_f16 v[28:31], v[220:223], v[188:191], 0
  v_mov_b32 v84, 0x3c2aaaab
  v_mfma_f32_16x16x32_f16 v[24:27], v[224:227], v[192:195], v[24:27]
  v_ldexp_f32 v84, v84, v85
  v_mfma_f32_16x16x32_f16 v[28:31], v[224:227], v[184:187], v[28:31]
  v_mfma_f32_16x16x32_f16 v[32:35], v[228:231], v[184:187], 0
  v_mfma_f32_16x16x32_f16 v[36:39], v[228:231], v[188:191], 0
  v_mfma_f32_16x16x32_f16 v[32:35], v[232:235], v[192:195], v[32:35]
  v_mfma_f32_16x16x32_f16 v[36:39], v[232:235], v[184:187], v[36:39]
  v_mfma_f32_16x16x32_f16 v[40:43], v[236:239], v[184:187], 0
  v_mfma_f32_16x16x32_f16 v[44:47], v[236:239], v[188:191], 0
  v_mfma_f32_16x16x32_f16 v[40:43], v[240:243], v[192:195], v[40:43]
  v_mfma_f32_16x16x32_f16 v[44:47], v[240:243], v[184:187], v[44:47]
  v_mul_f32 v72, v20, v156
  v_mul_f32 v73, v16, v156
  v_fma_f32 v16, v16, v152, -v72
  v_fma_f32 v20, v20, v152, v73
  v_mul_f32 v74, v21, v157
  v_mul_f32 v75, v17, v157
  v_fma_f32 v17, v17, v153, -v74
  v_fma_f32 v21, v21, v153, v75
  v_mul_f32 v76, v22, v158
  v_mul_f32 v77, v18, v158
  v_fma_f32 v18, v18, v154, -v76
  v_fma_f32 v22, v22, v154, v77
  v_mul_f32 v78, v23, v159
  v_mul_f32 v79, v19, v159
  v_fma_f32 v19, v19, v155, -v78
  v_fma_f32 v23, v23, v155, v79
  v_mul_f32 v72, v28, v164
  v_mul_f32 v73, v24, v164
  v_fma_f32 v24, v24, v160, -v72
  v_fma_f32 v28, v28, v160, v73
  v_mul_f32 v74, v29, v165
  v_mul_f32 v75, v25, v165
  v_fma_f32 v25, v25, v161, -v74
  v_fma_f32 v29, v29, v161, v75
  v_mul_f32 v76, v30, v166
  v_mul_f32 v77, v26, v166
  v_fma_f32 v26, v26, v162, -v76
  v_fma_f32 v30, v30, v162, v77
  v_mul_f32 v78, v31, v167
  v_mul_f32 v79, v27, v167
  v_fma_f32 v27, v27, v163, -v78
  v_fma_f32 v31, v31, v163, v79
  v_mul_f32 v72, v36, v172
  v_mul_f32 v73, v32, v172
  v_fma_f32 v32, v32, v168, -v72
  v_fma_f32 v36, v36, v168, v73
  v_mul_f32 v74, v37, v173
  v_mul_f32 v75, v33, v173
  v_fma_f32 v33, v33, v169, -v74
  v_fma_f32 v37, v37, v169, v75
  v_mul_f32 v76, v38, v174
  v_mul_f32 v77, v34, v174
  v_fma_f32 v34, v34, v170, -v76
  v_fma_f32 v38, v38, v170, v77
  v_mul_f32 v78, v39, v175
  v_mul_f32 v79, v35, v175
  v_fma_f32 v35, v35, v171, -v78
  v_fma_f32 v39, v39, v171, v79
  v_mul_f32 v72, v44, v180
  v_mul_f32 v73, v40, v180
  v_fma_f32 v40, v40, v176, -v72
  v_fma_f32 v44, v44, v176, v73
  v_mul_f32 v74, v45, v181
  v_mul_f32 v75, v41, v181
  v_fma_f32 v41, v41, v177, -v74
  v_fma_f32 v45, v45, v177, v75
  v_mul_f32 v76, v46, v182
  v_mul_f32 v77, v42, v182
  v_fma_f32 v42, v42, v178, -v76
  v_fma_f32 v46, v46, v178, v77
  v_mul_f32 v78, v47, v183
  v_mul_f32 v79, v43, v183
  v_fma_f32 v43, v43, v179, -v78
  v_fma_f32 v47, v47, v179, v79
  v_cvt_pk_f16_f32 v48, v16, v17
  v_cvt_pk_f16_f32 v56, v20, v21
  v_cvt_pk_f16_f32 v64, -v20, -v21
  v_cvt_pk_f16_f32 v49, v18, v19
  v_cvt_pk_f16_f32 v57, v22, v23
  v_cvt_pk_f16_f32 v65, -v22, -v23
  v_cvt_pk_f16_f32 v50, v24, v25
  v_cvt_pk_f16_f32 v58, v28, v29
  v_cvt_pk_f16_f32 v66, -v28, -v29
  v_cvt_pk_f16_f32 v51, v26, v27
  v_cvt_pk_f16_f32 v59, v30, v31
  v_cvt_pk_f16_f32 v67, -v30, -v31
  v_cvt_pk_f16_f32 v52, v32, v33
  v_cvt_pk_f16_f32 v60, v36, v37
  v_cvt_pk_f16_f32 v68, -v36, -v37
  v_cvt_pk_f16_f32 v53, v34, v35
  v_cvt_pk_f16_f32 v61, v38, v39
  v_cvt_pk_f16_f32 v69, -v38, -v39
  v_cvt_pk_f16_f32 v54, v40, v41
  v_cvt_pk_f16_f32 v62, v44, v45
  v_cvt_pk_f16_f32 v70, -v44, -v45
  v_cvt_pk_f16_f32 v55, v42, v43
  v_cvt_pk_f16_f32 v63, v46, v47
  v_cvt_pk_f16_f32 v71, -v46, -v47
  s_nop 0
  v_mfma_f32_16x16x32_f16 v[16:19], v[88:91], v[48:51], 0
  v_lshlrev_b32 v212, 16, v196
  v_and_b32 v216, 0xffff0000, v196
  v_mfma_f32_16x16x32_f16 v[20:23], v[92:95], v[48:51], 0
  v_lshlrev_b32 v213, 16, v197
  v_and_b32 v217, 0xffff0000, v197
  v_mfma_f32_16x16x32_f16 v[24:27], v[104:107], v[48:51], 0
  v_lshlrev_b32 v214, 16, v198
  v_and_b32 v218, 0xffff0000, v198
  v_mfma_f32_16x16x32_f16 v[28:31], v[108:111], v[48:51], 0
  v_lshlrev_b32 v215, 16, v199
  v_and_b32 v219, 0xffff0000, v199
  v_mfma_f32_16x16x32_f16 v[32:35], v[120:123], v[48:51], 0
  v_mul_f32 v212, v212, v15
  v_mul_f32 v213, v213, v15
  v_mfma_f32_16x16x32_f16 v[36:39], v[124:127], v[48:51], 0
  v_mul_f32 v214, v214, v15
  v_mul_f32 v215, v215, v15
  v_mfma_f32_16x16x32_f16 v[40:43], v[136:139], v[48:51], 0
  v_mul_f32 v216, v216, v15
  v_mul_f32 v217, v217, v15
  v_mfma_f32_16x16x32_f16 v[44:47], v[140:143], v[48:51], 0
  v_mul_f32 v218, v218, v15
  v_mul_f32 v219, v219, v15
  v_mfma_f32_16x16x32_f16 v[16:19], v[92:95], v[64:67], v[16:19]
  v_lshlrev_b32 v220, 16, v200
  v_and_b32 v224, 0xffff0000, v200
  v_mfma_f32_16x16x32_f16 v[20:23], v[88:91], v[56:59], v[20:23]
  v_lshlrev_b32 v221, 16, v201
  v_and_b32 v225, 0xffff0000, v201
  v_mfma_f32_16x16x32_f16 v[24:27], v[108:111], v[64:67], v[24:27]
  v_lshlrev_b32 v222, 16, v202
  v_and_b32 v226, 0xffff0000, v202
  v_mfma_f32_16x16x32_f16 v[28:31], v[104:107], v[56:59], v[28:31]
  v_lshlrev_b32 v223, 16, v203
  v_and_b32 v227, 0xffff0000, v203
  v_mfma_f32_16x16x32_f16 v[32:35], v[124:127], v[64:67], v[32:35]
  v_mul_f32 v220, v220, v15
  v_mul_f32 v221, v221, v15
  v_mfma_f32_16x16x32_f16 v[36:39], v[120:123], v[56:59], v[36:39]
  v_mul_f32 v222, v222, v15
  v_mul_f32 v223, v223, v15
  v_mfma_f32_16x16x32_f16 v[40:43], v[140:143], v[64:67], v[40:43]
  v_mul_f32 v224, v224, v15
  v_mul_f32 v225, v225, v15
  v_mfma_f32_16x16x32_f16 v[44:47], v[136:139], v[56:59], v[44:47]
  v_mul_f32 v226, v226, v15
  v_mul_f32 v227, v227, v15
  v_mfma_f32_16x16x32_f16 v[16:19], v[96:99], v[52:55], v[16:19]
  v_lshlrev_b32 v228, 16, v204
  v_and_b32 v232, 0xffff0000, v204
  v_mfma_f32_16x16x32_f16 v[20:23], v[100:103], v[52:55], v[20:23]
  v_lshlrev_b32 v229, 16, v205
  v_and_b32 v233, 0xffff0000, v205
  v_mfma_f32_16x16x32_f16 v[24:27], v[112:115], v[52:55], v[24:27]
  v_lshlrev_b32 v230, 16, v206
  v_and_b32 v234, 0xffff0000, v206
  v_mfma_f32_16x16x32_f16 v[28:31], v[116:119], v[52:55], v[28:31]
  v_lshlrev_b32 v231, 16, v207
  v_and_b32 v235, 0xffff0000, v207
  v_mfma_f32_16x16x32_f16 v[32:35], v[128:131], v[52:55], v[32:35]
  v_mul_f32 v228, v228, v15
  v_mul_f32 v229, v229, v15
  v_mfma_f32_16x16x32_f16 v[36:39], v[132:135], v[52:55], v[36:39]
  v_mul_f32 v230, v230, v15
  v_mul_f32 v231, v231, v15
  v_mfma_f32_16x16x32_f16 v[40:43], v[144:147], v[52:55], v[40:43]
  v_mul_f32 v232, v232, v15
  v_mul_f32 v233, v233, v15
  v_mfma_f32_16x16x32_f16 v[44:47], v[148:151], v[52:55], v[44:47]
  v_mul_f32 v234, v234, v15
  v_mul_f32 v235, v235, v15
  v_mfma_f32_16x16x32_f16 v[16:19], v[100:103], v[68:71], v[16:19]
  v_lshlrev_b32 v236, 16, v208
  v_and_b32 v240, 0xffff0000, v208
  v_mfma_f32_16x16x32_f16 v[20:23], v[96:99], v[60:63], v[20:23]
  v_lshlrev_b32 v237, 16, v209
  v_and_b32 v241, 0xffff0000, v209
  v_mfma_f32_16x16x32_f16 v[24:27], v[116:119], v[68:71], v[24:27]
  v_lshlrev_b32 v238, 16, v210
  v_and_b32 v242, 0xffff0000, v210
  v_mfma_f32_16x16x32_f16 v[28:31], v[112:115], v[60:63], v[28:31]
  v_lshlrev_b32 v239, 16, v211
  v_and_b32 v243, 0xffff0000, v211
  v_mfma_f32_16x16x32_f16 v[32:35], v[132:135], v[68:71], v[32:35]
  v_mul_f32 v236, v236, v15
  v_mul_f32 v237, v237, v15
  v_mfma_f32_16x16x32_f16 v[36:39], v[128:131], v[60:63], v[36:39]
  v_mul_f32 v238, v238, v15
  v_mul_f32 v239, v239, v15
  v_mfma_f32_16x16x32_f16 v[40:43], v[148:151], v[68:71], v[40:43]
  v_mul_f32 v240, v240, v15
  v_mul_f32 v241, v241, v15
  v_mfma_f32_16x16x32_f16 v[44:47], v[144:147], v[60:63], v[44:47]
  v_mul_f32 v242, v242, v15
  v_mul_f32 v243, v243, v15
  s_waitcnt vmcnt(0)
  v_mov_b32 v9, 151524
  v_mov_b32 v8, 1
  s_mov_b64 exec, 1
  ds_add_rtn_u32 v8, v9, v8
  s_waitcnt lgkmcnt(0)
  s_mov_b64 exec, -1
  v_readfirstlane_b32 s28, v8
  s_cmp_eq_u32 s28, 7
  s_cbranch_scc0 L_hnl_91
  s_add_u32 s28, s59, 3
  v_mov_b32 v253, 4
  v_mov_b32 v254, s28
  s_mov_b64 exec, 1
  buffer_store_dword v254, v253, s[4:7], s101 offen sc1
  s_mov_b64 exec, -1
L_hnl_91:
  s_add_u32 s32, s96, 0
  s_and_b32 s32, s32, 7
  s_add_u32 s32, s32, s92
  s_mul_i32 s31, s32, 36864
  s_add_u32 s31, s31, s34
  s_lshl_b32 s32, s32, 10
  s_add_u32 s32, s32, s36
  s_cmp_eq_u32 s19, 0
  s_cbranch_scc0 L_skip_92
  s_add_u32 m0, s38, 8192
  s_add_u32 s30, s31, 8192
  buffer_load_dwordx4 v3, s[4:7], s30 offen sc1 lds
L_skip_92:
  s_add_u32 m0, s38, 0
  s_add_u32 s30, s31, 0
  buffer_load_dwordx4 v3, s[4:7], s30 offen sc1 lds
  s_add_u32 m0, s38, 4096
  s_add_u32 s30, s31, 4096
  buffer_load_dwordx4 v3, s[4:7], s30 offen sc1 lds
  s_add_u32 m0, s38, 9216
  s_add_u32 s30, s32, 0
  buffer_load_dwordx4 v3, s[4:7], s30 offen sc1 lds
  s_add_u32 m0, s38, 13312
  s_add_u32 s30, s32, 589824
  buffer_load_dwordx4 v3, s[4:7], s30 offen sc1 lds
  s_add_u32 s32, s96, 1
  s_and_b32 s32, s32, 7
  s_add_u32 s32, s32, s92
  s_mul_i32 s31, s32, 36864
  s_add_u32 s31, s31, s34
  s_lshl_b32 s32, s32, 10
  s_add_u32 s32, s32, s36
  s_cmp_eq_u32 s19, 0
  s_cbranch_scc0 L_skip_93
  s_add_u32 m0, s38, 25600
  s_add_u32 s30, s31, 8192
  buffer_load_dwordx4 v3, s[4:7], s30 offen sc1 lds
L_skip_93:
  s_add_u32 m0, s38, 17408
  s_add_u32 s30, s31, 0
  buffer_load_dwordx4 v3, s[4:7], s30 offen sc1 lds
  s_add_u32 m0, s38, 21504
  s_add_u32 s30, s31, 4096
  buffer_load_dwordx4 v3, s[4:7], s30 offen sc1 lds
  s_add_u32 m0, s38, 26624
  s_add_u32 s30, s32, 0
  buffer_load_dwordx4 v3, s[4:7], s30 offen sc1 lds
  s_add_u32 m0, s38, 30720
  s_add_u32 s30, s32, 589824
  buffer_load_dwordx4 v3, s[4:7], s30 offen sc1 lds
  s_add_u32 s32, s96, 2
  s_and_b32 s32, s32, 7
  s_add_u32 s32, s32, s92
  s_mul_i32 s31, s32, 36864
  s_add_u32 s31, s31, s34
  s_lshl_b32 s32, s32, 10
  s_add_u32 s32, s32, s36
  s_cmp_eq_u32 s19, 0
  s_cbranch_scc0 L_skip_94
  s_add_u32 m0, s38, 43008
  s_add_u32 s30, s31, 8192
  buffer_load_dwordx4 v3, s[4:7], s30 offen sc1 lds
L_skip_94:
  s_add_u32 m0, s38, 34816
  s_add_u32 s30, s31, 0
  buffer_load_dwordx4 v3, s[4:7], s30 offen sc1 lds
  s_add_u32 m0, s38, 38912
  s_add_u32 s30, s31, 4096
  buffer_load_dwordx4 v3, s[4:7], s30 offen sc1 lds
  s_add_u32 m0, s38, 44032
  s_add_u32 s30, s32, 0
  buffer_load_dwordx4 v3, s[4:7], s30 offen sc1 lds
  s_add_u32 m0, s38, 48128
  s_add_u32 s30, s32, 589824
  buffer_load_dwordx4 v3, s[4:7], s30 offen sc1 lds
  s_add_u32 s32, s96, 3
  s_and_b32 s32, s32, 7
  s_add_u32 s32, s32, s92
  s_mul_i32 s31, s32, 36864
  s_add_u32 s31, s31, s34
  s_lshl_b32 s32, s32, 10
  s_add_u32 s32, s32, s36
  s_cmp_eq_u32 s19, 0
  s_cbranch_scc0 L_skip_95
  s_add_u32 m0, s38, 60416
  s_add_u32 s30, s31, 8192
  buffer_load_dwordx4 v3, s[4:7], s30 offen sc1 lds
L_skip_95:
  s_add_u32 m0, s38, 52224
  s_add_u32 s30, s31, 0
  buffer_load_dwordx4 v3, s[4:7], s30 offen sc1 lds
  s_add_u32 m0, s38, 56320
  s_add_u32 s30, s31, 4096
  buffer_load_dwordx4 v3, s[4:7], s30 offen sc1 lds
  s_add_u32 m0, s38, 61440
  s_add_u32 s30, s32, 0
  buffer_load_dwordx4 v3, s[4:7], s30 offen sc1 lds
  s_add_u32 m0, s38, 65536
  s_add_u32 s30, s32, 589824
  buffer_load_dwordx4 v3, s[4:7], s30 offen sc1 lds
  v_mul_f32 v72, v20, v216
  v_mul_f32 v73, v16, v216
  v_fma_f32 v16, v16, v212, -v72
  v_fma_f32 v20, v20, v212, v73
  v_mul_f32 v74, v21, v217
  v_mul_f32 v75, v17, v217
  v_fma_f32 v17, v17, v213, -v74
  v_fma_f32 v21, v21, v213, v75
  v_mul_f32 v76, v22, v218
  v_mul_f32 v77, v18, v218
  v_fma_f32 v18, v18, v214, -v76
  v_fma_f32 v22, v22, v214, v77
  v_mul_f32 v78, v23, v219
  v_mul_f32 v79, v19, v219
  v_fma_f32 v19, v19, v215, -v78
  v_fma_f32 v23, v23, v215, v79
  v_mul_f32 v72, v28, v224
  v_mul_f32 v73, v24, v224
  v_fma_f32 v24, v24, v220, -v72
  v_fma_f32 v28, v28, v220, v73
  v_mul_f32 v74, v29, v225
  v_mul_f32 v75, v25, v225
  v_fma_f32 v25, v25, v221, -v74
  v_fma_f32 v29, v29, v221, v75
  v_mul_f32 v76, v30, v226
  v_mul_f32 v77, v26, v226
  v_fma_f32 v26, v26, v222, -v76
  v_fma_f32 v30, v30, v222, v77
  v_mul_f32 v78, v31, v227
  v_mul_f32 v79, v27, v227
  v_fma_f32 v27, v27, v223, -v78
  v_fma_f32 v31, v31, v223, v79
  v_mul_f32 v72, v36, v232
  v_mul_f32 v73, v32, v232
  v_fma_f32 v32, v32, v228, -v72
  v_fma_f32 v36, v36, v228, v73
  v_mul_f32 v74, v37, v233
  v_mul_f32 v75, v33, v233
  v_fma_f32 v33, v33, v229, -v74
  v_fma_f32 v37, v37, v229, v75
  v_mul_f32 v76, v38, v234
  v_mul_f32 v77, v34, v234
  v_fma_f32 v34, v34, v230, -v76
  v_fma_f32 v38, v38, v230, v77
  v_mul_f32 v78, v39, v235
  v_mul_f32 v79, v35, v235
  v_fma_f32 v35, v35, v231, -v78
  v_fma_f32 v39, v39, v231, v79
  v_mul_f32 v72, v44, v240
  v_mul_f32 v73, v40, v240
  v_fma_f32 v40, v40, v236, -v72
  v_fma_f32 v44, v44, v236, v73
  v_mul_f32 v74, v45, v241
  v_mul_f32 v75, v41, v241
  v_fma_f32 v41, v41, v237, -v74
  v_fma_f32 v45, v45, v237, v75
  v_mul_f32 v76, v46, v242
  v_mul_f32 v77, v42, v242
  v_fma_f32 v42, v42, v238, -v76
  v_fma_f32 v46, v46, v238, v77
  v_mul_f32 v78, v47, v243
  v_mul_f32 v79, v43, v243
  v_fma_f32 v43, v43, v239, -v78
  v_fma_f32 v47, v47, v239, v79
  v_cvt_pk_f16_f32 v48, v16, v17
  v_cvt_pk_f16_f32 v56, v20, v21
  v_cvt_pk_f16_f32 v64, -v16, -v17
  v_cvt_pk_f16_f32 v49, v18, v19
  v_cvt_pk_f16_f32 v57, v22, v23
  v_cvt_pk_f16_f32 v65, -v18, -v19
  v_cvt_pk_f16_f32 v50, v24, v25
  v_cvt_pk_f16_f32 v58, v28, v29
  v_cvt_pk_f16_f32 v66, -v24, -v25
  v_cvt_pk_f16_f32 v51, v26, v27
  v_cvt_pk_f16_f32 v59, v30, v31
  v_cvt_pk_f16_f32 v67, -v26, -v27
  v_cvt_pk_f16_f32 v52, v32, v33
  v_cvt_pk_f16_f32 v60, v36, v37
  v_cvt_pk_f16_f32 v68, -v32, -v33
  v_cvt_pk_f16_f32 v53, v34, v35
  v_cvt_pk_f16_f32 v61, v38, v39
  v_cvt_pk_f16_f32 v69, -v34, -v35
  v_cvt_pk_f16_f32 v54, v40, v41
  v_cvt_pk_f16_f32 v62, v44, v45
  v_cvt_pk_f16_f32 v70, -v40, -v41
  v_cvt_pk_f16_f32 v55, v42, v43
  v_cvt_pk_f16_f32 v63, v46, v47
  v_cvt_pk_f16_f32 v71, -v42, -v43
  s_nop 0
  v_mfma_f32_16x16x32_f16 v[16:19], v[48:51], v[88:91], 0
  v_and_b32 v85, 15, v1
  v_cvt_f32_u32 v85, v85
  v_mfma_f32_16x16x32_f16 v[20:23], v[56:59], v[88:91], 0
  v_mul_f32 v85, 0x3a000000, v85
  v_lshrrev_b32 v86, 4, v1
  v_mfma_f32_16x16x32_f16 v[24:27], v[48:51], v[104:107], 0
  v_lshlrev_b32 v86, 2, v86
  s_lshl_b32 s46, s52, 4
  v_mfma_f32_16x16x32_f16 v[28:31], v[56:59], v[104:107], 0
  v_add_u32 v86, s46, v86
  v_cvt_f32_u32 v86, v86
  v_mfma_f32_16x16x32_f16 v[32:35], v[48:51], v[120:123], 0
  v_mul_f32 v156, v85, v86
  v_fmamk_f32 v157, v85, 0x3f800000, v156
  v_mfma_f32_16x16x32_f16 v[36:39], v[56:59], v[120:123], 0
  v_fmamk_f32 v158, v85, 0x40000000, v156
  v_fmamk_f32 v159, v85, 0x40400000, v156
  v_mfma_f32_16x16x32_f16 v[40:43], v[48:51], v[136:139], 0
  v_cos_f32 v152, v156
  v_cos_f32 v153, v157
  v_mfma_f32_16x16x32_f16 v[44:47], v[56:59], v[136:139], 0
  v_cos_f32 v154, v158
  v_cos_f32 v155, v159
  v_mfma_f32_16x16x32_f16 v[16:19], v[56:59], v[92:95], v[16:19]
  v_sin_f32 v156, v156
  v_sin_f32 v157, v157
  v_mfma_f32_16x16x32_f16 v[20:23], v[64:67], v[92:95], v[20:23]
  v_sin_f32 v158, v158
  v_sin_f32 v159, v159
  v_mfma_f32_16x16x32_f16 v[24:27], v[56:59], v[108:111], v[24:27]
  v_add_f32 v85, 0x3c000000, v85
  v_mul_f32 v164, v85, v86
  v_mfma_f32_16x16x32_f16 v[28:31], v[64:67], v[108:111], v[28:31]
  v_fmamk_f32 v165, v85, 0x3f800000, v164
  v_fmamk_f32 v166, v85, 0x40000000, v164
  v_mfma_f32_16x16x32_f16 v[32:35], v[56:59], v[124:127], v[32:35]
  v_fmamk_f32 v167, v85, 0x40400000, v164
  v_cos_f32 v160, v164
  v_mfma_f32_16x16x32_f16 v[36:39], v[64:67], v[124:127], v[36:39]
  v_cos_f32 v161, v165
  v_cos_f32 v162, v166
  v_mfma_f32_16x16x32_f16 v[40:43], v[56:59], v[140:143], v[40:43]
  v_cos_f32 v163, v167
  v_sin_f32 v164, v164
  v_mfma_f32_16x16x32_f16 v[44:47], v[64:67], v[140:143], v[44:47]
  v_sin_f32 v165, v165
  v_sin_f32 v166, v166
  v_mfma_f32_16x16x32_f16 v[16:19], v[52:55], v[96:99], v[16:19]
  v_sin_f32 v167, v167
  v_add_f32 v85, 0x3c000000, v85
  v_mfma_f32_16x16x32_f16 v[20:23], v[60:63], v[96:99], v[20:23]
  v_mul_f32 v172, v85, v86
  v_fmamk_f32 v173, v85, 0x3f800000, v172
  v_mfma_f32_16x16x32_f16 v[24:27], v[52:55], v[112:115], v[24:27]
  v_fmamk_f32 v174, v85, 0x40000000, v172
  v_fmamk_f32 v175, v85, 0x40400000, v172
  v_mfma_f32_16x16x32_f16 v[28:31], v[60:63], v[112:115], v[28:31]
  v_cos_f32 v168, v172
  v_cos_f32 v169, v173
  v_mfma_f32_16x16x32_f16 v[32:35], v[52:55], v[128:131], v[32:35]
  v_cos_f32 v170, v174
  v_cos_f32 v171, v175
  v_mfma_f32_16x16x32_f16 v[36:39], v[60:63], v[128:131], v[36:39]
  v_sin_f32 v172, v172
  v_sin_f32 v173, v173
  v_mfma_f32_16x16x32_f16 v[40:43], v[52:55], v[144:147], v[40:43]
  v_sin_f32 v174, v174
  v_sin_f32 v175, v175
  v_mfma_f32_16x16x32_f16 v[44:47], v[60:63], v[144:147], v[44:47]
  v_add_f32 v85, 0x3c000000, v85
  v_mul_f32 v180, v85, v86
  v_mfma_f32_16x16x32_f16 v[16:19], v[60:63], v[100:103], v[16:19]
  v_fmamk_f32 v181, v85, 0x3f800000, v180
  v_fmamk_f32 v182, v85, 0x40000000, v180
  v_mfma_f32_16x16x32_f16 v[20:23], v[68:71], v[100:103], v[20:23]
  v_fmamk_f32 v183, v85, 0x40400000, v180
  v_cos_f32 v176, v180
  v_mfma_f32_16x16x32_f16 v[24:27], v[60:63], v[116:119], v[24:27]
  v_cos_f32 v177, v181
  v_cos_f32 v178, v182
  v_mfma_f32_16x16x32_f16 v[28:31], v[68:71], v[116:119], v[28:31]
  v_cos_f32 v179, v183
  v_mfma_f32_16x16x32_f16 v[32:35], v[60:63], v[132:135], v[32:35]
  v_sin_f32 v180, v180
  v_mfma_f32_16x16x32_f16 v[36:39], v[68:71], v[132:135], v[36:39]
  v_sin_f32 v181, v181
  v_mfma_f32_16x16x32_f16 v[40:43], v[60:63], v[148:151], v[40:43]
  v_sin_f32 v182, v182
  v_mfma_f32_16x16x32_f16 v[44:47], v[68:71], v[148:151], v[44:47]
  v_sin_f32 v183, v183
  v_mul_lo_u32 v85, v12, s52
  v_xor_b32 v86, v85, v12
  v_xor_b32 v196, v85, v244
  v_xor_b32 v197, v85, v245
  v_xor_b32 v198, v85, v246
  v_xor_b32 v199, v85, v247
  v_xor_b32 v200, v85, v248
  v_xor_b32 v201, v85, v249
  v_xor_b32 v202, v85, v250
  v_xor_b32 v203, v85, v251
  v_xor_b32 v204, v86, v244
  v_xor_b32 v205, v86, v245
  v_xor_b32 v206, v86, v246
  v_xor_b32 v207, v86, v247
  v_xor_b32 v208, v86, v248
  v_xor_b32 v209, v86, v249
  v_xor_b32 v210, v86, v250
  v_xor_b32 v211, v86, v251
  v_xor_b32 v85, 0x80000000, v85
  v_xor_b32 v184, v85, v244
  v_xor_b32 v185, v85, v245
  v_xor_b32 v186, v85, v246
  v_xor_b32 v187, v85, v247
  v_xor_b32 v188, v85, v248
  v_xor_b32 v189, v85, v249
  v_xor_b32 v190, v85, v250
  v_xor_b32 v191, v85, v251
  v_xor_b32 v86, 0x80000000, v86
  v_xor_b32 v192, v86, v244
  v_xor_b32 v193, v86, v245
  v_xor_b32 v194, v86, v246
  v_xor_b32 v195, v86, v247
  v_xor_b32 v252, v86, v248
  v_xor_b32 v253, v86, v249
  v_xor_b32 v254, v86, v250
  v_xor_b32 v255, v86, v251
  v_mul_f32 v72, v20, v156
  v_mul_f32 v73, v16, v156
  v_fma_f32 v16, v16, v152, -v72
  v_fma_f32 v20, v20, v152, v73
  v_mul_f32 v74, v21, v157
  v_mul_f32 v75, v17, v157
  v_fma_f32 v17, v17, v153, -v74
  v_fma_f32 v21, v21, v153, v75
  v_mul_f32 v76, v22, v158
  v_mul_f32 v77, v18, v158
  v_fma_f32 v18, v18, v154, -v76
  v_fma_f32 v22, v22, v154, v77
  v_mul_f32 v78, v23, v159
  v_mul_f32 v79, v19, v159
  v_fma_f32 v19, v19, v155, -v78
  v_fma_f32 v23, v23, v155, v79
  v_mul_f32 v72, v28, v164
  v_mul_f32 v73, v24, v164
  v_fma_f32 v24, v24, v160, -v72
  v_fma_f32 v28, v28, v160, v73
  v_mul_f32 v74, v29, v165
  v_mul_f32 v75, v25, v165
  v_fma_f32 v25, v25, v161, -v74
  v_fma_f32 v29, v29, v161, v75
  v_mul_f32 v76, v30, v166
  v_mul_f32 v77, v26, v166
  v_fma_f32 v26, v26, v162, -v76
  v_fma_f32 v30, v30, v162, v77
  v_mul_f32 v78, v31, v167
  v_mul_f32 v79, v27, v167
  v_fma_f32 v27, v27, v163, -v78
  v_fma_f32 v31, v31, v163, v79
  v_mul_f32 v72, v36, v172
  v_mul_f32 v73, v32, v172
  v_fma_f32 v32, v32, v168, -v72
  v_fma_f32 v36, v36, v168, v73
  v_mul_f32 v74, v37, v173
  v_mul_f32 v75, v33, v173
  v_fma_f32 v33, v33, v169, -v74
  v_fma_f32 v37, v37, v169, v75
  v_mul_f32 v76, v38, v174
  v_mul_f32 v77, v34, v174
  v_fma_f32 v34, v34, v170, -v76
  v_fma_f32 v38, v38, v170, v77
  v_mul_f32 v78, v39, v175
  v_mul_f32 v79, v35, v175
  v_fma_f32 v35, v35, v171, -v78
  v_fma_f32 v39, v39, v171, v79
  v_mul_f32 v72, v44, v180
  v_mul_f32 v73, v40, v180
  v_fma_f32 v40, v40, v176, -v72
  v_fma_f32 v44, v44, v176, v73
  v_mul_f32 v74, v45, v181
  v_mul_f32 v75, v41, v181
  v_fma_f32 v41, v41, v177, -v74
  v_fma_f32 v45, v45, v177, v75
  v_mul_f32 v76, v46, v182
  v_mul_f32 v77, v42, v182
  v_fma_f32 v42, v42, v178, -v76
  v_fma_f32 v46, v46, v178, v77
  v_mul_f32 v78, v47, v183
  v_mul_f32 v79, v43, v183
  v_fma_f32 v43, v43, v179, -v78
  v_fma_f32 v47, v47, v179, v79
  v_cvt_pk_f16_f32 v48, v16, v17
  v_cvt_pk_f16_f32 v49, v18, v19
  v_cvt_pk_f16_f32 v50, v20, v21
  v_cvt_pk_f16_f32 v51, v22, v23
  v_cvt_pk_f16_f32 v52, v24, v25
  v_cvt_pk_f16_f32 v53, v26, v27
  v_cvt_pk_f16_f32 v54, v28, v29
  v_cvt_pk_f16_f32 v55, v30, v31
  v_cvt_pk_f16_f32 v56, v32, v33
  v_cvt_pk_f16_f32 v57, v34, v35
  v_cvt_pk_f16_f32 v58, v36, v37
  v_cvt_pk_f16_f32 v59, v38, v39
  v_cvt_pk_f16_f32 v60, v40, v41
  v_cvt_pk_f16_f32 v61, v42, v43
  v_cvt_pk_f16_f32 v62, v44, v45
  v_cvt_pk_f16_f32 v63, v46, v47
  s_xor_b32 s46, s52, 1
  s_lshl_b32 s46, s46, 11
  s_add_u32 s46, s46, s48
  v_add_u32 v85, s46, v3
  s_lshl_b32 s46, s52, 11
  s_add_u32 s46, s46, s48
  v_add_u32 v80, s46, v3
  s_mov_b32 s33, 0
L_pw_96:
  ds_read_b32 v87, v14
  s_waitcnt lgkmcnt(0)
  v_readfirstlane_b32 s28, v87
  s_cmp_ge_u32 s28, 3
  s_cbranch_scc1 L_spinout_97
  s_add_u32 s33, s33, 1
  s_cmp_lt_u32 s33, 0x40000
  s_cbranch_scc1 L_pw_96
L_spinout_97:
  s_cmp_eq_u32 s52, 1
  s_cbranch_scc1 L_fft_hw1_98
  ds_write_b128 v85, v[56:59]
  ds_write_b128 v85, v[60:63] offset:1024
  s_branch L_fft_j_99
L_fft_hw1_98:
  ds_write_b128 v85, v[48:51]
  ds_write_b128 v85, v[52:55] offset:1024
  s_waitcnt lgkmcnt(0)
  v_mov_b32 v48, v56
  v_mov_b32 v49, v57
  v_mov_b32 v50, v58
  v_mov_b32 v51, v59
  v_mov_b32 v52, v60
  v_mov_b32 v53, v61
  v_mov_b32 v54, v62
  v_mov_b32 v55, v63
L_fft_j_99:
  v_mov_b32 v87, 4
  ds_write_b32 v13, v87
  v_mfma_f32_16x16x32_f16 v[16:19], v[48:51], v[196:199], 0
  v_mfma_f32_16x16x32_f16 v[20:23], v[48:51], v[200:203], 0
  v_mfma_f32_16x16x32_f16 v[24:27], v[48:51], v[184:187], 0
  v_mfma_f32_16x16x32_f16 v[28:31], v[48:51], v[188:191], 0
  v_mfma_f32_16x16x32_f16 v[32:35], v[52:55], v[196:199], 0
  v_mfma_f32_16x16x32_f16 v[36:39], v[52:55], v[200:203], 0
  v_mfma_f32_16x16x32_f16 v[40:43], v[52:55], v[184:187], 0
  v_mfma_f32_16x16x32_f16 v[44:47], v[52:55], v[188:191], 0
  s_mov_b32 s33, 0
L_pw_100:
  ds_read_b32 v87, v14
  s_waitcnt lgkmcnt(0)
  v_readfirstlane_b32 s28, v87
  s_cmp_ge_u32 s28, 4
  s_cbranch_scc1 L_spinout_101
  s_add_u32 s33, s33, 1
  s_cmp_lt_u32 s33, 0x40000
  s_cbranch_scc1 L_pw_100
L_spinout_101:
  ds_read_b128 v[64:67], v80
  ds_read_b128 v[68:71], v80 offset:1024
  v_and_b32 v86, 15, v1
  v_lshlrev_b32 v86, 7, v86
  v_lshrrev_b32 v85, 4, v1
  v_lshl_add_u32 v86, v85, 3, v86
  s_lshl_b32 s46, s52, 6
  v_add_u32 v86, s46, v86
  v_bfe_u32 v72, v1, 1, 3
  v_lshlrev_b32 v72, 4, v72
  v_xor_b32 v86, v86, v72
  v_xor_b32 v72, 32, v86
  v_add_u32 v76, s48, v86
  v_add_u32 v81, s49, v86
  v_add_u32 v73, s48, v72
  v_add_u32 v74, s49, v72
  v_lshlrev_b32 v85, 4, v85
  v_xor_b32 v85, v85, v3
  v_xor_b32 v75, 64, v85
  v_add_u32 v85, s51, v85
  v_add_u32 v75, s51, v75
  v_add_u32 v86, s50, v3
  s_waitcnt lgkmcnt(0)
  v_mov_b32 v87, 5
  ds_write_b32 v13, v87
  v_mfma_f32_16x16x32_f16 v[16:19], v[64:67], v[204:207], v[16:19]
  v_mfma_f32_16x16x32_f16 v[20:23], v[64:67], v[208:211], v[20:23]
  v_mfma_f32_16x16x32_f16 v[24:27], v[64:67], v[192:195], v[24:27]
  v_mfma_f32_16x16x32_f16 v[28:31], v[64:67], v[252:255], v[28:31]
  v_mfma_f32_16x16x32_f16 v[32:35], v[68:71], v[204:207], v[32:35]
  v_mfma_f32_16x16x32_f16 v[36:39], v[68:71], v[208:211], v[36:39]
  v_mfma_f32_16x16x32_f16 v[40:43], v[68:71], v[192:195], v[40:43]
  v_mfma_f32_16x16x32_f16 v[44:47], v[68:71], v[252:255], v[44:47]
  s_mov_b32 s33, 0
L_pw_102:
  ds_read_b32 v87, v14
  s_waitcnt lgkmcnt(0)
  v_readfirstlane_b32 s28, v87
  s_cmp_ge_u32 s28, 5
  s_cbranch_scc1 L_spinout_103
  s_add_u32 s33, s33, 1
  s_cmp_lt_u32 s33, 0x40000
  s_cbranch_scc1 L_pw_102
L_spinout_103:
  v_mul_f32 v16, v16, v84
  v_mul_f32 v17, v17, v84
  v_cvt_pk_bf16_f32 v212, v16, v17
  v_mul_f32 v18, v18, v84
  v_mul_f32 v19, v19, v84
  v_cvt_pk_bf16_f32 v213, v18, v19
  v_mul_f32 v20, v20, v84
  v_mul_f32 v21, v21, v84
  v_cvt_pk_bf16_f32 v214, v20, v21
  v_mul_f32 v22, v22, v84
  v_mul_f32 v23, v23, v84
  v_cvt_pk_bf16_f32 v215, v22, v23
  v_mul_f32 v24, v24, v84
  v_mul_f32 v25, v25, v84
  v_cvt_pk_bf16_f32 v216, v24, v25
  v_mul_f32 v26, v26, v84
  v_mul_f32 v27, v27, v84
  v_cvt_pk_bf16_f32 v217, v26, v27
  v_mul_f32 v28, v28, v84
  v_mul_f32 v29, v29, v84
  v_cvt_pk_bf16_f32 v218, v28, v29
  v_mul_f32 v30, v30, v84
  v_mul_f32 v31, v31, v84
  v_cvt_pk_bf16_f32 v219, v30, v31
  v_mul_f32 v32, v32, v84
  v_mul_f32 v33, v33, v84
  v_cvt_pk_bf16_f32 v220, v32, v33
  v_mul_f32 v34, v34, v84
  v_mul_f32 v35, v35, v84
  v_cvt_pk_bf16_f32 v221, v34, v35
  v_mul_f32 v36, v36, v84
  v_mul_f32 v37, v37, v84
  v_cvt_pk_bf16_f32 v222, v36, v37
  v_mul_f32 v38, v38, v84
  v_mul_f32 v39, v39, v84
  v_cvt_pk_bf16_f32 v223, v38, v39
  v_mul_f32 v40, v40, v84
  v_mul_f32 v41, v41, v84
  v_cvt_pk_bf16_f32 v224, v40, v41
  v_mul_f32 v42, v42, v84
  v_mul_f32 v43, v43, v84
  v_cvt_pk_bf16_f32 v225, v42, v43
  v_mul_f32 v44, v44, v84
  v_mul_f32 v45, v45, v84
  v_cvt_pk_bf16_f32 v226, v44, v45
  v_mul_f32 v46, v46, v84
  v_mul_f32 v47, v47, v84
  v_cvt_pk_bf16_f32 v227, v46, v47
  ds_write_b64 v76, v[212:213] offset:0
  ds_write_b64 v81, v[214:215] offset:0
  ds_write_b64 v76, v[216:217] offset:2048
  ds_write_b64 v81, v[218:219] offset:2048
  ds_write_b64 v73, v[220:221] offset:0
  ds_write_b64 v74, v[222:223] offset:0
  ds_write_b64 v73, v[224:225] offset:2048
  ds_write_b64 v74, v[226:227] offset:2048
  v_mov_b32 v87, 6
  ds_write_b32 v13, v87
  s_mov_b32 s33, 0
L_pw_104:
  ds_read_b32 v87, v14
  s_waitcnt lgkmcnt(0)
  v_readfirstlane_b32 s28, v87
  s_cmp_ge_u32 s28, 6
  s_cbranch_scc1 L_spinout_105
  s_add_u32 s33, s33, 1
  s_cmp_lt_u32 s33, 0x40000
  s_cbranch_scc1 L_pw_104
L_spinout_105:
  ds_read_b128 v[16:19], v85 offset:0
  ds_read_b128 v[20:23], v75 offset:1024
  ds_read_b128 v[24:27], v85 offset:2048
  ds_read_b128 v[28:31], v75 offset:3072
  s_mov_b32 s46, 0x17a0000
  s_waitcnt lgkmcnt(3)
  buffer_store_dwordx4 v[16:19], v86, s[4:7], s46 offen offset:0 sc1
  s_waitcnt lgkmcnt(2)
  buffer_store_dwordx4 v[20:23], v86, s[4:7], s46 offen offset:1024 sc1
  s_waitcnt lgkmcnt(1)
  buffer_store_dwordx4 v[24:27], v86, s[4:7], s46 offen offset:2048 sc1
  s_waitcnt lgkmcnt(0)
  buffer_store_dwordx4 v[28:31], v86, s[4:7], s46 offen offset:3072 sc1
  s_waitcnt vmcnt(8)
  s_barrier
  s_add_u32 s32, s96, 4
  s_and_b32 s32, s32, 7
  s_add_u32 s32, s32, s92
  s_mul_i32 s31, s32, 36864
  s_add_u32 s31, s31, s34
  s_lshl_b32 s32, s32, 10
  s_add_u32 s32, s32, s36
  s_cmp_eq_u32 s19, 0
  s_cbranch_scc0 L_skip_106
  s_add_u32 m0, s38, 81920
  s_add_u32 s30, s31, 8192
  buffer_load_dwordx4 v3, s[4:7], s30 offen sc1 lds
L_skip_106:
  s_add_u32 m0, s38, 73728
  s_add_u32 s30, s31, 0
  buffer_load_dwordx4 v3, s[4:7], s30 offen sc1 lds
  s_add_u32 m0, s38, 77824
  s_add_u32 s30, s31, 4096
  buffer_load_dwordx4 v3, s[4:7], s30 offen sc1 lds
  s_add_u32 m0, s38, 82944
  s_add_u32 s30, s32, 0
  buffer_load_dwordx4 v3, s[4:7], s30 offen sc1 lds
  s_add_u32 m0, s38, 87040
  s_add_u32 s30, s32, 589824
  buffer_load_dwordx4 v3, s[4:7], s30 offen sc1 lds
  buffer_load_dword v2, v5, s[4:7], 0 offen sc1
  s_add_u32 s32, s96, 5
  s_and_b32 s32, s32, 7
  s_add_u32 s32, s32, s92
  s_mul_i32 s31, s32, 36864
  s_add_u32 s31, s31, s34
  s_lshl_b32 s32, s32, 10
  s_add_u32 s32, s32, s36
  s_cmp_eq_u32 s19, 0
  s_cbranch_scc0 L_skip_107
  s_add_u32 m0, s38, 99328
  s_add_u32 s30, s31, 8192
  buffer_load_dwordx4 v3, s[4:7], s30 offen sc1 lds
L_skip_107:
  s_add_u32 m0, s38, 91136
  s_add_u32 s30, s31, 0
  buffer_load_dwordx4 v3, s[4:7], s30 offen sc1 lds
  s_add_u32 m0, s38, 95232
  s_add_u32 s30, s31, 4096
  buffer_load_dwordx4 v3, s[4:7], s30 offen sc1 lds
  s_add_u32 m0, s38, 100352
  s_add_u32 s30, s32, 0
  buffer_load_dwordx4 v3, s[4:7], s30 offen sc1 lds
  s_add_u32 m0, s38, 104448
  s_add_u32 s30, s32, 589824
  buffer_load_dwordx4 v3, s[4:7], s30 offen sc1 lds
  s_add_u32 s32, s96, 6
  s_and_b32 s32, s32, 7
  s_add_u32 s32, s32, s92
  s_mul_i32 s31, s32, 36864
  s_add_u32 s31, s31, s34
  s_lshl_b32 s32, s32, 10
  s_add_u32 s32, s32, s36
  s_cmp_eq_u32 s19, 0
  s_cbranch_scc0 L_skip_108
  s_add_u32 m0, s38, 116736
  s_add_u32 s30, s31, 8192
  buffer_load_dwordx4 v3, s[4:7], s30 offen sc1 lds
L_skip_108:
  s_add_u32 m0, s38, 108544
  s_add_u32 s30, s31, 0
  buffer_load_dwordx4 v3, s[4:7], s30 offen sc1 lds
  s_add_u32 m0, s38, 112640
  s_add_u32 s30, s31, 4096
  buffer_load_dwordx4 v3, s[4:7], s30 offen sc1 lds
  s_add_u32 m0, s38, 117760
  s_add_u32 s30, s32, 0
  buffer_load_dwordx4 v3, s[4:7], s30 offen sc1 lds
  s_add_u32 m0, s38, 121856
  s_add_u32 s30, s32, 589824
  buffer_load_dwordx4 v3, s[4:7], s30 offen sc1 lds
  s_add_u32 s32, s96, 7
  s_and_b32 s32, s32, 7
  s_add_u32 s32, s32, s92
  s_mul_i32 s31, s32, 36864
  s_add_u32 s31, s31, s34
  s_lshl_b32 s32, s32, 10
  s_add_u32 s32, s32, s36
  s_cmp_eq_u32 s19, 0
  s_cbranch_scc0 L_skip_109
  s_add_u32 m0, s38, 134144
  s_add_u32 s30, s31, 8192
  buffer_load_dwordx4 v3, s[4:7], s30 offen sc1 lds
L_skip_109:
  s_add_u32 m0, s38, 125952
  s_add_u32 s30, s31, 0
  buffer_load_dwordx4 v3, s[4:7], s30 offen sc1 lds
  s_add_u32 m0, s38, 130048
  s_add_u32 s30, s31, 4096
  buffer_load_dwordx4 v3, s[4:7], s30 offen sc1 lds
  s_add_u32 m0, s38, 135168
  s_add_u32 s30, s32, 0
  buffer_load_dwordx4 v3, s[4:7], s30 offen sc1 lds
  s_add_u32 m0, s38, 139264
  s_add_u32 s30, s32, 589824
  buffer_load_dwordx4 v3, s[4:7], s30 offen sc1 lds
  s_waitcnt vmcnt(13)
  s_barrier
  s_mov_b32 s32, s12
  s_mul_i32 s31, s32, 36864
  s_add_u32 s31, s31, s34
  s_lshl_b32 s32, s32, 10
  s_add_u32 s32, s32, s36
  s_cmp_eq_u32 s19, 0
  s_cbranch_scc0 L_skip_110
  s_add_u32 m0, s38, 8192
  s_add_u32 s30, s31, 8192
  buffer_load_dwordx4 v3, s[4:7], s30 offen sc1 lds
L_skip_110:
  s_add_u32 m0, s38, 0
  s_add_u32 s30, s31, 0
  buffer_load_dwordx4 v3, s[4:7], s30 offen sc1 lds
  s_add_u32 m0, s38, 4096
  s_add_u32 s30, s31, 4096
  buffer_load_dwordx4 v3, s[4:7], s30 offen sc1 lds
  s_add_u32 m0, s38, 9216
  s_add_u32 s30, s32, 0
  buffer_load_dwordx4 v3, s[4:7], s30 offen sc1 lds
  s_add_u32 m0, s38, 13312
  s_add_u32 s30, s32, 589824
  buffer_load_dwordx4 v3, s[4:7], s30 offen sc1 lds
  s_waitcnt vmcnt(16)
  s_add_u32 s28, s59, 3
  v_subrev_u32 v2, s28, v2
  v_cmp_ge_u32 vcc, 0, v2
  s_nop 1
  s_cmp_eq_u64 vcc, -1
  s_cbranch_scc1 L_pok_111
  s_mov_b32 s33, 0
L_pgw_112:
  buffer_load_dword v2, v5, s[4:7], 0 offen sc1
  s_waitcnt vmcnt(0)
  s_add_u32 s28, s59, 3
  v_subrev_u32 v2, s28, v2
  v_cmp_ge_u32 vcc, 0, v2
  s_nop 1
  s_cmp_eq_u64 vcc, -1
  s_cbranch_scc1 L_spinout_113
  s_sleep 4
  s_add_u32 s33, s33, 1
  s_cmp_lt_u32 s33, 0x40000
  s_cbranch_scc1 L_pgw_112
L_spinout_113:
L_pok_111:
  s_add_u32 s32, s96, 0
  s_and_b32 s32, s32, 7
  s_add_u32 s32, s32, s93
  s_mul_i32 s31, s32, 36864
  s_add_u32 s31, s31, s34
  s_lshl_b32 s32, s32, 10
  s_add_u32 s32, s32, s36
  s_cmp_eq_u32 s19, 0
  s_cbranch_scc0 L_skip_114
  s_add_u32 m0, s38, 25600
  s_add_u32 s30, s31, 8192
  buffer_load_dwordx4 v3, s[4:7], s30 offen sc1 lds
L_skip_114:
  s_add_u32 m0, s38, 17408
  s_add_u32 s30, s31, 0
  buffer_load_dwordx4 v3, s[4:7], s30 offen sc1 lds
  s_add_u32 m0, s38, 21504
  s_add_u32 s30, s31, 4096
  buffer_load_dwordx4 v3, s[4:7], s30 offen sc1 lds
  s_add_u32 m0, s38, 26624
  s_add_u32 s30, s32, 0
  buffer_load_dwordx4 v3, s[4:7], s30 offen sc1 lds
  s_add_u32 m0, s38, 30720
  s_add_u32 s30, s32, 589824
  buffer_load_dwordx4 v3, s[4:7], s30 offen sc1 lds
  s_add_u32 s32, s96, 1
  s_and_b32 s32, s32, 7
  s_add_u32 s32, s32, s93
  s_mul_i32 s31, s32, 36864
  s_add_u32 s31, s31, s34
  s_lshl_b32 s32, s32, 10
  s_add_u32 s32, s32, s36
  s_cmp_eq_u32 s19, 0
  s_cbranch_scc0 L_skip_115
  s_add_u32 m0, s38, 43008
  s_add_u32 s30, s31, 8192
  buffer_load_dwordx4 v3, s[4:7], s30 offen sc1 lds
L_skip_115:
  s_add_u32 m0, s38, 34816
  s_add_u32 s30, s31, 0
  buffer_load_dwordx4 v3, s[4:7], s30 offen sc1 lds
  s_add_u32 m0, s38, 38912
  s_add_u32 s30, s31, 4096
  buffer_load_dwordx4 v3, s[4:7], s30 offen sc1 lds
  s_add_u32 m0, s38, 44032
  s_add_u32 s30, s32, 0
  buffer_load_dwordx4 v3, s[4:7], s30 offen sc1 lds
  s_add_u32 m0, s38, 48128
  s_add_u32 s30, s32, 589824
  buffer_load_dwordx4 v3, s[4:7], s30 offen sc1 lds
  s_waitcnt vmcnt(16)
  s_waitcnt vmcnt(29)
  s_barrier
  s_cmp_eq_u32 s19, 3
  s_cbranch_scc0 L_svc_116
  s_add_u32 s28, s59, 0
  v_mov_b32 v253, 12288
  v_mov_b32 v254, s28
  s_mov_b64 exec, 1
  buffer_store_dword v254, v253, s[4:7], s101 offen sc1
  s_mov_b64 exec, -1
L_svc_116:
  s_add_u32 s32, s96, 2
  s_and_b32 s32, s32, 7
  s_add_u32 s32, s32, s93
  s_mul_i32 s31, s32, 36864
  s_add_u32 s31, s31, s34
  s_lshl_b32 s32, s32, 10
  s_add_u32 s32, s32, s36
  s_cmp_eq_u32 s19, 0
  s_cbranch_scc0 L_skip_117
  s_add_u32 m0, s38, 60416
  s_add_u32 s30, s31, 8192
  buffer_load_dwordx4 v3, s[4:7], s30 offen sc1 lds
L_skip_117:
  s_add_u32 m0, s38, 52224
  s_add_u32 s30, s31, 0
  buffer_load_dwordx4 v3, s[4:7], s30 offen sc1 lds
  s_add_u32 m0, s38, 56320
  s_add_u32 s30, s31, 4096
  buffer_load_dwordx4 v3, s[4:7], s30 offen sc1 lds
  s_add_u32 m0, s38, 61440
  s_add_u32 s30, s32, 0
  buffer_load_dwordx4 v3, s[4:7], s30 offen sc1 lds
  s_add_u32 m0, s38, 65536
  s_add_u32 s30, s32, 589824
  buffer_load_dwordx4 v3, s[4:7], s30 offen sc1 lds
  s_add_u32 s32, s96, 3
  s_and_b32 s32, s32, 7
  s_add_u32 s32, s32, s93
  s_mul_i32 s31, s32, 36864
  s_add_u32 s31, s31, s34
  s_lshl_b32 s32, s32, 10
  s_add_u32 s32, s32, s36
  s_cmp_eq_u32 s19, 0
  s_cbranch_scc0 L_skip_118
  s_add_u32 m0, s38, 81920
  s_add_u32 s30, s31, 8192
  buffer_load_dwordx4 v3, s[4:7], s30 offen sc1 lds
L_skip_118:
  s_add_u32 m0, s38, 73728
  s_add_u32 s30, s31, 0
  buffer_load_dwordx4 v3, s[4:7], s30 offen sc1 lds
  s_add_u32 m0, s38, 77824
  s_add_u32 s30, s31, 4096
  buffer_load_dwordx4 v3, s[4:7], s30 offen sc1 lds
  s_add_u32 m0, s38, 82944
  s_add_u32 s30, s32, 0
  buffer_load_dwordx4 v3, s[4:7], s30 offen sc1 lds
  s_add_u32 m0, s38, 87040
  s_add_u32 s30, s32, 589824
  buffer_load_dwordx4 v3, s[4:7], s30 offen sc1 lds
  s_waitcnt vmcnt(16)
  s_barrier
  s_add_u32 s32, s96, 4
  s_and_b32 s32, s32, 7
  s_add_u32 s32, s32, s93
  s_mul_i32 s31, s32, 36864
  s_add_u32 s31, s31, s34
  s_lshl_b32 s32, s32, 10
  s_add_u32 s32, s32, s36
  s_cmp_eq_u32 s19, 0
  s_cbranch_scc0 L_skip_119
  s_add_u32 m0, s38, 99328
  s_add_u32 s30, s31, 8192
  buffer_load_dwordx4 v3, s[4:7], s30 offen sc1 lds
L_skip_119:
  s_add_u32 m0, s38, 91136
  s_add_u32 s30, s31, 0
  buffer_load_dwordx4 v3, s[4:7], s30 offen sc1 lds
  s_add_u32 m0, s38, 95232
  s_add_u32 s30, s31, 4096
  buffer_load_dwordx4 v3, s[4:7], s30 offen sc1 lds
  s_add_u32 m0, s38, 100352
  s_add_u32 s30, s32, 0
  buffer_load_dwordx4 v3, s[4:7], s30 offen sc1 lds
  s_add_u32 m0, s38, 104448
  s_add_u32 s30, s32, 589824
  buffer_load_dwordx4 v3, s[4:7], s30 offen sc1 lds
  s_add_u32 s32, s96, 5
  s_and_b32 s32, s32, 7
  s_add_u32 s32, s32, s93
  s_mul_i32 s31, s32, 36864
  s_add_u32 s31, s31, s34
  s_lshl_b32 s32, s32, 10
  s_add_u32 s32, s32, s36
  s_cmp_eq_u32 s19, 0
  s_cbranch_scc0 L_skip_120
  s_add_u32 m0, s38, 116736
  s_add_u32 s30, s31, 8192
  buffer_load_dwordx4 v3, s[4:7], s30 offen sc1 lds
L_skip_120:
  s_add_u32 m0, s38, 108544
  s_add_u32 s30, s31, 0
  buffer_load_dwordx4 v3, s[4:7], s30 offen sc1 lds
  s_add_u32 m0, s38, 112640
  s_add_u32 s30, s31, 4096
  buffer_load_dwordx4 v3, s[4:7], s30 offen sc1 lds
  s_add_u32 m0, s38, 117760
  s_add_u32 s30, s32, 0
  buffer_load_dwordx4 v3, s[4:7], s30 offen sc1 lds
  s_add_u32 m0, s38, 121856
  s_add_u32 s30, s32, 589824
  buffer_load_dwordx4 v3, s[4:7], s30 offen sc1 lds
  s_waitcnt vmcnt(16)
  s_barrier
  s_add_u32 s32, s96, 6
  s_and_b32 s32, s32, 7
  s_add_u32 s32, s32, s93
  s_mul_i32 s31, s32, 36864
  s_add_u32 s31, s31, s34
  s_lshl_b32 s32, s32, 10
  s_add_u32 s32, s32, s36
  s_cmp_eq_u32 s19, 0
  s_cbranch_scc0 L_skip_121
  s_add_u32 m0, s38, 134144
  s_add_u32 s30, s31, 8192
  buffer_load_dwordx4 v3, s[4:7], s30 offen sc1 lds
L_skip_121:
  s_add_u32 m0, s38, 125952
  s_add_u32 s30, s31, 0
  buffer_load_dwordx4 v3, s[4:7], s30 offen sc1 lds
  s_add_u32 m0, s38, 130048
  s_add_u32 s30, s31, 4096
  buffer_load_dwordx4 v3, s[4:7], s30 offen sc1 lds
  s_add_u32 m0, s38, 135168
  s_add_u32 s30, s32, 0
  buffer_load_dwordx4 v3, s[4:7], s30 offen sc1 lds
  s_add_u32 m0, s38, 139264
  s_add_u32 s30, s32, 589824
  buffer_load_dwordx4 v3, s[4:7], s30 offen sc1 lds
  s_add_u32 s32, s96, 7
  s_and_b32 s32, s32, 7
  s_add_u32 s32, s32, s93
  s_mul_i32 s31, s32, 36864
  s_add_u32 s31, s31, s34
  s_lshl_b32 s32, s32, 10
  s_add_u32 s32, s32, s36
  s_cmp_eq_u32 s19, 0
  s_cbranch_scc0 L_skip_122
  s_add_u32 m0, s38, 8192
  s_add_u32 s30, s31, 8192
  buffer_load_dwordx4 v3, s[4:7], s30 offen sc1 lds
L_skip_122:
  s_add_u32 m0, s38, 0
  s_add_u32 s30, s31, 0
  buffer_load_dwordx4 v3, s[4:7], s30 offen sc1 lds
  s_add_u32 m0, s38, 4096
  s_add_u32 s30, s31, 4096
  buffer_load_dwordx4 v3, s[4:7], s30 offen sc1 lds
  s_add_u32 m0, s38, 9216
  s_add_u32 s30, s32, 0
  buffer_load_dwordx4 v3, s[4:7], s30 offen sc1 lds
  s_add_u32 m0, s38, 13312
  s_add_u32 s30, s32, 589824
  buffer_load_dwordx4 v3, s[4:7], s30 offen sc1 lds
  s_waitcnt vmcnt(16)
  s_barrier
  s_mov_b32 s32, s13
  s_mul_i32 s31, s32, 36864
  s_add_u32 s31, s31, s34
  s_lshl_b32 s32, s32, 10
  s_add_u32 s32, s32, s36
  s_cmp_eq_u32 s19, 0
  s_cbranch_scc0 L_skip_123
  s_add_u32 m0, s38, 25600
  s_add_u32 s30, s31, 8192
  buffer_load_dwordx4 v3, s[4:7], s30 offen sc1 lds
L_skip_123:
  s_add_u32 m0, s38, 17408
  s_add_u32 s30, s31, 0
  buffer_load_dwordx4 v3, s[4:7], s30 offen sc1 lds
  s_add_u32 m0, s38, 21504
  s_add_u32 s30, s31, 4096
  buffer_load_dwordx4 v3, s[4:7], s30 offen sc1 lds
  s_add_u32 m0, s38, 26624
  s_add_u32 s30, s32, 0
  buffer_load_dwordx4 v3, s[4:7], s30 offen sc1 lds
  s_add_u32 m0, s38, 30720
  s_add_u32 s30, s32, 589824
  buffer_load_dwordx4 v3, s[4:7], s30 offen sc1 lds
  s_add_u32 s32, s96, 0
  s_and_b32 s32, s32, 7
  s_add_u32 s32, s32, s94
  s_mul_i32 s31, s32, 36864
  s_add_u32 s31, s31, s34
  s_lshl_b32 s32, s32, 10
  s_add_u32 s32, s32, s36
  s_cmp_eq_u32 s19, 0
  s_cbranch_scc0 L_skip_124
  s_add_u32 m0, s38, 43008
  s_add_u32 s30, s31, 8192
  buffer_load_dwordx4 v3, s[4:7], s30 offen sc1 lds
L_skip_124:
  s_add_u32 m0, s38, 34816
  s_add_u32 s30, s31, 0
  buffer_load_dwordx4 v3, s[4:7], s30 offen sc1 lds
  s_add_u32 m0, s38, 38912
  s_add_u32 s30, s31, 4096
  buffer_load_dwordx4 v3, s[4:7], s30 offen sc1 lds
  s_add_u32 m0, s38, 44032
  s_add_u32 s30, s32, 0
  buffer_load_dwordx4 v3, s[4:7], s30 offen sc1 lds
  s_add_u32 m0, s38, 48128
  s_add_u32 s30, s32, 589824
  buffer_load_dwordx4 v3, s[4:7], s30 offen sc1 lds
  s_waitcnt vmcnt(16)
  s_barrier
  s_add_u32 s32, s96, 1
  s_and_b32 s32, s32, 7
  s_add_u32 s32, s32, s94
  s_mul_i32 s31, s32, 36864
  s_add_u32 s31, s31, s34
  s_lshl_b32 s32, s32, 10
  s_add_u32 s32, s32, s36
  s_cmp_eq_u32 s19, 0
  s_cbranch_scc0 L_skip_125
  s_add_u32 m0, s38, 60416
  s_add_u32 s30, s31, 8192
  buffer_load_dwordx4 v3, s[4:7], s30 offen sc1 lds
L_skip_125:
  s_add_u32 m0, s38, 52224
  s_add_u32 s30, s31, 0
  buffer_load_dwordx4 v3, s[4:7], s30 offen sc1 lds
  s_add_u32 m0, s38, 56320
  s_add_u32 s30, s31, 4096
  buffer_load_dwordx4 v3, s[4:7], s30 offen sc1 lds
  s_add_u32 m0, s38, 61440
  s_add_u32 s30, s32, 0
  buffer_load_dwordx4 v3, s[4:7], s30 offen sc1 lds
  s_add_u32 m0, s38, 65536
  s_add_u32 s30, s32, 589824
  buffer_load_dwordx4 v3, s[4:7], s30 offen sc1 lds
  s_add_u32 s32, s96, 2
  s_and_b32 s32, s32, 7
  s_add_u32 s32, s32, s94
  s_mul_i32 s31, s32, 36864
  s_add_u32 s31, s31, s34
  s_lshl_b32 s32, s32, 10
  s_add_u32 s32, s32, s36
  s_cmp_eq_u32 s19, 0
  s_cbranch_scc0 L_skip_126
  s_add_u32 m0, s38, 81920
  s_add_u32 s30, s31, 8192
  buffer_load_dwordx4 v3, s[4:7], s30 offen sc1 lds
L_skip_126:
  s_add_u32 m0, s38, 73728
  s_add_u32 s30, s31, 0
  buffer_load_dwordx4 v3, s[4:7], s30 offen sc1 lds
  s_add_u32 m0, s38, 77824
  s_add_u32 s30, s31, 4096
  buffer_load_dwordx4 v3, s[4:7], s30 offen sc1 lds
  s_add_u32 m0, s38, 82944
  s_add_u32 s30, s32, 0
  buffer_load_dwordx4 v3, s[4:7], s30 offen sc1 lds
  s_add_u32 m0, s38, 87040
  s_add_u32 s30, s32, 589824
  buffer_load_dwordx4 v3, s[4:7], s30 offen sc1 lds
  s_waitcnt vmcnt(16)
  s_barrier
  s_add_u32 s32, s96, 3
  s_and_b32 s32, s32, 7
  s_add_u32 s32, s32, s94
  s_mul_i32 s31, s32, 36864
  s_add_u32 s31, s31, s34
  s_lshl_b32 s32, s32, 10
  s_add_u32 s32, s32, s36
  s_cmp_eq_u32 s19, 0
  s_cbranch_scc0 L_skip_127
  s_add_u32 m0, s38, 99328
  s_add_u32 s30, s31, 8192
  buffer_load_dwordx4 v3, s[4:7], s30 offen sc1 lds
L_skip_127:
  s_add_u32 m0, s38, 91136
  s_add_u32 s30, s31, 0
  buffer_load_dwordx4 v3, s[4:7], s30 offen sc1 lds
  s_add_u32 m0, s38, 95232
  s_add_u32 s30, s31, 4096
  buffer_load_dwordx4 v3, s[4:7], s30 offen sc1 lds
  s_add_u32 m0, s38, 100352
  s_add_u32 s30, s32, 0
  buffer_load_dwordx4 v3, s[4:7], s30 offen sc1 lds
  s_add_u32 m0, s38, 104448
  s_add_u32 s30, s32, 589824
  buffer_load_dwordx4 v3, s[4:7], s30 offen sc1 lds
  s_add_u32 s32, s96, 4
  s_and_b32 s32, s32, 7
  s_add_u32 s32, s32, s94
  s_mul_i32 s31, s32, 36864
  s_add_u32 s31, s31, s34
  s_lshl_b32 s32, s32, 10
  s_add_u32 s32, s32, s36
  s_cmp_eq_u32 s19, 0
  s_cbranch_scc0 L_skip_128
  s_add_u32 m0, s38, 116736
  s_add_u32 s30, s31, 8192
  buffer_load_dwordx4 v3, s[4:7], s30 offen sc1 lds
L_skip_128:
  s_add_u32 m0, s38, 108544
  s_add_u32 s30, s31, 0
  buffer_load_dwordx4 v3, s[4:7], s30 offen sc1 lds
  s_add_u32 m0, s38, 112640
  s_add_u32 s30, s31, 4096
  buffer_load_dwordx4 v3, s[4:7], s30 offen sc1 lds
  s_add_u32 m0, s38, 117760
  s_add_u32 s30, s32, 0
  buffer_load_dwordx4 v3, s[4:7], s30 offen sc1 lds
  s_add_u32 m0, s38, 121856
  s_add_u32 s30, s32, 589824
  buffer_load_dwordx4 v3, s[4:7], s30 offen sc1 lds
  s_waitcnt vmcnt(16)
  s_barrier
  s_add_u32 s32, s96, 5
  s_and_b32 s32, s32, 7
  s_add_u32 s32, s32, s94
  s_mul_i32 s31, s32, 36864
  s_add_u32 s31, s31, s34
  s_lshl_b32 s32, s32, 10
  s_add_u32 s32, s32, s36
  s_cmp_eq_u32 s19, 0
  s_cbranch_scc0 L_skip_129
  s_add_u32 m0, s38, 134144
  s_add_u32 s30, s31, 8192
  buffer_load_dwordx4 v3, s[4:7], s30 offen sc1 lds
L_skip_129:
  s_add_u32 m0, s38, 125952
  s_add_u32 s30, s31, 0
  buffer_load_dwordx4 v3, s[4:7], s30 offen sc1 lds
  s_add_u32 m0, s38, 130048
  s_add_u32 s30, s31, 4096
  buffer_load_dwordx4 v3, s[4:7], s30 offen sc1 lds
  s_add_u32 m0, s38, 135168
  s_add_u32 s30, s32, 0
  buffer_load_dwordx4 v3, s[4:7], s30 offen sc1 lds
  s_add_u32 m0, s38, 139264
  s_add_u32 s30, s32, 589824
  buffer_load_dwordx4 v3, s[4:7], s30 offen sc1 lds
  s_add_u32 s32, s96, 6
  s_and_b32 s32, s32, 7
  s_add_u32 s32, s32, s94
  s_mul_i32 s31, s32, 36864
  s_add_u32 s31, s31, s34
  s_lshl_b32 s32, s32, 10
  s_add_u32 s32, s32, s36
  s_cmp_eq_u32 s19, 0
  s_cbranch_scc0 L_skip_130
  s_add_u32 m0, s38, 8192
  s_add_u32 s30, s31, 8192
  buffer_load_dwordx4 v3, s[4:7], s30 offen sc1 lds
L_skip_130:
  s_add_u32 m0, s38, 0
  s_add_u32 s30, s31, 0
  buffer_load_dwordx4 v3, s[4:7], s30 offen sc1 lds
  s_add_u32 m0, s38, 4096
  s_add_u32 s30, s31, 4096
  buffer_load_dwordx4 v3, s[4:7], s30 offen sc1 lds
  s_add_u32 m0, s38, 9216
  s_add_u32 s30, s32, 0
  buffer_load_dwordx4 v3, s[4:7], s30 offen sc1 lds
  s_add_u32 m0, s38, 13312
  s_add_u32 s30, s32, 589824
  buffer_load_dwordx4 v3, s[4:7], s30 offen sc1 lds
  s_waitcnt vmcnt(16)
  s_barrier
  s_add_u32 s32, s96, 7
  s_and_b32 s32, s32, 7
  s_add_u32 s32, s32, s94
  s_mul_i32 s31, s32, 36864
  s_add_u32 s31, s31, s34
  s_lshl_b32 s32, s32, 10
  s_add_u32 s32, s32, s36
  s_cmp_eq_u32 s19, 0
  s_cbranch_scc0 L_skip_131
  s_add_u32 m0, s38, 25600
  s_add_u32 s30, s31, 8192
  buffer_load_dwordx4 v3, s[4:7], s30 offen sc1 lds
L_skip_131:
  s_add_u32 m0, s38, 17408
  s_add_u32 s30, s31, 0
  buffer_load_dwordx4 v3, s[4:7], s30 offen sc1 lds
  s_add_u32 m0, s38, 21504
  s_add_u32 s30, s31, 4096
  buffer_load_dwordx4 v3, s[4:7], s30 offen sc1 lds
  s_add_u32 m0, s38, 26624
  s_add_u32 s30, s32, 0
  buffer_load_dwordx4 v3, s[4:7], s30 offen sc1 lds
  s_add_u32 m0, s38, 30720
  s_add_u32 s30, s32, 589824
  buffer_load_dwordx4 v3, s[4:7], s30 offen sc1 lds
  s_mov_b32 s32, s14
  s_mul_i32 s31, s32, 36864
  s_add_u32 s31, s31, s34
  s_lshl_b32 s32, s32, 10
  s_add_u32 s32, s32, s36
  s_cmp_eq_u32 s19, 0
  s_cbranch_scc0 L_skip_132
  s_add_u32 m0, s38, 43008
  s_add_u32 s30, s31, 8192
  buffer_load_dwordx4 v3, s[4:7], s30 offen sc1 lds
L_skip_132:
  s_add_u32 m0, s38, 34816
  s_add_u32 s30, s31, 0
  buffer_load_dwordx4 v3, s[4:7], s30 offen sc1 lds
  s_add_u32 m0, s38, 38912
  s_add_u32 s30, s31, 4096
  buffer_load_dwordx4 v3, s[4:7], s30 offen sc1 lds
  s_add_u32 m0, s38, 44032
  s_add_u32 s30, s32, 0
  buffer_load_dwordx4 v3, s[4:7], s30 offen sc1 lds
  s_add_u32 m0, s38, 48128
  s_add_u32 s30, s32, 589824
  buffer_load_dwordx4 v3, s[4:7], s30 offen sc1 lds
  s_waitcnt vmcnt(16)
  s_barrier
  s_add_u32 s32, s96, 0
  s_and_b32 s32, s32, 7
  s_add_u32 s32, s32, s95
  s_mul_i32 s31, s32, 36864
  s_add_u32 s31, s31, s34
  s_lshl_b32 s32, s32, 10
  s_add_u32 s32, s32, s36
  s_cmp_eq_u32 s19, 0
  s_cbranch_scc0 L_skip_133
  s_add_u32 m0, s38, 60416
  s_add_u32 s30, s31, 8192
  buffer_load_dwordx4 v3, s[4:7], s30 offen sc1 lds
L_skip_133:
  s_add_u32 m0, s38, 52224
  s_add_u32 s30, s31, 0
  buffer_load_dwordx4 v3, s[4:7], s30 offen sc1 lds
  s_add_u32 m0, s38, 56320
  s_add_u32 s30, s31, 4096
  buffer_load_dwordx4 v3, s[4:7], s30 offen sc1 lds
  s_add_u32 m0, s38, 61440
  s_add_u32 s30, s32, 0
  buffer_load_dwordx4 v3, s[4:7], s30 offen sc1 lds
  s_add_u32 m0, s38, 65536
  s_add_u32 s30, s32, 589824
  buffer_load_dwordx4 v3, s[4:7], s30 offen sc1 lds
  s_add_u32 s32, s96, 1
  s_and_b32 s32, s32, 7
  s_add_u32 s32, s32, s95
  s_mul_i32 s31, s32, 36864
  s_add_u32 s31, s31, s34
  s_lshl_b32 s32, s32, 10
  s_add_u32 s32, s32, s36
  s_cmp_eq_u32 s19, 0
  s_cbranch_scc0 L_skip_134
  s_add_u32 m0, s38, 81920
  s_add_u32 s30, s31, 8192
  buffer_load_dwordx4 v3, s[4:7], s30 offen sc1 lds
L_skip_134:
  s_add_u32 m0, s38, 73728
  s_add_u32 s30, s31, 0
  buffer_load_dwordx4 v3, s[4:7], s30 offen sc1 lds
  s_add_u32 m0, s38, 77824
  s_add_u32 s30, s31, 4096
  buffer_load_dwordx4 v3, s[4:7], s30 offen sc1 lds
  s_add_u32 m0, s38, 82944
  s_add_u32 s30, s32, 0
  buffer_load_dwordx4 v3, s[4:7], s30 offen sc1 lds
  s_add_u32 m0, s38, 87040
  s_add_u32 s30, s32, 589824
  buffer_load_dwordx4 v3, s[4:7], s30 offen sc1 lds
  s_waitcnt vmcnt(16)
  s_barrier
  s_cmp_eq_u32 s18, 6
  s_cbranch_scc0 L_skip_135
  s_mov_b32 s29, 0x33e7000
  buffer_load_dword v8, v3, s[4:7], s29 offen offset:0 sc1
  buffer_load_dword v9, v3, s[4:7], s29 offen offset:1024 sc1
  buffer_load_dword v10, v3, s[4:7], s29 offen offset:2048 sc1
  buffer_load_dword v11, v3, s[4:7], s29 offen offset:3072 sc1
L_skip_135:
  s_add_u32 s32, s96, 2
  s_and_b32 s32, s32, 7
  s_add_u32 s32, s32, s95
  s_mul_i32 s31, s32, 36864
  s_add_u32 s31, s31, s34
  s_lshl_b32 s32, s32, 10
  s_add_u32 s32, s32, s36
  s_cmp_eq_u32 s19, 0
  s_cbranch_scc0 L_skip_136
  s_add_u32 m0, s38, 99328
  s_add_u32 s30, s31, 8192
  buffer_load_dwordx4 v3, s[4:7], s30 offen sc1 lds
L_skip_136:
  s_add_u32 m0, s38, 91136
  s_add_u32 s30, s31, 0
  buffer_load_dwordx4 v3, s[4:7], s30 offen sc1 lds
  s_add_u32 m0, s38, 95232
  s_add_u32 s30, s31, 4096
  buffer_load_dwordx4 v3, s[4:7], s30 offen sc1 lds
  s_add_u32 m0, s38, 100352
  s_add_u32 s30, s32, 0
  buffer_load_dwordx4 v3, s[4:7], s30 offen sc1 lds
  s_add_u32 m0, s38, 104448
  s_add_u32 s30, s32, 589824
  buffer_load_dwordx4 v3, s[4:7], s30 offen sc1 lds
  s_add_u32 s32, s96, 3
  s_and_b32 s32, s32, 7
  s_add_u32 s32, s32, s95
  s_mul_i32 s31, s32, 36864
  s_add_u32 s31, s31, s34
  s_lshl_b32 s32, s32, 10
  s_add_u32 s32, s32, s36
  s_cmp_eq_u32 s19, 0
  s_cbranch_scc0 L_skip_137
  s_add_u32 m0, s38, 116736
  s_add_u32 s30, s31, 8192
  buffer_load_dwordx4 v3, s[4:7], s30 offen sc1 lds
L_skip_137:
  s_add_u32 m0, s38, 108544
  s_add_u32 s30, s31, 0
  buffer_load_dwordx4 v3, s[4:7], s30 offen sc1 lds
  s_add_u32 m0, s38, 112640
  s_add_u32 s30, s31, 4096
  buffer_load_dwordx4 v3, s[4:7], s30 offen sc1 lds
  s_add_u32 m0, s38, 117760
  s_add_u32 s30, s32, 0
  buffer_load_dwordx4 v3, s[4:7], s30 offen sc1 lds
  s_add_u32 m0, s38, 121856
  s_add_u32 s30, s32, 589824
  buffer_load_dwordx4 v3, s[4:7], s30 offen sc1 lds
  s_waitcnt vmcnt(16)
  s_barrier
  s_add_u32 s32, s96, 4
  s_and_b32 s32, s32, 7
  s_add_u32 s32, s32, s95
  s_mul_i32 s31, s32, 36864
  s_add_u32 s31, s31, s34
  s_lshl_b32 s32, s32, 10
  s_add_u32 s32, s32, s36
  s_cmp_eq_u32 s19, 0
  s_cbranch_scc0 L_skip_138
  s_add_u32 m0, s38, 134144
  s_add_u32 s30, s31, 8192
  buffer_load_dwordx4 v3, s[4:7], s30 offen sc1 lds
L_skip_138:
  s_add_u32 m0, s38, 125952
  s_add_u32 s30, s31, 0
  buffer_load_dwordx4 v3, s[4:7], s30 offen sc1 lds
  s_add_u32 m0, s38, 130048
  s_add_u32 s30, s31, 4096
  buffer_load_dwordx4 v3, s[4:7], s30 offen sc1 lds
  s_add_u32 m0, s38, 135168
  s_add_u32 s30, s32, 0
  buffer_load_dwordx4 v3, s[4:7], s30 offen sc1 lds
  s_add_u32 m0, s38, 139264
  s_add_u32 s30, s32, 589824
  buffer_load_dwordx4 v3, s[4:7], s30 offen sc1 lds
  s_add_u32 s32, s96, 5
  s_and_b32 s32, s32, 7
  s_add_u32 s32, s32, s95
  s_mul_i32 s31, s32, 36864
  s_add_u32 s31, s31, s34
  s_lshl_b32 s32, s32, 10
  s_add_u32 s32, s32, s36
  s_cmp_eq_u32 s19, 0
  s_cbranch_scc0 L_skip_139
  s_add_u32 m0, s38, 8192
  s_add_u32 s30, s31, 8192
  buffer_load_dwordx4 v3, s[4:7], s30 offen sc1 lds
L_skip_139:
  s_add_u32 m0, s38, 0
  s_add_u32 s30, s31, 0
  buffer_load_dwordx4 v3, s[4:7], s30 offen sc1 lds
  s_add_u32 m0, s38, 4096
  s_add_u32 s30, s31, 4096
  buffer_load_dwordx4 v3, s[4:7], s30 offen sc1 lds
  s_add_u32 m0, s38, 9216
  s_add_u32 s30, s32, 0
  buffer_load_dwordx4 v3, s[4:7], s30 offen sc1 lds
  s_add_u32 m0, s38, 13312
  s_add_u32 s30, s32, 589824
  buffer_load_dwordx4 v3, s[4:7], s30 offen sc1 lds
  s_waitcnt vmcnt(16)
  s_barrier
  s_add_u32 s32, s96, 6
  s_and_b32 s32, s32, 7
  s_add_u32 s32, s32, s95
  s_mul_i32 s31, s32, 36864
  s_add_u32 s31, s31, s34
  s_lshl_b32 s32, s32, 10
  s_add_u32 s32, s32, s36
  s_cmp_eq_u32 s19, 0
  s_cbranch_scc0 L_skip_140
  s_add_u32 m0, s38, 25600
  s_add_u32 s30, s31, 8192
  buffer_load_dwordx4 v3, s[4:7], s30 offen sc1 lds
L_skip_140:
  s_add_u32 m0, s38, 17408
  s_add_u32 s30, s31, 0
  buffer_load_dwordx4 v3, s[4:7], s30 offen sc1 lds
  s_add_u32 m0, s38, 21504
  s_add_u32 s30, s31, 4096
  buffer_load_dwordx4 v3, s[4:7], s30 offen sc1 lds
  s_add_u32 m0, s38, 26624
  s_add_u32 s30, s32, 0
  buffer_load_dwordx4 v3, s[4:7], s30 offen sc1 lds
  s_add_u32 m0, s38, 30720
  s_add_u32 s30, s32, 589824
  buffer_load_dwordx4 v3, s[4:7], s30 offen sc1 lds
  s_add_u32 s32, s96, 7
  s_and_b32 s32, s32, 7
  s_add_u32 s32, s32, s95
  s_mul_i32 s31, s32, 36864
  s_add_u32 s31, s31, s34
  s_lshl_b32 s32, s32, 10
  s_add_u32 s32, s32, s36
  s_cmp_eq_u32 s19, 0
  s_cbranch_scc0 L_skip_141
  s_add_u32 m0, s38, 43008
  s_add_u32 s30, s31, 8192
  buffer_load_dwordx4 v3, s[4:7], s30 offen sc1 lds
L_skip_141:
  s_add_u32 m0, s38, 34816
  s_add_u32 s30, s31, 0
  buffer_load_dwordx4 v3, s[4:7], s30 offen sc1 lds
  s_add_u32 m0, s38, 38912
  s_add_u32 s30, s31, 4096
  buffer_load_dwordx4 v3, s[4:7], s30 offen sc1 lds
  s_add_u32 m0, s38, 44032
  s_add_u32 s30, s32, 0
  buffer_load_dwordx4 v3, s[4:7], s30 offen sc1 lds
  s_add_u32 m0, s38, 48128
  s_add_u32 s30, s32, 589824
  buffer_load_dwordx4 v3, s[4:7], s30 offen sc1 lds
  s_waitcnt vmcnt(16)
  s_cmp_eq_u32 s18, 6
  s_cbranch_scc0 L_aok_142
  s_waitcnt vmcnt(24)
  s_add_u32 s28, s59, 0
  v_subrev_u32 v8, s28, v8
  v_subrev_u32 v9, s28, v9
  v_subrev_u32 v10, s28, v10
  v_subrev_u32 v11, s28, v11
  v_max_u32 v8, v8, v9
  v_max_u32 v8, v8, v10
  v_max_u32 v8, v8, v11
  v_cmp_ge_u32 vcc, 0, v8
  s_nop 1
  s_cmp_eq_u64 vcc, -1
  s_cbranch_scc1 L_aok_142
  s_mov_b32 s33, 0
L_aspin_143:
  s_mov_b32 s29, 0x33e7000
  buffer_load_dword v8, v3, s[4:7], s29 offen offset:0 sc1
  buffer_load_dword v9, v3, s[4:7], s29 offen offset:1024 sc1
  buffer_load_dword v10, v3, s[4:7], s29 offen offset:2048 sc1
  buffer_load_dword v11, v3, s[4:7], s29 offen offset:3072 sc1
  s_waitcnt vmcnt(0)
  s_add_u32 s28, s59, 0
  v_subrev_u32 v8, s28, v8
  v_subrev_u32 v9, s28, v9
  v_subrev_u32 v10, s28, v10
  v_subrev_u32 v11, s28, v11
  v_max_u32 v8, v8, v9
  v_max_u32 v8, v8, v10
  v_max_u32 v8, v8, v11
  v_cmp_ge_u32 vcc, 0, v8
  s_nop 1
  s_cmp_eq_u64 vcc, -1
  s_cbranch_scc1 L_spinout_144
  s_sleep 8
  s_add_u32 s33, s33, 1
  s_cmp_lt_u32 s33, 0x40000
  s_cbranch_scc1 L_aspin_143
L_spinout_144:
L_aok_142:
  s_barrier
  s_mov_b32 s32, s15
  s_mul_i32 s31, s32, 36864
  s_add_u32 s31, s31, s34
  s_lshl_b32 s32, s32, 10
  s_add_u32 s32, s32, s36
  s_cmp_eq_u32 s19, 0
  s_cbranch_scc0 L_skip_145
  s_add_u32 m0, s38, 60416
  s_add_u32 s30, s31, 8192
  buffer_load_dwordx4 v3, s[4:7], s30 offen sc1 lds
L_skip_145:
  s_add_u32 m0, s38, 52224
  s_add_u32 s30, s31, 0
  buffer_load_dwordx4 v3, s[4:7], s30 offen sc1 lds
  s_add_u32 m0, s38, 56320
  s_add_u32 s30, s31, 4096
  buffer_load_dwordx4 v3, s[4:7], s30 offen sc1 lds
  s_add_u32 m0, s38, 61440
  s_add_u32 s30, s32, 0
  buffer_load_dwordx4 v3, s[4:7], s30 offen sc1 lds
  s_add_u32 m0, s38, 65536
  s_add_u32 s30, s32, 589824
  buffer_load_dwordx4 v3, s[4:7], s30 offen sc1 lds
  s_add_u32 s31, s35, 0
  s_cmp_eq_u32 s19, 0
  s_cbranch_scc0 L_skip_146
  s_add_u32 m0, s38, 81920
  s_add_u32 s30, s31, 8192
  buffer_load_dwordx4 v3, s[4:7], s30 offen sc1 lds
L_skip_146:
  s_add_u32 m0, s38, 73728
  s_add_u32 s30, s31, 0
  buffer_load_dwordx4 v3, s[4:7], s30 offen sc1 lds
  s_add_u32 m0, s38, 77824
  s_add_u32 s30, s31, 4096
  buffer_load_dwordx4 v3, s[4:7], s30 offen sc1 lds
  s_add_u32 m0, s38, 82944
  s_add_u32 s30, s37, 0
  buffer_load_dwordx4 v4, s[4:7], s30 offen sc1 lds
  s_add_u32 m0, s38, 87040
  s_add_u32 s30, s37, 65536
  buffer_load_dwordx4 v4, s[4:7], s30 offen sc1 lds
  s_waitcnt vmcnt(16)
  s_barrier
  s_add_u32 s31, s35, 36864
  s_cmp_eq_u32 s19, 0
  s_cbranch_scc0 L_skip_147
  s_add_u32 m0, s38, 99328
  s_add_u32 s30, s31, 8192
  buffer_load_dwordx4 v3, s[4:7], s30 offen sc1 lds
L_skip_147:
  s_add_u32 m0, s38, 91136
  s_add_u32 s30, s31, 0
  buffer_load_dwordx4 v3, s[4:7], s30 offen sc1 lds
  s_add_u32 m0, s38, 95232
  s_add_u32 s30, s31, 4096
  buffer_load_dwordx4 v3, s[4:7], s30 offen sc1 lds
  s_add_u32 m0, s38, 100352
  s_add_u32 s30, s37, 131072
  buffer_load_dwordx4 v4, s[4:7], s30 offen sc1 lds
  s_add_u32 m0, s38, 104448
  s_add_u32 s30, s37, 196608
  buffer_load_dwordx4 v4, s[4:7], s30 offen sc1 lds
  s_add_u32 s31, s35, 73728
  s_cmp_eq_u32 s19, 0
  s_cbranch_scc0 L_skip_148
  s_add_u32 m0, s38, 116736
  s_add_u32 s30, s31, 8192
  buffer_load_dwordx4 v3, s[4:7], s30 offen sc1 lds
L_skip_148:
  s_add_u32 m0, s38, 108544
  s_add_u32 s30, s31, 0
  buffer_load_dwordx4 v3, s[4:7], s30 offen sc1 lds
  s_add_u32 m0, s38, 112640
  s_add_u32 s30, s31, 4096
  buffer_load_dwordx4 v3, s[4:7], s30 offen sc1 lds
  s_add_u32 m0, s38, 117760
  s_add_u32 s30, s37, 262144
  buffer_load_dwordx4 v4, s[4:7], s30 offen sc1 lds
  s_add_u32 m0, s38, 121856
  s_add_u32 s30, s37, 327680
  buffer_load_dwordx4 v4, s[4:7], s30 offen sc1 lds
  s_waitcnt vmcnt(16)
  s_barrier
  s_add_u32 s31, s35, 110592
  s_cmp_eq_u32 s19, 0
  s_cbranch_scc0 L_skip_149
  s_add_u32 m0, s38, 134144
  s_add_u32 s30, s31, 8192
  buffer_load_dwordx4 v3, s[4:7], s30 offen sc1 lds
L_skip_149:
  s_add_u32 m0, s38, 125952
  s_add_u32 s30, s31, 0
  buffer_load_dwordx4 v3, s[4:7], s30 offen sc1 lds
  s_add_u32 m0, s38, 130048
  s_add_u32 s30, s31, 4096
  buffer_load_dwordx4 v3, s[4:7], s30 offen sc1 lds
  s_add_u32 m0, s38, 135168
  s_add_u32 s30, s37, 393216
  buffer_load_dwordx4 v4, s[4:7], s30 offen sc1 lds
  s_add_u32 m0, s38, 139264
  s_add_u32 s30, s37, 458752
  buffer_load_dwordx4 v4, s[4:7], s30 offen sc1 lds
  s_add_u32 s31, s35, 147456
  s_cmp_eq_u32 s19, 0
  s_cbranch_scc0 L_skip_150
  s_add_u32 m0, s38, 8192
  s_add_u32 s30, s31, 8192
  buffer_load_dwordx4 v3, s[4:7], s30 offen sc1 lds
L_skip_150:
  s_add_u32 m0, s38, 0
  s_add_u32 s30, s31, 0
  buffer_load_dwordx4 v3, s[4:7], s30 offen sc1 lds
  s_add_u32 m0, s38, 4096
  s_add_u32 s30, s31, 4096
  buffer_load_dwordx4 v3, s[4:7], s30 offen sc1 lds
  s_add_u32 m0, s38, 9216
  s_add_u32 s30, s37, 524288
  buffer_load_dwordx4 v4, s[4:7], s30 offen sc1 lds
  s_add_u32 m0, s38, 13312
  s_add_u32 s30, s37, 589824
  buffer_load_dwordx4 v4, s[4:7], s30 offen sc1 lds
  s_waitcnt vmcnt(16)
  s_barrier
  s_waitcnt vmcnt(8)
  s_barrier
  s_waitcnt vmcnt(0)
  s_barrier
  s_waitcnt vmcnt(0)
  s_barrier
  s_load_dwordx4 s[52:55], s[0:1], 56
  v_and_b32 v4, 15, v1
  s_lshl_b32 s28, s16, 7
  s_lshl_b32 s29, s26, 5
  s_add_u32 s28, s28, s29
  v_add_u32 v4, s28, v4
  v_mul_u32_u24 v4, 1152, v4
  v_lshrrev_b32 v5, 4, v1
  v_lshlrev_b32 v5, 3, v5
  s_mul_i32 s28, s27, 288
  s_lshl_b32 s29, s18, 5
  s_add_u32 s28, s28, s29
  v_add_u32 v5, s28, v5
  v_add_u32 v4, v4, v5
  v_add_u32 v6, 18432, v4
  s_lshl_b32 s30, s18, 11
  v_add_u32 v7, s30, v3
  v_add_u32 v7, 143360, v7
  v_and_b32 v8, 3, v1
  v_min_u32 v8, 2, v8
  s_add_u32 s28, s26, 1
  v_add_u32 v8, s28, v8
  v_and_b32 v8, 3, v8
  v_lshlrev_b32 v8, 2, v8
  s_lshl_b32 s34, s2, 7
  s_add_u32 s34, s34, 0x33e8000
  s_mul_i32 s35, s2, 36864
  s_lshl_b32 s30, s18, 10
  s_add_u32 s35, s35, s30
  s_add_u32 s35, s35, 0x21e4000
  s_waitcnt lgkmcnt(0)
  s_mov_b32 s44, s52
  s_and_b32 s45, s53, 0xffff
  s_mov_b32 s46, 0x480
  s_mov_b32 s47, 0x00020000
  s_mov_b32 s48, s54
  s_and_b32 s49, s55, 0xffff
  s_mov_b32 s50, 0x240000
  s_mov_b32 s51, 0x00020000
  buffer_load_dwordx2 v[16:17], v4, s[40:43], 0 offen offset:0
  buffer_load_dwordx2 v[18:19], v6, s[40:43], 0 offen offset:0
  buffer_load_dwordx2 v[24:25], v5, s[44:47], 0 offen offset:0
  s_cmp_eq_u32 s18, 0
  s_cbranch_scc0 L_f8_151
  buffer_load_dwordx2 v[20:21], v4, s[40:43], 0 offen offset:256
  buffer_load_dwordx2 v[22:23], v6, s[40:43], 0 offen offset:256
  buffer_load_dwordx2 v[26:27], v5, s[44:47], 0 offen offset:256
L_f8_151:
  s_barrier
  ds_read_b128 v[64:67], v7 offset:0
  ds_read_b128 v[68:71], v7 offset:1024
  s_cmp_eq_u32 s18, 0
  s_cbranch_scc0 L_f8_152
  ds_read_b128 v[72:75], v7 offset:16384
  ds_read_b128 v[76:79], v7 offset:17408
L_f8_152:
  s_mov_b32 s33, 0
L_xpoll_153:
  buffer_load_dword v9, v8, s[4:7], s34 offen sc1
  s_waitcnt vmcnt(0)
  s_add_u32 s28, s59, 0
  v_subrev_u32 v9, s28, v9
  v_cmp_ge_u32 vcc, 0, v9
  s_nop 1
  s_cmp_eq_u64 vcc, -1
  s_cbranch_scc1 L_spinout_154
  s_sleep 2
  s_add_u32 s33, s33, 1
  s_cmp_lt_u32 s33, 0x40000
  s_cbranch_scc1 L_xpoll_153
L_spinout_154:
  s_add_u32 s29, s26, 1
  s_and_b32 s29, s29, 3
  s_mul_i32 s29, s29, 9216
  s_add_u32 s29, s29, s35
  buffer_load_dwordx4 v[32:35], v3, s[4:7], s29 offen sc1
  s_add_u32 s29, s26, 2
  s_and_b32 s29, s29, 3
  s_mul_i32 s29, s29, 9216
  s_add_u32 s29, s29, s35
  buffer_load_dwordx4 v[36:39], v3, s[4:7], s29 offen sc1
  s_add_u32 s29, s26, 3
  s_and_b32 s29, s29, 3
  s_mul_i32 s29, s29, 9216
  s_add_u32 s29, s29, s35
  buffer_load_dwordx4 v[40:43], v3, s[4:7], s29 offen sc1
  s_cmp_eq_u32 s18, 0
  s_cbranch_scc0 L_f8_155
  s_add_u32 s29, s26, 1
  s_and_b32 s29, s29, 3
  s_mul_i32 s29, s29, 9216
  s_add_u32 s29, s29, s35
  s_add_u32 s29, s29, 8192
  buffer_load_dwordx4 v[44:47], v3, s[4:7], s29 offen sc1
  s_add_u32 s29, s26, 2
  s_and_b32 s29, s29, 3
  s_mul_i32 s29, s29, 9216
  s_add_u32 s29, s29, s35
  s_add_u32 s29, s29, 8192
  buffer_load_dwordx4 v[48:51], v3, s[4:7], s29 offen sc1
  s_add_u32 s29, s26, 3
  s_and_b32 s29, s29, 3
  s_mul_i32 s29, s29, 9216
  s_add_u32 s29, s29, s35
  s_add_u32 s29, s29, 8192
  buffer_load_dwordx4 v[52:55], v3, s[4:7], s29 offen sc1
L_f8_155:
  s_waitcnt lgkmcnt(0)
  v_lshlrev_b32 v10, 16, v16
  v_and_b32 v11, 0xffff0000, v16
  v_add_f32 v64, v64, v10
  v_add_f32 v65, v65, v11
  v_lshlrev_b32 v10, 16, v24
  v_and_b32 v11, 0xffff0000, v24
  v_add_f32 v64, v64, v10
  v_add_f32 v65, v65, v11
  v_lshlrev_b32 v10, 16, v17
  v_and_b32 v11, 0xffff0000, v17
  v_add_f32 v66, v66, v10
  v_add_f32 v67, v67, v11
  v_lshlrev_b32 v10, 16, v25
  v_and_b32 v11, 0xffff0000, v25
  v_add_f32 v66, v66, v10
  v_add_f32 v67, v67, v11
  v_lshlrev_b32 v10, 16, v18
  v_and_b32 v11, 0xffff0000, v18
  v_add_f32 v68, v68, v10
  v_add_f32 v69, v69, v11
  v_lshlrev_b32 v10, 16, v24
  v_and_b32 v11, 0xffff0000, v24
  v_add_f32 v68, v68, v10
  v_add_f32 v69, v69, v11
  v_lshlrev_b32 v10, 16, v19
  v_and_b32 v11, 0xffff0000, v19
  v_add_f32 v70, v70, v10
  v_add_f32 v71, v71, v11
  v_lshlrev_b32 v10, 16, v25
  v_and_b32 v11, 0xffff0000, v25
  v_add_f32 v70, v70, v10
  v_add_f32 v71, v71, v11
  s_cmp_eq_u32 s18, 0
  s_cbranch_scc0 L_f8_156
  v_lshlrev_b32 v10, 16, v20
  v_and_b32 v11, 0xffff0000, v20
  v_add_f32 v72, v72, v10
  v_add_f32 v73, v73, v11
  v_lshlrev_b32 v10, 16, v26
  v_and_b32 v11, 0xffff0000, v26
  v_add_f32 v72, v72, v10
  v_add_f32 v73, v73, v11
  v_lshlrev_b32 v10, 16, v21
  v_and_b32 v11, 0xffff0000, v21
  v_add_f32 v74, v74, v10
  v_add_f32 v75, v75, v11
  v_lshlrev_b32 v10, 16, v27
  v_and_b32 v11, 0xffff0000, v27
  v_add_f32 v74, v74, v10
  v_add_f32 v75, v75, v11
  v_lshlrev_b32 v10, 16, v22
  v_and_b32 v11, 0xffff0000, v22
  v_add_f32 v76, v76, v10
  v_add_f32 v77, v77, v11
  v_lshlrev_b32 v10, 16, v26
  v_and_b32 v11, 0xffff0000, v26
  v_add_f32 v76, v76, v10
  v_add_f32 v77, v77, v11
  v_lshlrev_b32 v10, 16, v23
  v_and_b32 v11, 0xffff0000, v23
  v_add_f32 v78, v78, v10
  v_add_f32 v79, v79, v11
  v_lshlrev_b32 v10, 16, v27
  v_and_b32 v11, 0xffff0000, v27
  v_add_f32 v78, v78, v10
  v_add_f32 v79, v79, v11
L_f8_156:
  s_waitcnt vmcnt(0)
  v_lshlrev_b32 v10, 16, v32
  v_and_b32 v11, 0xffff0000, v32
  v_add_f32 v64, v64, v10
  v_add_f32 v65, v65, v11
  v_lshlrev_b32 v10, 16, v33
  v_and_b32 v11, 0xffff0000, v33
  v_add_f32 v66, v66, v10
  v_add_f32 v67, v67, v11
  v_lshlrev_b32 v10, 16, v34
  v_and_b32 v11, 0xffff0000, v34
  v_add_f32 v68, v68, v10
  v_add_f32 v69, v69, v11
  v_lshlrev_b32 v10, 16, v35
  v_and_b32 v11, 0xffff0000, v35
  v_add_f32 v70, v70, v10
  v_add_f32 v71, v71, v11
  v_lshlrev_b32 v10, 16, v36
  v_and_b32 v11, 0xffff0000, v36
  v_add_f32 v64, v64, v10
  v_add_f32 v65, v65, v11
  v_lshlrev_b32 v10, 16, v37
  v_and_b32 v11, 0xffff0000, v37
  v_add_f32 v66, v66, v10
  v_add_f32 v67, v67, v11
  v_lshlrev_b32 v10, 16, v38
  v_and_b32 v11, 0xffff0000, v38
  v_add_f32 v68, v68, v10
  v_add_f32 v69, v69, v11
  v_lshlrev_b32 v10, 16, v39
  v_and_b32 v11, 0xffff0000, v39
  v_add_f32 v70, v70, v10
  v_add_f32 v71, v71, v11
  v_lshlrev_b32 v10, 16, v40
  v_and_b32 v11, 0xffff0000, v40
  v_add_f32 v64, v64, v10
  v_add_f32 v65, v65, v11
  v_lshlrev_b32 v10, 16, v41
  v_and_b32 v11, 0xffff0000, v41
  v_add_f32 v66, v66, v10
  v_add_f32 v67, v67, v11
  v_lshlrev_b32 v10, 16, v42
  v_and_b32 v11, 0xffff0000, v42
  v_add_f32 v68, v68, v10
  v_add_f32 v69, v69, v11
  v_lshlrev_b32 v10, 16, v43
  v_and_b32 v11, 0xffff0000, v43
  v_add_f32 v70, v70, v10
  v_add_f32 v71, v71, v11
  v_cvt_pk_bf16_f32 v16, v64, v65
  v_cvt_pk_bf16_f32 v17, v66, v67
  v_cvt_pk_bf16_f32 v18, v68, v69
  v_cvt_pk_bf16_f32 v19, v70, v71
  buffer_store_dwordx2 v[16:17], v4, s[48:51], 0 offen offset:0
  buffer_store_dwordx2 v[18:19], v6, s[48:51], 0 offen offset:0
  s_cmp_eq_u32 s18, 0
  s_cbranch_scc0 L_f8_157
  v_lshlrev_b32 v10, 16, v44
  v_and_b32 v11, 0xffff0000, v44
  v_add_f32 v72, v72, v10
  v_add_f32 v73, v73, v11
  v_lshlrev_b32 v10, 16, v45
  v_and_b32 v11, 0xffff0000, v45
  v_add_f32 v74, v74, v10
  v_add_f32 v75, v75, v11
  v_lshlrev_b32 v10, 16, v46
  v_and_b32 v11, 0xffff0000, v46
  v_add_f32 v76, v76, v10
  v_add_f32 v77, v77, v11
  v_lshlrev_b32 v10, 16, v47
  v_and_b32 v11, 0xffff0000, v47
  v_add_f32 v78, v78, v10
  v_add_f32 v79, v79, v11
  v_lshlrev_b32 v10, 16, v48
  v_and_b32 v11, 0xffff0000, v48
  v_add_f32 v72, v72, v10
  v_add_f32 v73, v73, v11
  v_lshlrev_b32 v10, 16, v49
  v_and_b32 v11, 0xffff0000, v49
  v_add_f32 v74, v74, v10
  v_add_f32 v75, v75, v11
  v_lshlrev_b32 v10, 16, v50
  v_and_b32 v11, 0xffff0000, v50
  v_add_f32 v76, v76, v10
  v_add_f32 v77, v77, v11
  v_lshlrev_b32 v10, 16, v51
  v_and_b32 v11, 0xffff0000, v51
  v_add_f32 v78, v78, v10
  v_add_f32 v79, v79, v11
  v_lshlrev_b32 v10, 16, v52
  v_and_b32 v11, 0xffff0000, v52
  v_add_f32 v72, v72, v10
  v_add_f32 v73, v73, v11
  v_lshlrev_b32 v10, 16, v53
  v_and_b32 v11, 0xffff0000, v53
  v_add_f32 v74, v74, v10
  v_add_f32 v75, v75, v11
  v_lshlrev_b32 v10, 16, v54
  v_and_b32 v11, 0xffff0000, v54
  v_add_f32 v76, v76, v10
  v_add_f32 v77, v77, v11
  v_lshlrev_b32 v10, 16, v55
  v_and_b32 v11, 0xffff0000, v55
  v_add_f32 v78, v78, v10
  v_add_f32 v79, v79, v11
  v_cvt_pk_bf16_f32 v20, v72, v73
  v_cvt_pk_bf16_f32 v21, v74, v75
  v_cvt_pk_bf16_f32 v22, v76, v77
  v_cvt_pk_bf16_f32 v23, v78, v79
  buffer_store_dwordx2 v[20:21], v4, s[48:51], 0 offen offset:256
  buffer_store_dwordx2 v[22:23], v6, s[48:51], 0 offen offset:256
L_f8_157:
  s_endpgm
L_nofft_84:
  s_waitcnt vmcnt(6)
  s_barrier
  v_mul_f32 v72, v16, v16
  v_mul_f32 v73, v17, v17
  v_mul_f32 v74, v18, v18
  v_mul_f32 v75, v19, v19
  v_mul_f32 v76, v20, v20
  v_mul_f32 v77, v21, v21
  v_mul_f32 v78, v22, v22
  v_mul_f32 v79, v23, v23
  v_fma_f32 v72, v72, v10, v9
  v_fma_f32 v73, v73, v10, v9
  v_fma_f32 v74, v74, v10, v9
  v_fma_f32 v75, v75, v10, v9
  v_fma_f32 v76, v76, v10, v9
  v_fma_f32 v77, v77, v10, v9
  v_fma_f32 v78, v78, v10, v9
  v_fma_f32 v79, v79, v10, v9
  v_mul_f32 v72, v16, v72
  v_mul_f32 v73, v17, v73
  v_mul_f32 v74, v18, v74
  v_mul_f32 v75, v19, v75
  v_mul_f32 v76, v20, v76
  v_mul_f32 v77, v21, v77
  v_mul_f32 v78, v22, v78
  v_mul_f32 v79, v23, v79
  v_exp_f32 v72, v72
  v_exp_f32 v73, v73
  v_exp_f32 v74, v74
  v_exp_f32 v75, v75
  v_exp_f32 v76, v76
  v_exp_f32 v77, v77
  v_exp_f32 v78, v78
  v_exp_f32 v79, v79
  v_fma_f32 v72, v72, v11, v11
  v_fma_f32 v73, v73, v11, v11
  v_fma_f32 v74, v74, v11, v11
  v_fma_f32 v75, v75, v11, v11
  v_fma_f32 v76, v76, v11, v11
  v_fma_f32 v77, v77, v11, v11
  v_fma_f32 v78, v78, v11, v11
  v_fma_f32 v79, v79, v11, v11
  v_rcp_f32 v72, v72
  v_rcp_f32 v73, v73
  v_rcp_f32 v74, v74
  v_rcp_f32 v75, v75
  v_rcp_f32 v76, v76
  v_rcp_f32 v77, v77
  v_rcp_f32 v78, v78
  v_rcp_f32 v79, v79
  v_mul_f32 v72, v16, v72
  v_mul_f32 v73, v17, v73
  v_mul_f32 v74, v18, v74
  v_mul_f32 v75, v19, v75
  v_mul_f32 v76, v20, v76
  v_mul_f32 v77, v21, v77
  v_mul_f32 v78, v22, v78
  v_mul_f32 v79, v23, v79
  v_cvt_pk_bf16_f32 v80, v72, v73
  v_cvt_pk_bf16_f32 v81, v74, v75
  v_cvt_pk_bf16_f32 v82, v76, v77
  v_cvt_pk_bf16_f32 v83, v78, v79
  s_add_u32 s28, s39, s36
  s_lshl_b32 s28, s28, 10
  buffer_store_dwordx4 v[80:83], v7, s[4:7], s28 offen offset:0 sc1
  s_cmp_eq_u32 s18, 5
  s_cbranch_scc0 L_aok_158
  s_waitcnt vmcnt(1)
  s_add_u32 s28, s59, 0
  v_subrev_u32 v232, s28, v232
  v_subrev_u32 v233, s28, v233
  v_subrev_u32 v234, s28, v234
  v_subrev_u32 v235, s28, v235
  v_max_u32 v232, v232, v233
  v_max_u32 v232, v232, v234
  v_max_u32 v232, v232, v235
  v_cmp_ge_u32 vcc, 0, v232
  s_nop 1
  s_cmp_eq_u64 vcc, -1
  s_cbranch_scc1 L_aok_158
  s_mov_b32 s33, 0
L_aspin_159:
  s_mov_b32 s29, 0x33e6000
  buffer_load_dword v232, v3, s[4:7], s29 offen offset:0 sc1
  buffer_load_dword v233, v3, s[4:7], s29 offen offset:1024 sc1
  buffer_load_dword v234, v3, s[4:7], s29 offen offset:2048 sc1
  buffer_load_dword v235, v3, s[4:7], s29 offen offset:3072 sc1
  s_waitcnt vmcnt(0)
  s_add_u32 s28, s59, 0
  v_subrev_u32 v232, s28, v232
  v_subrev_u32 v233, s28, v233
  v_subrev_u32 v234, s28, v234
  v_subrev_u32 v235, s28, v235
  v_max_u32 v232, v232, v233
  v_max_u32 v232, v232, v234
  v_max_u32 v232, v232, v235
  v_cmp_ge_u32 vcc, 0, v232
  s_nop 1
  s_cmp_eq_u64 vcc, -1
  s_cbranch_scc1 L_spinout_160
  s_sleep 8
  s_add_u32 s33, s33, 1
  s_cmp_lt_u32 s33, 0x40000
  s_cbranch_scc1 L_aspin_159
L_spinout_160:
L_aok_158:
  s_waitcnt vmcnt(2)
  s_waitcnt vmcnt(1)
  s_barrier
  v_mul_f32 v72, v24, v24
  v_mul_f32 v73, v25, v25
  v_mul_f32 v74, v26, v26
  v_mul_f32 v75, v27, v27
  v_mul_f32 v76, v28, v28
  v_mul_f32 v77, v29, v29
  v_mul_f32 v78, v30, v30
  v_mul_f32 v79, v31, v31
  v_fma_f32 v72, v72, v10, v9
  v_fma_f32 v73, v73, v10, v9
  v_fma_f32 v74, v74, v10, v9
  v_fma_f32 v75, v75, v10, v9
  v_fma_f32 v76, v76, v10, v9
  v_fma_f32 v77, v77, v10, v9
  v_fma_f32 v78, v78, v10, v9
  v_fma_f32 v79, v79, v10, v9
  v_mul_f32 v72, v24, v72
  v_mul_f32 v73, v25, v73
  v_mul_f32 v74, v26, v74
  v_mul_f32 v75, v27, v75
  v_mul_f32 v76, v28, v76
  v_mul_f32 v77, v29, v77
  v_mul_f32 v78, v30, v78
  v_mul_f32 v79, v31, v79
  v_exp_f32 v72, v72
  v_exp_f32 v73, v73
  v_exp_f32 v74, v74
  v_exp_f32 v75, v75
  v_exp_f32 v76, v76
  v_exp_f32 v77, v77
  v_exp_f32 v78, v78
  v_exp_f32 v79, v79
  v_fma_f32 v72, v72, v11, v11
  v_fma_f32 v73, v73, v11, v11
  v_fma_f32 v74, v74, v11, v11
  v_fma_f32 v75, v75, v11, v11
  v_fma_f32 v76, v76, v11, v11
  v_fma_f32 v77, v77, v11, v11
  v_fma_f32 v78, v78, v11, v11
  v_fma_f32 v79, v79, v11, v11
  v_rcp_f32 v72, v72
  v_rcp_f32 v73, v73
  v_rcp_f32 v74, v74
  v_rcp_f32 v75, v75
  v_rcp_f32 v76, v76
  v_rcp_f32 v77, v77
  v_rcp_f32 v78, v78
  v_rcp_f32 v79, v79
  v_mul_f32 v72, v24, v72
  v_mul_f32 v73, v25, v73
  v_mul_f32 v74, v26, v74
  v_mul_f32 v75, v27, v75
  v_mul_f32 v76, v28, v76
  v_mul_f32 v77, v29, v77
  v_mul_f32 v78, v30, v78
  v_mul_f32 v79, v31, v79
  v_cvt_pk_bf16_f32 v84, v72, v73
  v_cvt_pk_bf16_f32 v85, v74, v75
  v_cvt_pk_bf16_f32 v86, v76, v77
  v_cvt_pk_bf16_f32 v87, v78, v79
  s_add_u32 s28, s39, s36
  s_lshl_b32 s28, s28, 10
  buffer_store_dwordx4 v[84:87], v7, s[4:7], s28 offen offset:512 sc1
  s_lshr_b32 s26, s17, 2
  s_and_b32 s27, s17, 3
  s_mul_i32 s24, s26, 9
  s_add_u32 s24, s24, 1
  s_lshr_b32 s24, s24, 1
  s_and_b32 s25, s26, 1
  v_lshrrev_b32 v6, 4, v1
  s_and_b32 s28, s19, 1
  s_lshl_b32 s28, s28, 2
  v_add_u32 v5, s28, v6
  v_lshlrev_b32 v5, 1, v5
  v_and_b32 v7, 15, v1
  v_xor_b32 v5, v5, v7
  v_lshlrev_b32 v5, 4, v5
  v_lshl_add_u32 v4, v6, 12, v5
  v_mov_b32 v6, 0
  s_lshl_b32 s37, s24, 5
  s_lshl_b32 s28, s19, 2
  s_add_u32 s37, s37, s28
  s_lshl_b32 s37, s37, 12
  s_lshl_b32 s28, s16, 8
  s_add_u32 s37, s37, s28
  s_add_u32 s37, s37, 0x17a0000
  s_and_b32 s28, s2, 63
  v_and_b32 v5, 3, v1
  v_lshlrev_b32 v5, 6, v5
  v_add_u32 v5, s28, v5
  v_lshlrev_b32 v5, 4, v5
  v_add_u32 v5, 0x33e4004, v5
  s_lshl_b32 s38, s19, 10
  s_mul_i32 s34, s26, 1327104
  s_mul_i32 s28, s27, 9216
  s_add_u32 s28, s28, s38
  s_add_u32 s34, s34, s28
  s_add_u32 s34, s34, 0x1c22000
  s_add_u32 s35, s28, 0x2132000
  s_lshl_b32 s36, s16, 3
  s_add_u32 s36, s36, s19
  s_mul_i32 s36, s36, 144
  s_mul_i32 s28, s26, 36
  s_add_u32 s36, s36, s28
  s_lshl_b32 s36, s36, 10
  s_add_u32 s36, s36, 0x360000
  s_lshl_b32 s96, s96, 1
  s_add_u32 s28, s27, 0
  s_and_b32 s28, s28, 3
  s_mul_i32 s12, s28, 9
  s_and_b32 s28, s28, 1
  s_add_u32 s92, s12, s28
  s_cmp_eq_u32 s28, 0
  s_cselect_b32 s28, 8, 0
  s_add_u32 s12, s12, s28
  s_add_u32 s28, s27, 1
  s_and_b32 s28, s28, 3
  s_mul_i32 s13, s28, 9
  s_and_b32 s28, s28, 1
  s_add_u32 s93, s13, s28
  s_cmp_eq_u32 s28, 0
  s_cselect_b32 s28, 8, 0
  s_add_u32 s13, s13, s28
  s_add_u32 s28, s27, 2
  s_and_b32 s28, s28, 3
  s_mul_i32 s14, s28, 9
  s_and_b32 s28, s28, 1
  s_add_u32 s94, s14, s28
  s_cmp_eq_u32 s28, 0
  s_cselect_b32 s28, 8, 0
  s_add_u32 s14, s14, s28
  s_add_u32 s28, s27, 3
  s_and_b32 s28, s28, 3
  s_mul_i32 s15, s28, 9
  s_and_b32 s28, s28, 1
  s_add_u32 s95, s15, s28
  s_cmp_eq_u32 s28, 0
  s_cselect_b32 s28, 8, 0
  s_add_u32 s15, s15, s28
  s_mul_i32 s28, s24, 36864
  s_add_u32 s35, s35, s28
  buffer_load_dword v2, v5, s[4:7], 0 offen sc1
  s_waitcnt vmcnt(0)
  v_mov_b32 v9, 151524
  v_mov_b32 v8, 1
  s_mov_b64 exec, 1
  ds_add_rtn_u32 v8, v9, v8
  s_waitcnt lgkmcnt(0)
  s_mov_b64 exec, -1
  v_readfirstlane_b32 s28, v8
  s_cmp_eq_u32 s28, 7
  s_cbranch_scc0 L_hnl_161
  s_add_u32 s28, s59, 3
  v_mov_b32 v253, 4
  v_mov_b32 v254, s28
  s_mov_b64 exec, 1
  buffer_store_dword v254, v253, s[4:7], s101 offen sc1
  s_mov_b64 exec, -1
L_hnl_161:
  s_add_u32 s32, s96, 0
  s_and_b32 s32, s32, 7
  s_add_u32 s32, s32, s92
  s_mul_i32 s31, s32, 36864
  s_add_u32 s31, s31, s34
  s_lshl_b32 s32, s32, 10
  s_add_u32 s32, s32, s36
  s_cmp_eq_u32 s19, 0
  s_cbranch_scc0 L_skip_162
  s_add_u32 m0, s38, 8192
  s_add_u32 s30, s31, 8192
  buffer_load_dwordx4 v3, s[4:7], s30 offen sc1 lds
L_skip_162:
  s_add_u32 m0, s38, 0
  s_add_u32 s30, s31, 0
  buffer_load_dwordx4 v3, s[4:7], s30 offen sc1 lds
  s_add_u32 m0, s38, 4096
  s_add_u32 s30, s31, 4096
  buffer_load_dwordx4 v3, s[4:7], s30 offen sc1 lds
  s_add_u32 m0, s38, 9216
  s_add_u32 s30, s32, 0
  buffer_load_dwordx4 v3, s[4:7], s30 offen sc1 lds
  s_add_u32 m0, s38, 13312
  s_add_u32 s30, s32, 589824
  buffer_load_dwordx4 v3, s[4:7], s30 offen sc1 lds
  s_add_u32 s32, s96, 1
  s_and_b32 s32, s32, 7
  s_add_u32 s32, s32, s92
  s_mul_i32 s31, s32, 36864
  s_add_u32 s31, s31, s34
  s_lshl_b32 s32, s32, 10
  s_add_u32 s32, s32, s36
  s_cmp_eq_u32 s19, 0
  s_cbranch_scc0 L_skip_163
  s_add_u32 m0, s38, 25600
  s_add_u32 s30, s31, 8192
  buffer_load_dwordx4 v3, s[4:7], s30 offen sc1 lds
L_skip_163:
  s_add_u32 m0, s38, 17408
  s_add_u32 s30, s31, 0
  buffer_load_dwordx4 v3, s[4:7], s30 offen sc1 lds
  s_add_u32 m0, s38, 21504
  s_add_u32 s30, s31, 4096
  buffer_load_dwordx4 v3, s[4:7], s30 offen sc1 lds
  s_add_u32 m0, s38, 26624
  s_add_u32 s30, s32, 0
  buffer_load_dwordx4 v3, s[4:7], s30 offen sc1 lds
  s_add_u32 m0, s38, 30720
  s_add_u32 s30, s32, 589824
  buffer_load_dwordx4 v3, s[4:7], s30 offen sc1 lds
  s_add_u32 s32, s96, 2
  s_and_b32 s32, s32, 7
  s_add_u32 s32, s32, s92
  s_mul_i32 s31, s32, 36864
  s_add_u32 s31, s31, s34
  s_lshl_b32 s32, s32, 10
  s_add_u32 s32, s32, s36
  s_cmp_eq_u32 s19, 0
  s_cbranch_scc0 L_skip_164
  s_add_u32 m0, s38, 43008
  s_add_u32 s30, s31, 8192
  buffer_load_dwordx4 v3, s[4:7], s30 offen sc1 lds
L_skip_164:
  s_add_u32 m0, s38, 34816
  s_add_u32 s30, s31, 0
  buffer_load_dwordx4 v3, s[4:7], s30 offen sc1 lds
  s_add_u32 m0, s38, 38912
  s_add_u32 s30, s31, 4096
  buffer_load_dwordx4 v3, s[4:7], s30 offen sc1 lds
  s_add_u32 m0, s38, 44032
  s_add_u32 s30, s32, 0
  buffer_load_dwordx4 v3, s[4:7], s30 offen sc1 lds
  s_add_u32 m0, s38, 48128
  s_add_u32 s30, s32, 589824
  buffer_load_dwordx4 v3, s[4:7], s30 offen sc1 lds
  s_add_u32 s32, s96, 3
  s_and_b32 s32, s32, 7
  s_add_u32 s32, s32, s92
  s_mul_i32 s31, s32, 36864
  s_add_u32 s31, s31, s34
  s_lshl_b32 s32, s32, 10
  s_add_u32 s32, s32, s36
  s_cmp_eq_u32 s19, 0
  s_cbranch_scc0 L_skip_165
  s_add_u32 m0, s38, 60416
  s_add_u32 s30, s31, 8192
  buffer_load_dwordx4 v3, s[4:7], s30 offen sc1 lds
L_skip_165:
  s_add_u32 m0, s38, 52224
  s_add_u32 s30, s31, 0
  buffer_load_dwordx4 v3, s[4:7], s30 offen sc1 lds
  s_add_u32 m0, s38, 56320
  s_add_u32 s30, s31, 4096
  buffer_load_dwordx4 v3, s[4:7], s30 offen sc1 lds
  s_add_u32 m0, s38, 61440
  s_add_u32 s30, s32, 0
  buffer_load_dwordx4 v3, s[4:7], s30 offen sc1 lds
  s_add_u32 m0, s38, 65536
  s_add_u32 s30, s32, 589824
  buffer_load_dwordx4 v3, s[4:7], s30 offen sc1 lds
  s_sub_u32 s52, s2, 145
  s_lshl_b32 s52, s52, 2
  s_add_u32 s52, s52, s19
  s_cmp_ge_u32 s52, 648
  s_cbranch_scc1 L_finv_skip_166
  s_mul_hi_u32 s44, s52, 0x71c71c8
  s_mul_i32 s45, s44, 36
  s_sub_u32 s45, s52, s45
  s_lshl_b32 s45, s45, 4
  v_and_b32 v24, 15, v1
  v_add_u32 v24, s45, v24
  v_lshrrev_b32 v25, 5, v1
  v_lshlrev_b32 v25, 3, v25
  v_bfe_u32 v26, v1, 4, 1
  v_lshl_add_u32 v25, v26, 1, v25
  s_lshl_b32 s46, s44, 4
  v_add_u32 v25, s46, v25
  v_add_u32 v26, 0, v25
  v_mul_u32_u24 v27, v26, v24
  v_cvt_f32_u32 v28, v27
  v_mul_f32 v28, 0x3ae38e39, v28
  v_cvt_u32_f32 v28, v28
  v_mul_u32_u24 v28, 576, v28
  v_sub_u32 v28, v27, v28
  v_cvt_f32_i32 v28, v28
  v_mul_f32 v28, 0x3ae38e39, v28
  v_cos_f32 v16, v28
  v_cmp_eq_u32 vcc, 0, v26
  v_add_f32 v28, v16, v16
  s_nop 0
  v_cndmask_b32 v16, v28, v16, vcc
  v_add_u32 v26, 0, v25
  v_mul_u32_u24 v27, v26, v24
  v_add_u32 v27, 144, v27
  v_mul_u32_u24 v28, 288, v24
  v_cmp_eq_u32 vcc, 0, v26
  s_nop 1
  v_cndmask_b32 v27, v27, v28, vcc
  v_cvt_f32_u32 v28, v27
  v_mul_f32 v28, 0x3ae38e39, v28
  v_cvt_u32_f32 v28, v28
  v_mul_u32_u24 v28, 576, v28
  v_sub_u32 v28, v27, v28
  v_cvt_f32_i32 v28, v28
  v_mul_f32 v28, 0x3ae38e39, v28
  v_cos_f32 v17, v28
  v_cmp_eq_u32 vcc, 0, v26
  v_add_f32 v28, v17, v17
  s_nop 0
  v_cndmask_b32 v17, v28, v17, vcc
  v_add_u32 v26, 1, v25
  v_mul_u32_u24 v27, v26, v24
  v_cvt_f32_u32 v28, v27
  v_mul_f32 v28, 0x3ae38e39, v28
  v_cvt_u32_f32 v28, v28
  v_mul_u32_u24 v28, 576, v28
  v_sub_u32 v28, v27, v28
  v_cvt_f32_i32 v28, v28
  v_mul_f32 v28, 0x3ae38e39, v28
  v_cos_f32 v18, v28
  s_nop 0
  v_add_f32 v18, v18, v18
  v_add_u32 v26, 1, v25
  v_mul_u32_u24 v27, v26, v24
  v_add_u32 v27, 144, v27
  v_cvt_f32_u32 v28, v27
  v_mul_f32 v28, 0x3ae38e39, v28
  v_cvt_u32_f32 v28, v28
  v_mul_u32_u24 v28, 576, v28
  v_sub_u32 v28, v27, v28
  v_cvt_f32_i32 v28, v28
  v_mul_f32 v28, 0x3ae38e39, v28
  v_cos_f32 v19, v28
  s_nop 0
  v_add_f32 v19, v19, v19
  v_add_u32 v26, 4, v25
  v_mul_u32_u24 v27, v26, v24
  v_cvt_f32_u32 v28, v27
  v_mul_f32 v28, 0x3ae38e39, v28
  v_cvt_u32_f32 v28, v28
  v_mul_u32_u24 v28, 576, v28
  v_sub_u32 v28, v27, v28
  v_cvt_f32_i32 v28, v28
  v_mul_f32 v28, 0x3ae38e39, v28
  v_cos_f32 v20, v28
  s_nop 0
  v_add_f32 v20, v20, v20
  v_add_u32 v26, 4, v25
  v_mul_u32_u24 v27, v26, v24
  v_add_u32 v27, 144, v27
  v_cvt_f32_u32 v28, v27
  v_mul_f32 v28, 0x3ae38e39, v28
  v_cvt_u32_f32 v28, v28
  v_mul_u32_u24 v28, 576, v28
  v_sub_u32 v28, v27, v28
  v_cvt_f32_i32 v28, v28
  v_mul_f32 v28, 0x3ae38e39, v28
  v_cos_f32 v21, v28
  s_nop 0
  v_add_f32 v21, v21, v21
  v_add_u32 v26, 5, v25
  v_mul_u32_u24 v27, v26, v24
  v_cvt_f32_u32 v28, v27
  v_mul_f32 v28, 0x3ae38e39, v28
  v_cvt_u32_f32 v28, v28
  v_mul_u32_u24 v28, 576, v28
  v_sub_u32 v28, v27, v28
  v_cvt_f32_i32 v28, v28
  v_mul_f32 v28, 0x3ae38e39, v28
  v_cos_f32 v22, v28
  s_nop 0
  v_add_f32 v22, v22, v22
  v_add_u32 v26, 5, v25
  v_mul_u32_u24 v27, v26, v24
  v_add_u32 v27, 144, v27
  v_cvt_f32_u32 v28, v27
  v_mul_f32 v28, 0x3ae38e39, v28
  v_cvt_u32_f32 v28, v28
  v_mul_u32_u24 v28, 576, v28
  v_sub_u32 v28, v27, v28
  v_cvt_f32_i32 v28, v28
  v_mul_f32 v28, 0x3ae38e39, v28
  v_cos_f32 v23, v28
  s_nop 0
  v_add_f32 v23, v23, v23
  v_cvt_pk_bf16_f32 v32, v16, v17
  v_cvt_pk_bf16_f32 v33, v18, v19
  v_cvt_pk_bf16_f32 v34, v20, v21
  v_cvt_pk_bf16_f32 v35, v22, v23
  s_add_u32 s46, s52, 5184
  s_lshl_b32 s46, s46, 10
  s_add_u32 s46, s46, 0x1c22000
  v_lshlrev_b32 v24, 4, v1
  buffer_store_dwordx4 v[32:35], v24, s[4:7], s46 offen sc1
L_finv_skip_166:
  s_add_u32 s52, s52, 444
  s_cmp_ge_u32 s52, 648
  s_cbranch_scc1 L_finv_skip_167
  s_mul_hi_u32 s44, s52, 0x71c71c8
  s_mul_i32 s45, s44, 36
  s_sub_u32 s45, s52, s45
  s_lshl_b32 s45, s45, 4
  v_and_b32 v48, 15, v1
  v_add_u32 v48, s45, v48
  v_lshrrev_b32 v49, 5, v1
  v_lshlrev_b32 v49, 3, v49
  v_bfe_u32 v50, v1, 4, 1
  v_lshl_add_u32 v49, v50, 1, v49
  s_lshl_b32 s46, s44, 4
  v_add_u32 v49, s46, v49
  v_add_u32 v50, 0, v49
  v_mul_u32_u24 v51, v50, v48
  v_cvt_f32_u32 v52, v51
  v_mul_f32 v52, 0x3ae38e39, v52
  v_cvt_u32_f32 v52, v52
  v_mul_u32_u24 v52, 576, v52
  v_sub_u32 v52, v51, v52
  v_cvt_f32_i32 v52, v52
  v_mul_f32 v52, 0x3ae38e39, v52
  v_cos_f32 v40, v52
  v_cmp_eq_u32 vcc, 0, v50
  v_add_f32 v52, v40, v40
  s_nop 0
  v_cndmask_b32 v40, v52, v40, vcc
  v_add_u32 v50, 0, v49
  v_mul_u32_u24 v51, v50, v48
  v_add_u32 v51, 144, v51
  v_mul_u32_u24 v52, 288, v48
  v_cmp_eq_u32 vcc, 0, v50
  s_nop 1
  v_cndmask_b32 v51, v51, v52, vcc
  v_cvt_f32_u32 v52, v51
  v_mul_f32 v52, 0x3ae38e39, v52
  v_cvt_u32_f32 v52, v52
  v_mul_u32_u24 v52, 576, v52
  v_sub_u32 v52, v51, v52
  v_cvt_f32_i32 v52, v52
  v_mul_f32 v52, 0x3ae38e39, v52
  v_cos_f32 v41, v52
  v_cmp_eq_u32 vcc, 0, v50
  v_add_f32 v52, v41, v41
  s_nop 0
  v_cndmask_b32 v41, v52, v41, vcc
  v_add_u32 v50, 1, v49
  v_mul_u32_u24 v51, v50, v48
  v_cvt_f32_u32 v52, v51
  v_mul_f32 v52, 0x3ae38e39, v52
  v_cvt_u32_f32 v52, v52
  v_mul_u32_u24 v52, 576, v52
  v_sub_u32 v52, v51, v52
  v_cvt_f32_i32 v52, v52
  v_mul_f32 v52, 0x3ae38e39, v52
  v_cos_f32 v42, v52
  s_nop 0
  v_add_f32 v42, v42, v42
  v_add_u32 v50, 1, v49
  v_mul_u32_u24 v51, v50, v48
  v_add_u32 v51, 144, v51
  v_cvt_f32_u32 v52, v51
  v_mul_f32 v52, 0x3ae38e39, v52
  v_cvt_u32_f32 v52, v52
  v_mul_u32_u24 v52, 576, v52
  v_sub_u32 v52, v51, v52
  v_cvt_f32_i32 v52, v52
  v_mul_f32 v52, 0x3ae38e39, v52
  v_cos_f32 v43, v52
  s_nop 0
  v_add_f32 v43, v43, v43
  v_add_u32 v50, 4, v49
  v_mul_u32_u24 v51, v50, v48
  v_cvt_f32_u32 v52, v51
  v_mul_f32 v52, 0x3ae38e39, v52
  v_cvt_u32_f32 v52, v52
  v_mul_u32_u24 v52, 576, v52
  v_sub_u32 v52, v51, v52
  v_cvt_f32_i32 v52, v52
  v_mul_f32 v52, 0x3ae38e39, v52
  v_cos_f32 v44, v52
  s_nop 0
  v_add_f32 v44, v44, v44
  v_add_u32 v50, 4, v49
  v_mul_u32_u24 v51, v50, v48
  v_add_u32 v51, 144, v51
  v_cvt_f32_u32 v52, v51
  v_mul_f32 v52, 0x3ae38e39, v52
  v_cvt_u32_f32 v52, v52
  v_mul_u32_u24 v52, 576, v52
  v_sub_u32 v52, v51, v52
  v_cvt_f32_i32 v52, v52
  v_mul_f32 v52, 0x3ae38e39, v52
  v_cos_f32 v45, v52
  s_nop 0
  v_add_f32 v45, v45, v45
  v_add_u32 v50, 5, v49
  v_mul_u32_u24 v51, v50, v48
  v_cvt_f32_u32 v52, v51
  v_mul_f32 v52, 0x3ae38e39, v52
  v_cvt_u32_f32 v52, v52
  v_mul_u32_u24 v52, 576, v52
  v_sub_u32 v52, v51, v52
  v_cvt_f32_i32 v52, v52
  v_mul_f32 v52, 0x3ae38e39, v52
  v_cos_f32 v46, v52
  s_nop 0
  v_add_f32 v46, v46, v46
  v_add_u32 v50, 5, v49
  v_mul_u32_u24 v51, v50, v48
  v_add_u32 v51, 144, v51
  v_cvt_f32_u32 v52, v51
  v_mul_f32 v52, 0x3ae38e39, v52
  v_cvt_u32_f32 v52, v52
  v_mul_u32_u24 v52, 576, v52
  v_sub_u32 v52, v51, v52
  v_cvt_f32_i32 v52, v52
  v_mul_f32 v52, 0x3ae38e39, v52
  v_cos_f32 v47, v52
  s_nop 0
  v_add_f32 v47, v47, v47
  v_cvt_pk_bf16_f32 v56, v40, v41
  v_cvt_pk_bf16_f32 v57, v42, v43
  v_cvt_pk_bf16_f32 v58, v44, v45
  v_cvt_pk_bf16_f32 v59, v46, v47
  s_add_u32 s46, s52, 5184
  s_lshl_b32 s46, s46, 10
  s_add_u32 s46, s46, 0x1c22000
  v_lshlrev_b32 v48, 4, v1
  buffer_store_dwordx4 v[56:59], v48, s[4:7], s46 offen sc1
L_finv_skip_167:
  s_waitcnt vmcnt(4)
  s_barrier
  s_add_u32 s32, s96, 4
  s_and_b32 s32, s32, 7
  s_add_u32 s32, s32, s92
  s_mul_i32 s31, s32, 36864
  s_add_u32 s31, s31, s34
  s_lshl_b32 s32, s32, 10
  s_add_u32 s32, s32, s36
  s_cmp_eq_u32 s19, 0
  s_cbranch_scc0 L_skip_168
  s_add_u32 m0, s38, 81920
  s_add_u32 s30, s31, 8192
  buffer_load_dwordx4 v3, s[4:7], s30 offen sc1 lds
L_skip_168:
  s_add_u32 m0, s38, 73728
  s_add_u32 s30, s31, 0
  buffer_load_dwordx4 v3, s[4:7], s30 offen sc1 lds
  s_add_u32 m0, s38, 77824
  s_add_u32 s30, s31, 4096
  buffer_load_dwordx4 v3, s[4:7], s30 offen sc1 lds
  s_add_u32 m0, s38, 82944
  s_add_u32 s30, s32, 0
  buffer_load_dwordx4 v3, s[4:7], s30 offen sc1 lds
  s_add_u32 m0, s38, 87040
  s_add_u32 s30, s32, 589824
  buffer_load_dwordx4 v3, s[4:7], s30 offen sc1 lds
  buffer_load_dword v2, v5, s[4:7], 0 offen sc1
  s_add_u32 s32, s96, 5
  s_and_b32 s32, s32, 7
  s_add_u32 s32, s32, s92
  s_mul_i32 s31, s32, 36864
  s_add_u32 s31, s31, s34
  s_lshl_b32 s32, s32, 10
  s_add_u32 s32, s32, s36
  s_cmp_eq_u32 s19, 0
  s_cbranch_scc0 L_skip_169
  s_add_u32 m0, s38, 99328
  s_add_u32 s30, s31, 8192
  buffer_load_dwordx4 v3, s[4:7], s30 offen sc1 lds
L_skip_169:
  s_add_u32 m0, s38, 91136
  s_add_u32 s30, s31, 0
  buffer_load_dwordx4 v3, s[4:7], s30 offen sc1 lds
  s_add_u32 m0, s38, 95232
  s_add_u32 s30, s31, 4096
  buffer_load_dwordx4 v3, s[4:7], s30 offen sc1 lds
  s_add_u32 m0, s38, 100352
  s_add_u32 s30, s32, 0
  buffer_load_dwordx4 v3, s[4:7], s30 offen sc1 lds
  s_add_u32 m0, s38, 104448
  s_add_u32 s30, s32, 589824
  buffer_load_dwordx4 v3, s[4:7], s30 offen sc1 lds
  s_add_u32 s32, s96, 6
  s_and_b32 s32, s32, 7
  s_add_u32 s32, s32, s92
  s_mul_i32 s31, s32, 36864
  s_add_u32 s31, s31, s34
  s_lshl_b32 s32, s32, 10
  s_add_u32 s32, s32, s36
  s_cmp_eq_u32 s19, 0
  s_cbranch_scc0 L_skip_170
  s_add_u32 m0, s38, 116736
  s_add_u32 s30, s31, 8192
  buffer_load_dwordx4 v3, s[4:7], s30 offen sc1 lds
L_skip_170:
  s_add_u32 m0, s38, 108544
  s_add_u32 s30, s31, 0
  buffer_load_dwordx4 v3, s[4:7], s30 offen sc1 lds
  s_add_u32 m0, s38, 112640
  s_add_u32 s30, s31, 4096
  buffer_load_dwordx4 v3, s[4:7], s30 offen sc1 lds
  s_add_u32 m0, s38, 117760
  s_add_u32 s30, s32, 0
  buffer_load_dwordx4 v3, s[4:7], s30 offen sc1 lds
  s_add_u32 m0, s38, 121856
  s_add_u32 s30, s32, 589824
  buffer_load_dwordx4 v3, s[4:7], s30 offen sc1 lds
  s_add_u32 s32, s96, 7
  s_and_b32 s32, s32, 7
  s_add_u32 s32, s32, s92
  s_mul_i32 s31, s32, 36864
  s_add_u32 s31, s31, s34
  s_lshl_b32 s32, s32, 10
  s_add_u32 s32, s32, s36
  s_cmp_eq_u32 s19, 0
  s_cbranch_scc0 L_skip_171
  s_add_u32 m0, s38, 134144
  s_add_u32 s30, s31, 8192
  buffer_load_dwordx4 v3, s[4:7], s30 offen sc1 lds
L_skip_171:
  s_add_u32 m0, s38, 125952
  s_add_u32 s30, s31, 0
  buffer_load_dwordx4 v3, s[4:7], s30 offen sc1 lds
  s_add_u32 m0, s38, 130048
  s_add_u32 s30, s31, 4096
  buffer_load_dwordx4 v3, s[4:7], s30 offen sc1 lds
  s_add_u32 m0, s38, 135168
  s_add_u32 s30, s32, 0
  buffer_load_dwordx4 v3, s[4:7], s30 offen sc1 lds
  s_add_u32 m0, s38, 139264
  s_add_u32 s30, s32, 589824
  buffer_load_dwordx4 v3, s[4:7], s30 offen sc1 lds
  s_waitcnt vmcnt(13)
  s_barrier
  s_mov_b32 s32, s12
  s_mul_i32 s31, s32, 36864
  s_add_u32 s31, s31, s34
  s_lshl_b32 s32, s32, 10
  s_add_u32 s32, s32, s36
  s_cmp_eq_u32 s19, 0
  s_cbranch_scc0 L_skip_172
  s_add_u32 m0, s38, 8192
  s_add_u32 s30, s31, 8192
  buffer_load_dwordx4 v3, s[4:7], s30 offen sc1 lds
L_skip_172:
  s_add_u32 m0, s38, 0
  s_add_u32 s30, s31, 0
  buffer_load_dwordx4 v3, s[4:7], s30 offen sc1 lds
  s_add_u32 m0, s38, 4096
  s_add_u32 s30, s31, 4096
  buffer_load_dwordx4 v3, s[4:7], s30 offen sc1 lds
  s_add_u32 m0, s38, 9216
  s_add_u32 s30, s32, 0
  buffer_load_dwordx4 v3, s[4:7], s30 offen sc1 lds
  s_add_u32 m0, s38, 13312
  s_add_u32 s30, s32, 589824
  buffer_load_dwordx4 v3, s[4:7], s30 offen sc1 lds
  s_waitcnt vmcnt(16)
  s_add_u32 s28, s59, 3
  v_subrev_u32 v2, s28, v2
  v_cmp_ge_u32 vcc, 0, v2
  s_nop 1
  s_cmp_eq_u64 vcc, -1
  s_cbranch_scc1 L_pok_173
  s_mov_b32 s33, 0
L_pgw_174:
  buffer_load_dword v2, v5, s[4:7], 0 offen sc1
  s_waitcnt vmcnt(0)
  s_add_u32 s28, s59, 3
  v_subrev_u32 v2, s28, v2
  v_cmp_ge_u32 vcc, 0, v2
  s_nop 1
  s_cmp_eq_u64 vcc, -1
  s_cbranch_scc1 L_spinout_175
  s_sleep 4
  s_add_u32 s33, s33, 1
  s_cmp_lt_u32 s33, 0x40000
  s_cbranch_scc1 L_pgw_174
L_spinout_175:
L_pok_173:
  s_add_u32 s32, s96, 0
  s_and_b32 s32, s32, 7
  s_add_u32 s32, s32, s93
  s_mul_i32 s31, s32, 36864
  s_add_u32 s31, s31, s34
  s_lshl_b32 s32, s32, 10
  s_add_u32 s32, s32, s36
  s_cmp_eq_u32 s19, 0
  s_cbranch_scc0 L_skip_176
  s_add_u32 m0, s38, 25600
  s_add_u32 s30, s31, 8192
  buffer_load_dwordx4 v3, s[4:7], s30 offen sc1 lds
L_skip_176:
  s_add_u32 m0, s38, 17408
  s_add_u32 s30, s31, 0
  buffer_load_dwordx4 v3, s[4:7], s30 offen sc1 lds
  s_add_u32 m0, s38, 21504
  s_add_u32 s30, s31, 4096
  buffer_load_dwordx4 v3, s[4:7], s30 offen sc1 lds
  s_add_u32 m0, s38, 26624
  s_add_u32 s30, s32, 0
  buffer_load_dwordx4 v3, s[4:7], s30 offen sc1 lds
  s_add_u32 m0, s38, 30720
  s_add_u32 s30, s32, 589824
  buffer_load_dwordx4 v3, s[4:7], s30 offen sc1 lds
  s_add_u32 s32, s96, 1
  s_and_b32 s32, s32, 7
  s_add_u32 s32, s32, s93
  s_mul_i32 s31, s32, 36864
  s_add_u32 s31, s31, s34
  s_lshl_b32 s32, s32, 10
  s_add_u32 s32, s32, s36
  s_cmp_eq_u32 s19, 0
  s_cbranch_scc0 L_skip_177
  s_add_u32 m0, s38, 43008
  s_add_u32 s30, s31, 8192
  buffer_load_dwordx4 v3, s[4:7], s30 offen sc1 lds
L_skip_177:
  s_add_u32 m0, s38, 34816
  s_add_u32 s30, s31, 0
  buffer_load_dwordx4 v3, s[4:7], s30 offen sc1 lds
  s_add_u32 m0, s38, 38912
  s_add_u32 s30, s31, 4096
  buffer_load_dwordx4 v3, s[4:7], s30 offen sc1 lds
  s_add_u32 m0, s38, 44032
  s_add_u32 s30, s32, 0
  buffer_load_dwordx4 v3, s[4:7], s30 offen sc1 lds
  s_add_u32 m0, s38, 48128
  s_add_u32 s30, s32, 589824
  buffer_load_dwordx4 v3, s[4:7], s30 offen sc1 lds
  s_waitcnt vmcnt(16)
  s_waitcnt vmcnt(29)
  s_barrier
  s_cmp_eq_u32 s19, 3
  s_cbranch_scc0 L_svc_178
  s_add_u32 s28, s59, 0
  v_mov_b32 v253, 12288
  v_mov_b32 v254, s28
  s_mov_b64 exec, 1
  buffer_store_dword v254, v253, s[4:7], s101 offen sc1
  s_mov_b64 exec, -1
L_svc_178:
  s_add_u32 s32, s96, 2
  s_and_b32 s32, s32, 7
  s_add_u32 s32, s32, s93
  s_mul_i32 s31, s32, 36864
  s_add_u32 s31, s31, s34
  s_lshl_b32 s32, s32, 10
  s_add_u32 s32, s32, s36
  s_cmp_eq_u32 s19, 0
  s_cbranch_scc0 L_skip_179
  s_add_u32 m0, s38, 60416
  s_add_u32 s30, s31, 8192
  buffer_load_dwordx4 v3, s[4:7], s30 offen sc1 lds
L_skip_179:
  s_add_u32 m0, s38, 52224
  s_add_u32 s30, s31, 0
  buffer_load_dwordx4 v3, s[4:7], s30 offen sc1 lds
  s_add_u32 m0, s38, 56320
  s_add_u32 s30, s31, 4096
  buffer_load_dwordx4 v3, s[4:7], s30 offen sc1 lds
  s_add_u32 m0, s38, 61440
  s_add_u32 s30, s32, 0
  buffer_load_dwordx4 v3, s[4:7], s30 offen sc1 lds
  s_add_u32 m0, s38, 65536
  s_add_u32 s30, s32, 589824
  buffer_load_dwordx4 v3, s[4:7], s30 offen sc1 lds
  s_add_u32 s32, s96, 3
  s_and_b32 s32, s32, 7
  s_add_u32 s32, s32, s93
  s_mul_i32 s31, s32, 36864
  s_add_u32 s31, s31, s34
  s_lshl_b32 s32, s32, 10
  s_add_u32 s32, s32, s36
  s_cmp_eq_u32 s19, 0
  s_cbranch_scc0 L_skip_180
  s_add_u32 m0, s38, 81920
  s_add_u32 s30, s31, 8192
  buffer_load_dwordx4 v3, s[4:7], s30 offen sc1 lds
L_skip_180:
  s_add_u32 m0, s38, 73728
  s_add_u32 s30, s31, 0
  buffer_load_dwordx4 v3, s[4:7], s30 offen sc1 lds
  s_add_u32 m0, s38, 77824
  s_add_u32 s30, s31, 4096
  buffer_load_dwordx4 v3, s[4:7], s30 offen sc1 lds
  s_add_u32 m0, s38, 82944
  s_add_u32 s30, s32, 0
  buffer_load_dwordx4 v3, s[4:7], s30 offen sc1 lds
  s_add_u32 m0, s38, 87040
  s_add_u32 s30, s32, 589824
  buffer_load_dwordx4 v3, s[4:7], s30 offen sc1 lds
  s_waitcnt vmcnt(16)
  s_barrier
  s_add_u32 s32, s96, 4
  s_and_b32 s32, s32, 7
  s_add_u32 s32, s32, s93
  s_mul_i32 s31, s32, 36864
  s_add_u32 s31, s31, s34
  s_lshl_b32 s32, s32, 10
  s_add_u32 s32, s32, s36
  s_cmp_eq_u32 s19, 0
  s_cbranch_scc0 L_skip_181
  s_add_u32 m0, s38, 99328
  s_add_u32 s30, s31, 8192
  buffer_load_dwordx4 v3, s[4:7], s30 offen sc1 lds
L_skip_181:
  s_add_u32 m0, s38, 91136
  s_add_u32 s30, s31, 0
  buffer_load_dwordx4 v3, s[4:7], s30 offen sc1 lds
  s_add_u32 m0, s38, 95232
  s_add_u32 s30, s31, 4096
  buffer_load_dwordx4 v3, s[4:7], s30 offen sc1 lds
  s_add_u32 m0, s38, 100352
  s_add_u32 s30, s32, 0
  buffer_load_dwordx4 v3, s[4:7], s30 offen sc1 lds
  s_add_u32 m0, s38, 104448
  s_add_u32 s30, s32, 589824
  buffer_load_dwordx4 v3, s[4:7], s30 offen sc1 lds
  s_add_u32 s32, s96, 5
  s_and_b32 s32, s32, 7
  s_add_u32 s32, s32, s93
  s_mul_i32 s31, s32, 36864
  s_add_u32 s31, s31, s34
  s_lshl_b32 s32, s32, 10
  s_add_u32 s32, s32, s36
  s_cmp_eq_u32 s19, 0
  s_cbranch_scc0 L_skip_182
  s_add_u32 m0, s38, 116736
  s_add_u32 s30, s31, 8192
  buffer_load_dwordx4 v3, s[4:7], s30 offen sc1 lds
L_skip_182:
  s_add_u32 m0, s38, 108544
  s_add_u32 s30, s31, 0
  buffer_load_dwordx4 v3, s[4:7], s30 offen sc1 lds
  s_add_u32 m0, s38, 112640
  s_add_u32 s30, s31, 4096
  buffer_load_dwordx4 v3, s[4:7], s30 offen sc1 lds
  s_add_u32 m0, s38, 117760
  s_add_u32 s30, s32, 0
  buffer_load_dwordx4 v3, s[4:7], s30 offen sc1 lds
  s_add_u32 m0, s38, 121856
  s_add_u32 s30, s32, 589824
  buffer_load_dwordx4 v3, s[4:7], s30 offen sc1 lds
  s_waitcnt vmcnt(16)
  s_barrier
  s_add_u32 s32, s96, 6
  s_and_b32 s32, s32, 7
  s_add_u32 s32, s32, s93
  s_mul_i32 s31, s32, 36864
  s_add_u32 s31, s31, s34
  s_lshl_b32 s32, s32, 10
  s_add_u32 s32, s32, s36
  s_cmp_eq_u32 s19, 0
  s_cbranch_scc0 L_skip_183
  s_add_u32 m0, s38, 134144
  s_add_u32 s30, s31, 8192
  buffer_load_dwordx4 v3, s[4:7], s30 offen sc1 lds
L_skip_183:
  s_add_u32 m0, s38, 125952
  s_add_u32 s30, s31, 0
  buffer_load_dwordx4 v3, s[4:7], s30 offen sc1 lds
  s_add_u32 m0, s38, 130048
  s_add_u32 s30, s31, 4096
  buffer_load_dwordx4 v3, s[4:7], s30 offen sc1 lds
  s_add_u32 m0, s38, 135168
  s_add_u32 s30, s32, 0
  buffer_load_dwordx4 v3, s[4:7], s30 offen sc1 lds
  s_add_u32 m0, s38, 139264
  s_add_u32 s30, s32, 589824
  buffer_load_dwordx4 v3, s[4:7], s30 offen sc1 lds
  s_add_u32 s32, s96, 7
  s_and_b32 s32, s32, 7
  s_add_u32 s32, s32, s93
  s_mul_i32 s31, s32, 36864
  s_add_u32 s31, s31, s34
  s_lshl_b32 s32, s32, 10
  s_add_u32 s32, s32, s36
  s_cmp_eq_u32 s19, 0
  s_cbranch_scc0 L_skip_184
  s_add_u32 m0, s38, 8192
  s_add_u32 s30, s31, 8192
  buffer_load_dwordx4 v3, s[4:7], s30 offen sc1 lds
L_skip_184:
  s_add_u32 m0, s38, 0
  s_add_u32 s30, s31, 0
  buffer_load_dwordx4 v3, s[4:7], s30 offen sc1 lds
  s_add_u32 m0, s38, 4096
  s_add_u32 s30, s31, 4096
  buffer_load_dwordx4 v3, s[4:7], s30 offen sc1 lds
  s_add_u32 m0, s38, 9216
  s_add_u32 s30, s32, 0
  buffer_load_dwordx4 v3, s[4:7], s30 offen sc1 lds
  s_add_u32 m0, s38, 13312
  s_add_u32 s30, s32, 589824
  buffer_load_dwordx4 v3, s[4:7], s30 offen sc1 lds
  s_waitcnt vmcnt(16)
  s_barrier
  s_mov_b32 s32, s13
  s_mul_i32 s31, s32, 36864
  s_add_u32 s31, s31, s34
  s_lshl_b32 s32, s32, 10
  s_add_u32 s32, s32, s36
  s_cmp_eq_u32 s19, 0
  s_cbranch_scc0 L_skip_185
  s_add_u32 m0, s38, 25600
  s_add_u32 s30, s31, 8192
  buffer_load_dwordx4 v3, s[4:7], s30 offen sc1 lds
L_skip_185:
  s_add_u32 m0, s38, 17408
  s_add_u32 s30, s31, 0
  buffer_load_dwordx4 v3, s[4:7], s30 offen sc1 lds
  s_add_u32 m0, s38, 21504
  s_add_u32 s30, s31, 4096
  buffer_load_dwordx4 v3, s[4:7], s30 offen sc1 lds
  s_add_u32 m0, s38, 26624
  s_add_u32 s30, s32, 0
  buffer_load_dwordx4 v3, s[4:7], s30 offen sc1 lds
  s_add_u32 m0, s38, 30720
  s_add_u32 s30, s32, 589824
  buffer_load_dwordx4 v3, s[4:7], s30 offen sc1 lds
  s_add_u32 s32, s96, 0
  s_and_b32 s32, s32, 7
  s_add_u32 s32, s32, s94
  s_mul_i32 s31, s32, 36864
  s_add_u32 s31, s31, s34
  s_lshl_b32 s32, s32, 10
  s_add_u32 s32, s32, s36
  s_cmp_eq_u32 s19, 0
  s_cbranch_scc0 L_skip_186
  s_add_u32 m0, s38, 43008
  s_add_u32 s30, s31, 8192
  buffer_load_dwordx4 v3, s[4:7], s30 offen sc1 lds
L_skip_186:
  s_add_u32 m0, s38, 34816
  s_add_u32 s30, s31, 0
  buffer_load_dwordx4 v3, s[4:7], s30 offen sc1 lds
  s_add_u32 m0, s38, 38912
  s_add_u32 s30, s31, 4096
  buffer_load_dwordx4 v3, s[4:7], s30 offen sc1 lds
  s_add_u32 m0, s38, 44032
  s_add_u32 s30, s32, 0
  buffer_load_dwordx4 v3, s[4:7], s30 offen sc1 lds
  s_add_u32 m0, s38, 48128
  s_add_u32 s30, s32, 589824
  buffer_load_dwordx4 v3, s[4:7], s30 offen sc1 lds
  s_waitcnt vmcnt(16)
  s_barrier
  s_add_u32 s32, s96, 1
  s_and_b32 s32, s32, 7
  s_add_u32 s32, s32, s94
  s_mul_i32 s31, s32, 36864
  s_add_u32 s31, s31, s34
  s_lshl_b32 s32, s32, 10
  s_add_u32 s32, s32, s36
  s_cmp_eq_u32 s19, 0
  s_cbranch_scc0 L_skip_187
  s_add_u32 m0, s38, 60416
  s_add_u32 s30, s31, 8192
  buffer_load_dwordx4 v3, s[4:7], s30 offen sc1 lds
L_skip_187:
  s_add_u32 m0, s38, 52224
  s_add_u32 s30, s31, 0
  buffer_load_dwordx4 v3, s[4:7], s30 offen sc1 lds
  s_add_u32 m0, s38, 56320
  s_add_u32 s30, s31, 4096
  buffer_load_dwordx4 v3, s[4:7], s30 offen sc1 lds
  s_add_u32 m0, s38, 61440
  s_add_u32 s30, s32, 0
  buffer_load_dwordx4 v3, s[4:7], s30 offen sc1 lds
  s_add_u32 m0, s38, 65536
  s_add_u32 s30, s32, 589824
  buffer_load_dwordx4 v3, s[4:7], s30 offen sc1 lds
  s_add_u32 s32, s96, 2
  s_and_b32 s32, s32, 7
  s_add_u32 s32, s32, s94
  s_mul_i32 s31, s32, 36864
  s_add_u32 s31, s31, s34
  s_lshl_b32 s32, s32, 10
  s_add_u32 s32, s32, s36
  s_cmp_eq_u32 s19, 0
  s_cbranch_scc0 L_skip_188
  s_add_u32 m0, s38, 81920
  s_add_u32 s30, s31, 8192
  buffer_load_dwordx4 v3, s[4:7], s30 offen sc1 lds
L_skip_188:
  s_add_u32 m0, s38, 73728
  s_add_u32 s30, s31, 0
  buffer_load_dwordx4 v3, s[4:7], s30 offen sc1 lds
  s_add_u32 m0, s38, 77824
  s_add_u32 s30, s31, 4096
  buffer_load_dwordx4 v3, s[4:7], s30 offen sc1 lds
  s_add_u32 m0, s38, 82944
  s_add_u32 s30, s32, 0
  buffer_load_dwordx4 v3, s[4:7], s30 offen sc1 lds
  s_add_u32 m0, s38, 87040
  s_add_u32 s30, s32, 589824
  buffer_load_dwordx4 v3, s[4:7], s30 offen sc1 lds
  s_waitcnt vmcnt(16)
  s_barrier
  s_add_u32 s32, s96, 3
  s_and_b32 s32, s32, 7
  s_add_u32 s32, s32, s94
  s_mul_i32 s31, s32, 36864
  s_add_u32 s31, s31, s34
  s_lshl_b32 s32, s32, 10
  s_add_u32 s32, s32, s36
  s_cmp_eq_u32 s19, 0
  s_cbranch_scc0 L_skip_189
  s_add_u32 m0, s38, 99328
  s_add_u32 s30, s31, 8192
  buffer_load_dwordx4 v3, s[4:7], s30 offen sc1 lds
L_skip_189:
  s_add_u32 m0, s38, 91136
  s_add_u32 s30, s31, 0
  buffer_load_dwordx4 v3, s[4:7], s30 offen sc1 lds
  s_add_u32 m0, s38, 95232
  s_add_u32 s30, s31, 4096
  buffer_load_dwordx4 v3, s[4:7], s30 offen sc1 lds
  s_add_u32 m0, s38, 100352
  s_add_u32 s30, s32, 0
  buffer_load_dwordx4 v3, s[4:7], s30 offen sc1 lds
  s_add_u32 m0, s38, 104448
  s_add_u32 s30, s32, 589824
  buffer_load_dwordx4 v3, s[4:7], s30 offen sc1 lds
  s_add_u32 s32, s96, 4
  s_and_b32 s32, s32, 7
  s_add_u32 s32, s32, s94
  s_mul_i32 s31, s32, 36864
  s_add_u32 s31, s31, s34
  s_lshl_b32 s32, s32, 10
  s_add_u32 s32, s32, s36
  s_cmp_eq_u32 s19, 0
  s_cbranch_scc0 L_skip_190
  s_add_u32 m0, s38, 116736
  s_add_u32 s30, s31, 8192
  buffer_load_dwordx4 v3, s[4:7], s30 offen sc1 lds
L_skip_190:
  s_add_u32 m0, s38, 108544
  s_add_u32 s30, s31, 0
  buffer_load_dwordx4 v3, s[4:7], s30 offen sc1 lds
  s_add_u32 m0, s38, 112640
  s_add_u32 s30, s31, 4096
  buffer_load_dwordx4 v3, s[4:7], s30 offen sc1 lds
  s_add_u32 m0, s38, 117760
  s_add_u32 s30, s32, 0
  buffer_load_dwordx4 v3, s[4:7], s30 offen sc1 lds
  s_add_u32 m0, s38, 121856
  s_add_u32 s30, s32, 589824
  buffer_load_dwordx4 v3, s[4:7], s30 offen sc1 lds
  s_waitcnt vmcnt(16)
  s_barrier
  s_add_u32 s32, s96, 5
  s_and_b32 s32, s32, 7
  s_add_u32 s32, s32, s94
  s_mul_i32 s31, s32, 36864
  s_add_u32 s31, s31, s34
  s_lshl_b32 s32, s32, 10
  s_add_u32 s32, s32, s36
  s_cmp_eq_u32 s19, 0
  s_cbranch_scc0 L_skip_191
  s_add_u32 m0, s38, 134144
  s_add_u32 s30, s31, 8192
  buffer_load_dwordx4 v3, s[4:7], s30 offen sc1 lds
L_skip_191:
  s_add_u32 m0, s38, 125952
  s_add_u32 s30, s31, 0
  buffer_load_dwordx4 v3, s[4:7], s30 offen sc1 lds
  s_add_u32 m0, s38, 130048
  s_add_u32 s30, s31, 4096
  buffer_load_dwordx4 v3, s[4:7], s30 offen sc1 lds
  s_add_u32 m0, s38, 135168
  s_add_u32 s30, s32, 0
  buffer_load_dwordx4 v3, s[4:7], s30 offen sc1 lds
  s_add_u32 m0, s38, 139264
  s_add_u32 s30, s32, 589824
  buffer_load_dwordx4 v3, s[4:7], s30 offen sc1 lds
  s_add_u32 s32, s96, 6
  s_and_b32 s32, s32, 7
  s_add_u32 s32, s32, s94
  s_mul_i32 s31, s32, 36864
  s_add_u32 s31, s31, s34
  s_lshl_b32 s32, s32, 10
  s_add_u32 s32, s32, s36
  s_cmp_eq_u32 s19, 0
  s_cbranch_scc0 L_skip_192
  s_add_u32 m0, s38, 8192
  s_add_u32 s30, s31, 8192
  buffer_load_dwordx4 v3, s[4:7], s30 offen sc1 lds
L_skip_192:
  s_add_u32 m0, s38, 0
  s_add_u32 s30, s31, 0
  buffer_load_dwordx4 v3, s[4:7], s30 offen sc1 lds
  s_add_u32 m0, s38, 4096
  s_add_u32 s30, s31, 4096
  buffer_load_dwordx4 v3, s[4:7], s30 offen sc1 lds
  s_add_u32 m0, s38, 9216
  s_add_u32 s30, s32, 0
  buffer_load_dwordx4 v3, s[4:7], s30 offen sc1 lds
  s_add_u32 m0, s38, 13312
  s_add_u32 s30, s32, 589824
  buffer_load_dwordx4 v3, s[4:7], s30 offen sc1 lds
  s_waitcnt vmcnt(16)
  s_barrier
  s_add_u32 s32, s96, 7
  s_and_b32 s32, s32, 7
  s_add_u32 s32, s32, s94
  s_mul_i32 s31, s32, 36864
  s_add_u32 s31, s31, s34
  s_lshl_b32 s32, s32, 10
  s_add_u32 s32, s32, s36
  s_cmp_eq_u32 s19, 0
  s_cbranch_scc0 L_skip_193
  s_add_u32 m0, s38, 25600
  s_add_u32 s30, s31, 8192
  buffer_load_dwordx4 v3, s[4:7], s30 offen sc1 lds
L_skip_193:
  s_add_u32 m0, s38, 17408
  s_add_u32 s30, s31, 0
  buffer_load_dwordx4 v3, s[4:7], s30 offen sc1 lds
  s_add_u32 m0, s38, 21504
  s_add_u32 s30, s31, 4096
  buffer_load_dwordx4 v3, s[4:7], s30 offen sc1 lds
  s_add_u32 m0, s38, 26624
  s_add_u32 s30, s32, 0
  buffer_load_dwordx4 v3, s[4:7], s30 offen sc1 lds
  s_add_u32 m0, s38, 30720
  s_add_u32 s30, s32, 589824
  buffer_load_dwordx4 v3, s[4:7], s30 offen sc1 lds
  s_mov_b32 s32, s14
  s_mul_i32 s31, s32, 36864
  s_add_u32 s31, s31, s34
  s_lshl_b32 s32, s32, 10
  s_add_u32 s32, s32, s36
  s_cmp_eq_u32 s19, 0
  s_cbranch_scc0 L_skip_194
  s_add_u32 m0, s38, 43008
  s_add_u32 s30, s31, 8192
  buffer_load_dwordx4 v3, s[4:7], s30 offen sc1 lds
L_skip_194:
  s_add_u32 m0, s38, 34816
  s_add_u32 s30, s31, 0
  buffer_load_dwordx4 v3, s[4:7], s30 offen sc1 lds
  s_add_u32 m0, s38, 38912
  s_add_u32 s30, s31, 4096
  buffer_load_dwordx4 v3, s[4:7], s30 offen sc1 lds
  s_add_u32 m0, s38, 44032
  s_add_u32 s30, s32, 0
  buffer_load_dwordx4 v3, s[4:7], s30 offen sc1 lds
  s_add_u32 m0, s38, 48128
  s_add_u32 s30, s32, 589824
  buffer_load_dwordx4 v3, s[4:7], s30 offen sc1 lds
  s_waitcnt vmcnt(16)
  s_barrier
  s_add_u32 s32, s96, 0
  s_and_b32 s32, s32, 7
  s_add_u32 s32, s32, s95
  s_mul_i32 s31, s32, 36864
  s_add_u32 s31, s31, s34
  s_lshl_b32 s32, s32, 10
  s_add_u32 s32, s32, s36
  s_cmp_eq_u32 s19, 0
  s_cbranch_scc0 L_skip_195
  s_add_u32 m0, s38, 60416
  s_add_u32 s30, s31, 8192
  buffer_load_dwordx4 v3, s[4:7], s30 offen sc1 lds
L_skip_195:
  s_add_u32 m0, s38, 52224
  s_add_u32 s30, s31, 0
  buffer_load_dwordx4 v3, s[4:7], s30 offen sc1 lds
  s_add_u32 m0, s38, 56320
  s_add_u32 s30, s31, 4096
  buffer_load_dwordx4 v3, s[4:7], s30 offen sc1 lds
  s_add_u32 m0, s38, 61440
  s_add_u32 s30, s32, 0
  buffer_load_dwordx4 v3, s[4:7], s30 offen sc1 lds
  s_add_u32 m0, s38, 65536
  s_add_u32 s30, s32, 589824
  buffer_load_dwordx4 v3, s[4:7], s30 offen sc1 lds
  s_add_u32 s32, s96, 1
  s_and_b32 s32, s32, 7
  s_add_u32 s32, s32, s95
  s_mul_i32 s31, s32, 36864
  s_add_u32 s31, s31, s34
  s_lshl_b32 s32, s32, 10
  s_add_u32 s32, s32, s36
  s_cmp_eq_u32 s19, 0
  s_cbranch_scc0 L_skip_196
  s_add_u32 m0, s38, 81920
  s_add_u32 s30, s31, 8192
  buffer_load_dwordx4 v3, s[4:7], s30 offen sc1 lds
L_skip_196:
  s_add_u32 m0, s38, 73728
  s_add_u32 s30, s31, 0
  buffer_load_dwordx4 v3, s[4:7], s30 offen sc1 lds
  s_add_u32 m0, s38, 77824
  s_add_u32 s30, s31, 4096
  buffer_load_dwordx4 v3, s[4:7], s30 offen sc1 lds
  s_add_u32 m0, s38, 82944
  s_add_u32 s30, s32, 0
  buffer_load_dwordx4 v3, s[4:7], s30 offen sc1 lds
  s_add_u32 m0, s38, 87040
  s_add_u32 s30, s32, 589824
  buffer_load_dwordx4 v3, s[4:7], s30 offen sc1 lds
  s_waitcnt vmcnt(16)
  s_barrier
  s_cmp_eq_u32 s18, 6
  s_cbranch_scc0 L_skip_197
  s_mov_b32 s29, 0x33e7000
  buffer_load_dword v8, v3, s[4:7], s29 offen offset:0 sc1
  buffer_load_dword v9, v3, s[4:7], s29 offen offset:1024 sc1
  buffer_load_dword v10, v3, s[4:7], s29 offen offset:2048 sc1
  buffer_load_dword v11, v3, s[4:7], s29 offen offset:3072 sc1
L_skip_197:
  s_add_u32 s32, s96, 2
  s_and_b32 s32, s32, 7
  s_add_u32 s32, s32, s95
  s_mul_i32 s31, s32, 36864
  s_add_u32 s31, s31, s34
  s_lshl_b32 s32, s32, 10
  s_add_u32 s32, s32, s36
  s_cmp_eq_u32 s19, 0
  s_cbranch_scc0 L_skip_198
  s_add_u32 m0, s38, 99328
  s_add_u32 s30, s31, 8192
  buffer_load_dwordx4 v3, s[4:7], s30 offen sc1 lds
L_skip_198:
  s_add_u32 m0, s38, 91136
  s_add_u32 s30, s31, 0
  buffer_load_dwordx4 v3, s[4:7], s30 offen sc1 lds
  s_add_u32 m0, s38, 95232
  s_add_u32 s30, s31, 4096
  buffer_load_dwordx4 v3, s[4:7], s30 offen sc1 lds
  s_add_u32 m0, s38, 100352
  s_add_u32 s30, s32, 0
  buffer_load_dwordx4 v3, s[4:7], s30 offen sc1 lds
  s_add_u32 m0, s38, 104448
  s_add_u32 s30, s32, 589824
  buffer_load_dwordx4 v3, s[4:7], s30 offen sc1 lds
  s_add_u32 s32, s96, 3
  s_and_b32 s32, s32, 7
  s_add_u32 s32, s32, s95
  s_mul_i32 s31, s32, 36864
  s_add_u32 s31, s31, s34
  s_lshl_b32 s32, s32, 10
  s_add_u32 s32, s32, s36
  s_cmp_eq_u32 s19, 0
  s_cbranch_scc0 L_skip_199
  s_add_u32 m0, s38, 116736
  s_add_u32 s30, s31, 8192
  buffer_load_dwordx4 v3, s[4:7], s30 offen sc1 lds
L_skip_199:
  s_add_u32 m0, s38, 108544
  s_add_u32 s30, s31, 0
  buffer_load_dwordx4 v3, s[4:7], s30 offen sc1 lds
  s_add_u32 m0, s38, 112640
  s_add_u32 s30, s31, 4096
  buffer_load_dwordx4 v3, s[4:7], s30 offen sc1 lds
  s_add_u32 m0, s38, 117760
  s_add_u32 s30, s32, 0
  buffer_load_dwordx4 v3, s[4:7], s30 offen sc1 lds
  s_add_u32 m0, s38, 121856
  s_add_u32 s30, s32, 589824
  buffer_load_dwordx4 v3, s[4:7], s30 offen sc1 lds
  s_waitcnt vmcnt(16)
  s_barrier
  s_add_u32 s32, s96, 4
  s_and_b32 s32, s32, 7
  s_add_u32 s32, s32, s95
  s_mul_i32 s31, s32, 36864
  s_add_u32 s31, s31, s34
  s_lshl_b32 s32, s32, 10
  s_add_u32 s32, s32, s36
  s_cmp_eq_u32 s19, 0
  s_cbranch_scc0 L_skip_200
  s_add_u32 m0, s38, 134144
  s_add_u32 s30, s31, 8192
  buffer_load_dwordx4 v3, s[4:7], s30 offen sc1 lds
L_skip_200:
  s_add_u32 m0, s38, 125952
  s_add_u32 s30, s31, 0
  buffer_load_dwordx4 v3, s[4:7], s30 offen sc1 lds
  s_add_u32 m0, s38, 130048
  s_add_u32 s30, s31, 4096
  buffer_load_dwordx4 v3, s[4:7], s30 offen sc1 lds
  s_add_u32 m0, s38, 135168
  s_add_u32 s30, s32, 0
  buffer_load_dwordx4 v3, s[4:7], s30 offen sc1 lds
  s_add_u32 m0, s38, 139264
  s_add_u32 s30, s32, 589824
  buffer_load_dwordx4 v3, s[4:7], s30 offen sc1 lds
  s_add_u32 s32, s96, 5
  s_and_b32 s32, s32, 7
  s_add_u32 s32, s32, s95
  s_mul_i32 s31, s32, 36864
  s_add_u32 s31, s31, s34
  s_lshl_b32 s32, s32, 10
  s_add_u32 s32, s32, s36
  s_cmp_eq_u32 s19, 0
  s_cbranch_scc0 L_skip_201
  s_add_u32 m0, s38, 8192
  s_add_u32 s30, s31, 8192
  buffer_load_dwordx4 v3, s[4:7], s30 offen sc1 lds
L_skip_201:
  s_add_u32 m0, s38, 0
  s_add_u32 s30, s31, 0
  buffer_load_dwordx4 v3, s[4:7], s30 offen sc1 lds
  s_add_u32 m0, s38, 4096
  s_add_u32 s30, s31, 4096
  buffer_load_dwordx4 v3, s[4:7], s30 offen sc1 lds
  s_add_u32 m0, s38, 9216
  s_add_u32 s30, s32, 0
  buffer_load_dwordx4 v3, s[4:7], s30 offen sc1 lds
  s_add_u32 m0, s38, 13312
  s_add_u32 s30, s32, 589824
  buffer_load_dwordx4 v3, s[4:7], s30 offen sc1 lds
  s_waitcnt vmcnt(16)
  s_barrier
  s_add_u32 s32, s96, 6
  s_and_b32 s32, s32, 7
  s_add_u32 s32, s32, s95
  s_mul_i32 s31, s32, 36864
  s_add_u32 s31, s31, s34
  s_lshl_b32 s32, s32, 10
  s_add_u32 s32, s32, s36
  s_cmp_eq_u32 s19, 0
  s_cbranch_scc0 L_skip_202
  s_add_u32 m0, s38, 25600
  s_add_u32 s30, s31, 8192
  buffer_load_dwordx4 v3, s[4:7], s30 offen sc1 lds
L_skip_202:
  s_add_u32 m0, s38, 17408
  s_add_u32 s30, s31, 0
  buffer_load_dwordx4 v3, s[4:7], s30 offen sc1 lds
  s_add_u32 m0, s38, 21504
  s_add_u32 s30, s31, 4096
  buffer_load_dwordx4 v3, s[4:7], s30 offen sc1 lds
  s_add_u32 m0, s38, 26624
  s_add_u32 s30, s32, 0
  buffer_load_dwordx4 v3, s[4:7], s30 offen sc1 lds
  s_add_u32 m0, s38, 30720
  s_add_u32 s30, s32, 589824
  buffer_load_dwordx4 v3, s[4:7], s30 offen sc1 lds
  s_add_u32 s32, s96, 7
  s_and_b32 s32, s32, 7
  s_add_u32 s32, s32, s95
  s_mul_i32 s31, s32, 36864
  s_add_u32 s31, s31, s34
  s_lshl_b32 s32, s32, 10
  s_add_u32 s32, s32, s36
  s_cmp_eq_u32 s19, 0
  s_cbranch_scc0 L_skip_203
  s_add_u32 m0, s38, 43008
  s_add_u32 s30, s31, 8192
  buffer_load_dwordx4 v3, s[4:7], s30 offen sc1 lds
L_skip_203:
  s_add_u32 m0, s38, 34816
  s_add_u32 s30, s31, 0
  buffer_load_dwordx4 v3, s[4:7], s30 offen sc1 lds
  s_add_u32 m0, s38, 38912
  s_add_u32 s30, s31, 4096
  buffer_load_dwordx4 v3, s[4:7], s30 offen sc1 lds
  s_add_u32 m0, s38, 44032
  s_add_u32 s30, s32, 0
  buffer_load_dwordx4 v3, s[4:7], s30 offen sc1 lds
  s_add_u32 m0, s38, 48128
  s_add_u32 s30, s32, 589824
  buffer_load_dwordx4 v3, s[4:7], s30 offen sc1 lds
  s_waitcnt vmcnt(16)
  s_cmp_eq_u32 s18, 6
  s_cbranch_scc0 L_aok_204
  s_waitcnt vmcnt(24)
  s_add_u32 s28, s59, 0
  v_subrev_u32 v8, s28, v8
  v_subrev_u32 v9, s28, v9
  v_subrev_u32 v10, s28, v10
  v_subrev_u32 v11, s28, v11
  v_max_u32 v8, v8, v9
  v_max_u32 v8, v8, v10
  v_max_u32 v8, v8, v11
  v_cmp_ge_u32 vcc, 0, v8
  s_nop 1
  s_cmp_eq_u64 vcc, -1
  s_cbranch_scc1 L_aok_204
  s_mov_b32 s33, 0
L_aspin_205:
  s_mov_b32 s29, 0x33e7000
  buffer_load_dword v8, v3, s[4:7], s29 offen offset:0 sc1
  buffer_load_dword v9, v3, s[4:7], s29 offen offset:1024 sc1
  buffer_load_dword v10, v3, s[4:7], s29 offen offset:2048 sc1
  buffer_load_dword v11, v3, s[4:7], s29 offen offset:3072 sc1
  s_waitcnt vmcnt(0)
  s_add_u32 s28, s59, 0
  v_subrev_u32 v8, s28, v8
  v_subrev_u32 v9, s28, v9
  v_subrev_u32 v10, s28, v10
  v_subrev_u32 v11, s28, v11
  v_max_u32 v8, v8, v9
  v_max_u32 v8, v8, v10
  v_max_u32 v8, v8, v11
  v_cmp_ge_u32 vcc, 0, v8
  s_nop 1
  s_cmp_eq_u64 vcc, -1
  s_cbranch_scc1 L_spinout_206
  s_sleep 8
  s_add_u32 s33, s33, 1
  s_cmp_lt_u32 s33, 0x40000
  s_cbranch_scc1 L_aspin_205
L_spinout_206:
L_aok_204:
  s_barrier
  s_mov_b32 s32, s15
  s_mul_i32 s31, s32, 36864
  s_add_u32 s31, s31, s34
  s_lshl_b32 s32, s32, 10
  s_add_u32 s32, s32, s36
  s_cmp_eq_u32 s19, 0
  s_cbranch_scc0 L_skip_207
  s_add_u32 m0, s38, 60416
  s_add_u32 s30, s31, 8192
  buffer_load_dwordx4 v3, s[4:7], s30 offen sc1 lds
L_skip_207:
  s_add_u32 m0, s38, 52224
  s_add_u32 s30, s31, 0
  buffer_load_dwordx4 v3, s[4:7], s30 offen sc1 lds
  s_add_u32 m0, s38, 56320
  s_add_u32 s30, s31, 4096
  buffer_load_dwordx4 v3, s[4:7], s30 offen sc1 lds
  s_add_u32 m0, s38, 61440
  s_add_u32 s30, s32, 0
  buffer_load_dwordx4 v3, s[4:7], s30 offen sc1 lds
  s_add_u32 m0, s38, 65536
  s_add_u32 s30, s32, 589824
  buffer_load_dwordx4 v3, s[4:7], s30 offen sc1 lds
  s_add_u32 s31, s35, 0
  s_cmp_eq_u32 s19, 0
  s_cbranch_scc0 L_skip_208
  s_add_u32 m0, s38, 81920
  s_add_u32 s30, s31, 8192
  buffer_load_dwordx4 v3, s[4:7], s30 offen sc1 lds
L_skip_208:
  s_add_u32 m0, s38, 73728
  s_add_u32 s30, s31, 0
  buffer_load_dwordx4 v3, s[4:7], s30 offen sc1 lds
  s_add_u32 m0, s38, 77824
  s_add_u32 s30, s31, 4096
  buffer_load_dwordx4 v3, s[4:7], s30 offen sc1 lds
  s_add_u32 m0, s38, 82944
  s_add_u32 s30, s37, 0
  buffer_load_dwordx4 v4, s[4:7], s30 offen sc1 lds
  s_add_u32 m0, s38, 87040
  s_add_u32 s30, s37, 65536
  buffer_load_dwordx4 v4, s[4:7], s30 offen sc1 lds
  s_waitcnt vmcnt(16)
  s_barrier
  s_add_u32 s31, s35, 36864
  s_cmp_eq_u32 s19, 0
  s_cbranch_scc0 L_skip_209
  s_add_u32 m0, s38, 99328
  s_add_u32 s30, s31, 8192
  buffer_load_dwordx4 v3, s[4:7], s30 offen sc1 lds
L_skip_209:
  s_add_u32 m0, s38, 91136
  s_add_u32 s30, s31, 0
  buffer_load_dwordx4 v3, s[4:7], s30 offen sc1 lds
  s_add_u32 m0, s38, 95232
  s_add_u32 s30, s31, 4096
  buffer_load_dwordx4 v3, s[4:7], s30 offen sc1 lds
  s_add_u32 m0, s38, 100352
  s_add_u32 s30, s37, 131072
  buffer_load_dwordx4 v4, s[4:7], s30 offen sc1 lds
  s_add_u32 m0, s38, 104448
  s_add_u32 s30, s37, 196608
  buffer_load_dwordx4 v4, s[4:7], s30 offen sc1 lds
  s_add_u32 s31, s35, 73728
  s_cmp_eq_u32 s19, 0
  s_cbranch_scc0 L_skip_210
  s_add_u32 m0, s38, 116736
  s_add_u32 s30, s31, 8192
  buffer_load_dwordx4 v3, s[4:7], s30 offen sc1 lds
L_skip_210:
  s_add_u32 m0, s38, 108544
  s_add_u32 s30, s31, 0
  buffer_load_dwordx4 v3, s[4:7], s30 offen sc1 lds
  s_add_u32 m0, s38, 112640
  s_add_u32 s30, s31, 4096
  buffer_load_dwordx4 v3, s[4:7], s30 offen sc1 lds
  s_add_u32 m0, s38, 117760
  s_add_u32 s30, s37, 262144
  buffer_load_dwordx4 v4, s[4:7], s30 offen sc1 lds
  s_add_u32 m0, s38, 121856
  s_add_u32 s30, s37, 327680
  buffer_load_dwordx4 v4, s[4:7], s30 offen sc1 lds
  s_waitcnt vmcnt(16)
  s_barrier
  s_add_u32 s31, s35, 110592
  s_cmp_eq_u32 s19, 0
  s_cbranch_scc0 L_skip_211
  s_add_u32 m0, s38, 134144
  s_add_u32 s30, s31, 8192
  buffer_load_dwordx4 v3, s[4:7], s30 offen sc1 lds
L_skip_211:
  s_add_u32 m0, s38, 125952
  s_add_u32 s30, s31, 0
  buffer_load_dwordx4 v3, s[4:7], s30 offen sc1 lds
  s_add_u32 m0, s38, 130048
  s_add_u32 s30, s31, 4096
  buffer_load_dwordx4 v3, s[4:7], s30 offen sc1 lds
  s_add_u32 m0, s38, 135168
  s_add_u32 s30, s37, 393216
  buffer_load_dwordx4 v4, s[4:7], s30 offen sc1 lds
  s_add_u32 m0, s38, 139264
  s_add_u32 s30, s37, 458752
  buffer_load_dwordx4 v4, s[4:7], s30 offen sc1 lds
  s_add_u32 s31, s35, 147456
  s_cmp_eq_u32 s19, 0
  s_cbranch_scc0 L_skip_212
  s_add_u32 m0, s38, 8192
  s_add_u32 s30, s31, 8192
  buffer_load_dwordx4 v3, s[4:7], s30 offen sc1 lds
L_skip_212:
  s_add_u32 m0, s38, 0
  s_add_u32 s30, s31, 0
  buffer_load_dwordx4 v3, s[4:7], s30 offen sc1 lds
  s_add_u32 m0, s38, 4096
  s_add_u32 s30, s31, 4096
  buffer_load_dwordx4 v3, s[4:7], s30 offen sc1 lds
  s_add_u32 m0, s38, 9216
  s_add_u32 s30, s37, 524288
  buffer_load_dwordx4 v4, s[4:7], s30 offen sc1 lds
  s_add_u32 m0, s38, 13312
  s_add_u32 s30, s37, 589824
  buffer_load_dwordx4 v4, s[4:7], s30 offen sc1 lds
  s_waitcnt vmcnt(16)
  s_barrier
  s_waitcnt vmcnt(8)
  s_barrier
  s_waitcnt vmcnt(0)
  s_barrier
  s_waitcnt vmcnt(0)
  s_barrier
  s_load_dwordx4 s[52:55], s[0:1], 56
  v_and_b32 v4, 15, v1
  s_lshl_b32 s28, s16, 7
  s_lshl_b32 s29, s26, 5
  s_add_u32 s28, s28, s29
  v_add_u32 v4, s28, v4
  v_mul_u32_u24 v4, 1152, v4
  v_lshrrev_b32 v5, 4, v1
  v_lshlrev_b32 v5, 3, v5
  s_mul_i32 s28, s27, 288
  s_lshl_b32 s29, s18, 5
  s_add_u32 s28, s28, s29
  v_add_u32 v5, s28, v5
  v_add_u32 v4, v4, v5
  v_add_u32 v6, 18432, v4
  s_lshl_b32 s30, s18, 11
  v_add_u32 v7, s30, v3
  v_add_u32 v7, 143360, v7
  v_and_b32 v8, 3, v1
  v_min_u32 v8, 2, v8
  s_add_u32 s28, s26, 1
  v_add_u32 v8, s28, v8
  v_and_b32 v8, 3, v8
  v_lshlrev_b32 v8, 2, v8
  s_lshl_b32 s34, s2, 7
  s_add_u32 s34, s34, 0x33e8000
  s_mul_i32 s35, s2, 36864
  s_lshl_b32 s30, s18, 10
  s_add_u32 s35, s35, s30
  s_add_u32 s35, s35, 0x21e4000
  s_waitcnt lgkmcnt(0)
  s_mov_b32 s44, s52
  s_and_b32 s45, s53, 0xffff
  s_mov_b32 s46, 0x480
  s_mov_b32 s47, 0x00020000
  s_mov_b32 s48, s54
  s_and_b32 s49, s55, 0xffff
  s_mov_b32 s50, 0x240000
  s_mov_b32 s51, 0x00020000
  buffer_load_dwordx2 v[16:17], v4, s[40:43], 0 offen offset:0
  buffer_load_dwordx2 v[18:19], v6, s[40:43], 0 offen offset:0
  buffer_load_dwordx2 v[24:25], v5, s[44:47], 0 offen offset:0
  s_cmp_eq_u32 s18, 0
  s_cbranch_scc0 L_f8_213
  buffer_load_dwordx2 v[20:21], v4, s[40:43], 0 offen offset:256
  buffer_load_dwordx2 v[22:23], v6, s[40:43], 0 offen offset:256
  buffer_load_dwordx2 v[26:27], v5, s[44:47], 0 offen offset:256
L_f8_213:
  s_barrier
  ds_read_b128 v[64:67], v7 offset:0
  ds_read_b128 v[68:71], v7 offset:1024
  s_cmp_eq_u32 s18, 0
  s_cbranch_scc0 L_f8_214
  ds_read_b128 v[72:75], v7 offset:16384
  ds_read_b128 v[76:79], v7 offset:17408
L_f8_214:
  s_mov_b32 s33, 0
L_xpoll_215:
  buffer_load_dword v9, v8, s[4:7], s34 offen sc1
  s_waitcnt vmcnt(0)
  s_add_u32 s28, s59, 0
  v_subrev_u32 v9, s28, v9
  v_cmp_ge_u32 vcc, 0, v9
  s_nop 1
  s_cmp_eq_u64 vcc, -1
  s_cbranch_scc1 L_spinout_216
  s_sleep 2
  s_add_u32 s33, s33, 1
  s_cmp_lt_u32 s33, 0x40000
  s_cbranch_scc1 L_xpoll_215
L_spinout_216:
  s_add_u32 s29, s26, 1
  s_and_b32 s29, s29, 3
  s_mul_i32 s29, s29, 9216
  s_add_u32 s29, s29, s35
  buffer_load_dwordx4 v[32:35], v3, s[4:7], s29 offen sc1
  s_add_u32 s29, s26, 2
  s_and_b32 s29, s29, 3
  s_mul_i32 s29, s29, 9216
  s_add_u32 s29, s29, s35
  buffer_load_dwordx4 v[36:39], v3, s[4:7], s29 offen sc1
  s_add_u32 s29, s26, 3
  s_and_b32 s29, s29, 3
  s_mul_i32 s29, s29, 9216
  s_add_u32 s29, s29, s35
  buffer_load_dwordx4 v[40:43], v3, s[4:7], s29 offen sc1
  s_cmp_eq_u32 s18, 0
  s_cbranch_scc0 L_f8_217
  s_add_u32 s29, s26, 1
  s_and_b32 s29, s29, 3
  s_mul_i32 s29, s29, 9216
  s_add_u32 s29, s29, s35
  s_add_u32 s29, s29, 8192
  buffer_load_dwordx4 v[44:47], v3, s[4:7], s29 offen sc1
  s_add_u32 s29, s26, 2
  s_and_b32 s29, s29, 3
  s_mul_i32 s29, s29, 9216
  s_add_u32 s29, s29, s35
  s_add_u32 s29, s29, 8192
  buffer_load_dwordx4 v[48:51], v3, s[4:7], s29 offen sc1
  s_add_u32 s29, s26, 3
  s_and_b32 s29, s29, 3
  s_mul_i32 s29, s29, 9216
  s_add_u32 s29, s29, s35
  s_add_u32 s29, s29, 8192
  buffer_load_dwordx4 v[52:55], v3, s[4:7], s29 offen sc1
L_f8_217:
  s_waitcnt lgkmcnt(0)
  v_lshlrev_b32 v10, 16, v16
  v_and_b32 v11, 0xffff0000, v16
  v_add_f32 v64, v64, v10
  v_add_f32 v65, v65, v11
  v_lshlrev_b32 v10, 16, v24
  v_and_b32 v11, 0xffff0000, v24
  v_add_f32 v64, v64, v10
  v_add_f32 v65, v65, v11
  v_lshlrev_b32 v10, 16, v17
  v_and_b32 v11, 0xffff0000, v17
  v_add_f32 v66, v66, v10
  v_add_f32 v67, v67, v11
  v_lshlrev_b32 v10, 16, v25
  v_and_b32 v11, 0xffff0000, v25
  v_add_f32 v66, v66, v10
  v_add_f32 v67, v67, v11
  v_lshlrev_b32 v10, 16, v18
  v_and_b32 v11, 0xffff0000, v18
  v_add_f32 v68, v68, v10
  v_add_f32 v69, v69, v11
  v_lshlrev_b32 v10, 16, v24
  v_and_b32 v11, 0xffff0000, v24
  v_add_f32 v68, v68, v10
  v_add_f32 v69, v69, v11
  v_lshlrev_b32 v10, 16, v19
  v_and_b32 v11, 0xffff0000, v19
  v_add_f32 v70, v70, v10
  v_add_f32 v71, v71, v11
  v_lshlrev_b32 v10, 16, v25
  v_and_b32 v11, 0xffff0000, v25
  v_add_f32 v70, v70, v10
  v_add_f32 v71, v71, v11
  s_cmp_eq_u32 s18, 0
  s_cbranch_scc0 L_f8_218
  v_lshlrev_b32 v10, 16, v20
  v_and_b32 v11, 0xffff0000, v20
  v_add_f32 v72, v72, v10
  v_add_f32 v73, v73, v11
  v_lshlrev_b32 v10, 16, v26
  v_and_b32 v11, 0xffff0000, v26
  v_add_f32 v72, v72, v10
  v_add_f32 v73, v73, v11
  v_lshlrev_b32 v10, 16, v21
  v_and_b32 v11, 0xffff0000, v21
  v_add_f32 v74, v74, v10
  v_add_f32 v75, v75, v11
  v_lshlrev_b32 v10, 16, v27
  v_and_b32 v11, 0xffff0000, v27
  v_add_f32 v74, v74, v10
  v_add_f32 v75, v75, v11
  v_lshlrev_b32 v10, 16, v22
  v_and_b32 v11, 0xffff0000, v22
  v_add_f32 v76, v76, v10
  v_add_f32 v77, v77, v11
  v_lshlrev_b32 v10, 16, v26
  v_and_b32 v11, 0xffff0000, v26
  v_add_f32 v76, v76, v10
  v_add_f32 v77, v77, v11
  v_lshlrev_b32 v10, 16, v23
  v_and_b32 v11, 0xffff0000, v23
  v_add_f32 v78, v78, v10
  v_add_f32 v79, v79, v11
  v_lshlrev_b32 v10, 16, v27
  v_and_b32 v11, 0xffff0000, v27
  v_add_f32 v78, v78, v10
  v_add_f32 v79, v79, v11
L_f8_218:
  s_waitcnt vmcnt(0)
  v_lshlrev_b32 v10, 16, v32
  v_and_b32 v11, 0xffff0000, v32
  v_add_f32 v64, v64, v10
  v_add_f32 v65, v65, v11
  v_lshlrev_b32 v10, 16, v33
  v_and_b32 v11, 0xffff0000, v33
  v_add_f32 v66, v66, v10
  v_add_f32 v67, v67, v11
  v_lshlrev_b32 v10, 16, v34
  v_and_b32 v11, 0xffff0000, v34
  v_add_f32 v68, v68, v10
  v_add_f32 v69, v69, v11
  v_lshlrev_b32 v10, 16, v35
  v_and_b32 v11, 0xffff0000, v35
  v_add_f32 v70, v70, v10
  v_add_f32 v71, v71, v11
  v_lshlrev_b32 v10, 16, v36
  v_and_b32 v11, 0xffff0000, v36
  v_add_f32 v64, v64, v10
  v_add_f32 v65, v65, v11
  v_lshlrev_b32 v10, 16, v37
  v_and_b32 v11, 0xffff0000, v37
  v_add_f32 v66, v66, v10
  v_add_f32 v67, v67, v11
  v_lshlrev_b32 v10, 16, v38
  v_and_b32 v11, 0xffff0000, v38
  v_add_f32 v68, v68, v10
  v_add_f32 v69, v69, v11
  v_lshlrev_b32 v10, 16, v39
  v_and_b32 v11, 0xffff0000, v39
  v_add_f32 v70, v70, v10
  v_add_f32 v71, v71, v11
  v_lshlrev_b32 v10, 16, v40
  v_and_b32 v11, 0xffff0000, v40
  v_add_f32 v64, v64, v10
  v_add_f32 v65, v65, v11
  v_lshlrev_b32 v10, 16, v41
  v_and_b32 v11, 0xffff0000, v41
  v_add_f32 v66, v66, v10
  v_add_f32 v67, v67, v11
  v_lshlrev_b32 v10, 16, v42
  v_and_b32 v11, 0xffff0000, v42
  v_add_f32 v68, v68, v10
  v_add_f32 v69, v69, v11
  v_lshlrev_b32 v10, 16, v43
  v_and_b32 v11, 0xffff0000, v43
  v_add_f32 v70, v70, v10
  v_add_f32 v71, v71, v11
  v_cvt_pk_bf16_f32 v16, v64, v65
  v_cvt_pk_bf16_f32 v17, v66, v67
  v_cvt_pk_bf16_f32 v18, v68, v69
  v_cvt_pk_bf16_f32 v19, v70, v71
  buffer_store_dwordx2 v[16:17], v4, s[48:51], 0 offen offset:0
  buffer_store_dwordx2 v[18:19], v6, s[48:51], 0 offen offset:0
  s_cmp_eq_u32 s18, 0
  s_cbranch_scc0 L_f8_219
  v_lshlrev_b32 v10, 16, v44
  v_and_b32 v11, 0xffff0000, v44
  v_add_f32 v72, v72, v10
  v_add_f32 v73, v73, v11
  v_lshlrev_b32 v10, 16, v45
  v_and_b32 v11, 0xffff0000, v45
  v_add_f32 v74, v74, v10
  v_add_f32 v75, v75, v11
  v_lshlrev_b32 v10, 16, v46
  v_and_b32 v11, 0xffff0000, v46
  v_add_f32 v76, v76, v10
  v_add_f32 v77, v77, v11
  v_lshlrev_b32 v10, 16, v47
  v_and_b32 v11, 0xffff0000, v47
  v_add_f32 v78, v78, v10
  v_add_f32 v79, v79, v11
  v_lshlrev_b32 v10, 16, v48
  v_and_b32 v11, 0xffff0000, v48
  v_add_f32 v72, v72, v10
  v_add_f32 v73, v73, v11
  v_lshlrev_b32 v10, 16, v49
  v_and_b32 v11, 0xffff0000, v49
  v_add_f32 v74, v74, v10
  v_add_f32 v75, v75, v11
  v_lshlrev_b32 v10, 16, v50
  v_and_b32 v11, 0xffff0000, v50
  v_add_f32 v76, v76, v10
  v_add_f32 v77, v77, v11
  v_lshlrev_b32 v10, 16, v51
  v_and_b32 v11, 0xffff0000, v51
  v_add_f32 v78, v78, v10
  v_add_f32 v79, v79, v11
  v_lshlrev_b32 v10, 16, v52
  v_and_b32 v11, 0xffff0000, v52
  v_add_f32 v72, v72, v10
  v_add_f32 v73, v73, v11
  v_lshlrev_b32 v10, 16, v53
  v_and_b32 v11, 0xffff0000, v53
  v_add_f32 v74, v74, v10
  v_add_f32 v75, v75, v11
  v_lshlrev_b32 v10, 16, v54
  v_and_b32 v11, 0xffff0000, v54
  v_add_f32 v76, v76, v10
  v_add_f32 v77, v77, v11
  v_lshlrev_b32 v10, 16, v55
  v_and_b32 v11, 0xffff0000, v55
  v_add_f32 v78, v78, v10
  v_add_f32 v79, v79, v11
  v_cvt_pk_bf16_f32 v20, v72, v73
  v_cvt_pk_bf16_f32 v21, v74, v75
  v_cvt_pk_bf16_f32 v22, v76, v77
  v_cvt_pk_bf16_f32 v23, v78, v79
  buffer_store_dwordx2 v[20:21], v4, s[48:51], 0 offen offset:256
  buffer_store_dwordx2 v[22:23], v6, s[48:51], 0 offen offset:256
L_f8_219:
  s_endpgm
L_k1_end:
  s_endpgm
.section .rodata,"a"
.p2align 6
.amdhsa_kernel mega_kernel
  .amdhsa_next_free_vgpr 256
  .amdhsa_next_free_sgpr 102
  .amdhsa_accum_offset 256
  .amdhsa_group_segment_fixed_size 0
  .amdhsa_kernarg_size 88
  .amdhsa_user_sgpr_count 2
  .amdhsa_user_sgpr_kernarg_segment_ptr 1
  .amdhsa_system_sgpr_workgroup_id_x 1
.end_amdhsa_kernel
```
